```python
import torch

def _softmax(x, axis=-1):
    return torch.softmax(x, dim=axis)

def _gelu(x):
    return torch.nn.functional.gelu(x, approximate='tanh')

def _silu(x):
    return torch.nn.functional.silu(x)

def _sigmoid(x):
    return torch.sigmoid(x)

def _layernorm(x, axis=-1, eps=1e-05):
    m = x.mean(dim=axis, keepdim=True)
    v = x.var(dim=axis, keepdim=True, unbiased=False)
    return (x - m) / torch.sqrt(v + eps)

def _scatter_add(tgt, idx, src, axis=0):
    return tgt.clone().index_add_(axis, idx, src)

def _segment_sum(src, seg, n):
    out = torch.zeros((n,) + src.shape[1:], dtype=src.dtype)
    return out.index_add_(0, seg, src)

def _pad(x, pw):
    flat = tuple((v for pair in reversed(pw) for v in pair))
    return torch.nn.functional.pad(x, flat)
kernel_name = 'recurrent_scan__memory_aug_recurrent_mem_tr__mixer_token_mlp__prompt'

def setup_inputs():

    _w = lambda a: (lambda t: t.to(torch.bfloat16) if t.is_floating_point() else t)(torch.as_tensor(a))

    def _A_setup():
        B, S, Dm = (1, 2048, 1024)
        H, Dh = (32, 128)
        M, seg = (8, 32)
        seg = min(seg, S)
        S = S // seg * seg
        return {'x': _w((lambda *s: torch.randn(*s, dtype=torch.bfloat16) * 0.05)(B, S, Dm)), 'mem0': _w((lambda *s: torch.randn(*s, dtype=torch.bfloat16) * 0.8)(B, M, Dm)), 'Wq': _w((lambda *s: torch.randn(*s, dtype=torch.bfloat16) * 1.6)(Dm, H, Dh) * Dm ** (-0.5)), 'Wk': _w((lambda *s: torch.randn(*s, dtype=torch.bfloat16) * 1.6)(Dm, H, Dh) * Dm ** (-0.5)), 'Wv': _w((lambda *s: torch.randn(*s, dtype=torch.bfloat16) * 0.8)(Dm, H, Dh) * Dm ** (-0.5)), 'Wo': _w((lambda *s: torch.randn(*s, dtype=torch.bfloat16) * 0.8)(H, Dh, Dm) * (H * Dh) ** (-0.5)), 'seg_len': seg}
    _A_in = _A_setup()

    def _B_setup():
        B, S, D, F = (1, 2048, 1024, 3584)
        return {'x': _w((lambda *s: torch.randn(*s, dtype=torch.bfloat16) * 0.05)(B, S, D)), 'w1': _w((lambda *s: torch.randn(*s, dtype=torch.bfloat16) * 0.8)(S, F) * S ** (-0.5)), 'b1': _w((lambda *s: torch.randn(*s, dtype=torch.bfloat16) * 12.8)(F) * 0.02), 'w2': _w((lambda *s: torch.randn(*s, dtype=torch.bfloat16) * 0.2)(F, S) * F ** (-0.5)), 'b2': _w((lambda *s: torch.randn(*s, dtype=torch.bfloat16) * 1.6)(S) * 0.02)}
    _B_in = _B_setup()
    return {'A_x': _A_in['x'], 'A_mem0': _A_in['mem0'], 'A_Wq': _A_in['Wq'], 'A_Wk': _A_in['Wk'], 'A_Wv': _A_in['Wv'], 'A_Wo': _A_in['Wo'], 'A_seg_len': _A_in['seg_len'], 'B_x': _B_in['x'], 'B_w1': _B_in['w1'], 'B_b1': _B_in['b1'], 'B_w2': _B_in['w2'], 'B_b2': _B_in['b2']}

def reference(A_x, A_mem0, A_Wq, A_Wk, A_Wv, A_Wo, A_seg_len, B_x, B_w1, B_b1, B_w2, B_b2):

    def _A_ref(x, mem0, Wq, Wk, Wv, Wo, seg_len):
        B, S, Dm = x.shape
        H, Dh = (Wq.shape[1], Wq.shape[2])
        M = mem0.shape[1]
        scale = Dh ** (-0.5)
        n_seg = S // seg_len
        L = M + seg_len
        idx = torch.arange(L)
        mask = (idx[:, None] < M) | (idx[:, None] >= idx[None, :])
        mem = mem0
        outs = []
        for s in range(n_seg):
            xs = x[:, s * seg_len:(s + 1) * seg_len, :].clone()
            h = torch.concatenate([mem, xs], axis=1)
            q = torch.einsum('btd,dhe->bhte', h, Wq)
            k = torch.einsum('btd,dhe->bhte', h, Wk)
            v = torch.einsum('btd,dhe->bhte', h, Wv)
            scores = torch.einsum('bhqe,bhke->bhqk', q, k) * scale
            scores = torch.where(mask[None, None], scores, -1000000000.0)
            p = _softmax(scores, axis=-1)
            o = torch.einsum('bhqk,bhke->bhqe', p, v)
            o = torch.einsum('bhte,hed->btd', o, Wo)
            mem = o[:, :M, :].clone()
            outs.append(o[:, M:, :])
        return torch.concatenate(outs, axis=1)

    def _B_ref(x, w1, b1, w2, b2):
        B, S, D = x.shape
        h = _layernorm(x, axis=-1)
        u = torch.einsum('bsd,sf->bdf', h, w1) + b1
        u = _gelu(u)
        y = torch.einsum('bdf,fs->bds', u, w2) + b2
        return (lambda x, *d: x.permute(*d))(y, 0, 2, 1)
    x = A_x
    xn = _layernorm(x, axis=-1)
    s = _A_ref(xn, A_mem0, A_Wq, A_Wk, A_Wv, A_Wo, A_seg_len)
    g = _silu(_B_ref(xn, B_w1, B_b1, B_w2, B_b2))
    return x + s * g
```

```asm
; @launch grid=(256,1,1) block=(256,1,1) lds=163840
.amdgcn_target "amdgcn-amd-amdhsa--gfx950"
.text
.globl recurrent_scan__memory_aug_recurrent_mem_tr__mixer_token_mlp__prompt_kernel
.p2align 8
.type recurrent_scan__memory_aug_recurrent_mem_tr__mixer_token_mlp__prompt_kernel,@function
recurrent_scan__memory_aug_recurrent_mem_tr__mixer_token_mlp__prompt_kernel:

  s_cmp_ge_u32 s2, 256
  s_cbranch_scc1 L_exit
  s_and_b32 s4, s2, 7
  s_lshl_b32 s4, s4, 2
  s_lshr_b32 s4, 0x73625140, s4
  s_and_b32 s4, s4, 7
  s_lshr_b32 s19, s2, 3
  s_lshl_b32 s3, s19, 2
  s_and_b32 s18, s4, 3
  s_add_u32 s3, s3, s18
  s_and_b32 s4, s4, 4
  s_cmp_lg_u32 s4, 0
  s_cbranch_scc1 L_worker
  s_nop 0
  s_lshl_b32 s18, s18, 1
  s_and_b32 s4, s19, 1
  s_add_u32 s18, s18, s4
  s_lshr_b32 s19, s19, 1
  s_nop 0
  s_load_dwordx2 s[4:5], s[0:1], 16
  s_load_dwordx2 s[6:7], s[0:1], 24
  s_load_dwordx2 s[8:9], s[0:1], 32
  s_load_dwordx2 s[10:11], s[0:1], 40
  s_load_dwordx2 s[12:13], s[0:1], 8
  s_load_dwordx2 s[14:15], s[0:1], 112
  s_load_dwordx2 s[16:17], s[0:1], 104
  v_lshrrev_b32 v2, 6, v0
  v_and_b32 v1, 63, v0
  v_readfirstlane_b32 s20, v2
  s_lshr_b32 s21, s19, 2
  s_and_b32 s22, s19, 3
  v_lshlrev_b32 v4, 4, v1
  v_add_u32 v21, 4096, v4
  s_waitcnt lgkmcnt(0)
  s_mov_b32 s28, s14
  s_mov_b32 s29, s15
  s_mov_b32 s30, 268435456
  s_mov_b32 s31, 0x20000
  s_lshl_b32 s25, s20, 15
  v_lshrrev_b32 v2, 2, v1
  v_lshlrev_b32 v2, 13, v2
  v_and_b32 v3, 3, v1
  v_lshlrev_b32 v3, 4, v3
  v_add_u32 v44, v2, v3
  v_lshrrev_b32 v2, 3, v1
  v_lshlrev_b32 v2, 11, v2
  v_and_b32 v3, 7, v1
  v_lshlrev_b32 v3, 4, v3
  v_add_u32 v45, v2, v3
  v_lshrrev_b32 v2, 4, v1
  v_lshlrev_b32 v2, 3, v2
  v_bfe_u32 v3, v1, 2, 2
  v_add_u32 v2, v2, v3
  v_and_b32 v3, 3, v1
  v_lshlrev_b32 v3, 3, v3
  v_lshlrev_b32 v46, 6, v2
  v_add_u32 v46, v46, v3
  v_add_u32 v46, s25, v46
  v_lshlrev_b32 v47, 7, v2
  v_add_u32 v47, v47, v3
  v_add_u32 v47, s25, v47
  s_lshl_b32 s24, s18, 2
  s_add_u32 s24, s24, s21
  s_lshl_b32 s24, s24, 8
  s_lshl_b32 s56, s22, 6
  s_add_u32 s56, s56, s24
  s_lshl_b32 s24, s20, 21
  s_add_u32 s56, s56, s24
  s_lshl_b32 s24, s18, 2
  s_add_u32 s24, s24, s20
  s_lshl_b32 s24, s24, 18
  s_lshl_b32 s57, s19, 7
  s_add_u32 s57, s57, s24
  v_add_u32 v48, s25, v4
  s_add_u32 s52, s6, s56
  s_addc_u32 s53, s7, 0
  s_add_u32 m0, s25, 0
  s_nop 0
  global_load_lds_dwordx4 v44, s[52:53]
  s_add_u32 s52, s52, 131072
  s_addc_u32 s53, s53, 0
  s_add_u32 m0, m0, 1024
  s_nop 0
  global_load_lds_dwordx4 v44, s[52:53]
  s_add_u32 s52, s52, 131072
  s_addc_u32 s53, s53, 0
  s_add_u32 m0, m0, 1024
  s_nop 0
  global_load_lds_dwordx4 v44, s[52:53]
  s_add_u32 s52, s52, 131072
  s_addc_u32 s53, s53, 0
  s_add_u32 m0, m0, 1024
  s_nop 0
  global_load_lds_dwordx4 v44, s[52:53]
  s_add_u32 s52, s52, 131072
  s_addc_u32 s53, s53, 0
  s_add_u32 m0, m0, 1024
  s_nop 0
  global_load_lds_dwordx4 v44, s[52:53]
  s_add_u32 s52, s52, 131072
  s_addc_u32 s53, s53, 0
  s_add_u32 m0, m0, 1024
  s_nop 0
  global_load_lds_dwordx4 v44, s[52:53]
  s_add_u32 s52, s52, 131072
  s_addc_u32 s53, s53, 0
  s_add_u32 m0, m0, 1024
  s_nop 0
  global_load_lds_dwordx4 v44, s[52:53]
  s_add_u32 s52, s52, 131072
  s_addc_u32 s53, s53, 0
  s_add_u32 m0, m0, 1024
  s_nop 0
  global_load_lds_dwordx4 v44, s[52:53]
  s_add_u32 s52, s52, 131072
  s_addc_u32 s53, s53, 0
  s_add_u32 m0, m0, 1024
  s_nop 0
  global_load_lds_dwordx4 v44, s[52:53]
  s_add_u32 s52, s52, 131072
  s_addc_u32 s53, s53, 0
  s_add_u32 m0, m0, 1024
  s_nop 0
  global_load_lds_dwordx4 v44, s[52:53]
  s_add_u32 s52, s52, 131072
  s_addc_u32 s53, s53, 0
  s_add_u32 m0, m0, 1024
  s_nop 0
  global_load_lds_dwordx4 v44, s[52:53]
  s_add_u32 s52, s52, 131072
  s_addc_u32 s53, s53, 0
  s_add_u32 m0, m0, 1024
  s_nop 0
  global_load_lds_dwordx4 v44, s[52:53]
  s_add_u32 s52, s52, 131072
  s_addc_u32 s53, s53, 0
  s_add_u32 m0, m0, 1024
  s_nop 0
  global_load_lds_dwordx4 v44, s[52:53]
  s_add_u32 s52, s52, 131072
  s_addc_u32 s53, s53, 0
  s_add_u32 m0, m0, 1024
  s_nop 0
  global_load_lds_dwordx4 v44, s[52:53]
  s_add_u32 s52, s52, 131072
  s_addc_u32 s53, s53, 0
  s_add_u32 m0, m0, 1024
  s_nop 0
  global_load_lds_dwordx4 v44, s[52:53]
  s_add_u32 s52, s52, 131072
  s_addc_u32 s53, s53, 0
  s_add_u32 m0, m0, 1024
  s_nop 0
  global_load_lds_dwordx4 v44, s[52:53]
  s_add_u32 s52, s8, s56
  s_addc_u32 s53, s9, 0
  s_add_u32 m0, s25, 16384
  s_nop 0
  global_load_lds_dwordx4 v44, s[52:53]
  s_add_u32 s52, s52, 131072
  s_addc_u32 s53, s53, 0
  s_add_u32 m0, m0, 1024
  s_nop 0
  global_load_lds_dwordx4 v44, s[52:53]
  s_add_u32 s52, s52, 131072
  s_addc_u32 s53, s53, 0
  s_add_u32 m0, m0, 1024
  s_nop 0
  global_load_lds_dwordx4 v44, s[52:53]
  s_add_u32 s52, s52, 131072
  s_addc_u32 s53, s53, 0
  s_add_u32 m0, m0, 1024
  s_nop 0
  global_load_lds_dwordx4 v44, s[52:53]
  s_add_u32 s52, s52, 131072
  s_addc_u32 s53, s53, 0
  s_add_u32 m0, m0, 1024
  s_nop 0
  global_load_lds_dwordx4 v44, s[52:53]
  s_add_u32 s52, s52, 131072
  s_addc_u32 s53, s53, 0
  s_add_u32 m0, m0, 1024
  s_nop 0
  global_load_lds_dwordx4 v44, s[52:53]
  s_add_u32 s52, s52, 131072
  s_addc_u32 s53, s53, 0
  s_add_u32 m0, m0, 1024
  s_nop 0
  global_load_lds_dwordx4 v44, s[52:53]
  s_add_u32 s52, s52, 131072
  s_addc_u32 s53, s53, 0
  s_add_u32 m0, m0, 1024
  s_nop 0
  global_load_lds_dwordx4 v44, s[52:53]
  s_add_u32 s52, s52, 131072
  s_addc_u32 s53, s53, 0
  s_add_u32 m0, m0, 1024
  s_nop 0
  global_load_lds_dwordx4 v44, s[52:53]
  s_add_u32 s52, s52, 131072
  s_addc_u32 s53, s53, 0
  s_add_u32 m0, m0, 1024
  s_nop 0
  global_load_lds_dwordx4 v44, s[52:53]
  s_add_u32 s52, s52, 131072
  s_addc_u32 s53, s53, 0
  s_add_u32 m0, m0, 1024
  s_nop 0
  global_load_lds_dwordx4 v44, s[52:53]
  s_add_u32 s52, s52, 131072
  s_addc_u32 s53, s53, 0
  s_add_u32 m0, m0, 1024
  s_nop 0
  global_load_lds_dwordx4 v44, s[52:53]
  s_add_u32 s52, s52, 131072
  s_addc_u32 s53, s53, 0
  s_add_u32 m0, m0, 1024
  s_nop 0
  global_load_lds_dwordx4 v44, s[52:53]
  s_add_u32 s52, s52, 131072
  s_addc_u32 s53, s53, 0
  s_add_u32 m0, m0, 1024
  s_nop 0
  global_load_lds_dwordx4 v44, s[52:53]
  s_add_u32 s52, s52, 131072
  s_addc_u32 s53, s53, 0
  s_add_u32 m0, m0, 1024
  s_nop 0
  global_load_lds_dwordx4 v44, s[52:53]
  s_add_u32 s52, s52, 131072
  s_addc_u32 s53, s53, 0
  s_add_u32 m0, m0, 1024
  s_nop 0
  global_load_lds_dwordx4 v44, s[52:53]
  s_add_u32 s52, s4, s56
  s_addc_u32 s53, s5, 0
  global_load_dwordx4 v[100:103], v44, s[52:53]
  s_add_u32 s52, s52, 131072
  s_addc_u32 s53, s53, 0
  global_load_dwordx4 v[104:107], v44, s[52:53]
  s_add_u32 s52, s52, 131072
  s_addc_u32 s53, s53, 0
  global_load_dwordx4 v[108:111], v44, s[52:53]
  s_add_u32 s52, s52, 131072
  s_addc_u32 s53, s53, 0
  global_load_dwordx4 v[112:115], v44, s[52:53]
  s_add_u32 s52, s52, 131072
  s_addc_u32 s53, s53, 0
  global_load_dwordx4 v[116:119], v44, s[52:53]
  s_add_u32 s52, s52, 131072
  s_addc_u32 s53, s53, 0
  global_load_dwordx4 v[120:123], v44, s[52:53]
  s_add_u32 s52, s52, 131072
  s_addc_u32 s53, s53, 0
  global_load_dwordx4 v[124:127], v44, s[52:53]
  s_add_u32 s52, s52, 131072
  s_addc_u32 s53, s53, 0
  global_load_dwordx4 v[128:131], v44, s[52:53]
  s_add_u32 s52, s52, 131072
  s_addc_u32 s53, s53, 0
  global_load_dwordx4 v[132:135], v44, s[52:53]
  s_add_u32 s52, s52, 131072
  s_addc_u32 s53, s53, 0
  global_load_dwordx4 v[136:139], v44, s[52:53]
  s_add_u32 s52, s52, 131072
  s_addc_u32 s53, s53, 0
  global_load_dwordx4 v[140:143], v44, s[52:53]
  s_add_u32 s52, s52, 131072
  s_addc_u32 s53, s53, 0
  global_load_dwordx4 v[144:147], v44, s[52:53]
  s_add_u32 s52, s52, 131072
  s_addc_u32 s53, s53, 0
  global_load_dwordx4 v[148:151], v44, s[52:53]
  s_add_u32 s52, s52, 131072
  s_addc_u32 s53, s53, 0
  global_load_dwordx4 v[152:155], v44, s[52:53]
  s_add_u32 s52, s52, 131072
  s_addc_u32 s53, s53, 0
  global_load_dwordx4 v[156:159], v44, s[52:53]
  s_add_u32 s52, s52, 131072
  s_addc_u32 s53, s53, 0
  global_load_dwordx4 v[160:163], v44, s[52:53]
  s_add_u32 s52, s10, s57
  s_addc_u32 s53, s11, 0
  global_load_dwordx4 v[164:167], v45, s[52:53]
  s_add_u32 s52, s52, 16384
  s_addc_u32 s53, s53, 0
  global_load_dwordx4 v[168:171], v45, s[52:53]
  s_add_u32 s52, s52, 16384
  s_addc_u32 s53, s53, 0
  global_load_dwordx4 v[172:175], v45, s[52:53]
  s_add_u32 s52, s52, 16384
  s_addc_u32 s53, s53, 0
  global_load_dwordx4 v[176:179], v45, s[52:53]
  s_add_u32 s52, s52, 16384
  s_addc_u32 s53, s53, 0
  global_load_dwordx4 v[180:183], v45, s[52:53]
  s_add_u32 s52, s52, 16384
  s_addc_u32 s53, s53, 0
  global_load_dwordx4 v[184:187], v45, s[52:53]
  s_add_u32 s52, s52, 16384
  s_addc_u32 s53, s53, 0
  global_load_dwordx4 v[188:191], v45, s[52:53]
  s_add_u32 s52, s52, 16384
  s_addc_u32 s53, s53, 0
  global_load_dwordx4 v[192:195], v45, s[52:53]
  s_add_u32 s52, s52, 16384
  s_addc_u32 s53, s53, 0
  global_load_dwordx4 v[196:199], v45, s[52:53]
  s_add_u32 s52, s52, 16384
  s_addc_u32 s53, s53, 0
  global_load_dwordx4 v[200:203], v45, s[52:53]
  s_add_u32 s52, s52, 16384
  s_addc_u32 s53, s53, 0
  global_load_dwordx4 v[204:207], v45, s[52:53]
  s_add_u32 s52, s52, 16384
  s_addc_u32 s53, s53, 0
  global_load_dwordx4 v[208:211], v45, s[52:53]
  s_add_u32 s52, s52, 16384
  s_addc_u32 s53, s53, 0
  global_load_dwordx4 v[212:215], v45, s[52:53]
  s_add_u32 s52, s52, 16384
  s_addc_u32 s53, s53, 0
  global_load_dwordx4 v[216:219], v45, s[52:53]
  s_add_u32 s52, s52, 16384
  s_addc_u32 s53, s53, 0
  global_load_dwordx4 v[220:223], v45, s[52:53]
  s_add_u32 s52, s52, 16384
  s_addc_u32 s53, s53, 0
  global_load_dwordx4 v[224:227], v45, s[52:53]
  s_waitcnt vmcnt(48)
  ds_read_b64_tr_b16 a[64:65], v46 offset:0
  ds_read_b64_tr_b16 a[66:67], v46 offset:256
  ds_read_b64_tr_b16 a[68:69], v46 offset:2048
  ds_read_b64_tr_b16 a[70:71], v46 offset:2304
  ds_read_b64_tr_b16 a[72:73], v46 offset:4096
  ds_read_b64_tr_b16 a[74:75], v46 offset:4352
  ds_read_b64_tr_b16 a[76:77], v46 offset:6144
  ds_read_b64_tr_b16 a[78:79], v46 offset:6400
  s_waitcnt lgkmcnt(0)
  ds_read_b64_tr_b16 a[80:81], v46 offset:8192
  ds_read_b64_tr_b16 a[82:83], v46 offset:8448
  ds_read_b64_tr_b16 a[84:85], v46 offset:10240
  ds_read_b64_tr_b16 a[86:87], v46 offset:10496
  ds_read_b64_tr_b16 a[88:89], v46 offset:12288
  ds_read_b64_tr_b16 a[90:91], v46 offset:12544
  ds_read_b64_tr_b16 a[92:93], v46 offset:14336
  ds_read_b64_tr_b16 a[94:95], v46 offset:14592
  s_waitcnt lgkmcnt(0)
  ds_read_b64_tr_b16 a[96:97], v46 offset:32
  ds_read_b64_tr_b16 a[98:99], v46 offset:288
  ds_read_b64_tr_b16 a[100:101], v46 offset:2080
  ds_read_b64_tr_b16 a[102:103], v46 offset:2336
  ds_read_b64_tr_b16 a[104:105], v46 offset:4128
  ds_read_b64_tr_b16 a[106:107], v46 offset:4384
  ds_read_b64_tr_b16 a[108:109], v46 offset:6176
  ds_read_b64_tr_b16 a[110:111], v46 offset:6432
  s_waitcnt lgkmcnt(0)
  ds_read_b64_tr_b16 a[112:113], v46 offset:8224
  ds_read_b64_tr_b16 a[114:115], v46 offset:8480
  ds_read_b64_tr_b16 a[116:117], v46 offset:10272
  ds_read_b64_tr_b16 a[118:119], v46 offset:10528
  ds_read_b64_tr_b16 a[120:121], v46 offset:12320
  ds_read_b64_tr_b16 a[122:123], v46 offset:12576
  ds_read_b64_tr_b16 a[124:125], v46 offset:14368
  ds_read_b64_tr_b16 a[126:127], v46 offset:14624
  s_waitcnt lgkmcnt(0)
  s_waitcnt vmcnt(32)
  ds_read_b64_tr_b16 a[128:129], v46 offset:16384
  ds_read_b64_tr_b16 a[130:131], v46 offset:16640
  ds_read_b64_tr_b16 a[132:133], v46 offset:18432
  ds_read_b64_tr_b16 a[134:135], v46 offset:18688
  ds_read_b64_tr_b16 a[136:137], v46 offset:20480
  ds_read_b64_tr_b16 a[138:139], v46 offset:20736
  ds_read_b64_tr_b16 a[140:141], v46 offset:22528
  ds_read_b64_tr_b16 a[142:143], v46 offset:22784
  s_waitcnt lgkmcnt(0)
  ds_read_b64_tr_b16 a[144:145], v46 offset:24576
  ds_read_b64_tr_b16 a[146:147], v46 offset:24832
  ds_read_b64_tr_b16 a[148:149], v46 offset:26624
  ds_read_b64_tr_b16 a[150:151], v46 offset:26880
  ds_read_b64_tr_b16 a[152:153], v46 offset:28672
  ds_read_b64_tr_b16 a[154:155], v46 offset:28928
  ds_read_b64_tr_b16 a[156:157], v46 offset:30720
  ds_read_b64_tr_b16 a[158:159], v46 offset:30976
  s_waitcnt lgkmcnt(0)
  ds_read_b64_tr_b16 a[160:161], v46 offset:16416
  ds_read_b64_tr_b16 a[162:163], v46 offset:16672
  ds_read_b64_tr_b16 a[164:165], v46 offset:18464
  ds_read_b64_tr_b16 a[166:167], v46 offset:18720
  ds_read_b64_tr_b16 a[168:169], v46 offset:20512
  ds_read_b64_tr_b16 a[170:171], v46 offset:20768
  ds_read_b64_tr_b16 a[172:173], v46 offset:22560
  ds_read_b64_tr_b16 a[174:175], v46 offset:22816
  s_waitcnt lgkmcnt(0)
  ds_read_b64_tr_b16 a[176:177], v46 offset:24608
  ds_read_b64_tr_b16 a[178:179], v46 offset:24864
  ds_read_b64_tr_b16 a[180:181], v46 offset:26656
  ds_read_b64_tr_b16 a[182:183], v46 offset:26912
  ds_read_b64_tr_b16 a[184:185], v46 offset:28704
  ds_read_b64_tr_b16 a[186:187], v46 offset:28960
  ds_read_b64_tr_b16 a[188:189], v46 offset:30752
  ds_read_b64_tr_b16 a[190:191], v46 offset:31008
  s_waitcnt lgkmcnt(0)
  s_waitcnt vmcnt(16)
  ds_write_b128 v48, v[100:103] offset:0
  ds_write_b128 v48, v[104:107] offset:1024
  ds_write_b128 v48, v[108:111] offset:2048
  ds_write_b128 v48, v[112:115] offset:3072
  ds_write_b128 v48, v[116:119] offset:4096
  ds_write_b128 v48, v[120:123] offset:5120
  ds_write_b128 v48, v[124:127] offset:6144
  ds_write_b128 v48, v[128:131] offset:7168
  ds_write_b128 v48, v[132:135] offset:8192
  ds_write_b128 v48, v[136:139] offset:9216
  ds_write_b128 v48, v[140:143] offset:10240
  ds_write_b128 v48, v[144:147] offset:11264
  ds_write_b128 v48, v[148:151] offset:12288
  ds_write_b128 v48, v[152:155] offset:13312
  ds_write_b128 v48, v[156:159] offset:14336
  ds_write_b128 v48, v[160:163] offset:15360
  s_waitcnt lgkmcnt(0)
  ds_read_b64_tr_b16 a[0:1], v46 offset:0
  ds_read_b64_tr_b16 a[2:3], v46 offset:256
  ds_read_b64_tr_b16 a[4:5], v46 offset:2048
  ds_read_b64_tr_b16 a[6:7], v46 offset:2304
  ds_read_b64_tr_b16 a[8:9], v46 offset:4096
  ds_read_b64_tr_b16 a[10:11], v46 offset:4352
  ds_read_b64_tr_b16 a[12:13], v46 offset:6144
  ds_read_b64_tr_b16 a[14:15], v46 offset:6400
  s_waitcnt lgkmcnt(0)
  ds_read_b64_tr_b16 a[16:17], v46 offset:8192
  ds_read_b64_tr_b16 a[18:19], v46 offset:8448
  ds_read_b64_tr_b16 a[20:21], v46 offset:10240
  ds_read_b64_tr_b16 a[22:23], v46 offset:10496
  ds_read_b64_tr_b16 a[24:25], v46 offset:12288
  ds_read_b64_tr_b16 a[26:27], v46 offset:12544
  ds_read_b64_tr_b16 a[28:29], v46 offset:14336
  ds_read_b64_tr_b16 a[30:31], v46 offset:14592
  s_waitcnt lgkmcnt(0)
  ds_read_b64_tr_b16 a[32:33], v46 offset:32
  ds_read_b64_tr_b16 a[34:35], v46 offset:288
  ds_read_b64_tr_b16 a[36:37], v46 offset:2080
  ds_read_b64_tr_b16 a[38:39], v46 offset:2336
  ds_read_b64_tr_b16 a[40:41], v46 offset:4128
  ds_read_b64_tr_b16 a[42:43], v46 offset:4384
  ds_read_b64_tr_b16 a[44:45], v46 offset:6176
  ds_read_b64_tr_b16 a[46:47], v46 offset:6432
  s_waitcnt lgkmcnt(0)
  ds_read_b64_tr_b16 a[48:49], v46 offset:8224
  ds_read_b64_tr_b16 a[50:51], v46 offset:8480
  ds_read_b64_tr_b16 a[52:53], v46 offset:10272
  ds_read_b64_tr_b16 a[54:55], v46 offset:10528
  ds_read_b64_tr_b16 a[56:57], v46 offset:12320
  ds_read_b64_tr_b16 a[58:59], v46 offset:12576
  ds_read_b64_tr_b16 a[60:61], v46 offset:14368
  ds_read_b64_tr_b16 a[62:63], v46 offset:14624
  s_waitcnt lgkmcnt(0)
  s_waitcnt vmcnt(0)
  ds_write_b128 v48, v[164:167] offset:16384
  ds_write_b128 v48, v[168:171] offset:17408
  ds_write_b128 v48, v[172:175] offset:18432
  ds_write_b128 v48, v[176:179] offset:19456
  ds_write_b128 v48, v[180:183] offset:20480
  ds_write_b128 v48, v[184:187] offset:21504
  ds_write_b128 v48, v[188:191] offset:22528
  ds_write_b128 v48, v[192:195] offset:23552
  ds_write_b128 v48, v[196:199] offset:24576
  ds_write_b128 v48, v[200:203] offset:25600
  ds_write_b128 v48, v[204:207] offset:26624
  ds_write_b128 v48, v[208:211] offset:27648
  ds_write_b128 v48, v[212:215] offset:28672
  ds_write_b128 v48, v[216:219] offset:29696
  ds_write_b128 v48, v[220:223] offset:30720
  ds_write_b128 v48, v[224:227] offset:31744
  s_waitcnt lgkmcnt(0)
  ds_read_b64_tr_b16 a[192:193], v47 offset:16384
  ds_read_b64_tr_b16 a[194:195], v47 offset:16896
  ds_read_b64_tr_b16 a[196:197], v47 offset:20480
  ds_read_b64_tr_b16 a[198:199], v47 offset:20992
  ds_read_b64_tr_b16 a[200:201], v47 offset:24576
  ds_read_b64_tr_b16 a[202:203], v47 offset:25088
  ds_read_b64_tr_b16 a[204:205], v47 offset:28672
  ds_read_b64_tr_b16 a[206:207], v47 offset:29184
  s_waitcnt lgkmcnt(0)
  ds_read_b64_tr_b16 a[208:209], v47 offset:16416
  ds_read_b64_tr_b16 a[210:211], v47 offset:16928
  ds_read_b64_tr_b16 a[212:213], v47 offset:20512
  ds_read_b64_tr_b16 a[214:215], v47 offset:21024
  ds_read_b64_tr_b16 a[216:217], v47 offset:24608
  ds_read_b64_tr_b16 a[218:219], v47 offset:25120
  ds_read_b64_tr_b16 a[220:221], v47 offset:28704
  ds_read_b64_tr_b16 a[222:223], v47 offset:29216
  s_waitcnt lgkmcnt(0)
  ds_read_b64_tr_b16 a[224:225], v47 offset:16448
  ds_read_b64_tr_b16 a[226:227], v47 offset:16960
  ds_read_b64_tr_b16 a[228:229], v47 offset:20544
  ds_read_b64_tr_b16 a[230:231], v47 offset:21056
  ds_read_b64_tr_b16 a[232:233], v47 offset:24640
  ds_read_b64_tr_b16 a[234:235], v47 offset:25152
  ds_read_b64_tr_b16 a[236:237], v47 offset:28736
  ds_read_b64_tr_b16 a[238:239], v47 offset:29248
  s_waitcnt lgkmcnt(0)
  ds_read_b64_tr_b16 a[240:241], v47 offset:16480
  ds_read_b64_tr_b16 a[242:243], v47 offset:16992
  ds_read_b64_tr_b16 a[244:245], v47 offset:20576
  ds_read_b64_tr_b16 a[246:247], v47 offset:21088
  ds_read_b64_tr_b16 a[248:249], v47 offset:24672
  ds_read_b64_tr_b16 a[250:251], v47 offset:25184
  ds_read_b64_tr_b16 a[252:253], v47 offset:28768
  ds_read_b64_tr_b16 a[254:255], v47 offset:29280
  s_waitcnt lgkmcnt(0)
  s_mov_b32 s26, 4194304
  s_load_dwordx2 s[80:81], s[0:1], 104
  v_and_b32 v96, 63, v0
  s_waitcnt lgkmcnt(0)
  s_mov_b32 s82, 256
  s_mov_b32 s83, 0x20000
  v_lshlrev_b32 v98, 2, v96
  v_lshrrev_b32 v99, 6, v0
  s_mov_b32 s85, 0x10001
  v_readfirstlane_b32 s87, v99
  s_nop 3
  s_cmp_lg_u32 s87, 0
  s_cbranch_scc1 p0w_1_ok
p0w_1:
  buffer_load_dword v99, v98, s[80:83], 0 offen sc1
  s_waitcnt vmcnt(0)
  v_cmp_ne_u32 vcc, 32, v99
  s_nop 3
  s_and_b32 vcc_lo, vcc_lo, s85
  s_and_b32 vcc_hi, vcc_hi, s85
  s_or_b32 s87, vcc_lo, vcc_hi
  s_cmp_eq_u32 s87, 0
  s_cbranch_scc1 p0w_1_ok
  s_sub_u32 s26, s26, 1
  s_cselect_b32 s26, 0, s26
  s_cbranch_scc1 p0w_1_ok
  s_sleep 24
  s_branch p0w_1
p0w_1_ok:
  s_barrier
  s_nop 0
  s_barrier
  v_bfe_u32 v2, v1, 4, 1
  v_lshlrev_b32 v2, 2, v2
  v_lshrrev_b32 v3, 5, v1
  v_add_u32 v2, v2, v3
  s_lshl_b32 s24, s20, 3
  v_add_u32 v2, s24, v2
  v_mul_u32_u24 v2, 400, v2
  v_and_b32 v3, 15, v1
  v_lshl_add_u32 v5, v3, 2, v2
  v_add_u32 v242, 192, v5
  v_and_b32 v2, 7, v1
  v_mul_u32_u24 v2, 400, v2
  s_cmp_eq_u32 s20, 0
  s_cbranch_scc0 qr1_2
  v_bfe_u32 v3, v1, 3, 1
  v_lshl_add_u32 v2, v3, 7, v2
  v_lshrrev_b32 v3, 4, v1
  v_lshl_add_u32 v6, v3, 5, v2
  s_branch qrj_3
qr1_2:
  v_lshrrev_b32 v3, 3, v1
  v_add_u32 v3, 16, v3
  v_lshl_add_u32 v6, v3, 4, v2
qrj_3:
  s_nop 1
  s_lshl_b32 s24, s21, 13
  s_lshr_b32 s25, s22, 1
  s_lshl_b32 s25, s25, 10
  s_add_u32 s24, s24, s25
  s_and_b32 s25, s22, 1
  s_lshl_b32 s25, s25, 7
  v_add_u32 v22, s25, v4
  v_add_u32 v22, s24, v22
  s_lshl_b32 s52, s20, 11
  s_cmp_eq_u32 s52, s52
  v_add_u32 v22, 0, v22
  s_add_u32 s24, s24, 6144
  s_and_b32 s25, s22, 1
  s_lshl_b32 s25, s25, 1
  v_and_b32 v2, 7, v1
  v_lshrrev_b32 v3, 5, v1
  v_add_u32 v3, s25, v3
  v_lshl_add_u32 v2, v3, 4, v2
  v_lshlrev_b32 v2, 4, v2
  v_bfe_u32 v3, v1, 3, 2
  v_lshl_add_u32 v2, v3, 2, v2
  v_add_u32 v7, s24, v2
  v_add_u32 v8, 128, v7
  v_and_b32 v2, 15, v1
  s_lshl_b32 s24, s20, 4
  v_add_u32 v2, s24, v2
  v_lshlrev_b32 v2, 4, v2
  v_lshrrev_b32 v3, 4, v1
  v_lshl_add_u32 v184, v3, 10, v2
  v_add_u32 v185, 4096, v184
  v_lshl_add_u32 v186, v3, 3, v2
  s_lshl_b32 s24, s19, 10
  v_add_u32 v186, s24, v186
  s_lshl_b32 s24, s21, 13
  s_lshl_b32 s25, s22, 8
  s_add_u32 s24, s24, s25
  v_and_b32 v2, 15, v1
  v_lshlrev_b32 v2, 4, v2
  v_lshrrev_b32 v3, 4, v1
  v_lshl_add_u32 v2, v3, 3, v2
  v_add_u32 v22, s24, v2
  v_and_b32 v2, 7, v1
  v_mov_b32 v180, 0
  v_mov_b32 v3, 0x3f80
  v_cmp_eq_u32 vcc, 0, v2
  s_nop 1
  v_cndmask_b32 v180, v180, v3, vcc
  v_mov_b32 v3, 0x3f800000
  v_cmp_eq_u32 vcc, 1, v2
  s_nop 1
  v_cndmask_b32 v180, v180, v3, vcc
  v_mov_b32 v181, 0
  v_mov_b32 v3, 0x3f80
  v_cmp_eq_u32 vcc, 2, v2
  s_nop 1
  v_cndmask_b32 v181, v181, v3, vcc
  v_mov_b32 v3, 0x3f800000
  v_cmp_eq_u32 vcc, 3, v2
  s_nop 1
  v_cndmask_b32 v181, v181, v3, vcc
  v_mov_b32 v182, 0
  v_mov_b32 v3, 0x3f80
  v_cmp_eq_u32 vcc, 4, v2
  s_nop 1
  v_cndmask_b32 v182, v182, v3, vcc
  v_mov_b32 v3, 0x3f800000
  v_cmp_eq_u32 vcc, 5, v2
  s_nop 1
  v_cndmask_b32 v182, v182, v3, vcc
  v_mov_b32 v183, 0
  v_mov_b32 v3, 0x3f80
  v_cmp_eq_u32 vcc, 6, v2
  s_nop 1
  v_cndmask_b32 v183, v183, v3, vcc
  v_mov_b32 v3, 0x3f800000
  v_cmp_eq_u32 vcc, 7, v2
  s_nop 1
  v_cndmask_b32 v183, v183, v3, vcc
  s_lshl_b32 s24, s18, 2
  s_add_u32 s24, s24, s21
  s_lshl_b32 s24, s24, 12
  s_lshr_b32 s25, s22, 1
  s_lshl_b32 s25, s25, 10
  s_add_u32 s52, s24, s25
  s_and_b32 s25, s22, 1
  s_lshl_b32 s25, s25, 7
  s_add_u32 s52, s52, s25
  v_and_b32 v2, 0x37, v1
  v_lshlrev_b32 v2, 4, v2
  v_add_u32 v23, s52, v2
  s_lshl_b32 s25, s22, 6
  s_add_u32 s24, s24, s25
  s_add_u32 s24, s24, 2048
  v_and_b32 v2, 7, v1
  v_lshlrev_b32 v2, 8, v2
  v_lshrrev_b32 v3, 3, v1
  v_lshl_add_u32 v2, v3, 3, v2
  v_add_u32 v9, s24, v2
  v_and_b32 v2, 7, v1
  s_lshl_b32 s24, s20, 3
  v_add_u32 v2, s24, v2
  v_mul_u32_u24 v2, 272, v2
  v_bfe_u32 v3, v1, 3, 1
  v_lshl_add_u32 v2, v3, 7, v2
  v_lshrrev_b32 v3, 4, v1
  v_lshl_add_u32 v2, v3, 4, v2
  v_add_u32 v10, 16384, v2
  v_bfe_u32 v2, v0, 2, 3
  v_mul_u32_u24 v2, 272, v2
  v_bfe_u32 v3, v0, 6, 2
  v_lshl_add_u32 v2, v3, 6, v2
  v_and_b32 v3, 3, v0
  v_lshl_add_u32 v2, v3, 4, v2
  v_bfe_u32 v3, v0, 5, 1
  v_lshl_add_u32 v2, v3, 3, v2
  v_add_u32 v11, 16384, v2
  v_lshlrev_b32 v15, 3, v0
  v_lshlrev_b32 v16, 2, v0
  v_add_u32 v17, 4096, v16
  s_lshl_b32 s24, s19, 10
  v_add_u32 v18, s24, v16
  v_and_b32 v2, 8, v1
  v_cmp_eq_u32 vcc, 0, v2
  v_mov_b32 v3, 0xEEEE
  v_mov_b32 v19, 0x4444
  v_cndmask_b32 v19, v3, v19, vcc
  s_mov_b32 s76, -1
  s_mov_b32 s77, 0
  s_mov_b32 s74, 0x11111111
  s_mov_b32 s75, 0x11111111
  s_mov_b32 s58, 0x00ff00ff
  s_mov_b32 s59, 0x00ff00ff
  v_mov_b32 v20, -1
  v_mov_b32 v12, -1
  v_mov_b32 v13, -1
  v_mov_b32 v14, -1
  v_mov_b32 v15, -1
  v_cmp_gt_u32 vcc, 32, v1
  v_mov_b32 v3, 0xff800000
  s_nop 0
  v_cndmask_b32_e64 v24, v3, 0, vcc
  v_mov_b32 v25, v24
  v_mov_b32 v26, v24
  v_mov_b32 v27, v24
  v_mov_b32 v250, 0x3f80
  v_mov_b32 v251, 0x3f800000
  s_mov_b32 s54, 0x3e0293ee
  s_mov_b32 s55, s54
  s_lshl_b32 s42, s18, 15
  s_add_u32 s42, s42, 96468992
  s_lshl_b32 s24, s20, 13
  s_add_u32 s43, s42, s24
  s_lshl_b32 s45, s19, 13
  s_add_u32 s45, s45, 97517568
  s_lshl_b32 s24, s18, 10
  s_add_u32 s44, s45, s24
  s_lshl_b32 s46, s18, 14
  s_add_u32 s46, s46, 98566144
  s_lshl_b32 s24, s20, 12
  s_add_u32 s47, s46, s24
  v_and_b32 v2, 7, v1
  v_lshlrev_b32 v2, 11, v2
  v_lshrrev_b32 v3, 4, v1
  v_lshl_add_u32 v2, v3, 5, v2
  v_bfe_u32 v3, v1, 3, 1
  v_lshl_add_u32 v2, v3, 2, v2
  s_lshl_b32 s24, s20, 9
  v_add_u32 v2, s24, v2
  global_load_dword v28, v2, s[12:13] offset:0
  global_load_dword v29, v2, s[12:13] offset:8
  global_load_dword v30, v2, s[12:13] offset:16
  global_load_dword v31, v2, s[12:13] offset:24
  global_load_dword v32, v2, s[12:13] offset:128
  global_load_dword v33, v2, s[12:13] offset:136
  global_load_dword v34, v2, s[12:13] offset:144
  global_load_dword v35, v2, s[12:13] offset:152
  global_load_dword v36, v2, s[12:13] offset:256
  global_load_dword v37, v2, s[12:13] offset:264
  global_load_dword v38, v2, s[12:13] offset:272
  global_load_dword v39, v2, s[12:13] offset:280
  global_load_dword v40, v2, s[12:13] offset:384
  global_load_dword v41, v2, s[12:13] offset:392
  global_load_dword v42, v2, s[12:13] offset:400
  global_load_dword v43, v2, s[12:13] offset:408
  s_lshl_b32 s24, s18, 2
  s_add_u32 s25, s24, s20
  s_lshl_b32 s25, s25, 13
  s_add_u32 s49, s25, 41943040
  s_add_u32 s25, s24, s21
  s_lshl_b32 s25, s25, 13
  s_lshl_b32 s24, s22, 10
  s_add_u32 s25, s25, s24
  s_add_u32 s48, s25, 25165824
  s_mov_b32 s50, 88080384
  s_lshl_b32 s24, s18, 2
  s_add_u32 s24, s24, s21
  s_lshl_b32 s24, s24, 13
  s_lshl_b32 s25, s22, 11
  s_add_u32 s66, s24, s25
  s_add_u32 s66, s66, 42729472
  s_lshl_b32 s25, s22, 10
  s_add_u32 s67, s24, s25
  s_add_u32 s67, s67, 25690112
  s_add_u32 s24, s66, 1024
  s_cmp_eq_u32 s20, 1
  s_cselect_b32 s66, s24, s66
  s_cmp_eq_u32 s20, 2
  s_cselect_b32 s66, s67, s66
  s_add_u32 s24, s67, 4096
  s_cmp_eq_u32 s20, 3
  s_cselect_b32 s66, s24, s66
  s_mov_b32 s26, 4194304
  s_getreg_b32 s24, hwreg(HW_REG_XCC_ID, 0, 4)
  s_add_u32 s24, s24, 1
  s_lshl_b32 s25, s18, 4
  s_add_u32 s52, s25, s19
  s_add_u32 s52, s52, 192
  s_lshl_b32 s52, s52, 7
  s_add_u32 s52, s52, 99614720
  v_mov_b32 v2, s24
  v_mov_b32 v3, 0
  buffer_store_dword v2, v3, s[28:31], s52 offen sc1
  s_add_u32 s52, s25, 192
  s_lshl_b32 s52, s52, 7
  s_add_u32 s52, s52, 99614720
  v_and_b32 v3, 15, v1
  v_lshlrev_b32 v3, 7, v3
xcc_poll_5:
  buffer_load_dword v248, v3, s[28:31], s52 offen sc1
  s_waitcnt vmcnt(0)
  v_cmp_eq_u32 vcc, 0, v248
  s_cbranch_vccz xcc_poll_5_ok
  s_sub_u32 s26, s26, 1
  s_cbranch_scc1 L_exit
  s_sleep 4
  s_branch xcc_poll_5
xcc_poll_5_ok:
  v_cmp_ne_u32 vcc, s24, v248
  s_mov_b32 s70, 1
  s_cbranch_vccz xcc_poll_5_same
  s_mov_b32 s70, 0
xcc_poll_5_same:
  s_nop 1
  v_mov_b32 v253, 0
  s_mov_b32 s51, 99614720
  s_mov_b32 s52, 99619328
kvw_6:
  buffer_load_dword v252, v253, s[28:31], s52 offen sc1
  s_waitcnt vmcnt(0)
  v_readfirstlane_b32 s24, v252
  s_nop 3
  s_cmp_ge_u32 s24, 32
  s_cbranch_scc1 kvw_6_ok
  s_sub_u32 s26, s26, 1
  s_cbranch_scc1 L_exit
  s_sleep 8
  s_branch kvw_6
kvw_6_ok:
  v_mov_b32 v252, 0
  buffer_load_dwordx4 v[88:91], v4, s[28:31], s49 offen offset:0 sc1
  buffer_load_dwordx4 v[92:95], v4, s[28:31], s49 offen offset:1024 sc1
  buffer_load_dwordx4 v[96:99], v4, s[28:31], s49 offen offset:2048 sc1
  buffer_load_dwordx4 v[100:103], v4, s[28:31], s49 offen offset:3072 sc1
  buffer_load_dwordx4 v[104:107], v21, s[28:31], s49 offen offset:0 sc1
  buffer_load_dwordx4 v[108:111], v21, s[28:31], s49 offen offset:1024 sc1
  buffer_load_dwordx4 v[112:115], v21, s[28:31], s49 offen offset:2048 sc1
  buffer_load_dwordx4 v[116:119], v21, s[28:31], s49 offen offset:3072 sc1
  buffer_load_dwordx4 v[68:71], v4, s[28:31], s48 offen offset:0 sc1
  buffer_load_dwordx4 v[72:75], v21, s[28:31], s48 offen offset:0 sc1
  s_add_u32 s49, s49, 262144
  s_add_u32 s48, s48, 262144
  s_mov_b32 s23, 0
  s_and_b32 s27, s23, 3
  s_lshl_b32 s24, s27, 18
  s_add_u32 s32, s42, s24
  s_add_u32 s33, s43, s24
  s_xor_b32 s24, s24, 524288
  s_add_u32 s34, s42, s24
  s_lshl_b32 s24, s27, 17
  s_add_u32 s35, s44, s24
  s_add_u32 s36, s45, s24
  s_xor_b32 s24, s24, 262144
  s_add_u32 s37, s44, s24
  s_add_u32 s27, s27, 1
  s_and_b32 s27, s27, 3
  s_lshl_b32 s24, s27, 17
  s_add_u32 s38, s46, s24
  s_add_u32 s39, s47, s24
  s_xor_b32 s24, s24, 262144
  s_add_u32 s40, s46, s24
  s_waitcnt vmcnt(0)
  v_mfma_f32_16x16x32_bf16 v[136:139], v[88:91], a[192:195], 0
  v_mov_b32 v44, 0
  v_mov_b32 v45, 0
  v_mfma_f32_16x16x32_bf16 v[140:143], v[88:91], a[208:211], 0
  v_mov_b32 v46, 0
  v_mov_b32 v47, 0
  v_mfma_f32_16x16x32_bf16 v[144:147], v[88:91], a[224:227], 0
  v_mov_b32 v48, 0
  v_mov_b32 v49, 0
  v_mfma_f32_16x16x32_bf16 v[148:151], v[88:91], a[240:243], 0
  v_mov_b32 v50, 0
  v_mov_b32 v51, 0
  buffer_load_dwordx4 v[88:91], v4, s[28:31], s49 offen offset:0 sc1
  v_mfma_f32_16x16x32_bf16 v[136:139], v[92:95], a[196:199], v[136:139]
  v_mov_b32 v52, 0
  v_mov_b32 v53, 0
  v_mfma_f32_16x16x32_bf16 v[140:143], v[92:95], a[212:215], v[140:143]
  v_mov_b32 v54, 0
  v_mov_b32 v55, 0
  v_mfma_f32_16x16x32_bf16 v[144:147], v[92:95], a[228:231], v[144:147]
  v_mov_b32 v56, 0
  v_mov_b32 v57, 0
  v_mfma_f32_16x16x32_bf16 v[148:151], v[92:95], a[244:247], v[148:151]
  v_mov_b32 v58, 0
  v_mov_b32 v59, 0
  buffer_load_dwordx4 v[92:95], v4, s[28:31], s49 offen offset:1024 sc1
  v_mfma_f32_16x16x32_bf16 v[136:139], v[96:99], a[200:203], v[136:139]
  v_mov_b32 v60, 0
  v_mov_b32 v61, 0
  v_mfma_f32_16x16x32_bf16 v[140:143], v[96:99], a[216:219], v[140:143]
  v_mov_b32 v62, 0
  v_mov_b32 v63, 0
  v_mfma_f32_16x16x32_bf16 v[144:147], v[96:99], a[232:235], v[144:147]
  v_mov_b32 v64, 0
  v_mov_b32 v65, 0
  v_mfma_f32_16x16x32_bf16 v[148:151], v[96:99], a[248:251], v[148:151]
  v_mov_b32 v66, 0
  v_mov_b32 v67, 0
  buffer_load_dwordx4 v[96:99], v4, s[28:31], s49 offen offset:2048 sc1
  v_mfma_f32_16x16x32_bf16 v[136:139], v[100:103], a[204:207], v[136:139]
  v_mov_b32 v212, 0
  v_mov_b32 v213, 0
  v_mfma_f32_16x16x32_bf16 v[140:143], v[100:103], a[220:223], v[140:143]
  v_mov_b32 v214, 0
  v_mov_b32 v215, 0
  v_mfma_f32_16x16x32_bf16 v[144:147], v[100:103], a[236:239], v[144:147]
  v_mov_b32 v216, 0
  v_mov_b32 v217, 0
  v_mfma_f32_16x16x32_bf16 v[148:151], v[100:103], a[252:255], v[148:151]
  v_mov_b32 v218, 0
  v_mov_b32 v219, 0
  buffer_load_dwordx4 v[100:103], v4, s[28:31], s49 offen offset:3072 sc1
  v_mfma_f32_16x16x32_bf16 v[152:155], v[104:107], a[192:195], 0
  v_mov_b32 v220, 0
  v_mov_b32 v221, 0
  v_mfma_f32_16x16x32_bf16 v[156:159], v[104:107], a[208:211], 0
  v_mov_b32 v222, 0
  v_mov_b32 v223, 0
  v_mfma_f32_16x16x32_bf16 v[160:163], v[104:107], a[224:227], 0
  v_mov_b32 v224, 0
  v_mov_b32 v225, 0
  v_mfma_f32_16x16x32_bf16 v[164:167], v[104:107], a[240:243], 0
  v_mov_b32 v226, 0
  v_mov_b32 v227, 0
  buffer_load_dwordx4 v[104:107], v21, s[28:31], s49 offen offset:0 sc1
  v_mfma_f32_16x16x32_bf16 v[152:155], v[108:111], a[196:199], v[152:155]
  v_cvt_pk_bf16_f32 v120, v136, v137
  v_cvt_pk_bf16_f32 v121, v138, v139
  v_mfma_f32_16x16x32_bf16 v[156:159], v[108:111], a[212:215], v[156:159]
  v_cvt_pk_bf16_f32 v124, v140, v141
  v_cvt_pk_bf16_f32 v125, v142, v143
  v_mfma_f32_16x16x32_bf16 v[160:163], v[108:111], a[228:231], v[160:163]
  v_cvt_pk_bf16_f32 v128, v144, v145
  v_cvt_pk_bf16_f32 v129, v146, v147
  v_mfma_f32_16x16x32_bf16 v[164:167], v[108:111], a[244:247], v[164:167]
  v_cvt_pk_bf16_f32 v132, v148, v149
  v_cvt_pk_bf16_f32 v133, v150, v151
  buffer_load_dwordx4 v[108:111], v21, s[28:31], s49 offen offset:1024 sc1
  v_mfma_f32_16x16x32_bf16 v[152:155], v[112:115], a[200:203], v[152:155]
  v_mfma_f32_16x16x32_bf16 v[156:159], v[112:115], a[216:219], v[156:159]
  v_mfma_f32_16x16x32_bf16 v[160:163], v[112:115], a[232:235], v[160:163]
  v_mfma_f32_16x16x32_bf16 v[164:167], v[112:115], a[248:251], v[164:167]
  buffer_load_dwordx4 v[112:115], v21, s[28:31], s49 offen offset:2048 sc1
  v_mfma_f32_16x16x32_bf16 v[152:155], v[116:119], a[204:207], v[152:155]
  v_mfma_f32_16x16x32_bf16 v[156:159], v[116:119], a[220:223], v[156:159]
  v_mfma_f32_16x16x32_bf16 v[160:163], v[116:119], a[236:239], v[160:163]
  v_mfma_f32_16x16x32_bf16 v[164:167], v[116:119], a[252:255], v[164:167]
  buffer_load_dwordx4 v[116:119], v21, s[28:31], s49 offen offset:3072 sc1
  v_cvt_pk_bf16_f32 v122, v152, v153
  v_cvt_pk_bf16_f32 v123, v154, v155
  v_cvt_pk_bf16_f32 v126, v156, v157
  v_cvt_pk_bf16_f32 v127, v158, v159
  v_cvt_pk_bf16_f32 v130, v160, v161
  v_cvt_pk_bf16_f32 v131, v162, v163
  s_nop 0
  v_cvt_pk_bf16_f32 v134, v164, v165
  v_cvt_pk_bf16_f32 v135, v166, v167
  s_add_u32 s49, s49, 262144
  s_cmp_lg_u32 s70, 0
  s_cbranch_scc0 chain_slow_4
  s_nop 0
chain_loop_7:
  v_smfmac_f32_16x16x64_bf16 v[44:47], v[28:31], a[0:7], v19
  v_smfmac_f32_16x16x64_bf16 v[44:47], v[32:35], a[8:15], v19
  v_smfmac_f32_16x16x64_bf16 v[44:47], v[36:39], a[16:23], v19
  v_smfmac_f32_16x16x64_bf16 v[44:47], v[40:43], a[24:31], v19
  v_smfmac_f32_16x16x64_bf16 v[48:51], v[28:31], a[32:39], v19
  v_smfmac_f32_16x16x64_bf16 v[48:51], v[32:35], a[40:47], v19
  v_permlane32_swap_b32 v44, v45
  v_smfmac_f32_16x16x64_bf16 v[48:51], v[36:39], a[48:55], v19
  v_permlane32_swap_b32 v46, v47
  v_smfmac_f32_16x16x64_bf16 v[48:51], v[40:43], a[56:63], v19
  v_add_f32 v44, v44, v45
  v_add_f32 v46, v46, v47
  v_smfmac_f32_16x16x64_bf16 v[52:55], v[28:31], a[64:71], v19
  ds_write_b32 v5, v44 offset:0
  ds_write_b32 v5, v46 offset:800
  v_smfmac_f32_16x16x64_bf16 v[52:55], v[32:35], a[72:79], v19
  v_permlane32_swap_b32 v48, v49
  v_smfmac_f32_16x16x64_bf16 v[52:55], v[36:39], a[80:87], v19
  v_permlane32_swap_b32 v50, v51
  v_smfmac_f32_16x16x64_bf16 v[52:55], v[40:43], a[88:95], v19
  v_add_f32 v48, v48, v49
  v_add_f32 v50, v50, v51
  v_smfmac_f32_16x16x64_bf16 v[56:59], v[28:31], a[96:103], v19
  ds_write_b32 v5, v48 offset:64
  ds_write_b32 v5, v50 offset:864
  v_smfmac_f32_16x16x64_bf16 v[56:59], v[32:35], a[104:111], v19
  v_permlane32_swap_b32 v52, v53
  v_smfmac_f32_16x16x64_bf16 v[56:59], v[36:39], a[112:119], v19
  v_permlane32_swap_b32 v54, v55
  v_smfmac_f32_16x16x64_bf16 v[56:59], v[40:43], a[120:127], v19
  v_add_f32 v52, v52, v53
  v_add_f32 v54, v54, v55
  v_smfmac_f32_16x16x64_bf16 v[60:63], v[28:31], a[128:135], v19
  ds_write_b32 v5, v52 offset:128
  ds_write_b32 v5, v54 offset:928
  v_smfmac_f32_16x16x64_bf16 v[60:63], v[32:35], a[136:143], v19
  v_permlane32_swap_b32 v56, v57
  v_smfmac_f32_16x16x64_bf16 v[60:63], v[36:39], a[144:151], v19
  v_permlane32_swap_b32 v58, v59
  v_smfmac_f32_16x16x64_bf16 v[60:63], v[40:43], a[152:159], v19
  v_add_f32 v56, v56, v57
  v_add_f32 v58, v58, v59
  v_smfmac_f32_16x16x64_bf16 v[64:67], v[28:31], a[160:167], v19
  ds_write_b32 v5, v56 offset:192
  ds_write_b32 v5, v58 offset:992
  v_smfmac_f32_16x16x64_bf16 v[64:67], v[32:35], a[168:175], v19
  v_permlane32_swap_b32 v60, v61
  v_smfmac_f32_16x16x64_bf16 v[64:67], v[36:39], a[176:183], v19
  v_permlane32_swap_b32 v62, v63
  v_smfmac_f32_16x16x64_bf16 v[64:67], v[40:43], a[184:191], v19
  v_add_f32 v60, v60, v61
  v_add_f32 v62, v62, v63
  ds_write_b32 v5, v60 offset:256
  ds_write_b32 v5, v62 offset:1056
  s_nop 3
  v_permlane32_swap_b32 v64, v65
  v_permlane32_swap_b32 v66, v67
  v_add_f32 v64, v64, v65
  v_add_f32 v66, v66, v67
  ds_write_b32 v5, v64 offset:320
  ds_write_b32 v5, v66 offset:1120
  s_waitcnt lgkmcnt(0)
  s_barrier
  s_cmp_lg_u32 s20, 0
  s_cbranch_scc1 qk_skip_8
  ds_read_b128 v[136:139], v6 offset:0
  ds_read_b128 v[140:143], v6 offset:16
  ds_read_b128 v[144:147], v6 offset:3200
  ds_read_b128 v[148:151], v6 offset:3216
  ds_read_b128 v[152:155], v6 offset:6400
  ds_read_b128 v[156:159], v6 offset:6416
  ds_read_b128 v[160:163], v6 offset:9600
  ds_read_b128 v[164:167], v6 offset:9616
  v_add_u32 v2, 4096, v22
  s_waitcnt lgkmcnt(4)
  v_pk_add_f32 v[136:137], v[136:137], v[144:145]
  v_pk_add_f32 v[138:139], v[138:139], v[146:147]
  v_pk_add_f32 v[140:141], v[140:141], v[148:149]
  v_pk_add_f32 v[142:143], v[142:143], v[150:151]
  s_waitcnt lgkmcnt(0)
  v_pk_add_f32 v[152:153], v[152:153], v[160:161]
  v_pk_add_f32 v[154:155], v[154:155], v[162:163]
  v_pk_add_f32 v[156:157], v[156:157], v[164:165]
  v_pk_add_f32 v[158:159], v[158:159], v[166:167]
  v_pk_add_f32 v[136:137], v[136:137], v[152:153]
  v_pk_add_f32 v[138:139], v[138:139], v[154:155]
  v_pk_add_f32 v[140:141], v[140:141], v[156:157]
  v_pk_add_f32 v[142:143], v[142:143], v[158:159]
  v_cvt_pk_bf16_f32 v76, v136, v137
  v_cvt_pk_bf16_f32 v77, v138, v139
  v_cvt_pk_bf16_f32 v78, v140, v141
  v_cvt_pk_bf16_f32 v79, v142, v143
  s_nop 1
  v_mfma_f32_16x16x32_bf16 v[204:207], v[76:79], v[68:71], 0
  v_mov_b32_dpp v80, v76 row_ror:8 row_mask:0xf bank_mask:0xf
  v_mov_b32_dpp v81, v77 row_ror:8 row_mask:0xf bank_mask:0xf
  v_mov_b32_dpp v82, v78 row_ror:8 row_mask:0xf bank_mask:0xf
  v_mov_b32_dpp v83, v79 row_ror:8 row_mask:0xf bank_mask:0xf
  v_mfma_f32_16x16x32_bf16 v[208:211], v[76:79], v[72:75], 0
  v_mfma_f32_16x16x32_bf16 v[200:203], v[76:79], v[80:83], 0
  s_mov_b64 exec, s[76:77]
  v_cvt_pk_bf16_f32 v204, v204, v205
  v_cvt_pk_bf16_f32 v205, v206, v207
  v_min_u32 v204, -2, v204
  v_min_u32 v205, -2, v205
  buffer_store_dwordx2 v[204:205], v22, s[28:31], s32 offen offset:0
  v_cvt_pk_bf16_f32 v208, v208, v209
  v_cvt_pk_bf16_f32 v209, v210, v211
  v_min_u32 v208, -2, v208
  v_min_u32 v209, -2, v209
  buffer_store_dwordx2 v[208:209], v22, s[28:31], s32 offen offset:1024
  v_cvt_pk_bf16_f32 v200, v200, v201
  v_cvt_pk_bf16_f32 v201, v202, v203
  v_min_u32 v200, -2, v200
  v_min_u32 v201, -2, v201
  buffer_store_dwordx2 v[200:201], v22, s[28:31], s32 offen offset:2048
  s_mov_b64 exec, -1
  s_nop 0
qk_skip_8:
  s_cmp_lg_u32 s20, 1
  s_cbranch_scc1 v_skip_9
  ds_read_b128 v[136:139], v6 offset:0
  ds_read_b128 v[140:143], v6 offset:3200
  ds_read_b128 v[144:147], v6 offset:6400
  ds_read_b128 v[148:151], v6 offset:9600
  s_waitcnt lgkmcnt(2)
  v_pk_add_f32 v[136:137], v[136:137], v[140:141]
  v_pk_add_f32 v[138:139], v[138:139], v[142:143]
  s_waitcnt lgkmcnt(0)
  v_pk_add_f32 v[144:145], v[144:145], v[148:149]
  v_pk_add_f32 v[146:147], v[146:147], v[150:151]
  v_pk_add_f32 v[136:137], v[136:137], v[144:145]
  v_pk_add_f32 v[138:139], v[138:139], v[146:147]
  v_cvt_pk_bf16_f32 v84, v136, v137
  v_cvt_pk_bf16_f32 v85, v138, v139
  v_min_u32 v84, -2, v84
  v_min_u32 v85, -2, v85
  buffer_store_dword v84, v7, s[28:31], s32 offen
  buffer_store_dword v85, v8, s[28:31], s32 offen
v_skip_9:
  s_nop 0
  s_cmp_eq_u32 s23, 63
  s_cbranch_scc1 last_10
  s_barrier
pollA_11:
  buffer_load_dwordx4 v[168:171], v4, s[28:31], s33 offen offset:0 sc1
  buffer_load_dwordx4 v[172:175], v4, s[28:31], s33 offen offset:1024 sc1
  buffer_load_dwordx4 v[176:179], v4, s[28:31], s33 offen offset:2048 sc1
  s_nop 11
  buffer_load_dwordx4 v[192:195], v21, s[28:31], s33 offen offset:2048 sc1
  buffer_load_dwordx4 v[196:199], v21, s[28:31], s33 offen offset:3072 sc1
  s_waitcnt vmcnt(2)
  v_max3_u32 v248, v168, v170, v172
  v_max3_u32 v248, v248, v174, v176
  v_max_u32 v248, v248, v178
  v_cmp_eq_u32 vcc, -1, v248
  s_cbranch_vccnz retry_12
  v_mfma_f32_16x16x32_bf16 v[204:207], v[168:171], v[180:183], 0
  v_mfma_f32_16x16x32_bf16 v[208:211], v[172:175], v[180:183], 0
  v_mfma_f32_16x16x32_bf16 v[200:203], v[176:179], v[180:183], v[24:27]
  v_max3_f32 v248, v204, v205, v206
  s_nop 2
  v_max3_f32 v249, v207, v208, v209
  v_max3_f32 v248, v248, v210, v211
  s_nop 1
  v_max3_f32 v249, v249, v200, v201
  v_max3_f32 v248, v248, v202, v203
  v_max_f32 v244, v248, v249
  v_mov_b32 v248, v244
  s_nop 1
  v_permlane32_swap_b32 v244, v248
  v_max_f32 v244, v244, v248
  v_mov_b32 v248, v244
  s_nop 1
  v_permlane16_swap_b32 v244, v248
  v_max_f32 v244, v244, v248
  v_mul_f32 v244, s54, v244
  v_pk_fma_f32 v[200:201], v[200:201], s[54:55], v[244:245] op_sel_hi:[1,1,0] neg_lo:[0,0,1] neg_hi:[0,0,1]
  v_pk_fma_f32 v[202:203], v[202:203], s[54:55], v[244:245] op_sel_hi:[1,1,0] neg_lo:[0,0,1] neg_hi:[0,0,1]
  v_pk_fma_f32 v[204:205], v[204:205], s[54:55], v[244:245] op_sel_hi:[1,1,0] neg_lo:[0,0,1] neg_hi:[0,0,1]
  v_pk_fma_f32 v[206:207], v[206:207], s[54:55], v[244:245] op_sel_hi:[1,1,0] neg_lo:[0,0,1] neg_hi:[0,0,1]
  v_pk_fma_f32 v[208:209], v[208:209], s[54:55], v[244:245] op_sel_hi:[1,1,0] neg_lo:[0,0,1] neg_hi:[0,0,1]
  v_pk_fma_f32 v[210:211], v[210:211], s[54:55], v[244:245] op_sel_hi:[1,1,0] neg_lo:[0,0,1] neg_hi:[0,0,1]
  s_waitcnt vmcnt(0)
  v_max3_u32 v249, v192, v193, v194
  v_max3_u32 v248, v195, v196, v197
  v_max3_u32 v249, v249, v198, v199
  v_max_u32 v249, v249, v248
  v_cmp_eq_u32 vcc, -1, v249
  s_cbranch_vccnz pollV_13
pollV_back_14:
  buffer_load_dword v243, v4, s[28:31], s66 offen sc1
  s_add_u32 s66, s66, 262144
  v_smfmac_f32_16x16x64_bf16 v[212:215], v[192:195], a[192:199], v19
  v_exp_f32 v204, v204
  v_smfmac_f32_16x16x64_bf16 v[212:215], v[196:199], a[200:207], v19
  v_exp_f32 v205, v205
  v_smfmac_f32_16x16x64_bf16 v[216:219], v[192:195], a[208:215], v19
  v_exp_f32 v206, v206
  v_smfmac_f32_16x16x64_bf16 v[216:219], v[196:199], a[216:223], v19
  v_exp_f32 v207, v207
  v_smfmac_f32_16x16x64_bf16 v[220:223], v[192:195], a[224:231], v19
  v_exp_f32 v208, v208
  v_smfmac_f32_16x16x64_bf16 v[220:223], v[196:199], a[232:239], v19
  v_exp_f32 v209, v209
  v_smfmac_f32_16x16x64_bf16 v[224:227], v[192:195], a[240:247], v19
  v_exp_f32 v210, v210
  v_smfmac_f32_16x16x64_bf16 v[224:227], v[196:199], a[248:255], v19
  v_exp_f32 v211, v211
  v_exp_f32 v200, v200
  v_exp_f32 v201, v201
  v_exp_f32 v202, v202
  v_exp_f32 v203, v203
  v_cvt_pk_bf16_f32 v236, v204, v205
  v_cvt_pk_bf16_f32 v237, v206, v207
  v_cvt_pk_bf16_f32 v238, v208, v209
  v_cvt_pk_bf16_f32 v239, v210, v211
  v_cvt_pk_bf16_f32 v240, v200, v201
  v_cvt_pk_bf16_f32 v241, v202, v203
  v_mfma_f32_16x16x32_bf16 v[136:139], v[120:123], v[236:239], 0
  v_mov_b32 v248, v240
  v_mov_b32 v249, v241
  v_mfma_f32_16x16x32_bf16 v[140:143], v[124:127], v[236:239], 0
  v_permlane32_swap_b32 v240, v248
  v_permlane32_swap_b32 v241, v249
  v_mfma_f32_16x16x32_bf16 v[144:147], v[128:131], v[236:239], 0
  v_cvt_pk_bf16_f32 v228, v212, v213
  v_cvt_pk_bf16_f32 v229, v214, v215
  v_cvt_pk_bf16_f32 v230, v216, v217
  v_cvt_pk_bf16_f32 v231, v218, v219
  v_mfma_f32_16x16x32_bf16 v[148:151], v[132:135], v[236:239], 0
  v_cvt_pk_bf16_f32 v232, v220, v221
  v_cvt_pk_bf16_f32 v233, v222, v223
  v_cvt_pk_bf16_f32 v234, v224, v225
  v_cvt_pk_bf16_f32 v235, v226, v227
  v_mfma_f32_16x16x16_bf16 v[136:139], v[228:229], v[240:241], v[136:139]
  v_pk_add_f32 v[200:201], v[200:201], v[202:203]
  v_pk_add_f32 v[204:205], v[204:205], v[206:207]
  v_mfma_f32_16x16x16_bf16 v[140:143], v[230:231], v[240:241], v[140:143]
  v_pk_add_f32 v[208:209], v[208:209], v[210:211]
  v_pk_add_f32 v[200:201], v[200:201], v[204:205]
  v_mfma_f32_16x16x16_bf16 v[144:147], v[232:233], v[240:241], v[144:147]
  v_pk_add_f32 v[200:201], v[200:201], v[208:209]
  v_add_f32 v245, v200, v201
  v_mfma_f32_16x16x16_bf16 v[148:151], v[234:235], v[240:241], v[148:151]
  v_mov_b32 v248, v245
  s_nop 1
  v_permlane32_swap_b32 v245, v248
  v_add_f32 v245, v245, v248
  v_mov_b32 v248, v245
  s_nop 1
  v_permlane16_swap_b32 v245, v248
  v_add_f32 v245, v245, v248
  v_rcp_f32 v246, v245
  v_cndmask_b32 v136, v144, v136, s[58:59]
  v_cndmask_b32 v137, v145, v137, s[58:59]
  v_cndmask_b32 v138, v146, v138, s[58:59]
  v_cndmask_b32 v139, v147, v139, s[58:59]
  v_pk_mul_f32 v[136:137], v[136:137], v[246:247] op_sel_hi:[1,0]
  v_pk_mul_f32 v[138:139], v[138:139], v[246:247] op_sel_hi:[1,0]
  ds_write_b128 v10, v[136:139] offset:0
  v_cndmask_b32 v140, v148, v140, s[58:59]
  v_cndmask_b32 v141, v149, v141, s[58:59]
  v_cndmask_b32 v142, v150, v142, s[58:59]
  v_cndmask_b32 v143, v151, v143, s[58:59]
  v_pk_mul_f32 v[140:141], v[140:141], v[246:247] op_sel_hi:[1,0]
  v_pk_mul_f32 v[142:143], v[142:143], v[246:247] op_sel_hi:[1,0]
  ds_write_b128 v10, v[140:143] offset:64
  s_waitcnt lgkmcnt(0)
  s_barrier
  ds_read_b64 v[136:137], v11 offset:0
  ds_read_b64 v[138:139], v11 offset:2176
  ds_read_b64 v[140:141], v11 offset:4352
  ds_read_b64 v[142:143], v11 offset:6528
  s_waitcnt lgkmcnt(2)
  v_pk_add_f32 v[136:137], v[136:137], v[138:139]
  s_waitcnt lgkmcnt(0)
  v_pk_add_f32 v[140:141], v[140:141], v[142:143]
  v_pk_add_f32 v[136:137], v[136:137], v[140:141]
  v_cvt_pk_bf16_f32 v136, v136, v137
  v_min_u32 v136, -2, v136
  buffer_store_dword v136, v16, s[28:31], s35 offen sc1
  buffer_store_dword v20, v16, s[28:31], s37 offen sc1
  s_cmp_lg_u32 s20, 0
  s_cbranch_scc1 w0_skip_15
  s_mov_b64 exec, s[76:77]
  buffer_store_dwordx2 v[12:13], v22, s[28:31], s34 offen offset:0
  buffer_store_dwordx2 v[12:13], v22, s[28:31], s34 offen offset:1024
  buffer_store_dwordx2 v[12:13], v22, s[28:31], s34 offen offset:2048
  s_not_b64 exec, s[58:59]
  buffer_store_dwordx4 v[76:79], v23, s[28:31], s50 offen sc1
  s_mov_b64 exec, -1
w0_skip_15:
  s_cmp_lg_u32 s20, 1
  s_cbranch_scc1 w1_skip_16
  buffer_store_dword v20, v7, s[28:31], s34 offen
  buffer_store_dword v20, v8, s[28:31], s34 offen
  buffer_store_dwordx2 v[84:85], v9, s[28:31], s50 offen sc1
w1_skip_16:
  s_cmp_lg_u32 s20, 2
  s_cbranch_scc1 w2_skip_17
  s_cmp_eq_u32 s23, 0
  s_cbranch_scc1 w2_skip_17
  s_sub_u32 s24, s23, 1
  s_lshl_b32 s25, s18, 6
  s_add_u32 s24, s24, s25
  s_add_u32 s24, s24, 448
  s_lshl_b32 s24, s24, 7
  s_lshl_b32 s25, s19, 2
  s_add_u32 s24, s24, s25
  s_add_u32 s24, s24, 99614720
  v_mov_b32 v248, 1
  s_mov_b64 exec, 1
  buffer_store_dword v248, v253, s[28:31], s24 offen sc1
  s_mov_b64 exec, -1
w2_skip_17:
  s_nop 0
  buffer_store_dword v20, v18, s[28:31], s40 offen
  s_add_u32 s50, s50, 131072
  v_readfirstlane_b32 s24, v252
  s_nop 3
  s_cmp_lt_u32 s24, 64
  s_cbranch_scc1 kv_poll_19
kv_ok_18:
  s_add_u32 s51, s23, 3
  s_lshr_b32 s51, s51, 2
  s_min_u32 s51, s51, 15
  s_lshl_b32 s51, s51, 7
  s_add_u32 s51, s51, 99614720
  s_cmp_lg_u32 s20, 0
  s_cbranch_scc1 ks_skip_20
  buffer_load_dwordx4 v[68:71], v4, s[28:31], s48 offen offset:0 sc1
  buffer_load_dwordx4 v[72:75], v21, s[28:31], s48 offen offset:0 sc1
ks_skip_20:
  s_add_u32 s48, s48, 262144
  buffer_load_dword v252, v253, s[28:31], s51 offen sc1
  v_mfma_f32_16x16x32_bf16 v[136:139], v[88:91], a[192:195], 0
  v_mfma_f32_16x16x32_bf16 v[140:143], v[88:91], a[208:211], 0
  v_mfma_f32_16x16x32_bf16 v[144:147], v[88:91], a[224:227], 0
  v_mfma_f32_16x16x32_bf16 v[148:151], v[88:91], a[240:243], 0
  buffer_load_dwordx4 v[88:91], v4, s[28:31], s49 offen offset:0 sc1
  v_mfma_f32_16x16x32_bf16 v[136:139], v[92:95], a[196:199], v[136:139]
  v_mfma_f32_16x16x32_bf16 v[140:143], v[92:95], a[212:215], v[140:143]
  v_mfma_f32_16x16x32_bf16 v[144:147], v[92:95], a[228:231], v[144:147]
  v_mfma_f32_16x16x32_bf16 v[148:151], v[92:95], a[244:247], v[148:151]
  buffer_load_dwordx4 v[92:95], v4, s[28:31], s49 offen offset:1024 sc1
  v_mfma_f32_16x16x32_bf16 v[136:139], v[96:99], a[200:203], v[136:139]
  v_mfma_f32_16x16x32_bf16 v[140:143], v[96:99], a[216:219], v[140:143]
  v_mfma_f32_16x16x32_bf16 v[144:147], v[96:99], a[232:235], v[144:147]
  v_mfma_f32_16x16x32_bf16 v[148:151], v[96:99], a[248:251], v[148:151]
  buffer_load_dwordx4 v[96:99], v4, s[28:31], s49 offen offset:2048 sc1
  v_mfma_f32_16x16x32_bf16 v[136:139], v[100:103], a[204:207], v[136:139]
  v_mfma_f32_16x16x32_bf16 v[140:143], v[100:103], a[220:223], v[140:143]
  v_mfma_f32_16x16x32_bf16 v[144:147], v[100:103], a[236:239], v[144:147]
  v_mfma_f32_16x16x32_bf16 v[148:151], v[100:103], a[252:255], v[148:151]
  buffer_load_dwordx4 v[100:103], v4, s[28:31], s49 offen offset:3072 sc1
  v_mfma_f32_16x16x32_bf16 v[152:155], v[104:107], a[192:195], 0
  v_mfma_f32_16x16x32_bf16 v[156:159], v[104:107], a[208:211], 0
  v_mfma_f32_16x16x32_bf16 v[160:163], v[104:107], a[224:227], 0
  v_mfma_f32_16x16x32_bf16 v[164:167], v[104:107], a[240:243], 0
  buffer_load_dwordx4 v[104:107], v21, s[28:31], s49 offen offset:0 sc1
  v_mfma_f32_16x16x32_bf16 v[152:155], v[108:111], a[196:199], v[152:155]
  v_cvt_pk_bf16_f32 v120, v136, v137
  v_cvt_pk_bf16_f32 v121, v138, v139
  v_mfma_f32_16x16x32_bf16 v[156:159], v[108:111], a[212:215], v[156:159]
  v_cvt_pk_bf16_f32 v124, v140, v141
  v_cvt_pk_bf16_f32 v125, v142, v143
  v_mfma_f32_16x16x32_bf16 v[160:163], v[108:111], a[228:231], v[160:163]
  v_cvt_pk_bf16_f32 v128, v144, v145
  v_cvt_pk_bf16_f32 v129, v146, v147
  v_mfma_f32_16x16x32_bf16 v[164:167], v[108:111], a[244:247], v[164:167]
  v_cvt_pk_bf16_f32 v132, v148, v149
  v_cvt_pk_bf16_f32 v133, v150, v151
  buffer_load_dwordx4 v[108:111], v21, s[28:31], s49 offen offset:1024 sc1
  v_mfma_f32_16x16x32_bf16 v[152:155], v[112:115], a[200:203], v[152:155]
  v_mfma_f32_16x16x32_bf16 v[156:159], v[112:115], a[216:219], v[156:159]
  v_mfma_f32_16x16x32_bf16 v[160:163], v[112:115], a[232:235], v[160:163]
  v_mfma_f32_16x16x32_bf16 v[164:167], v[112:115], a[248:251], v[164:167]
  buffer_load_dwordx4 v[112:115], v21, s[28:31], s49 offen offset:2048 sc1
  v_mfma_f32_16x16x32_bf16 v[152:155], v[116:119], a[204:207], v[152:155]
  v_mfma_f32_16x16x32_bf16 v[156:159], v[116:119], a[220:223], v[156:159]
  v_mfma_f32_16x16x32_bf16 v[160:163], v[116:119], a[236:239], v[160:163]
  v_mfma_f32_16x16x32_bf16 v[164:167], v[116:119], a[252:255], v[164:167]
  buffer_load_dwordx4 v[116:119], v21, s[28:31], s49 offen offset:3072 sc1
  v_cvt_pk_bf16_f32 v122, v152, v153
  v_cvt_pk_bf16_f32 v123, v154, v155
  v_cvt_pk_bf16_f32 v126, v156, v157
  v_cvt_pk_bf16_f32 v127, v158, v159
  v_cvt_pk_bf16_f32 v130, v160, v161
  v_cvt_pk_bf16_f32 v131, v162, v163
  s_nop 0
  v_cvt_pk_bf16_f32 v134, v164, v165
  v_cvt_pk_bf16_f32 v135, v166, v167
  s_add_u32 s49, s49, 262144
  s_nop 0
pollX_21:
  buffer_load_dwordx4 v[136:139], v184, s[28:31], s36 offen offset:0 sc1
  buffer_load_dwordx4 v[140:143], v185, s[28:31], s36 offen offset:0 sc1
  s_waitcnt vmcnt(0)
  v_max_u32 v248, v136, v140
  v_cmp_eq_u32 vcc, -1, v248
  s_cbranch_vccnz retry_22
  v_mfma_f32_16x16x32_bf16 v[144:147], v[180:183], v[136:139], 0
  v_mfma_f32_16x16x32_bf16 v[144:147], v[180:183], v[140:143], v[144:147]
  s_mov_b64 exec, s[76:77]
  s_nop 6
  v_cvt_pk_bf16_f32 v144, v144, v145
  v_cvt_pk_bf16_f32 v145, v146, v147
  v_min_u32 v144, -2, v144
  v_min_u32 v145, -2, v145
  buffer_store_dwordx2 v[144:145], v186, s[28:31], s38 offen
  s_mov_b64 exec, -1
  s_mov_b32 s41, s39
  s_add_u32 s23, s23, 1
  s_and_b32 s27, s23, 3
  s_lshl_b32 s24, s27, 18
  s_add_u32 s32, s42, s24
  s_add_u32 s33, s43, s24
  s_xor_b32 s24, s24, 524288
  s_add_u32 s34, s42, s24
  s_lshl_b32 s24, s27, 17
  s_add_u32 s35, s44, s24
  s_add_u32 s36, s45, s24
  s_xor_b32 s24, s24, 262144
  s_add_u32 s37, s44, s24
  s_add_u32 s27, s27, 1
  s_and_b32 s27, s27, 3
  s_lshl_b32 s24, s27, 17
  s_add_u32 s38, s46, s24
  s_add_u32 s39, s47, s24
  s_xor_b32 s24, s24, 262144
  s_add_u32 s40, s46, s24
  v_mov_b32 v44, 0
  v_mov_b32 v45, 0
  v_mov_b32 v46, 0
  v_mov_b32 v47, 0
  v_mov_b32 v48, 0
  v_mov_b32 v49, 0
  v_mov_b32 v50, 0
  v_mov_b32 v51, 0
  v_mov_b32 v52, 0
  v_mov_b32 v53, 0
  v_mov_b32 v54, 0
  v_mov_b32 v55, 0
  v_mov_b32 v56, 0
  v_mov_b32 v57, 0
  v_mov_b32 v58, 0
  v_mov_b32 v59, 0
  v_mov_b32 v60, 0
  v_mov_b32 v61, 0
  v_mov_b32 v62, 0
  v_mov_b32 v63, 0
  v_mov_b32 v64, 0
  v_mov_b32 v65, 0
  v_mov_b32 v66, 0
  v_mov_b32 v67, 0
  v_mov_b32 v212, 0
  v_mov_b32 v213, 0
  v_mov_b32 v214, 0
  v_mov_b32 v215, 0
  v_mov_b32 v216, 0
  v_mov_b32 v217, 0
  v_mov_b32 v218, 0
  v_mov_b32 v219, 0
  v_mov_b32 v220, 0
  v_mov_b32 v221, 0
  v_mov_b32 v222, 0
  v_mov_b32 v223, 0
  v_mov_b32 v224, 0
  v_mov_b32 v225, 0
  v_mov_b32 v226, 0
  v_mov_b32 v227, 0
  s_nop 1
pollB_23:
  buffer_load_dwordx4 v[28:31], v4, s[28:31], s41 offen offset:0 sc1
  buffer_load_dwordx4 v[32:35], v4, s[28:31], s41 offen offset:1024 sc1
  buffer_load_dwordx4 v[36:39], v4, s[28:31], s41 offen offset:2048 sc1
  buffer_load_dwordx4 v[40:43], v4, s[28:31], s41 offen offset:3072 sc1
  s_waitcnt vmcnt(0)
  v_max3_u32 v248, v28, v30, v32
  v_max3_u32 v248, v248, v34, v36
  v_max3_u32 v248, v248, v38, v40
  v_max_u32 v248, v248, v42
  v_cmp_eq_u32 vcc, -1, v248
  s_cbranch_vccnz retry_24
  s_branch chain_loop_7
retry_12:
  s_sub_u32 s26, s26, 1
  s_cbranch_scc1 L_exit
  s_branch pollA_11
retry_22:
  s_sub_u32 s26, s26, 1
  s_cbranch_scc1 L_exit
  s_branch pollX_21
retry_24:
  s_sub_u32 s26, s26, 1
  s_cbranch_scc1 L_exit
  s_branch pollB_23
kv_poll_19:
  s_add_u32 s25, s23, 2
  s_lshr_b32 s25, s25, 2
  s_min_u32 s25, s25, 15
  s_lshl_b32 s25, s25, 7
  s_add_u32 s25, s25, 99614720
  buffer_load_dword v252, v253, s[28:31], s25 offen sc1
  s_waitcnt vmcnt(0)
  v_readfirstlane_b32 s24, v252
  s_nop 3
  s_cmp_ge_u32 s24, 64
  s_cbranch_scc1 kv_ok_18
  s_sub_u32 s26, s26, 1
  s_cbranch_scc1 L_exit
  s_sleep 4
  s_branch kv_poll_19
pollV_13:
  buffer_load_dwordx4 v[192:195], v21, s[28:31], s33 offen offset:2048 sc1
  buffer_load_dwordx4 v[196:199], v21, s[28:31], s33 offen offset:3072 sc1
  s_waitcnt vmcnt(0)
  v_max3_u32 v249, v192, v193, v194
  v_max3_u32 v248, v195, v196, v197
  v_max3_u32 v249, v249, v198, v199
  v_max_u32 v249, v249, v248
  v_cmp_eq_u32 vcc, -1, v249
  s_cbranch_vccz pollV_back_14
  s_sub_u32 s26, s26, 1
  s_cbranch_scc1 L_exit
  s_branch pollV_13
last_10:
  s_cmp_lg_u32 s20, 0
  s_cbranch_scc1 last0_25
  s_not_b64 exec, s[58:59]
  buffer_store_dwordx4 v[76:79], v23, s[28:31], s50 offen sc1
  s_mov_b64 exec, -1
last0_25:
  s_cmp_lg_u32 s20, 1
  s_cbranch_scc1 last1_26
  buffer_store_dwordx2 v[84:85], v9, s[28:31], s50 offen sc1
last1_26:
  s_waitcnt vmcnt(0)
  s_barrier
  s_cmp_lg_u32 s20, 2
  s_cbranch_scc1 km_last_27
  s_sub_u32 s24, s23, 1
  s_lshl_b32 s25, s18, 6
  s_add_u32 s24, s24, s25
  s_add_u32 s24, s24, 448
  s_lshl_b32 s24, s24, 7
  s_lshl_b32 s25, s19, 2
  s_add_u32 s24, s24, s25
  s_add_u32 s24, s24, 99614720
  v_mov_b32 v248, 1
  s_mov_b64 exec, 1
  buffer_store_dword v248, v253, s[28:31], s24 offen sc1
  s_mov_b64 exec, -1
  s_mov_b32 s24, s23
  s_lshl_b32 s25, s18, 6
  s_add_u32 s24, s24, s25
  s_add_u32 s24, s24, 448
  s_lshl_b32 s24, s24, 7
  s_lshl_b32 s25, s19, 2
  s_add_u32 s24, s24, s25
  s_add_u32 s24, s24, 99614720
  v_mov_b32 v248, 1
  s_mov_b64 exec, 1
  buffer_store_dword v248, v253, s[28:31], s24 offen sc1
  s_mov_b64 exec, -1
  s_waitcnt vmcnt(0)
km_last_27:
  s_branch L_exit
chain_slow_4:
  s_nop 0
chain_loop_28:
  v_smfmac_f32_16x16x64_bf16 v[44:47], v[28:31], a[0:7], v19
  v_smfmac_f32_16x16x64_bf16 v[44:47], v[32:35], a[8:15], v19
  v_smfmac_f32_16x16x64_bf16 v[44:47], v[36:39], a[16:23], v19
  v_smfmac_f32_16x16x64_bf16 v[44:47], v[40:43], a[24:31], v19
  v_smfmac_f32_16x16x64_bf16 v[48:51], v[28:31], a[32:39], v19
  v_smfmac_f32_16x16x64_bf16 v[48:51], v[32:35], a[40:47], v19
  v_permlane32_swap_b32 v44, v45
  v_smfmac_f32_16x16x64_bf16 v[48:51], v[36:39], a[48:55], v19
  v_permlane32_swap_b32 v46, v47
  v_smfmac_f32_16x16x64_bf16 v[48:51], v[40:43], a[56:63], v19
  v_add_f32 v44, v44, v45
  v_add_f32 v46, v46, v47
  v_smfmac_f32_16x16x64_bf16 v[52:55], v[28:31], a[64:71], v19
  ds_write_b32 v5, v44 offset:0
  ds_write_b32 v5, v46 offset:800
  v_smfmac_f32_16x16x64_bf16 v[52:55], v[32:35], a[72:79], v19
  v_permlane32_swap_b32 v48, v49
  v_smfmac_f32_16x16x64_bf16 v[52:55], v[36:39], a[80:87], v19
  v_permlane32_swap_b32 v50, v51
  v_smfmac_f32_16x16x64_bf16 v[52:55], v[40:43], a[88:95], v19
  v_add_f32 v48, v48, v49
  v_add_f32 v50, v50, v51
  v_smfmac_f32_16x16x64_bf16 v[56:59], v[28:31], a[96:103], v19
  ds_write_b32 v5, v48 offset:64
  ds_write_b32 v5, v50 offset:864
  v_smfmac_f32_16x16x64_bf16 v[56:59], v[32:35], a[104:111], v19
  v_permlane32_swap_b32 v52, v53
  v_smfmac_f32_16x16x64_bf16 v[56:59], v[36:39], a[112:119], v19
  v_permlane32_swap_b32 v54, v55
  v_smfmac_f32_16x16x64_bf16 v[56:59], v[40:43], a[120:127], v19
  v_add_f32 v52, v52, v53
  v_add_f32 v54, v54, v55
  v_smfmac_f32_16x16x64_bf16 v[60:63], v[28:31], a[128:135], v19
  ds_write_b32 v5, v52 offset:128
  ds_write_b32 v5, v54 offset:928
  v_smfmac_f32_16x16x64_bf16 v[60:63], v[32:35], a[136:143], v19
  v_permlane32_swap_b32 v56, v57
  v_smfmac_f32_16x16x64_bf16 v[60:63], v[36:39], a[144:151], v19
  v_permlane32_swap_b32 v58, v59
  v_smfmac_f32_16x16x64_bf16 v[60:63], v[40:43], a[152:159], v19
  v_add_f32 v56, v56, v57
  v_add_f32 v58, v58, v59
  v_smfmac_f32_16x16x64_bf16 v[64:67], v[28:31], a[160:167], v19
  ds_write_b32 v5, v56 offset:192
  ds_write_b32 v5, v58 offset:992
  v_smfmac_f32_16x16x64_bf16 v[64:67], v[32:35], a[168:175], v19
  v_permlane32_swap_b32 v60, v61
  v_smfmac_f32_16x16x64_bf16 v[64:67], v[36:39], a[176:183], v19
  v_permlane32_swap_b32 v62, v63
  v_smfmac_f32_16x16x64_bf16 v[64:67], v[40:43], a[184:191], v19
  v_add_f32 v60, v60, v61
  v_add_f32 v62, v62, v63
  ds_write_b32 v5, v60 offset:256
  ds_write_b32 v5, v62 offset:1056
  s_nop 3
  v_permlane32_swap_b32 v64, v65
  v_permlane32_swap_b32 v66, v67
  v_add_f32 v64, v64, v65
  v_add_f32 v66, v66, v67
  ds_write_b32 v5, v64 offset:320
  ds_write_b32 v5, v66 offset:1120
  s_waitcnt lgkmcnt(0)
  s_barrier
  s_cmp_lg_u32 s20, 0
  s_cbranch_scc1 qk_skip_29
  ds_read_b128 v[136:139], v6 offset:0
  ds_read_b128 v[140:143], v6 offset:16
  ds_read_b128 v[144:147], v6 offset:3200
  ds_read_b128 v[148:151], v6 offset:3216
  ds_read_b128 v[152:155], v6 offset:6400
  ds_read_b128 v[156:159], v6 offset:6416
  ds_read_b128 v[160:163], v6 offset:9600
  ds_read_b128 v[164:167], v6 offset:9616
  v_add_u32 v2, 4096, v22
  s_waitcnt lgkmcnt(4)
  v_pk_add_f32 v[136:137], v[136:137], v[144:145]
  v_pk_add_f32 v[138:139], v[138:139], v[146:147]
  v_pk_add_f32 v[140:141], v[140:141], v[148:149]
  v_pk_add_f32 v[142:143], v[142:143], v[150:151]
  s_waitcnt lgkmcnt(0)
  v_pk_add_f32 v[152:153], v[152:153], v[160:161]
  v_pk_add_f32 v[154:155], v[154:155], v[162:163]
  v_pk_add_f32 v[156:157], v[156:157], v[164:165]
  v_pk_add_f32 v[158:159], v[158:159], v[166:167]
  v_pk_add_f32 v[136:137], v[136:137], v[152:153]
  v_pk_add_f32 v[138:139], v[138:139], v[154:155]
  v_pk_add_f32 v[140:141], v[140:141], v[156:157]
  v_pk_add_f32 v[142:143], v[142:143], v[158:159]
  v_cvt_pk_bf16_f32 v76, v136, v137
  v_cvt_pk_bf16_f32 v77, v138, v139
  v_cvt_pk_bf16_f32 v78, v140, v141
  v_cvt_pk_bf16_f32 v79, v142, v143
  s_nop 1
  v_mfma_f32_16x16x32_bf16 v[204:207], v[76:79], v[68:71], 0
  v_mov_b32_dpp v80, v76 row_ror:8 row_mask:0xf bank_mask:0xf
  v_mov_b32_dpp v81, v77 row_ror:8 row_mask:0xf bank_mask:0xf
  v_mov_b32_dpp v82, v78 row_ror:8 row_mask:0xf bank_mask:0xf
  v_mov_b32_dpp v83, v79 row_ror:8 row_mask:0xf bank_mask:0xf
  v_mfma_f32_16x16x32_bf16 v[208:211], v[76:79], v[72:75], 0
  v_mfma_f32_16x16x32_bf16 v[200:203], v[76:79], v[80:83], 0
  s_mov_b64 exec, s[76:77]
  v_cvt_pk_bf16_f32 v204, v204, v205
  v_cvt_pk_bf16_f32 v205, v206, v207
  v_min_u32 v204, -2, v204
  v_min_u32 v205, -2, v205
  buffer_store_dwordx2 v[204:205], v22, s[28:31], s32 offen offset:0 sc1
  v_cvt_pk_bf16_f32 v208, v208, v209
  v_cvt_pk_bf16_f32 v209, v210, v211
  v_min_u32 v208, -2, v208
  v_min_u32 v209, -2, v209
  buffer_store_dwordx2 v[208:209], v22, s[28:31], s32 offen offset:1024 sc1
  v_cvt_pk_bf16_f32 v200, v200, v201
  v_cvt_pk_bf16_f32 v201, v202, v203
  v_min_u32 v200, -2, v200
  v_min_u32 v201, -2, v201
  buffer_store_dwordx2 v[200:201], v22, s[28:31], s32 offen offset:2048 sc1
  s_mov_b64 exec, -1
  s_nop 0
qk_skip_29:
  s_cmp_lg_u32 s20, 1
  s_cbranch_scc1 v_skip_30
  ds_read_b128 v[136:139], v6 offset:0
  ds_read_b128 v[140:143], v6 offset:3200
  ds_read_b128 v[144:147], v6 offset:6400
  ds_read_b128 v[148:151], v6 offset:9600
  s_waitcnt lgkmcnt(2)
  v_pk_add_f32 v[136:137], v[136:137], v[140:141]
  v_pk_add_f32 v[138:139], v[138:139], v[142:143]
  s_waitcnt lgkmcnt(0)
  v_pk_add_f32 v[144:145], v[144:145], v[148:149]
  v_pk_add_f32 v[146:147], v[146:147], v[150:151]
  v_pk_add_f32 v[136:137], v[136:137], v[144:145]
  v_pk_add_f32 v[138:139], v[138:139], v[146:147]
  v_cvt_pk_bf16_f32 v84, v136, v137
  v_cvt_pk_bf16_f32 v85, v138, v139
  v_min_u32 v84, -2, v84
  v_min_u32 v85, -2, v85
  buffer_store_dword v84, v7, s[28:31], s32 offen sc1
  buffer_store_dword v85, v8, s[28:31], s32 offen sc1
v_skip_30:
  s_nop 0
  s_cmp_eq_u32 s23, 63
  s_cbranch_scc1 last_31
  s_barrier
pollA_32:
  buffer_load_dwordx4 v[168:171], v4, s[28:31], s33 offen offset:0 sc1
  buffer_load_dwordx4 v[172:175], v4, s[28:31], s33 offen offset:1024 sc1
  buffer_load_dwordx4 v[176:179], v4, s[28:31], s33 offen offset:2048 sc1
  s_nop 11
  buffer_load_dwordx4 v[192:195], v21, s[28:31], s33 offen offset:2048 sc1
  buffer_load_dwordx4 v[196:199], v21, s[28:31], s33 offen offset:3072 sc1
  s_waitcnt vmcnt(2)
  v_max3_u32 v248, v168, v170, v172
  v_max3_u32 v248, v248, v174, v176
  v_max_u32 v248, v248, v178
  v_cmp_eq_u32 vcc, -1, v248
  s_cbranch_vccnz retry_33
  v_mfma_f32_16x16x32_bf16 v[204:207], v[168:171], v[180:183], 0
  v_mfma_f32_16x16x32_bf16 v[208:211], v[172:175], v[180:183], 0
  v_mfma_f32_16x16x32_bf16 v[200:203], v[176:179], v[180:183], v[24:27]
  v_max3_f32 v248, v204, v205, v206
  s_nop 2
  v_max3_f32 v249, v207, v208, v209
  v_max3_f32 v248, v248, v210, v211
  s_nop 1
  v_max3_f32 v249, v249, v200, v201
  v_max3_f32 v248, v248, v202, v203
  v_max_f32 v244, v248, v249
  v_mov_b32 v248, v244
  s_nop 1
  v_permlane32_swap_b32 v244, v248
  v_max_f32 v244, v244, v248
  v_mov_b32 v248, v244
  s_nop 1
  v_permlane16_swap_b32 v244, v248
  v_max_f32 v244, v244, v248
  v_mul_f32 v244, s54, v244
  v_pk_fma_f32 v[200:201], v[200:201], s[54:55], v[244:245] op_sel_hi:[1,1,0] neg_lo:[0,0,1] neg_hi:[0,0,1]
  v_pk_fma_f32 v[202:203], v[202:203], s[54:55], v[244:245] op_sel_hi:[1,1,0] neg_lo:[0,0,1] neg_hi:[0,0,1]
  v_pk_fma_f32 v[204:205], v[204:205], s[54:55], v[244:245] op_sel_hi:[1,1,0] neg_lo:[0,0,1] neg_hi:[0,0,1]
  v_pk_fma_f32 v[206:207], v[206:207], s[54:55], v[244:245] op_sel_hi:[1,1,0] neg_lo:[0,0,1] neg_hi:[0,0,1]
  v_pk_fma_f32 v[208:209], v[208:209], s[54:55], v[244:245] op_sel_hi:[1,1,0] neg_lo:[0,0,1] neg_hi:[0,0,1]
  v_pk_fma_f32 v[210:211], v[210:211], s[54:55], v[244:245] op_sel_hi:[1,1,0] neg_lo:[0,0,1] neg_hi:[0,0,1]
  s_waitcnt vmcnt(0)
  v_max3_u32 v249, v192, v193, v194
  v_max3_u32 v248, v195, v196, v197
  v_max3_u32 v249, v249, v198, v199
  v_max_u32 v249, v249, v248
  v_cmp_eq_u32 vcc, -1, v249
  s_cbranch_vccnz pollV_34
pollV_back_35:
  buffer_load_dword v243, v4, s[28:31], s66 offen sc1
  s_add_u32 s66, s66, 262144
  v_smfmac_f32_16x16x64_bf16 v[212:215], v[192:195], a[192:199], v19
  v_exp_f32 v204, v204
  v_smfmac_f32_16x16x64_bf16 v[212:215], v[196:199], a[200:207], v19
  v_exp_f32 v205, v205
  v_smfmac_f32_16x16x64_bf16 v[216:219], v[192:195], a[208:215], v19
  v_exp_f32 v206, v206
  v_smfmac_f32_16x16x64_bf16 v[216:219], v[196:199], a[216:223], v19
  v_exp_f32 v207, v207
  v_smfmac_f32_16x16x64_bf16 v[220:223], v[192:195], a[224:231], v19
  v_exp_f32 v208, v208
  v_smfmac_f32_16x16x64_bf16 v[220:223], v[196:199], a[232:239], v19
  v_exp_f32 v209, v209
  v_smfmac_f32_16x16x64_bf16 v[224:227], v[192:195], a[240:247], v19
  v_exp_f32 v210, v210
  v_smfmac_f32_16x16x64_bf16 v[224:227], v[196:199], a[248:255], v19
  v_exp_f32 v211, v211
  v_exp_f32 v200, v200
  v_exp_f32 v201, v201
  v_exp_f32 v202, v202
  v_exp_f32 v203, v203
  v_cvt_pk_bf16_f32 v236, v204, v205
  v_cvt_pk_bf16_f32 v237, v206, v207
  v_cvt_pk_bf16_f32 v238, v208, v209
  v_cvt_pk_bf16_f32 v239, v210, v211
  v_cvt_pk_bf16_f32 v240, v200, v201
  v_cvt_pk_bf16_f32 v241, v202, v203
  v_mfma_f32_16x16x32_bf16 v[136:139], v[120:123], v[236:239], 0
  v_mov_b32 v248, v240
  v_mov_b32 v249, v241
  v_mfma_f32_16x16x32_bf16 v[140:143], v[124:127], v[236:239], 0
  v_permlane32_swap_b32 v240, v248
  v_permlane32_swap_b32 v241, v249
  v_mfma_f32_16x16x32_bf16 v[144:147], v[128:131], v[236:239], 0
  v_cvt_pk_bf16_f32 v228, v212, v213
  v_cvt_pk_bf16_f32 v229, v214, v215
  v_cvt_pk_bf16_f32 v230, v216, v217
  v_cvt_pk_bf16_f32 v231, v218, v219
  v_mfma_f32_16x16x32_bf16 v[148:151], v[132:135], v[236:239], 0
  v_cvt_pk_bf16_f32 v232, v220, v221
  v_cvt_pk_bf16_f32 v233, v222, v223
  v_cvt_pk_bf16_f32 v234, v224, v225
  v_cvt_pk_bf16_f32 v235, v226, v227
  v_mfma_f32_16x16x16_bf16 v[136:139], v[228:229], v[240:241], v[136:139]
  v_pk_add_f32 v[200:201], v[200:201], v[202:203]
  v_pk_add_f32 v[204:205], v[204:205], v[206:207]
  v_mfma_f32_16x16x16_bf16 v[140:143], v[230:231], v[240:241], v[140:143]
  v_pk_add_f32 v[208:209], v[208:209], v[210:211]
  v_pk_add_f32 v[200:201], v[200:201], v[204:205]
  v_mfma_f32_16x16x16_bf16 v[144:147], v[232:233], v[240:241], v[144:147]
  v_pk_add_f32 v[200:201], v[200:201], v[208:209]
  v_add_f32 v245, v200, v201
  v_mfma_f32_16x16x16_bf16 v[148:151], v[234:235], v[240:241], v[148:151]
  v_mov_b32 v248, v245
  s_nop 1
  v_permlane32_swap_b32 v245, v248
  v_add_f32 v245, v245, v248
  v_mov_b32 v248, v245
  s_nop 1
  v_permlane16_swap_b32 v245, v248
  v_add_f32 v245, v245, v248
  v_rcp_f32 v246, v245
  v_cndmask_b32 v136, v144, v136, s[58:59]
  v_cndmask_b32 v137, v145, v137, s[58:59]
  v_cndmask_b32 v138, v146, v138, s[58:59]
  v_cndmask_b32 v139, v147, v139, s[58:59]
  v_pk_mul_f32 v[136:137], v[136:137], v[246:247] op_sel_hi:[1,0]
  v_pk_mul_f32 v[138:139], v[138:139], v[246:247] op_sel_hi:[1,0]
  ds_write_b128 v10, v[136:139] offset:0
  v_cndmask_b32 v140, v148, v140, s[58:59]
  v_cndmask_b32 v141, v149, v141, s[58:59]
  v_cndmask_b32 v142, v150, v142, s[58:59]
  v_cndmask_b32 v143, v151, v143, s[58:59]
  v_pk_mul_f32 v[140:141], v[140:141], v[246:247] op_sel_hi:[1,0]
  v_pk_mul_f32 v[142:143], v[142:143], v[246:247] op_sel_hi:[1,0]
  ds_write_b128 v10, v[140:143] offset:64
  s_waitcnt lgkmcnt(0)
  s_barrier
  ds_read_b64 v[136:137], v11 offset:0
  ds_read_b64 v[138:139], v11 offset:2176
  ds_read_b64 v[140:141], v11 offset:4352
  ds_read_b64 v[142:143], v11 offset:6528
  s_waitcnt lgkmcnt(2)
  v_pk_add_f32 v[136:137], v[136:137], v[138:139]
  s_waitcnt lgkmcnt(0)
  v_pk_add_f32 v[140:141], v[140:141], v[142:143]
  v_pk_add_f32 v[136:137], v[136:137], v[140:141]
  v_cvt_pk_bf16_f32 v136, v136, v137
  v_min_u32 v136, -2, v136
  buffer_store_dword v136, v16, s[28:31], s35 offen sc1
  buffer_store_dword v20, v16, s[28:31], s37 offen sc1
  s_cmp_lg_u32 s20, 0
  s_cbranch_scc1 w0_skip_36
  s_mov_b64 exec, s[76:77]
  buffer_store_dwordx2 v[12:13], v22, s[28:31], s34 offen offset:0 sc1
  buffer_store_dwordx2 v[12:13], v22, s[28:31], s34 offen offset:1024 sc1
  buffer_store_dwordx2 v[12:13], v22, s[28:31], s34 offen offset:2048 sc1
  s_not_b64 exec, s[58:59]
  buffer_store_dwordx4 v[76:79], v23, s[28:31], s50 offen sc1
  s_mov_b64 exec, -1
w0_skip_36:
  s_cmp_lg_u32 s20, 1
  s_cbranch_scc1 w1_skip_37
  buffer_store_dword v20, v7, s[28:31], s34 offen sc1
  buffer_store_dword v20, v8, s[28:31], s34 offen sc1
  buffer_store_dwordx2 v[84:85], v9, s[28:31], s50 offen sc1
w1_skip_37:
  s_cmp_lg_u32 s20, 2
  s_cbranch_scc1 w2_skip_38
  s_cmp_eq_u32 s23, 0
  s_cbranch_scc1 w2_skip_38
  s_sub_u32 s24, s23, 1
  s_lshl_b32 s25, s18, 6
  s_add_u32 s24, s24, s25
  s_add_u32 s24, s24, 448
  s_lshl_b32 s24, s24, 7
  s_lshl_b32 s25, s19, 2
  s_add_u32 s24, s24, s25
  s_add_u32 s24, s24, 99614720
  v_mov_b32 v248, 1
  s_mov_b64 exec, 1
  buffer_store_dword v248, v253, s[28:31], s24 offen sc1
  s_mov_b64 exec, -1
w2_skip_38:
  s_nop 0
  buffer_store_dword v20, v18, s[28:31], s40 offen sc1
  s_add_u32 s50, s50, 131072
  v_readfirstlane_b32 s24, v252
  s_nop 3
  s_cmp_lt_u32 s24, 64
  s_cbranch_scc1 kv_poll_40
kv_ok_39:
  s_add_u32 s51, s23, 3
  s_lshr_b32 s51, s51, 2
  s_min_u32 s51, s51, 15
  s_lshl_b32 s51, s51, 7
  s_add_u32 s51, s51, 99614720
  s_cmp_lg_u32 s20, 0
  s_cbranch_scc1 ks_skip_41
  buffer_load_dwordx4 v[68:71], v4, s[28:31], s48 offen offset:0 sc1
  buffer_load_dwordx4 v[72:75], v21, s[28:31], s48 offen offset:0 sc1
ks_skip_41:
  s_add_u32 s48, s48, 262144
  buffer_load_dword v252, v253, s[28:31], s51 offen sc1
  v_mfma_f32_16x16x32_bf16 v[136:139], v[88:91], a[192:195], 0
  v_mfma_f32_16x16x32_bf16 v[140:143], v[88:91], a[208:211], 0
  v_mfma_f32_16x16x32_bf16 v[144:147], v[88:91], a[224:227], 0
  v_mfma_f32_16x16x32_bf16 v[148:151], v[88:91], a[240:243], 0
  buffer_load_dwordx4 v[88:91], v4, s[28:31], s49 offen offset:0 sc1
  v_mfma_f32_16x16x32_bf16 v[136:139], v[92:95], a[196:199], v[136:139]
  v_mfma_f32_16x16x32_bf16 v[140:143], v[92:95], a[212:215], v[140:143]
  v_mfma_f32_16x16x32_bf16 v[144:147], v[92:95], a[228:231], v[144:147]
  v_mfma_f32_16x16x32_bf16 v[148:151], v[92:95], a[244:247], v[148:151]
  buffer_load_dwordx4 v[92:95], v4, s[28:31], s49 offen offset:1024 sc1
  v_mfma_f32_16x16x32_bf16 v[136:139], v[96:99], a[200:203], v[136:139]
  v_mfma_f32_16x16x32_bf16 v[140:143], v[96:99], a[216:219], v[140:143]
  v_mfma_f32_16x16x32_bf16 v[144:147], v[96:99], a[232:235], v[144:147]
  v_mfma_f32_16x16x32_bf16 v[148:151], v[96:99], a[248:251], v[148:151]
  buffer_load_dwordx4 v[96:99], v4, s[28:31], s49 offen offset:2048 sc1
  v_mfma_f32_16x16x32_bf16 v[136:139], v[100:103], a[204:207], v[136:139]
  v_mfma_f32_16x16x32_bf16 v[140:143], v[100:103], a[220:223], v[140:143]
  v_mfma_f32_16x16x32_bf16 v[144:147], v[100:103], a[236:239], v[144:147]
  v_mfma_f32_16x16x32_bf16 v[148:151], v[100:103], a[252:255], v[148:151]
  buffer_load_dwordx4 v[100:103], v4, s[28:31], s49 offen offset:3072 sc1
  v_mfma_f32_16x16x32_bf16 v[152:155], v[104:107], a[192:195], 0
  v_mfma_f32_16x16x32_bf16 v[156:159], v[104:107], a[208:211], 0
  v_mfma_f32_16x16x32_bf16 v[160:163], v[104:107], a[224:227], 0
  v_mfma_f32_16x16x32_bf16 v[164:167], v[104:107], a[240:243], 0
  buffer_load_dwordx4 v[104:107], v21, s[28:31], s49 offen offset:0 sc1
  v_mfma_f32_16x16x32_bf16 v[152:155], v[108:111], a[196:199], v[152:155]
  v_cvt_pk_bf16_f32 v120, v136, v137
  v_cvt_pk_bf16_f32 v121, v138, v139
  v_mfma_f32_16x16x32_bf16 v[156:159], v[108:111], a[212:215], v[156:159]
  v_cvt_pk_bf16_f32 v124, v140, v141
  v_cvt_pk_bf16_f32 v125, v142, v143
  v_mfma_f32_16x16x32_bf16 v[160:163], v[108:111], a[228:231], v[160:163]
  v_cvt_pk_bf16_f32 v128, v144, v145
  v_cvt_pk_bf16_f32 v129, v146, v147
  v_mfma_f32_16x16x32_bf16 v[164:167], v[108:111], a[244:247], v[164:167]
  v_cvt_pk_bf16_f32 v132, v148, v149
  v_cvt_pk_bf16_f32 v133, v150, v151
  buffer_load_dwordx4 v[108:111], v21, s[28:31], s49 offen offset:1024 sc1
  v_mfma_f32_16x16x32_bf16 v[152:155], v[112:115], a[200:203], v[152:155]
  v_mfma_f32_16x16x32_bf16 v[156:159], v[112:115], a[216:219], v[156:159]
  v_mfma_f32_16x16x32_bf16 v[160:163], v[112:115], a[232:235], v[160:163]
  v_mfma_f32_16x16x32_bf16 v[164:167], v[112:115], a[248:251], v[164:167]
  buffer_load_dwordx4 v[112:115], v21, s[28:31], s49 offen offset:2048 sc1
  v_mfma_f32_16x16x32_bf16 v[152:155], v[116:119], a[204:207], v[152:155]
  v_mfma_f32_16x16x32_bf16 v[156:159], v[116:119], a[220:223], v[156:159]
  v_mfma_f32_16x16x32_bf16 v[160:163], v[116:119], a[236:239], v[160:163]
  v_mfma_f32_16x16x32_bf16 v[164:167], v[116:119], a[252:255], v[164:167]
  buffer_load_dwordx4 v[116:119], v21, s[28:31], s49 offen offset:3072 sc1
  v_cvt_pk_bf16_f32 v122, v152, v153
  v_cvt_pk_bf16_f32 v123, v154, v155
  v_cvt_pk_bf16_f32 v126, v156, v157
  v_cvt_pk_bf16_f32 v127, v158, v159
  v_cvt_pk_bf16_f32 v130, v160, v161
  v_cvt_pk_bf16_f32 v131, v162, v163
  s_nop 0
  v_cvt_pk_bf16_f32 v134, v164, v165
  v_cvt_pk_bf16_f32 v135, v166, v167
  s_add_u32 s49, s49, 262144
  s_nop 0
pollX_42:
  buffer_load_dwordx4 v[136:139], v184, s[28:31], s36 offen offset:0 sc1
  buffer_load_dwordx4 v[140:143], v185, s[28:31], s36 offen offset:0 sc1
  s_waitcnt vmcnt(0)
  v_max_u32 v248, v136, v140
  v_cmp_eq_u32 vcc, -1, v248
  s_cbranch_vccnz retry_43
  v_mfma_f32_16x16x32_bf16 v[144:147], v[180:183], v[136:139], 0
  v_mfma_f32_16x16x32_bf16 v[144:147], v[180:183], v[140:143], v[144:147]
  s_mov_b64 exec, s[76:77]
  s_nop 6
  v_cvt_pk_bf16_f32 v144, v144, v145
  v_cvt_pk_bf16_f32 v145, v146, v147
  v_min_u32 v144, -2, v144
  v_min_u32 v145, -2, v145
  buffer_store_dwordx2 v[144:145], v186, s[28:31], s38 offen sc1
  s_mov_b64 exec, -1
  s_mov_b32 s41, s39
  s_add_u32 s23, s23, 1
  s_and_b32 s27, s23, 3
  s_lshl_b32 s24, s27, 18
  s_add_u32 s32, s42, s24
  s_add_u32 s33, s43, s24
  s_xor_b32 s24, s24, 524288
  s_add_u32 s34, s42, s24
  s_lshl_b32 s24, s27, 17
  s_add_u32 s35, s44, s24
  s_add_u32 s36, s45, s24
  s_xor_b32 s24, s24, 262144
  s_add_u32 s37, s44, s24
  s_add_u32 s27, s27, 1
  s_and_b32 s27, s27, 3
  s_lshl_b32 s24, s27, 17
  s_add_u32 s38, s46, s24
  s_add_u32 s39, s47, s24
  s_xor_b32 s24, s24, 262144
  s_add_u32 s40, s46, s24
  v_mov_b32 v44, 0
  v_mov_b32 v45, 0
  v_mov_b32 v46, 0
  v_mov_b32 v47, 0
  v_mov_b32 v48, 0
  v_mov_b32 v49, 0
  v_mov_b32 v50, 0
  v_mov_b32 v51, 0
  v_mov_b32 v52, 0
  v_mov_b32 v53, 0
  v_mov_b32 v54, 0
  v_mov_b32 v55, 0
  v_mov_b32 v56, 0
  v_mov_b32 v57, 0
  v_mov_b32 v58, 0
  v_mov_b32 v59, 0
  v_mov_b32 v60, 0
  v_mov_b32 v61, 0
  v_mov_b32 v62, 0
  v_mov_b32 v63, 0
  v_mov_b32 v64, 0
  v_mov_b32 v65, 0
  v_mov_b32 v66, 0
  v_mov_b32 v67, 0
  v_mov_b32 v212, 0
  v_mov_b32 v213, 0
  v_mov_b32 v214, 0
  v_mov_b32 v215, 0
  v_mov_b32 v216, 0
  v_mov_b32 v217, 0
  v_mov_b32 v218, 0
  v_mov_b32 v219, 0
  v_mov_b32 v220, 0
  v_mov_b32 v221, 0
  v_mov_b32 v222, 0
  v_mov_b32 v223, 0
  v_mov_b32 v224, 0
  v_mov_b32 v225, 0
  v_mov_b32 v226, 0
  v_mov_b32 v227, 0
  s_nop 1
pollB_44:
  buffer_load_dwordx4 v[28:31], v4, s[28:31], s41 offen offset:0 sc1
  buffer_load_dwordx4 v[32:35], v4, s[28:31], s41 offen offset:1024 sc1
  buffer_load_dwordx4 v[36:39], v4, s[28:31], s41 offen offset:2048 sc1
  buffer_load_dwordx4 v[40:43], v4, s[28:31], s41 offen offset:3072 sc1
  s_waitcnt vmcnt(0)
  v_max3_u32 v248, v28, v30, v32
  v_max3_u32 v248, v248, v34, v36
  v_max3_u32 v248, v248, v38, v40
  v_max_u32 v248, v248, v42
  v_cmp_eq_u32 vcc, -1, v248
  s_cbranch_vccnz retry_45
  s_branch chain_loop_28
retry_33:
  s_sub_u32 s26, s26, 1
  s_cbranch_scc1 L_exit
  s_branch pollA_32
retry_43:
  s_sub_u32 s26, s26, 1
  s_cbranch_scc1 L_exit
  s_branch pollX_42
retry_45:
  s_sub_u32 s26, s26, 1
  s_cbranch_scc1 L_exit
  s_branch pollB_44
kv_poll_40:
  s_add_u32 s25, s23, 2
  s_lshr_b32 s25, s25, 2
  s_min_u32 s25, s25, 15
  s_lshl_b32 s25, s25, 7
  s_add_u32 s25, s25, 99614720
  buffer_load_dword v252, v253, s[28:31], s25 offen sc1
  s_waitcnt vmcnt(0)
  v_readfirstlane_b32 s24, v252
  s_nop 3
  s_cmp_ge_u32 s24, 64
  s_cbranch_scc1 kv_ok_39
  s_sub_u32 s26, s26, 1
  s_cbranch_scc1 L_exit
  s_sleep 4
  s_branch kv_poll_40
pollV_34:
  buffer_load_dwordx4 v[192:195], v21, s[28:31], s33 offen offset:2048 sc1
  buffer_load_dwordx4 v[196:199], v21, s[28:31], s33 offen offset:3072 sc1
  s_waitcnt vmcnt(0)
  v_max3_u32 v249, v192, v193, v194
  v_max3_u32 v248, v195, v196, v197
  v_max3_u32 v249, v249, v198, v199
  v_max_u32 v249, v249, v248
  v_cmp_eq_u32 vcc, -1, v249
  s_cbranch_vccz pollV_back_35
  s_sub_u32 s26, s26, 1
  s_cbranch_scc1 L_exit
  s_branch pollV_34
last_31:
  s_cmp_lg_u32 s20, 0
  s_cbranch_scc1 last0_46
  s_not_b64 exec, s[58:59]
  buffer_store_dwordx4 v[76:79], v23, s[28:31], s50 offen sc1
  s_mov_b64 exec, -1
last0_46:
  s_cmp_lg_u32 s20, 1
  s_cbranch_scc1 last1_47
  buffer_store_dwordx2 v[84:85], v9, s[28:31], s50 offen sc1
last1_47:
  s_waitcnt vmcnt(0)
  s_barrier
  s_cmp_lg_u32 s20, 2
  s_cbranch_scc1 km_last_48
  s_sub_u32 s24, s23, 1
  s_lshl_b32 s25, s18, 6
  s_add_u32 s24, s24, s25
  s_add_u32 s24, s24, 448
  s_lshl_b32 s24, s24, 7
  s_lshl_b32 s25, s19, 2
  s_add_u32 s24, s24, s25
  s_add_u32 s24, s24, 99614720
  v_mov_b32 v248, 1
  s_mov_b64 exec, 1
  buffer_store_dword v248, v253, s[28:31], s24 offen sc1
  s_mov_b64 exec, -1
  s_mov_b32 s24, s23
  s_lshl_b32 s25, s18, 6
  s_add_u32 s24, s24, s25
  s_add_u32 s24, s24, 448
  s_lshl_b32 s24, s24, 7
  s_lshl_b32 s25, s19, 2
  s_add_u32 s24, s24, s25
  s_add_u32 s24, s24, 99614720
  v_mov_b32 v248, 1
  s_mov_b64 exec, 1
  buffer_store_dword v248, v253, s[28:31], s24 offen sc1
  s_mov_b64 exec, -1
  s_waitcnt vmcnt(0)
km_last_48:
  s_branch L_exit
L_worker:
  s_nop 0
  s_load_dwordx2 s[72:73], s[0:1], 0
  s_load_dwordx2 s[76:77], s[0:1], 112
  s_load_dwordx2 s[80:81], s[0:1], 104
  v_lshrrev_b32 v98, 6, v0
  v_and_b32 v96, 63, v0
  v_readfirstlane_b32 s84, v98
  s_mov_b32 s88, 0x3a800000
  s_mov_b32 s92, 0x3727c5ac
  v_lshlrev_b32 v97, 4, v96
  s_waitcnt lgkmcnt(0)
  s_mov_b32 s74, 4194304
  s_mov_b32 s75, 0x20000
  s_mov_b32 s78, 268435456
  s_mov_b32 s79, 0x20000
  s_mov_b32 s82, 256
  s_mov_b32 s83, 0x20000
  s_lshl_b32 s85, s3, 4
  s_lshl_b32 s86, s84, 2
  s_add_u32 s85, s85, s86
  s_lshl_b32 s85, s85, 11
  s_add_u32 s86, s85, 4096
  buffer_load_dwordx4 v[104:107], v97, s[72:75], s85 offen offset:0
  buffer_load_dwordx4 v[108:111], v97, s[72:75], s85 offen offset:1024
  buffer_load_dwordx4 v[112:115], v97, s[72:75], s85 offen offset:2048
  buffer_load_dwordx4 v[116:119], v97, s[72:75], s85 offen offset:3072
  buffer_load_dwordx4 v[120:123], v97, s[72:75], s86 offen offset:0
  buffer_load_dwordx4 v[124:127], v97, s[72:75], s86 offen offset:1024
  buffer_load_dwordx4 v[128:131], v97, s[72:75], s86 offen offset:2048
  buffer_load_dwordx4 v[132:135], v97, s[72:75], s86 offen offset:3072
  v_mov_b32 v200, -1
  v_mov_b32 v201, -1
  v_mov_b32 v202, -1
  v_mov_b32 v203, -1
  v_lshlrev_b32 v98, 4, v0
  s_lshl_b32 s86, s3, 13
  s_add_u32 s86, s86, 96468992
  buffer_store_dwordx4 v[200:203], v98, s[76:79], s86 offen sc1
  s_add_u32 s86, s86, 4096
  buffer_store_dwordx4 v[200:203], v98, s[76:79], s86 offen sc1
  s_lshl_b32 s86, s3, 12
  s_add_u32 s87, s86, 97517568
  buffer_store_dwordx4 v[200:203], v98, s[76:79], s87 offen sc1
  s_add_u32 s87, s86, 98566144
  buffer_store_dwordx4 v[200:203], v98, s[76:79], s87 offen sc1
  v_mov_b32 v204, 0
  s_nop 0
  v_lshlrev_b32 v98, 2, v0
  s_lshl_b32 s86, s3, 10
  s_add_u32 s86, s86, 99614720
  buffer_store_dword v204, v98, s[76:79], s86 offen sc1
  s_waitcnt vmcnt(5)
  v_lshlrev_b32 v136, 16, v104
  v_and_b32 v137, 0xffff0000, v104
  v_lshlrev_b32 v138, 16, v105
  v_and_b32 v139, 0xffff0000, v105
  v_lshlrev_b32 v140, 16, v106
  v_and_b32 v141, 0xffff0000, v106
  v_lshlrev_b32 v142, 16, v107
  v_and_b32 v143, 0xffff0000, v107
  v_lshlrev_b32 v144, 16, v108
  v_and_b32 v145, 0xffff0000, v108
  v_lshlrev_b32 v146, 16, v109
  v_and_b32 v147, 0xffff0000, v109
  v_lshlrev_b32 v148, 16, v110
  v_and_b32 v149, 0xffff0000, v110
  v_lshlrev_b32 v150, 16, v111
  v_and_b32 v151, 0xffff0000, v111
  v_lshlrev_b32 v152, 16, v112
  v_and_b32 v153, 0xffff0000, v112
  v_lshlrev_b32 v154, 16, v113
  v_and_b32 v155, 0xffff0000, v113
  v_lshlrev_b32 v156, 16, v114
  v_and_b32 v157, 0xffff0000, v114
  v_lshlrev_b32 v158, 16, v115
  v_and_b32 v159, 0xffff0000, v115
  v_lshlrev_b32 v160, 16, v116
  v_and_b32 v161, 0xffff0000, v116
  v_lshlrev_b32 v162, 16, v117
  v_and_b32 v163, 0xffff0000, v117
  v_lshlrev_b32 v164, 16, v118
  v_and_b32 v165, 0xffff0000, v118
  v_lshlrev_b32 v166, 16, v119
  v_and_b32 v167, 0xffff0000, v119
  v_lshlrev_b32 v208, 16, v120
  v_and_b32 v209, 0xffff0000, v120
  v_lshlrev_b32 v210, 16, v121
  v_and_b32 v211, 0xffff0000, v121
  v_lshlrev_b32 v212, 16, v122
  v_and_b32 v213, 0xffff0000, v122
  v_lshlrev_b32 v214, 16, v123
  v_and_b32 v215, 0xffff0000, v123
  v_lshlrev_b32 v216, 16, v124
  v_and_b32 v217, 0xffff0000, v124
  v_lshlrev_b32 v218, 16, v125
  v_and_b32 v219, 0xffff0000, v125
  v_lshlrev_b32 v220, 16, v126
  v_and_b32 v221, 0xffff0000, v126
  v_lshlrev_b32 v222, 16, v127
  v_and_b32 v223, 0xffff0000, v127
  v_lshlrev_b32 v224, 16, v128
  v_and_b32 v225, 0xffff0000, v128
  v_lshlrev_b32 v226, 16, v129
  v_and_b32 v227, 0xffff0000, v129
  v_lshlrev_b32 v228, 16, v130
  v_and_b32 v229, 0xffff0000, v130
  v_lshlrev_b32 v230, 16, v131
  v_and_b32 v231, 0xffff0000, v131
  v_lshlrev_b32 v232, 16, v132
  v_and_b32 v233, 0xffff0000, v132
  v_lshlrev_b32 v234, 16, v133
  v_and_b32 v235, 0xffff0000, v133
  v_lshlrev_b32 v236, 16, v134
  v_and_b32 v237, 0xffff0000, v134
  v_lshlrev_b32 v238, 16, v135
  v_and_b32 v239, 0xffff0000, v135
  s_add_u32 s86, s85, 0
  v_pk_add_f32 v[168:169], v[136:137], v[138:139]
  v_pk_add_f32 v[184:185], v[152:153], v[154:155]
  v_pk_add_f32 v[168:169], v[168:169], v[140:141]
  v_pk_add_f32 v[184:185], v[184:185], v[156:157]
  v_pk_add_f32 v[168:169], v[168:169], v[142:143]
  v_pk_add_f32 v[184:185], v[184:185], v[158:159]
  v_pk_add_f32 v[168:169], v[168:169], v[144:145]
  v_pk_add_f32 v[184:185], v[184:185], v[160:161]
  v_pk_add_f32 v[168:169], v[168:169], v[146:147]
  v_pk_add_f32 v[184:185], v[184:185], v[162:163]
  v_pk_add_f32 v[168:169], v[168:169], v[148:149]
  v_pk_add_f32 v[184:185], v[184:185], v[164:165]
  v_pk_add_f32 v[168:169], v[168:169], v[150:151]
  v_pk_add_f32 v[184:185], v[184:185], v[166:167]
  v_add_f32 v168, v168, v169
  v_add_f32 v184, v184, v185
  s_nop 0
  v_add_f32_dpp v168, v168, v168 quad_perm:[1,0,3,2] row_mask:0xf bank_mask:0xf
  v_add_f32_dpp v184, v184, v184 quad_perm:[1,0,3,2] row_mask:0xf bank_mask:0xf
  s_nop 0
  v_add_f32_dpp v168, v168, v168 quad_perm:[2,3,0,1] row_mask:0xf bank_mask:0xf
  v_add_f32_dpp v184, v184, v184 quad_perm:[2,3,0,1] row_mask:0xf bank_mask:0xf
  s_nop 0
  v_add_f32_dpp v168, v168, v168 row_half_mirror row_mask:0xf bank_mask:0xf
  v_add_f32_dpp v184, v184, v184 row_half_mirror row_mask:0xf bank_mask:0xf
  s_nop 0
  v_add_f32_dpp v168, v168, v168 row_mirror row_mask:0xf bank_mask:0xf
  v_add_f32_dpp v184, v184, v184 row_mirror row_mask:0xf bank_mask:0xf
  v_mov_b32 v170, v168
  v_mov_b32 v186, v184
  s_nop 0
  v_permlane16_swap_b32 v168, v170
  v_permlane16_swap_b32 v184, v186
  v_add_f32 v168, v168, v170
  v_add_f32 v184, v184, v186
  v_mov_b32 v170, v168
  v_mov_b32 v186, v184
  s_nop 0
  v_permlane32_swap_b32 v168, v170
  v_permlane32_swap_b32 v184, v186
  v_add_f32 v168, v168, v170
  v_add_f32 v184, v184, v186
  v_mul_f32 v172, s88, v168
  v_mul_f32 v188, s88, v184
  v_pk_add_f32 v[170:171], v[136:137], v[172:173] op_sel_hi:[1,0] neg_lo:[0,1] neg_hi:[0,1]
  v_pk_add_f32 v[186:187], v[152:153], v[188:189] op_sel_hi:[1,0] neg_lo:[0,1] neg_hi:[0,1]
  v_pk_mul_f32 v[168:169], v[170:171], v[170:171]
  v_pk_mul_f32 v[184:185], v[186:187], v[186:187]
  v_pk_add_f32 v[170:171], v[138:139], v[172:173] op_sel_hi:[1,0] neg_lo:[0,1] neg_hi:[0,1]
  v_pk_add_f32 v[186:187], v[154:155], v[188:189] op_sel_hi:[1,0] neg_lo:[0,1] neg_hi:[0,1]
  v_pk_fma_f32 v[168:169], v[170:171], v[170:171], v[168:169]
  v_pk_fma_f32 v[184:185], v[186:187], v[186:187], v[184:185]
  v_pk_add_f32 v[170:171], v[140:141], v[172:173] op_sel_hi:[1,0] neg_lo:[0,1] neg_hi:[0,1]
  v_pk_add_f32 v[186:187], v[156:157], v[188:189] op_sel_hi:[1,0] neg_lo:[0,1] neg_hi:[0,1]
  v_pk_fma_f32 v[168:169], v[170:171], v[170:171], v[168:169]
  v_pk_fma_f32 v[184:185], v[186:187], v[186:187], v[184:185]
  v_pk_add_f32 v[170:171], v[142:143], v[172:173] op_sel_hi:[1,0] neg_lo:[0,1] neg_hi:[0,1]
  v_pk_add_f32 v[186:187], v[158:159], v[188:189] op_sel_hi:[1,0] neg_lo:[0,1] neg_hi:[0,1]
  v_pk_fma_f32 v[168:169], v[170:171], v[170:171], v[168:169]
  v_pk_fma_f32 v[184:185], v[186:187], v[186:187], v[184:185]
  v_pk_add_f32 v[170:171], v[144:145], v[172:173] op_sel_hi:[1,0] neg_lo:[0,1] neg_hi:[0,1]
  v_pk_add_f32 v[186:187], v[160:161], v[188:189] op_sel_hi:[1,0] neg_lo:[0,1] neg_hi:[0,1]
  v_pk_fma_f32 v[168:169], v[170:171], v[170:171], v[168:169]
  v_pk_fma_f32 v[184:185], v[186:187], v[186:187], v[184:185]
  v_pk_add_f32 v[170:171], v[146:147], v[172:173] op_sel_hi:[1,0] neg_lo:[0,1] neg_hi:[0,1]
  v_pk_add_f32 v[186:187], v[162:163], v[188:189] op_sel_hi:[1,0] neg_lo:[0,1] neg_hi:[0,1]
  v_pk_fma_f32 v[168:169], v[170:171], v[170:171], v[168:169]
  v_pk_fma_f32 v[184:185], v[186:187], v[186:187], v[184:185]
  v_pk_add_f32 v[170:171], v[148:149], v[172:173] op_sel_hi:[1,0] neg_lo:[0,1] neg_hi:[0,1]
  v_pk_add_f32 v[186:187], v[164:165], v[188:189] op_sel_hi:[1,0] neg_lo:[0,1] neg_hi:[0,1]
  v_pk_fma_f32 v[168:169], v[170:171], v[170:171], v[168:169]
  v_pk_fma_f32 v[184:185], v[186:187], v[186:187], v[184:185]
  v_pk_add_f32 v[170:171], v[150:151], v[172:173] op_sel_hi:[1,0] neg_lo:[0,1] neg_hi:[0,1]
  v_pk_add_f32 v[186:187], v[166:167], v[188:189] op_sel_hi:[1,0] neg_lo:[0,1] neg_hi:[0,1]
  v_pk_fma_f32 v[168:169], v[170:171], v[170:171], v[168:169]
  v_pk_fma_f32 v[184:185], v[186:187], v[186:187], v[184:185]
  v_add_f32 v168, v168, v169
  v_add_f32 v184, v184, v185
  s_nop 0
  v_add_f32_dpp v168, v168, v168 quad_perm:[1,0,3,2] row_mask:0xf bank_mask:0xf
  v_add_f32_dpp v184, v184, v184 quad_perm:[1,0,3,2] row_mask:0xf bank_mask:0xf
  s_nop 0
  v_add_f32_dpp v168, v168, v168 quad_perm:[2,3,0,1] row_mask:0xf bank_mask:0xf
  v_add_f32_dpp v184, v184, v184 quad_perm:[2,3,0,1] row_mask:0xf bank_mask:0xf
  s_nop 0
  v_add_f32_dpp v168, v168, v168 row_half_mirror row_mask:0xf bank_mask:0xf
  v_add_f32_dpp v184, v184, v184 row_half_mirror row_mask:0xf bank_mask:0xf
  s_nop 0
  v_add_f32_dpp v168, v168, v168 row_mirror row_mask:0xf bank_mask:0xf
  v_add_f32_dpp v184, v184, v184 row_mirror row_mask:0xf bank_mask:0xf
  v_mov_b32 v170, v168
  v_mov_b32 v186, v184
  s_nop 0
  v_permlane16_swap_b32 v168, v170
  v_permlane16_swap_b32 v184, v186
  v_add_f32 v168, v168, v170
  v_add_f32 v184, v184, v186
  v_mov_b32 v170, v168
  v_mov_b32 v186, v184
  s_nop 0
  v_permlane32_swap_b32 v168, v170
  v_permlane32_swap_b32 v184, v186
  v_add_f32 v168, v168, v170
  v_add_f32 v184, v184, v186
  v_mul_f32 v168, s88, v168
  v_mul_f32 v184, s88, v184
  v_cvt_pk_bf16_f32 v170, v168, v168
  v_cvt_pk_bf16_f32 v186, v184, v184
  v_lshlrev_b32 v168, 16, v170
  v_lshlrev_b32 v184, 16, v186
  v_add_f32 v168, s92, v168
  v_add_f32 v184, s92, v184
  v_cvt_pk_bf16_f32 v170, v168, v168
  v_cvt_pk_bf16_f32 v186, v184, v184
  v_lshlrev_b32 v168, 16, v170
  v_lshlrev_b32 v184, 16, v186
  v_sqrt_f32 v168, v168
  v_sqrt_f32 v184, v184
  v_cvt_pk_bf16_f32 v170, v168, v168
  v_cvt_pk_bf16_f32 v186, v184, v184
  v_lshlrev_b32 v168, 16, v170
  v_lshlrev_b32 v184, 16, v186
  v_rcp_f32 v168, v168
  v_rcp_f32 v184, v184
  v_cvt_pk_bf16_f32 v170, v172, v172
  v_cvt_pk_bf16_f32 v186, v188, v188
  v_lshlrev_b32 v172, 16, v170
  v_lshlrev_b32 v188, 16, v186
  v_pk_add_f32 v[136:137], v[136:137], v[172:173] op_sel_hi:[1,0] neg_lo:[0,1] neg_hi:[0,1]
  v_pk_add_f32 v[152:153], v[152:153], v[188:189] op_sel_hi:[1,0] neg_lo:[0,1] neg_hi:[0,1]
  v_cvt_pk_bf16_f32 v170, v136, v137
  v_cvt_pk_bf16_f32 v186, v152, v153
  v_lshlrev_b32 v136, 16, v170
  v_lshlrev_b32 v152, 16, v186
  v_and_b32 v137, 0xffff0000, v170
  v_and_b32 v153, 0xffff0000, v186
  v_pk_mul_f32 v[136:137], v[136:137], v[168:169] op_sel_hi:[1,0]
  v_pk_mul_f32 v[152:153], v[152:153], v[184:185] op_sel_hi:[1,0]
  v_cvt_pk_bf16_f32 v176, v136, v137
  v_cvt_pk_bf16_f32 v192, v152, v153
  v_pk_add_f32 v[138:139], v[138:139], v[172:173] op_sel_hi:[1,0] neg_lo:[0,1] neg_hi:[0,1]
  v_pk_add_f32 v[154:155], v[154:155], v[188:189] op_sel_hi:[1,0] neg_lo:[0,1] neg_hi:[0,1]
  v_cvt_pk_bf16_f32 v170, v138, v139
  v_cvt_pk_bf16_f32 v186, v154, v155
  v_lshlrev_b32 v138, 16, v170
  v_lshlrev_b32 v154, 16, v186
  v_and_b32 v139, 0xffff0000, v170
  v_and_b32 v155, 0xffff0000, v186
  v_pk_mul_f32 v[138:139], v[138:139], v[168:169] op_sel_hi:[1,0]
  v_pk_mul_f32 v[154:155], v[154:155], v[184:185] op_sel_hi:[1,0]
  v_cvt_pk_bf16_f32 v177, v138, v139
  v_cvt_pk_bf16_f32 v193, v154, v155
  v_pk_add_f32 v[140:141], v[140:141], v[172:173] op_sel_hi:[1,0] neg_lo:[0,1] neg_hi:[0,1]
  v_pk_add_f32 v[156:157], v[156:157], v[188:189] op_sel_hi:[1,0] neg_lo:[0,1] neg_hi:[0,1]
  v_cvt_pk_bf16_f32 v170, v140, v141
  v_cvt_pk_bf16_f32 v186, v156, v157
  v_lshlrev_b32 v140, 16, v170
  v_lshlrev_b32 v156, 16, v186
  v_and_b32 v141, 0xffff0000, v170
  v_and_b32 v157, 0xffff0000, v186
  v_pk_mul_f32 v[140:141], v[140:141], v[168:169] op_sel_hi:[1,0]
  v_pk_mul_f32 v[156:157], v[156:157], v[184:185] op_sel_hi:[1,0]
  v_cvt_pk_bf16_f32 v178, v140, v141
  v_cvt_pk_bf16_f32 v194, v156, v157
  v_pk_add_f32 v[142:143], v[142:143], v[172:173] op_sel_hi:[1,0] neg_lo:[0,1] neg_hi:[0,1]
  v_pk_add_f32 v[158:159], v[158:159], v[188:189] op_sel_hi:[1,0] neg_lo:[0,1] neg_hi:[0,1]
  v_cvt_pk_bf16_f32 v170, v142, v143
  v_cvt_pk_bf16_f32 v186, v158, v159
  v_lshlrev_b32 v142, 16, v170
  v_lshlrev_b32 v158, 16, v186
  v_and_b32 v143, 0xffff0000, v170
  v_and_b32 v159, 0xffff0000, v186
  v_pk_mul_f32 v[142:143], v[142:143], v[168:169] op_sel_hi:[1,0]
  v_pk_mul_f32 v[158:159], v[158:159], v[184:185] op_sel_hi:[1,0]
  v_cvt_pk_bf16_f32 v179, v142, v143
  v_cvt_pk_bf16_f32 v195, v158, v159
  v_pk_add_f32 v[144:145], v[144:145], v[172:173] op_sel_hi:[1,0] neg_lo:[0,1] neg_hi:[0,1]
  v_pk_add_f32 v[160:161], v[160:161], v[188:189] op_sel_hi:[1,0] neg_lo:[0,1] neg_hi:[0,1]
  v_cvt_pk_bf16_f32 v170, v144, v145
  v_cvt_pk_bf16_f32 v186, v160, v161
  v_lshlrev_b32 v144, 16, v170
  v_lshlrev_b32 v160, 16, v186
  v_and_b32 v145, 0xffff0000, v170
  v_and_b32 v161, 0xffff0000, v186
  v_pk_mul_f32 v[144:145], v[144:145], v[168:169] op_sel_hi:[1,0]
  v_pk_mul_f32 v[160:161], v[160:161], v[184:185] op_sel_hi:[1,0]
  v_cvt_pk_bf16_f32 v180, v144, v145
  v_cvt_pk_bf16_f32 v196, v160, v161
  v_pk_add_f32 v[146:147], v[146:147], v[172:173] op_sel_hi:[1,0] neg_lo:[0,1] neg_hi:[0,1]
  v_pk_add_f32 v[162:163], v[162:163], v[188:189] op_sel_hi:[1,0] neg_lo:[0,1] neg_hi:[0,1]
  v_cvt_pk_bf16_f32 v170, v146, v147
  v_cvt_pk_bf16_f32 v186, v162, v163
  v_lshlrev_b32 v146, 16, v170
  v_lshlrev_b32 v162, 16, v186
  v_and_b32 v147, 0xffff0000, v170
  v_and_b32 v163, 0xffff0000, v186
  v_pk_mul_f32 v[146:147], v[146:147], v[168:169] op_sel_hi:[1,0]
  v_pk_mul_f32 v[162:163], v[162:163], v[184:185] op_sel_hi:[1,0]
  v_cvt_pk_bf16_f32 v181, v146, v147
  v_cvt_pk_bf16_f32 v197, v162, v163
  v_pk_add_f32 v[148:149], v[148:149], v[172:173] op_sel_hi:[1,0] neg_lo:[0,1] neg_hi:[0,1]
  v_pk_add_f32 v[164:165], v[164:165], v[188:189] op_sel_hi:[1,0] neg_lo:[0,1] neg_hi:[0,1]
  v_cvt_pk_bf16_f32 v170, v148, v149
  v_cvt_pk_bf16_f32 v186, v164, v165
  v_lshlrev_b32 v148, 16, v170
  v_lshlrev_b32 v164, 16, v186
  v_and_b32 v149, 0xffff0000, v170
  v_and_b32 v165, 0xffff0000, v186
  v_pk_mul_f32 v[148:149], v[148:149], v[168:169] op_sel_hi:[1,0]
  v_pk_mul_f32 v[164:165], v[164:165], v[184:185] op_sel_hi:[1,0]
  v_cvt_pk_bf16_f32 v182, v148, v149
  v_cvt_pk_bf16_f32 v198, v164, v165
  v_pk_add_f32 v[150:151], v[150:151], v[172:173] op_sel_hi:[1,0] neg_lo:[0,1] neg_hi:[0,1]
  v_pk_add_f32 v[166:167], v[166:167], v[188:189] op_sel_hi:[1,0] neg_lo:[0,1] neg_hi:[0,1]
  v_cvt_pk_bf16_f32 v170, v150, v151
  v_cvt_pk_bf16_f32 v186, v166, v167
  v_lshlrev_b32 v150, 16, v170
  v_lshlrev_b32 v166, 16, v186
  v_and_b32 v151, 0xffff0000, v170
  v_and_b32 v167, 0xffff0000, v186
  v_pk_mul_f32 v[150:151], v[150:151], v[168:169] op_sel_hi:[1,0]
  v_pk_mul_f32 v[166:167], v[166:167], v[184:185] op_sel_hi:[1,0]
  v_cvt_pk_bf16_f32 v183, v150, v151
  v_cvt_pk_bf16_f32 v199, v166, v167
  buffer_store_dwordx4 v[176:179], v97, s[76:79], s86 offen offset:0 sc1
  buffer_store_dwordx4 v[180:183], v97, s[76:79], s86 offen offset:1024 sc1
  buffer_store_dwordx4 v[192:195], v97, s[76:79], s86 offen offset:2048 sc1
  buffer_store_dwordx4 v[196:199], v97, s[76:79], s86 offen offset:3072 sc1
  s_nop 1
  s_add_u32 s86, s85, 4096
  v_pk_add_f32 v[168:169], v[208:209], v[210:211]
  v_pk_add_f32 v[184:185], v[224:225], v[226:227]
  v_pk_add_f32 v[168:169], v[168:169], v[212:213]
  v_pk_add_f32 v[184:185], v[184:185], v[228:229]
  v_pk_add_f32 v[168:169], v[168:169], v[214:215]
  v_pk_add_f32 v[184:185], v[184:185], v[230:231]
  v_pk_add_f32 v[168:169], v[168:169], v[216:217]
  v_pk_add_f32 v[184:185], v[184:185], v[232:233]
  v_pk_add_f32 v[168:169], v[168:169], v[218:219]
  v_pk_add_f32 v[184:185], v[184:185], v[234:235]
  v_pk_add_f32 v[168:169], v[168:169], v[220:221]
  v_pk_add_f32 v[184:185], v[184:185], v[236:237]
  v_pk_add_f32 v[168:169], v[168:169], v[222:223]
  v_pk_add_f32 v[184:185], v[184:185], v[238:239]
  v_add_f32 v168, v168, v169
  v_add_f32 v184, v184, v185
  s_nop 0
  v_add_f32_dpp v168, v168, v168 quad_perm:[1,0,3,2] row_mask:0xf bank_mask:0xf
  v_add_f32_dpp v184, v184, v184 quad_perm:[1,0,3,2] row_mask:0xf bank_mask:0xf
  s_nop 0
  v_add_f32_dpp v168, v168, v168 quad_perm:[2,3,0,1] row_mask:0xf bank_mask:0xf
  v_add_f32_dpp v184, v184, v184 quad_perm:[2,3,0,1] row_mask:0xf bank_mask:0xf
  s_nop 0
  v_add_f32_dpp v168, v168, v168 row_half_mirror row_mask:0xf bank_mask:0xf
  v_add_f32_dpp v184, v184, v184 row_half_mirror row_mask:0xf bank_mask:0xf
  s_nop 0
  v_add_f32_dpp v168, v168, v168 row_mirror row_mask:0xf bank_mask:0xf
  v_add_f32_dpp v184, v184, v184 row_mirror row_mask:0xf bank_mask:0xf
  v_mov_b32 v170, v168
  v_mov_b32 v186, v184
  s_nop 0
  v_permlane16_swap_b32 v168, v170
  v_permlane16_swap_b32 v184, v186
  v_add_f32 v168, v168, v170
  v_add_f32 v184, v184, v186
  v_mov_b32 v170, v168
  v_mov_b32 v186, v184
  s_nop 0
  v_permlane32_swap_b32 v168, v170
  v_permlane32_swap_b32 v184, v186
  v_add_f32 v168, v168, v170
  v_add_f32 v184, v184, v186
  v_mul_f32 v172, s88, v168
  v_mul_f32 v188, s88, v184
  v_pk_add_f32 v[170:171], v[208:209], v[172:173] op_sel_hi:[1,0] neg_lo:[0,1] neg_hi:[0,1]
  v_pk_add_f32 v[186:187], v[224:225], v[188:189] op_sel_hi:[1,0] neg_lo:[0,1] neg_hi:[0,1]
  v_pk_mul_f32 v[168:169], v[170:171], v[170:171]
  v_pk_mul_f32 v[184:185], v[186:187], v[186:187]
  v_pk_add_f32 v[170:171], v[210:211], v[172:173] op_sel_hi:[1,0] neg_lo:[0,1] neg_hi:[0,1]
  v_pk_add_f32 v[186:187], v[226:227], v[188:189] op_sel_hi:[1,0] neg_lo:[0,1] neg_hi:[0,1]
  v_pk_fma_f32 v[168:169], v[170:171], v[170:171], v[168:169]
  v_pk_fma_f32 v[184:185], v[186:187], v[186:187], v[184:185]
  v_pk_add_f32 v[170:171], v[212:213], v[172:173] op_sel_hi:[1,0] neg_lo:[0,1] neg_hi:[0,1]
  v_pk_add_f32 v[186:187], v[228:229], v[188:189] op_sel_hi:[1,0] neg_lo:[0,1] neg_hi:[0,1]
  v_pk_fma_f32 v[168:169], v[170:171], v[170:171], v[168:169]
  v_pk_fma_f32 v[184:185], v[186:187], v[186:187], v[184:185]
  v_pk_add_f32 v[170:171], v[214:215], v[172:173] op_sel_hi:[1,0] neg_lo:[0,1] neg_hi:[0,1]
  v_pk_add_f32 v[186:187], v[230:231], v[188:189] op_sel_hi:[1,0] neg_lo:[0,1] neg_hi:[0,1]
  v_pk_fma_f32 v[168:169], v[170:171], v[170:171], v[168:169]
  v_pk_fma_f32 v[184:185], v[186:187], v[186:187], v[184:185]
  v_pk_add_f32 v[170:171], v[216:217], v[172:173] op_sel_hi:[1,0] neg_lo:[0,1] neg_hi:[0,1]
  v_pk_add_f32 v[186:187], v[232:233], v[188:189] op_sel_hi:[1,0] neg_lo:[0,1] neg_hi:[0,1]
  v_pk_fma_f32 v[168:169], v[170:171], v[170:171], v[168:169]
  v_pk_fma_f32 v[184:185], v[186:187], v[186:187], v[184:185]
  v_pk_add_f32 v[170:171], v[218:219], v[172:173] op_sel_hi:[1,0] neg_lo:[0,1] neg_hi:[0,1]
  v_pk_add_f32 v[186:187], v[234:235], v[188:189] op_sel_hi:[1,0] neg_lo:[0,1] neg_hi:[0,1]
  v_pk_fma_f32 v[168:169], v[170:171], v[170:171], v[168:169]
  v_pk_fma_f32 v[184:185], v[186:187], v[186:187], v[184:185]
  v_pk_add_f32 v[170:171], v[220:221], v[172:173] op_sel_hi:[1,0] neg_lo:[0,1] neg_hi:[0,1]
  v_pk_add_f32 v[186:187], v[236:237], v[188:189] op_sel_hi:[1,0] neg_lo:[0,1] neg_hi:[0,1]
  v_pk_fma_f32 v[168:169], v[170:171], v[170:171], v[168:169]
  v_pk_fma_f32 v[184:185], v[186:187], v[186:187], v[184:185]
  v_pk_add_f32 v[170:171], v[222:223], v[172:173] op_sel_hi:[1,0] neg_lo:[0,1] neg_hi:[0,1]
  v_pk_add_f32 v[186:187], v[238:239], v[188:189] op_sel_hi:[1,0] neg_lo:[0,1] neg_hi:[0,1]
  v_pk_fma_f32 v[168:169], v[170:171], v[170:171], v[168:169]
  v_pk_fma_f32 v[184:185], v[186:187], v[186:187], v[184:185]
  v_add_f32 v168, v168, v169
  v_add_f32 v184, v184, v185
  s_nop 0
  v_add_f32_dpp v168, v168, v168 quad_perm:[1,0,3,2] row_mask:0xf bank_mask:0xf
  v_add_f32_dpp v184, v184, v184 quad_perm:[1,0,3,2] row_mask:0xf bank_mask:0xf
  s_nop 0
  v_add_f32_dpp v168, v168, v168 quad_perm:[2,3,0,1] row_mask:0xf bank_mask:0xf
  v_add_f32_dpp v184, v184, v184 quad_perm:[2,3,0,1] row_mask:0xf bank_mask:0xf
  s_nop 0
  v_add_f32_dpp v168, v168, v168 row_half_mirror row_mask:0xf bank_mask:0xf
  v_add_f32_dpp v184, v184, v184 row_half_mirror row_mask:0xf bank_mask:0xf
  s_nop 0
  v_add_f32_dpp v168, v168, v168 row_mirror row_mask:0xf bank_mask:0xf
  v_add_f32_dpp v184, v184, v184 row_mirror row_mask:0xf bank_mask:0xf
  v_mov_b32 v170, v168
  v_mov_b32 v186, v184
  s_nop 0
  v_permlane16_swap_b32 v168, v170
  v_permlane16_swap_b32 v184, v186
  v_add_f32 v168, v168, v170
  v_add_f32 v184, v184, v186
  v_mov_b32 v170, v168
  v_mov_b32 v186, v184
  s_nop 0
  v_permlane32_swap_b32 v168, v170
  v_permlane32_swap_b32 v184, v186
  v_add_f32 v168, v168, v170
  v_add_f32 v184, v184, v186
  v_mul_f32 v168, s88, v168
  v_mul_f32 v184, s88, v184
  v_cvt_pk_bf16_f32 v170, v168, v168
  v_cvt_pk_bf16_f32 v186, v184, v184
  v_lshlrev_b32 v168, 16, v170
  v_lshlrev_b32 v184, 16, v186
  v_add_f32 v168, s92, v168
  v_add_f32 v184, s92, v184
  v_cvt_pk_bf16_f32 v170, v168, v168
  v_cvt_pk_bf16_f32 v186, v184, v184
  v_lshlrev_b32 v168, 16, v170
  v_lshlrev_b32 v184, 16, v186
  v_sqrt_f32 v168, v168
  v_sqrt_f32 v184, v184
  v_cvt_pk_bf16_f32 v170, v168, v168
  v_cvt_pk_bf16_f32 v186, v184, v184
  v_lshlrev_b32 v168, 16, v170
  v_lshlrev_b32 v184, 16, v186
  v_rcp_f32 v168, v168
  v_rcp_f32 v184, v184
  v_cvt_pk_bf16_f32 v170, v172, v172
  v_cvt_pk_bf16_f32 v186, v188, v188
  v_lshlrev_b32 v172, 16, v170
  v_lshlrev_b32 v188, 16, v186
  v_pk_add_f32 v[208:209], v[208:209], v[172:173] op_sel_hi:[1,0] neg_lo:[0,1] neg_hi:[0,1]
  v_pk_add_f32 v[224:225], v[224:225], v[188:189] op_sel_hi:[1,0] neg_lo:[0,1] neg_hi:[0,1]
  v_cvt_pk_bf16_f32 v170, v208, v209
  v_cvt_pk_bf16_f32 v186, v224, v225
  v_lshlrev_b32 v208, 16, v170
  v_lshlrev_b32 v224, 16, v186
  v_and_b32 v209, 0xffff0000, v170
  v_and_b32 v225, 0xffff0000, v186
  v_pk_mul_f32 v[208:209], v[208:209], v[168:169] op_sel_hi:[1,0]
  v_pk_mul_f32 v[224:225], v[224:225], v[184:185] op_sel_hi:[1,0]
  v_cvt_pk_bf16_f32 v176, v208, v209
  v_cvt_pk_bf16_f32 v192, v224, v225
  v_pk_add_f32 v[210:211], v[210:211], v[172:173] op_sel_hi:[1,0] neg_lo:[0,1] neg_hi:[0,1]
  v_pk_add_f32 v[226:227], v[226:227], v[188:189] op_sel_hi:[1,0] neg_lo:[0,1] neg_hi:[0,1]
  v_cvt_pk_bf16_f32 v170, v210, v211
  v_cvt_pk_bf16_f32 v186, v226, v227
  v_lshlrev_b32 v210, 16, v170
  v_lshlrev_b32 v226, 16, v186
  v_and_b32 v211, 0xffff0000, v170
  v_and_b32 v227, 0xffff0000, v186
  v_pk_mul_f32 v[210:211], v[210:211], v[168:169] op_sel_hi:[1,0]
  v_pk_mul_f32 v[226:227], v[226:227], v[184:185] op_sel_hi:[1,0]
  v_cvt_pk_bf16_f32 v177, v210, v211
  v_cvt_pk_bf16_f32 v193, v226, v227
  v_pk_add_f32 v[212:213], v[212:213], v[172:173] op_sel_hi:[1,0] neg_lo:[0,1] neg_hi:[0,1]
  v_pk_add_f32 v[228:229], v[228:229], v[188:189] op_sel_hi:[1,0] neg_lo:[0,1] neg_hi:[0,1]
  v_cvt_pk_bf16_f32 v170, v212, v213
  v_cvt_pk_bf16_f32 v186, v228, v229
  v_lshlrev_b32 v212, 16, v170
  v_lshlrev_b32 v228, 16, v186
  v_and_b32 v213, 0xffff0000, v170
  v_and_b32 v229, 0xffff0000, v186
  v_pk_mul_f32 v[212:213], v[212:213], v[168:169] op_sel_hi:[1,0]
  v_pk_mul_f32 v[228:229], v[228:229], v[184:185] op_sel_hi:[1,0]
  v_cvt_pk_bf16_f32 v178, v212, v213
  v_cvt_pk_bf16_f32 v194, v228, v229
  v_pk_add_f32 v[214:215], v[214:215], v[172:173] op_sel_hi:[1,0] neg_lo:[0,1] neg_hi:[0,1]
  v_pk_add_f32 v[230:231], v[230:231], v[188:189] op_sel_hi:[1,0] neg_lo:[0,1] neg_hi:[0,1]
  v_cvt_pk_bf16_f32 v170, v214, v215
  v_cvt_pk_bf16_f32 v186, v230, v231
  v_lshlrev_b32 v214, 16, v170
  v_lshlrev_b32 v230, 16, v186
  v_and_b32 v215, 0xffff0000, v170
  v_and_b32 v231, 0xffff0000, v186
  v_pk_mul_f32 v[214:215], v[214:215], v[168:169] op_sel_hi:[1,0]
  v_pk_mul_f32 v[230:231], v[230:231], v[184:185] op_sel_hi:[1,0]
  v_cvt_pk_bf16_f32 v179, v214, v215
  v_cvt_pk_bf16_f32 v195, v230, v231
  v_pk_add_f32 v[216:217], v[216:217], v[172:173] op_sel_hi:[1,0] neg_lo:[0,1] neg_hi:[0,1]
  v_pk_add_f32 v[232:233], v[232:233], v[188:189] op_sel_hi:[1,0] neg_lo:[0,1] neg_hi:[0,1]
  v_cvt_pk_bf16_f32 v170, v216, v217
  v_cvt_pk_bf16_f32 v186, v232, v233
  v_lshlrev_b32 v216, 16, v170
  v_lshlrev_b32 v232, 16, v186
  v_and_b32 v217, 0xffff0000, v170
  v_and_b32 v233, 0xffff0000, v186
  v_pk_mul_f32 v[216:217], v[216:217], v[168:169] op_sel_hi:[1,0]
  v_pk_mul_f32 v[232:233], v[232:233], v[184:185] op_sel_hi:[1,0]
  v_cvt_pk_bf16_f32 v180, v216, v217
  v_cvt_pk_bf16_f32 v196, v232, v233
  v_pk_add_f32 v[218:219], v[218:219], v[172:173] op_sel_hi:[1,0] neg_lo:[0,1] neg_hi:[0,1]
  v_pk_add_f32 v[234:235], v[234:235], v[188:189] op_sel_hi:[1,0] neg_lo:[0,1] neg_hi:[0,1]
  v_cvt_pk_bf16_f32 v170, v218, v219
  v_cvt_pk_bf16_f32 v186, v234, v235
  v_lshlrev_b32 v218, 16, v170
  v_lshlrev_b32 v234, 16, v186
  v_and_b32 v219, 0xffff0000, v170
  v_and_b32 v235, 0xffff0000, v186
  v_pk_mul_f32 v[218:219], v[218:219], v[168:169] op_sel_hi:[1,0]
  v_pk_mul_f32 v[234:235], v[234:235], v[184:185] op_sel_hi:[1,0]
  v_cvt_pk_bf16_f32 v181, v218, v219
  v_cvt_pk_bf16_f32 v197, v234, v235
  v_pk_add_f32 v[220:221], v[220:221], v[172:173] op_sel_hi:[1,0] neg_lo:[0,1] neg_hi:[0,1]
  v_pk_add_f32 v[236:237], v[236:237], v[188:189] op_sel_hi:[1,0] neg_lo:[0,1] neg_hi:[0,1]
  v_cvt_pk_bf16_f32 v170, v220, v221
  v_cvt_pk_bf16_f32 v186, v236, v237
  v_lshlrev_b32 v220, 16, v170
  v_lshlrev_b32 v236, 16, v186
  v_and_b32 v221, 0xffff0000, v170
  v_and_b32 v237, 0xffff0000, v186
  v_pk_mul_f32 v[220:221], v[220:221], v[168:169] op_sel_hi:[1,0]
  v_pk_mul_f32 v[236:237], v[236:237], v[184:185] op_sel_hi:[1,0]
  v_cvt_pk_bf16_f32 v182, v220, v221
  v_cvt_pk_bf16_f32 v198, v236, v237
  v_pk_add_f32 v[222:223], v[222:223], v[172:173] op_sel_hi:[1,0] neg_lo:[0,1] neg_hi:[0,1]
  v_pk_add_f32 v[238:239], v[238:239], v[188:189] op_sel_hi:[1,0] neg_lo:[0,1] neg_hi:[0,1]
  v_cvt_pk_bf16_f32 v170, v222, v223
  v_cvt_pk_bf16_f32 v186, v238, v239
  v_lshlrev_b32 v222, 16, v170
  v_lshlrev_b32 v238, 16, v186
  v_and_b32 v223, 0xffff0000, v170
  v_and_b32 v239, 0xffff0000, v186
  v_pk_mul_f32 v[222:223], v[222:223], v[168:169] op_sel_hi:[1,0]
  v_pk_mul_f32 v[238:239], v[238:239], v[184:185] op_sel_hi:[1,0]
  v_cvt_pk_bf16_f32 v183, v222, v223
  v_cvt_pk_bf16_f32 v199, v238, v239
  buffer_store_dwordx4 v[176:179], v97, s[76:79], s86 offen offset:0 sc1
  buffer_store_dwordx4 v[180:183], v97, s[76:79], s86 offen offset:1024 sc1
  buffer_store_dwordx4 v[192:195], v97, s[76:79], s86 offen offset:2048 sc1
  buffer_store_dwordx4 v[196:199], v97, s[76:79], s86 offen offset:3072 sc1
  s_nop 1
  s_waitcnt vmcnt(0)
  s_barrier
  s_cmp_lg_u32 s84, 0
  s_cbranch_scc1 p0s_49
  s_and_b32 s86, s3, 3
  s_lshl_b32 s86, s86, 6
  s_add_u32 s86, s86, 0
  v_mov_b32 v98, 1
  v_mov_b32 v99, 0
  s_mov_b64 exec, 1
  buffer_atomic_add v98, v99, s[80:83], s86 offen sc1
  s_cmp_ge_u32 s3, 8
  s_cbranch_scc1 p0s_49_x
  s_mov_b32 s86, 32
  buffer_atomic_add v98, v99, s[80:83], s86 offen sc1
p0s_49_x:
  s_mov_b64 exec, -1
p0s_49:
  s_nop 0
  s_mov_b32 s90, 0x100000
  s_cmp_lt_u32 s3, 64
  s_cbranch_scc1 L_early
  v_lshlrev_b32 v98, 2, v96
  v_lshrrev_b32 v99, 6, v0
  s_mov_b32 s85, 0x10001
  v_readfirstlane_b32 s87, v99
  s_nop 3
  s_cmp_lg_u32 s87, 0
  s_cbranch_scc1 p0w_50_ok
p0w_50:
  buffer_load_dword v99, v98, s[80:83], 0 offen sc1
  s_waitcnt vmcnt(0)
  v_cmp_ne_u32 vcc, 32, v99
  s_nop 3
  s_and_b32 vcc_lo, vcc_lo, s85
  s_and_b32 vcc_hi, vcc_hi, s85
  s_or_b32 s87, vcc_lo, vcc_hi
  s_cmp_eq_u32 s87, 0
  s_cbranch_scc1 p0w_50_ok
  s_sub_u32 s90, s90, 1
  s_cselect_b32 s90, 0, s90
  s_cbranch_scc1 p0w_50_ok
  s_sleep 4
  s_branch p0w_50
p0w_50_ok:
  s_barrier
  s_nop 0
  s_branch L_p0done
L_early:
  v_mov_b32 v98, 32
  s_cmp_lg_u32 s84, 0
  s_cbranch_scc1 p0e_51_ok
p0e_51:
  buffer_load_dword v99, v98, s[80:83], 0 offen sc1
  s_waitcnt vmcnt(0)
  v_readfirstlane_b32 s87, v99
  s_nop 3
  s_cmp_ge_u32 s87, 8
  s_cbranch_scc1 p0e_51_ok
  s_sub_u32 s90, s90, 1
  s_cselect_b32 s90, 0, s90
  s_cbranch_scc1 p0e_51_ok
  s_sleep 2
  s_branch p0e_51
p0e_51_ok:
  s_barrier
  s_nop 0
L_p0done:
  s_load_dwordx2 s[4:5], s[0:1], 0
  s_load_dwordx2 s[6:7], s[0:1], 16
  s_load_dwordx2 s[8:9], s[0:1], 24
  s_load_dwordx2 s[10:11], s[0:1], 32
  s_load_dwordx2 s[12:13], s[0:1], 40
  s_load_dwordx2 s[14:15], s[0:1], 112
  s_load_dwordx2 s[16:17], s[0:1], 64
  s_load_dwordx2 s[18:19], s[0:1], 72
  s_load_dwordx2 s[20:21], s[0:1], 80
  s_load_dwordx2 s[22:23], s[0:1], 88
  s_load_dwordx2 s[24:25], s[0:1], 96
  s_getpc_b64 s[26:27]
Lpc:
  s_lshl_b32 s3, s3, 7
  s_add_u32 s26, s26, sched_table-Lpc
  s_addc_u32 s27, s27, 0
  s_add_u32 s26, s26, s3
  s_addc_u32 s27, s27, 0
  s_mov_b32 s88, 1048576
  v_mov_b32 v255, 0
  v_lshrrev_b32 v26, 6, v0
  v_and_b32 v1, 63, v0
  v_readfirstlane_b32 s58, v26
  s_nop 3
  s_and_b32 s59, s58, 1
  s_lshr_b32 s60, s58, 1
  v_lshrrev_b32 v26, 5, v1
  v_lshlrev_b32 v26, 3, v26
  v_bfe_u32 v27, v1, 2, 2
  v_add_u32 v26, v26, v27
  v_lshlrev_b32 v26, 9, v26
  v_bfe_u32 v18, v1, 4, 1
  v_lshlrev_b32 v18, 5, v18
  v_add_u32 v26, v26, v18
  v_and_b32 v18, 3, v1
  v_lshlrev_b32 v18, 3, v18
  v_add_u32 v26, v26, v18
  s_lshl_b32 s61, s59, 8
  s_add_u32 s61, s61, 98304
  v_add_u32 v26, s61, v26
  v_xor_b32 v18, 0, v27
  v_lshl_add_u32 v22, v18, 6, v26
  v_xor_b32 v18, 1, v27
  v_lshl_add_u32 v23, v18, 6, v26
  v_xor_b32 v18, 2, v27
  v_lshl_add_u32 v24, v18, 6, v26
  v_xor_b32 v18, 3, v27
  v_lshl_add_u32 v25, v18, 6, v26
  s_lshl_b32 s55, s58, 12
  s_add_u32 s55, s55, 98304
  s_waitcnt lgkmcnt(0)
  s_mov_b32 s28, s14
  s_mov_b32 s29, s15
  s_mov_b32 s30, 268435456
  s_mov_b32 s31, 0x20000
  s_mov_b32 s79, 0
w_next:
  s_load_dword s80, s[26:27], 0
  s_add_u32 s26, s26, 4
  s_addc_u32 s27, s27, 0
  s_waitcnt lgkmcnt(0)
  s_cmp_eq_u32 s80, -1
  s_cbranch_scc1 L_exit

  s_and_b32 s81, s80, 15
  s_bfe_u32 s82, s80, 0x60004
  s_bfe_u32 s83, s80, 0x6000a
  s_bfe_u32 s84, s80, 0x30010
  s_cmp_eq_u32 s79, 1
  s_cbranch_scc1 w_qf_pre
  s_cmp_eq_u32 s81, 4
  s_cbranch_scc1 w_att
  s_cmp_eq_u32 s81, 6
  s_cbranch_scc1 w_att
  s_cmp_eq_u32 s81, 7
  s_cbranch_scc1 w_g5s
  s_cmp_eq_u32 s81, 8
  s_cbranch_scc1 w_g5h
  s_cmp_eq_u32 s81, 10
  s_cbranch_scc1 w_ln2
  s_cmp_eq_u32 s81, 2
  s_cbranch_scc1 w_g3
  s_cmp_eq_u32 s81, 3
  s_cbranch_scc1 w_g4
  s_cmp_eq_u32 s81, 5
  s_cbranch_scc1 w_g5
  s_cmp_eq_u32 s84, 1
  s_cselect_b32 s64, s8, s6
  s_cselect_b32 s65, s9, s7
  s_cmp_eq_u32 s84, 2
  s_cselect_b32 s64, s10, s64
  s_cselect_b32 s65, s11, s65
  s_lshl_b32 s89, s83, 9
  s_add_u32 s44, s64, s89
  s_addc_u32 s45, s65, 0
  s_sub_u32 s46, 8388608, s89
  s_mov_b32 s47, 0x20000
  s_mov_b32 s56, 2048
  s_mov_b32 s57, 8192
  s_mov_b32 s51, 7
  s_cmp_eq_u32 s81, 1
  s_cbranch_scc1 w_qf
  s_cmp_eq_u32 s81, 9
  s_cbranch_scc1 w_qq
  s_lshl_b32 s89, s82, 18
  s_add_u32 s89, s89, 0
  s_add_u32 s40, s14, s89
  s_addc_u32 s41, s15, 0
  s_sub_u32 s40, s40, 4096
  s_subb_u32 s41, s41, 0
  s_sub_u32 s42, 268439552, s89
  s_mov_b32 s43, 0x20000
  s_mov_b32 s56, 2048
  s_mov_b32 s75, 3
  s_mov_b32 s76, 0
  s_mov_b32 s77, 128
  s_branch w_h0
w_qq:
  s_lshl_b32 s89, s82, 17
  s_add_u32 s89, s89, 0
  s_add_u32 s40, s14, s89
  s_addc_u32 s41, s15, 0
  s_sub_u32 s40, s40, 4096
  s_subb_u32 s41, s41, 0
  s_sub_u32 s42, 268439552, s89
  s_mov_b32 s43, 0x20000
  s_mov_b32 s56, 2048
  s_mov_b32 s75, 3
  s_mov_b32 s76, 0
  s_mov_b32 s77, 128
  v_and_b32 v26, 31, v1
  s_mul_i32 s61, s60, 32
  v_add_u32 v27, s61, v26
  v_lshlrev_b32 v27, 7, v27
  v_bfe_u32 v26, v1, 1, 3
  v_lshrrev_b32 v18, 5, v1
  v_add_u32 v19, 0, v18
  v_xor_b32 v19, v19, v26
  v_lshl_add_u32 v14, v19, 4, v27
  v_add_u32 v19, 2, v18
  v_xor_b32 v19, v19, v26
  v_lshl_add_u32 v15, v19, 4, v27
  v_add_u32 v19, 4, v18
  v_xor_b32 v19, v19, v26
  v_lshl_add_u32 v16, v19, 4, v27
  v_add_u32 v19, 6, v18
  v_xor_b32 v19, v19, v26
  v_lshl_add_u32 v17, v19, 4, v27
  v_lshrrev_b32 v26, 3, v1
  s_mul_i32 s61, s58, 16
  v_add_u32 v26, s61, v26
  v_mul_lo_u32 v26, v26, s56
  v_lshrrev_b32 v27, 4, v1
  v_and_b32 v18, 7, v1
  s_lshl_b32 s62, s56, 3
  s_lshl_b32 s54, 1, s75
  s_sub_u32 s54, s54, 1
  v_add_u32 v19, 0, v27
  v_xor_b32 v19, v19, v18
  v_lshrrev_b32 v20, s75, v19
  v_mul_lo_u32 v20, v20, s76
  v_and_b32 v19, s54, v19
  v_lshl_add_u32 v2, v19, 4, v26
  v_add_u32 v2, v2, v20
  v_add_u32 v2, 4096, v2
  v_add_u32 v26, s62, v26
  v_add_u32 v19, 4, v27
  v_xor_b32 v19, v19, v18
  v_lshrrev_b32 v20, s75, v19
  v_mul_lo_u32 v20, v20, s76
  v_and_b32 v19, s54, v19
  v_lshl_add_u32 v3, v19, 4, v26
  v_add_u32 v3, v3, v20
  v_add_u32 v3, 4096, v3
  s_mul_i32 s54, s58, 2048
  v_lshrrev_b32 v27, 5, v1
  s_lshl_b32 s61, s58, 3
  v_add_u32 v26, s61, v27
  v_mul_lo_u32 v26, v26, s57
  v_and_b32 v18, 31, v1
  s_lshl_b32 s62, s57, 1
  v_add_u32 v19, 0, v27
  v_lshlrev_b32 v19, 2, v19
  v_xor_b32 v19, v19, v18
  v_lshl_add_u32 v10, v19, 4, v26
  v_add_u32 v26, s62, v26
  v_add_u32 v19, 2, v27
  v_lshlrev_b32 v19, 2, v19
  v_xor_b32 v19, v19, v18
  v_lshl_add_u32 v11, v19, 4, v26
  v_subrev_u32 v11, 1024, v11
  v_add_u32 v26, s62, v26
  v_add_u32 v19, 0, v27
  v_lshlrev_b32 v19, 2, v19
  v_xor_b32 v19, v19, v18
  v_lshl_add_u32 v12, v19, 4, v26
  v_subrev_u32 v12, 2048, v12
  v_add_u32 v26, s62, v26
  v_add_u32 v19, 2, v27
  v_lshlrev_b32 v19, 2, v19
  v_xor_b32 v19, v19, v18
  v_lshl_add_u32 v13, v19, 4, v26
  v_subrev_u32 v13, 3072, v13
  s_lshl_b32 s50, s57, 5
  s_mov_b32 s48, 0
  s_mov_b32 s53, s54
  s_mov_b32 s49, 0
  s_add_u32 m0, s53, 0
  s_nop 0
  buffer_load_dwordx4 v2, s[40:43], s48 offen offset:0 sc1 lds
  s_add_u32 m0, s55, 0
  s_nop 0
  buffer_load_dwordx4 v10, s[44:47], s49 offen offset:0 lds
  buffer_load_dwordx4 v11, s[44:47], s49 offen offset:1024 lds
  buffer_load_dwordx4 v12, s[44:47], s49 offen offset:2048 lds
  buffer_load_dwordx4 v13, s[44:47], s49 offen offset:3072 lds
  s_add_u32 s49, s49, s50
  s_add_u32 m0, s53, 1024
  s_nop 0
  buffer_load_dwordx4 v3, s[40:43], s48 offen offset:0 sc1 lds
  s_add_u32 s48, s48, s77
  s_add_u32 s53, s54, 8192
  s_add_u32 m0, s55, 16384
  s_nop 0
  buffer_load_dwordx4 v10, s[44:47], s49 offen offset:0 lds
  buffer_load_dwordx4 v11, s[44:47], s49 offen offset:1024 lds
  buffer_load_dwordx4 v12, s[44:47], s49 offen offset:2048 lds
  buffer_load_dwordx4 v13, s[44:47], s49 offen offset:3072 lds
  s_add_u32 s49, s49, s50
  s_add_u32 m0, s53, 0
  s_nop 0
  buffer_load_dwordx4 v2, s[40:43], s48 offen offset:0 sc1 lds
  s_add_u32 m0, s55, 32768
  s_nop 0
  buffer_load_dwordx4 v10, s[44:47], s49 offen offset:0 lds
  buffer_load_dwordx4 v11, s[44:47], s49 offen offset:1024 lds
  buffer_load_dwordx4 v12, s[44:47], s49 offen offset:2048 lds
  buffer_load_dwordx4 v13, s[44:47], s49 offen offset:3072 lds
  s_add_u32 s49, s49, s50
  s_add_u32 m0, s53, 1024
  s_nop 0
  buffer_load_dwordx4 v3, s[40:43], s48 offen offset:0 sc1 lds
  s_add_u32 s48, s48, s77
  s_add_u32 s53, s54, 16384
  s_add_u32 m0, s55, 49152
  s_nop 0
  buffer_load_dwordx4 v10, s[44:47], s49 offen offset:0 lds
  buffer_load_dwordx4 v11, s[44:47], s49 offen offset:1024 lds
  buffer_load_dwordx4 v12, s[44:47], s49 offen offset:2048 lds
  buffer_load_dwordx4 v13, s[44:47], s49 offen offset:3072 lds
  s_add_u32 s49, s49, s50
  s_add_u32 m0, s53, 0
  s_nop 0
  buffer_load_dwordx4 v2, s[40:43], s48 offen offset:0 sc1 lds
  s_mov_b32 s52, 0
  v_mov_b32 v18, v14
  v_mov_b32 v19, v15
  v_mov_b32 v20, v16
  v_mov_b32 v21, v17
  s_waitcnt vmcnt(15)
  s_barrier
  ds_read_b128 v[48:51], v18 offset:0
  ds_read_b64_tr_b16 v[32:33], v22 offset:0
  ds_read_b64_tr_b16 v[34:35], v22 offset:2048
  ds_read_b64_tr_b16 v[36:37], v23 offset:0
  ds_read_b64_tr_b16 v[38:39], v23 offset:2048
  ds_read_b64_tr_b16 v[40:41], v24 offset:0
  ds_read_b64_tr_b16 v[42:43], v24 offset:2048
  ds_read_b64_tr_b16 v[44:45], v25 offset:0
  ds_read_b64_tr_b16 v[46:47], v25 offset:2048
  s_waitcnt lgkmcnt(0)
  v_mfma_f32_32x32x16_bf16 a[0:15], v[32:35], v[48:51], 0
  ds_read_b128 v[80:83], v19 offset:0
  ds_read_b64_tr_b16 v[64:65], v22 offset:8192
  ds_read_b64_tr_b16 v[66:67], v22 offset:10240
  v_mfma_f32_32x32x16_bf16 a[16:31], v[36:39], v[48:51], 0
  ds_read_b64_tr_b16 v[68:69], v23 offset:8192
  ds_read_b64_tr_b16 v[70:71], v23 offset:10240
  ds_read_b64_tr_b16 v[72:73], v24 offset:8192
  v_mfma_f32_32x32x16_bf16 a[32:47], v[40:43], v[48:51], 0
  ds_read_b64_tr_b16 v[74:75], v24 offset:10240
  ds_read_b64_tr_b16 v[76:77], v25 offset:8192
  ds_read_b64_tr_b16 v[78:79], v25 offset:10240
  v_mfma_f32_32x32x16_bf16 a[48:63], v[44:47], v[48:51], 0
  s_branch gm_q
  s_nop 10
gl_q:
  s_waitcnt lgkmcnt(0)
  v_mfma_f32_32x32x16_bf16 a[0:15], v[32:35], v[48:51], a[0:15]
  ds_read_b128 v[80:83], v19 offset:0
  ds_read_b64_tr_b16 v[64:65], v22 offset:8192
  ds_read_b64_tr_b16 v[66:67], v22 offset:10240
  v_mfma_f32_32x32x16_bf16 a[16:31], v[36:39], v[48:51], a[16:31]
  ds_read_b64_tr_b16 v[68:69], v23 offset:8192
  ds_read_b64_tr_b16 v[70:71], v23 offset:10240
  ds_read_b64_tr_b16 v[72:73], v24 offset:8192
  v_mfma_f32_32x32x16_bf16 a[32:47], v[40:43], v[48:51], a[32:47]
  ds_read_b64_tr_b16 v[74:75], v24 offset:10240
  ds_read_b64_tr_b16 v[76:77], v25 offset:8192
  ds_read_b64_tr_b16 v[78:79], v25 offset:10240
  v_mfma_f32_32x32x16_bf16 a[48:63], v[44:47], v[48:51], a[48:63]
gm_q:
  s_waitcnt lgkmcnt(0)
  v_mfma_f32_32x32x16_bf16 a[0:15], v[64:67], v[80:83], a[0:15]
  v_mfma_f32_32x32x16_bf16 a[16:31], v[68:71], v[80:83], a[16:31]
  s_waitcnt vmcnt(10)
  s_barrier
  v_mfma_f32_32x32x16_bf16 a[32:47], v[72:75], v[80:83], a[32:47]
  ds_read_b128 v[48:51], v20 offset:0
  s_add_u32 m0, s55, 0
  ds_read_b64_tr_b16 v[32:33], v22 offset:16384
  buffer_load_dwordx4 v10, s[44:47], s49 offen offset:0 lds
  ds_read_b64_tr_b16 v[34:35], v22 offset:18432
  buffer_load_dwordx4 v11, s[44:47], s49 offen offset:1024 lds
  ds_read_b64_tr_b16 v[36:37], v23 offset:16384
  buffer_load_dwordx4 v12, s[44:47], s49 offen offset:2048 lds
  ds_read_b64_tr_b16 v[38:39], v23 offset:18432
  buffer_load_dwordx4 v13, s[44:47], s49 offen offset:3072 lds
  ds_read_b64_tr_b16 v[40:41], v24 offset:16384
  s_add_u32 s49, s49, s50
  ds_read_b64_tr_b16 v[42:43], v24 offset:18432
  s_add_u32 m0, s53, 1024
  ds_read_b64_tr_b16 v[44:45], v25 offset:16384
  buffer_load_dwordx4 v3, s[40:43], s48 offen offset:0 sc1 lds
  ds_read_b64_tr_b16 v[46:47], v25 offset:18432
  s_add_u32 s48, s48, s77
  v_mfma_f32_32x32x16_bf16 a[48:63], v[76:79], v[80:83], a[48:63]
  s_waitcnt lgkmcnt(0)
  v_mfma_f32_32x32x16_bf16 a[0:15], v[32:35], v[48:51], a[0:15]
  ds_read_b128 v[80:83], v21 offset:0
  ds_read_b64_tr_b16 v[64:65], v22 offset:24576
  ds_read_b64_tr_b16 v[66:67], v22 offset:26624
  v_mfma_f32_32x32x16_bf16 a[16:31], v[36:39], v[48:51], a[16:31]
  ds_read_b64_tr_b16 v[68:69], v23 offset:24576
  ds_read_b64_tr_b16 v[70:71], v23 offset:26624
  ds_read_b64_tr_b16 v[72:73], v24 offset:24576
  v_mfma_f32_32x32x16_bf16 a[32:47], v[40:43], v[48:51], a[32:47]
  ds_read_b64_tr_b16 v[74:75], v24 offset:26624
  ds_read_b64_tr_b16 v[76:77], v25 offset:24576
  ds_read_b64_tr_b16 v[78:79], v25 offset:26624
  v_mfma_f32_32x32x16_bf16 a[48:63], v[44:47], v[48:51], a[48:63]
  s_waitcnt lgkmcnt(0)
  v_mfma_f32_32x32x16_bf16 a[0:15], v[64:67], v[80:83], a[0:15]
  v_mfma_f32_32x32x16_bf16 a[16:31], v[68:71], v[80:83], a[16:31]
  s_add_u32 s53, s52, s54
  s_add_u32 s52, s52, 8192
  s_cmp_eq_u32 s52, 24576
  s_cselect_b32 s52, 0, s52
  v_add_u32 v18, s52, v14
  v_add_u32 v19, s52, v15
  v_add_u32 v20, s52, v16
  v_add_u32 v21, s52, v17
  s_waitcnt vmcnt(10)
  s_barrier
  v_mfma_f32_32x32x16_bf16 a[32:47], v[72:75], v[80:83], a[32:47]
  ds_read_b128 v[48:51], v18 offset:0
  s_add_u32 m0, s55, 16384
  ds_read_b64_tr_b16 v[32:33], v22 offset:32768
  buffer_load_dwordx4 v10, s[44:47], s49 offen offset:0 lds
  ds_read_b64_tr_b16 v[34:35], v22 offset:34816
  buffer_load_dwordx4 v11, s[44:47], s49 offen offset:1024 lds
  ds_read_b64_tr_b16 v[36:37], v23 offset:32768
  buffer_load_dwordx4 v12, s[44:47], s49 offen offset:2048 lds
  ds_read_b64_tr_b16 v[38:39], v23 offset:34816
  buffer_load_dwordx4 v13, s[44:47], s49 offen offset:3072 lds
  ds_read_b64_tr_b16 v[40:41], v24 offset:32768
  s_add_u32 s49, s49, s50
  ds_read_b64_tr_b16 v[42:43], v24 offset:34816
  s_add_u32 m0, s53, 0
  ds_read_b64_tr_b16 v[44:45], v25 offset:32768
  buffer_load_dwordx4 v2, s[40:43], s48 offen offset:0 sc1 lds
  ds_read_b64_tr_b16 v[46:47], v25 offset:34816
  v_mfma_f32_32x32x16_bf16 a[48:63], v[76:79], v[80:83], a[48:63]
  s_waitcnt lgkmcnt(0)
  v_mfma_f32_32x32x16_bf16 a[0:15], v[32:35], v[48:51], a[0:15]
  ds_read_b128 v[80:83], v19 offset:0
  ds_read_b64_tr_b16 v[64:65], v22 offset:40960
  ds_read_b64_tr_b16 v[66:67], v22 offset:43008
  v_mfma_f32_32x32x16_bf16 a[16:31], v[36:39], v[48:51], a[16:31]
  ds_read_b64_tr_b16 v[68:69], v23 offset:40960
  ds_read_b64_tr_b16 v[70:71], v23 offset:43008
  ds_read_b64_tr_b16 v[72:73], v24 offset:40960
  v_mfma_f32_32x32x16_bf16 a[32:47], v[40:43], v[48:51], a[32:47]
  ds_read_b64_tr_b16 v[74:75], v24 offset:43008
  ds_read_b64_tr_b16 v[76:77], v25 offset:40960
  ds_read_b64_tr_b16 v[78:79], v25 offset:43008
  v_mfma_f32_32x32x16_bf16 a[48:63], v[44:47], v[48:51], a[48:63]
  s_waitcnt lgkmcnt(0)
  v_mfma_f32_32x32x16_bf16 a[0:15], v[64:67], v[80:83], a[0:15]
  v_mfma_f32_32x32x16_bf16 a[16:31], v[68:71], v[80:83], a[16:31]
  s_waitcnt vmcnt(10)
  s_barrier
  v_mfma_f32_32x32x16_bf16 a[32:47], v[72:75], v[80:83], a[32:47]
  ds_read_b128 v[48:51], v20 offset:0
  s_add_u32 m0, s55, 32768
  ds_read_b64_tr_b16 v[32:33], v22 offset:49152
  buffer_load_dwordx4 v10, s[44:47], s49 offen offset:0 lds
  ds_read_b64_tr_b16 v[34:35], v22 offset:51200
  buffer_load_dwordx4 v11, s[44:47], s49 offen offset:1024 lds
  ds_read_b64_tr_b16 v[36:37], v23 offset:49152
  buffer_load_dwordx4 v12, s[44:47], s49 offen offset:2048 lds
  ds_read_b64_tr_b16 v[38:39], v23 offset:51200
  buffer_load_dwordx4 v13, s[44:47], s49 offen offset:3072 lds
  ds_read_b64_tr_b16 v[40:41], v24 offset:49152
  s_add_u32 s49, s49, s50
  ds_read_b64_tr_b16 v[42:43], v24 offset:51200
  s_add_u32 m0, s53, 1024
  ds_read_b64_tr_b16 v[44:45], v25 offset:49152
  buffer_load_dwordx4 v3, s[40:43], s48 offen offset:0 sc1 lds
  ds_read_b64_tr_b16 v[46:47], v25 offset:51200
  s_add_u32 s48, s48, s77
  v_mfma_f32_32x32x16_bf16 a[48:63], v[76:79], v[80:83], a[48:63]
  s_waitcnt lgkmcnt(0)
  v_mfma_f32_32x32x16_bf16 a[0:15], v[32:35], v[48:51], a[0:15]
  ds_read_b128 v[80:83], v21 offset:0
  ds_read_b64_tr_b16 v[64:65], v22 offset:57344
  ds_read_b64_tr_b16 v[66:67], v22 offset:59392
  v_mfma_f32_32x32x16_bf16 a[16:31], v[36:39], v[48:51], a[16:31]
  ds_read_b64_tr_b16 v[68:69], v23 offset:57344
  ds_read_b64_tr_b16 v[70:71], v23 offset:59392
  ds_read_b64_tr_b16 v[72:73], v24 offset:57344
  v_mfma_f32_32x32x16_bf16 a[32:47], v[40:43], v[48:51], a[32:47]
  ds_read_b64_tr_b16 v[74:75], v24 offset:59392
  ds_read_b64_tr_b16 v[76:77], v25 offset:57344
  ds_read_b64_tr_b16 v[78:79], v25 offset:59392
  v_mfma_f32_32x32x16_bf16 a[48:63], v[44:47], v[48:51], a[48:63]
  s_waitcnt lgkmcnt(0)
  v_mfma_f32_32x32x16_bf16 a[0:15], v[64:67], v[80:83], a[0:15]
  v_mfma_f32_32x32x16_bf16 a[16:31], v[68:71], v[80:83], a[16:31]
  s_add_u32 s53, s52, s54
  s_add_u32 s52, s52, 8192
  s_cmp_eq_u32 s52, 24576
  s_cselect_b32 s52, 0, s52
  v_add_u32 v18, s52, v14
  v_add_u32 v19, s52, v15
  v_add_u32 v20, s52, v16
  v_add_u32 v21, s52, v17
  s_waitcnt vmcnt(10)
  s_barrier
  v_mfma_f32_32x32x16_bf16 a[32:47], v[72:75], v[80:83], a[32:47]
  s_add_u32 m0, s55, 49152
  s_nop 0
  buffer_load_dwordx4 v10, s[44:47], s49 offen offset:0 lds
  buffer_load_dwordx4 v11, s[44:47], s49 offen offset:1024 lds
  buffer_load_dwordx4 v12, s[44:47], s49 offen offset:2048 lds
  buffer_load_dwordx4 v13, s[44:47], s49 offen offset:3072 lds
  s_add_u32 s49, s49, s50
  s_cmp_eq_u32 s51, 1
  s_cbranch_scc1 gs_q
  s_add_u32 m0, s53, 0
  s_nop 0
  buffer_load_dwordx4 v2, s[40:43], s48 offen offset:0 sc1 lds
gs_q:
  v_mfma_f32_32x32x16_bf16 a[48:63], v[76:79], v[80:83], a[48:63]
  ds_read_b128 v[48:51], v18 offset:0
  ds_read_b64_tr_b16 v[32:33], v22 offset:0
  ds_read_b64_tr_b16 v[34:35], v22 offset:2048
  ds_read_b64_tr_b16 v[36:37], v23 offset:0
  ds_read_b64_tr_b16 v[38:39], v23 offset:2048
  ds_read_b64_tr_b16 v[40:41], v24 offset:0
  ds_read_b64_tr_b16 v[42:43], v24 offset:2048
  ds_read_b64_tr_b16 v[44:45], v25 offset:0
  ds_read_b64_tr_b16 v[46:47], v25 offset:2048
  s_sub_u32 s51, s51, 1
  s_cmp_lg_u32 s51, 0
  s_cbranch_scc1 gl_q
  s_waitcnt lgkmcnt(0)
  v_mfma_f32_32x32x16_bf16 a[0:15], v[32:35], v[48:51], a[0:15]
  ds_read_b128 v[80:83], v19 offset:0
  ds_read_b64_tr_b16 v[64:65], v22 offset:8192
  ds_read_b64_tr_b16 v[66:67], v22 offset:10240
  v_mfma_f32_32x32x16_bf16 a[16:31], v[36:39], v[48:51], a[16:31]
  ds_read_b64_tr_b16 v[68:69], v23 offset:8192
  ds_read_b64_tr_b16 v[70:71], v23 offset:10240
  ds_read_b64_tr_b16 v[72:73], v24 offset:8192
  v_mfma_f32_32x32x16_bf16 a[32:47], v[40:43], v[48:51], a[32:47]
  ds_read_b64_tr_b16 v[74:75], v24 offset:10240
  ds_read_b64_tr_b16 v[76:77], v25 offset:8192
  ds_read_b64_tr_b16 v[78:79], v25 offset:10240
  v_mfma_f32_32x32x16_bf16 a[48:63], v[44:47], v[48:51], a[48:63]
  s_waitcnt lgkmcnt(0)
  v_mfma_f32_32x32x16_bf16 a[0:15], v[64:67], v[80:83], a[0:15]
  v_mfma_f32_32x32x16_bf16 a[16:31], v[68:71], v[80:83], a[16:31]
  s_waitcnt vmcnt(9)
  s_barrier
  v_mfma_f32_32x32x16_bf16 a[32:47], v[72:75], v[80:83], a[32:47]
  ds_read_b128 v[48:51], v20 offset:0
  ds_read_b64_tr_b16 v[32:33], v22 offset:16384
  ds_read_b64_tr_b16 v[34:35], v22 offset:18432
  ds_read_b64_tr_b16 v[36:37], v23 offset:16384
  ds_read_b64_tr_b16 v[38:39], v23 offset:18432
  ds_read_b64_tr_b16 v[40:41], v24 offset:16384
  ds_read_b64_tr_b16 v[42:43], v24 offset:18432
  ds_read_b64_tr_b16 v[44:45], v25 offset:16384
  ds_read_b64_tr_b16 v[46:47], v25 offset:18432
  v_mfma_f32_32x32x16_bf16 a[48:63], v[76:79], v[80:83], a[48:63]
  s_waitcnt lgkmcnt(0)
  v_mfma_f32_32x32x16_bf16 a[0:15], v[32:35], v[48:51], a[0:15]
  ds_read_b128 v[80:83], v21 offset:0
  ds_read_b64_tr_b16 v[64:65], v22 offset:24576
  ds_read_b64_tr_b16 v[66:67], v22 offset:26624
  v_mfma_f32_32x32x16_bf16 a[16:31], v[36:39], v[48:51], a[16:31]
  ds_read_b64_tr_b16 v[68:69], v23 offset:24576
  ds_read_b64_tr_b16 v[70:71], v23 offset:26624
  ds_read_b64_tr_b16 v[72:73], v24 offset:24576
  v_mfma_f32_32x32x16_bf16 a[32:47], v[40:43], v[48:51], a[32:47]
  ds_read_b64_tr_b16 v[74:75], v24 offset:26624
  ds_read_b64_tr_b16 v[76:77], v25 offset:24576
  ds_read_b64_tr_b16 v[78:79], v25 offset:26624
  v_mfma_f32_32x32x16_bf16 a[48:63], v[44:47], v[48:51], a[48:63]
  s_waitcnt lgkmcnt(0)
  v_mfma_f32_32x32x16_bf16 a[0:15], v[64:67], v[80:83], a[0:15]
  v_mfma_f32_32x32x16_bf16 a[16:31], v[68:71], v[80:83], a[16:31]
  s_add_u32 s53, s52, s54
  s_add_u32 s52, s52, 8192
  s_cmp_eq_u32 s52, 24576
  s_cselect_b32 s52, 0, s52
  v_add_u32 v18, s52, v14
  v_add_u32 v19, s52, v15
  v_add_u32 v20, s52, v16
  v_add_u32 v21, s52, v17
  s_waitcnt vmcnt(4)
  s_barrier
  v_mfma_f32_32x32x16_bf16 a[32:47], v[72:75], v[80:83], a[32:47]
  ds_read_b128 v[48:51], v18 offset:0
  ds_read_b64_tr_b16 v[32:33], v22 offset:32768
  ds_read_b64_tr_b16 v[34:35], v22 offset:34816
  ds_read_b64_tr_b16 v[36:37], v23 offset:32768
  ds_read_b64_tr_b16 v[38:39], v23 offset:34816
  ds_read_b64_tr_b16 v[40:41], v24 offset:32768
  ds_read_b64_tr_b16 v[42:43], v24 offset:34816
  ds_read_b64_tr_b16 v[44:45], v25 offset:32768
  ds_read_b64_tr_b16 v[46:47], v25 offset:34816
  v_mfma_f32_32x32x16_bf16 a[48:63], v[76:79], v[80:83], a[48:63]
  s_waitcnt lgkmcnt(0)
  v_mfma_f32_32x32x16_bf16 a[0:15], v[32:35], v[48:51], a[0:15]
  ds_read_b128 v[80:83], v19 offset:0
  ds_read_b64_tr_b16 v[64:65], v22 offset:40960
  ds_read_b64_tr_b16 v[66:67], v22 offset:43008
  v_mfma_f32_32x32x16_bf16 a[16:31], v[36:39], v[48:51], a[16:31]
  ds_read_b64_tr_b16 v[68:69], v23 offset:40960
  ds_read_b64_tr_b16 v[70:71], v23 offset:43008
  ds_read_b64_tr_b16 v[72:73], v24 offset:40960
  v_mfma_f32_32x32x16_bf16 a[32:47], v[40:43], v[48:51], a[32:47]
  ds_read_b64_tr_b16 v[74:75], v24 offset:43008
  ds_read_b64_tr_b16 v[76:77], v25 offset:40960
  ds_read_b64_tr_b16 v[78:79], v25 offset:43008
  v_mfma_f32_32x32x16_bf16 a[48:63], v[44:47], v[48:51], a[48:63]
  s_waitcnt lgkmcnt(0)
  v_mfma_f32_32x32x16_bf16 a[0:15], v[64:67], v[80:83], a[0:15]
  v_mfma_f32_32x32x16_bf16 a[16:31], v[68:71], v[80:83], a[16:31]
  s_waitcnt vmcnt(0)
  s_barrier
  v_mfma_f32_32x32x16_bf16 a[32:47], v[72:75], v[80:83], a[32:47]
  ds_read_b128 v[48:51], v20 offset:0
  ds_read_b64_tr_b16 v[32:33], v22 offset:49152
  ds_read_b64_tr_b16 v[34:35], v22 offset:51200
  ds_read_b64_tr_b16 v[36:37], v23 offset:49152
  ds_read_b64_tr_b16 v[38:39], v23 offset:51200
  ds_read_b64_tr_b16 v[40:41], v24 offset:49152
  ds_read_b64_tr_b16 v[42:43], v24 offset:51200
  ds_read_b64_tr_b16 v[44:45], v25 offset:49152
  ds_read_b64_tr_b16 v[46:47], v25 offset:51200
  v_mfma_f32_32x32x16_bf16 a[48:63], v[76:79], v[80:83], a[48:63]
  s_waitcnt lgkmcnt(0)
  v_mfma_f32_32x32x16_bf16 a[0:15], v[32:35], v[48:51], a[0:15]
  ds_read_b128 v[80:83], v21 offset:0
  ds_read_b64_tr_b16 v[64:65], v22 offset:57344
  ds_read_b64_tr_b16 v[66:67], v22 offset:59392
  v_mfma_f32_32x32x16_bf16 a[16:31], v[36:39], v[48:51], a[16:31]
  ds_read_b64_tr_b16 v[68:69], v23 offset:57344
  ds_read_b64_tr_b16 v[70:71], v23 offset:59392
  ds_read_b64_tr_b16 v[72:73], v24 offset:57344
  v_mfma_f32_32x32x16_bf16 a[32:47], v[40:43], v[48:51], a[32:47]
  ds_read_b64_tr_b16 v[74:75], v24 offset:59392
  ds_read_b64_tr_b16 v[76:77], v25 offset:57344
  ds_read_b64_tr_b16 v[78:79], v25 offset:59392
  v_mfma_f32_32x32x16_bf16 a[48:63], v[44:47], v[48:51], a[48:63]
  s_waitcnt lgkmcnt(0)
  v_mfma_f32_32x32x16_bf16 a[0:15], v[64:67], v[80:83], a[0:15]
  v_mfma_f32_32x32x16_bf16 a[16:31], v[68:71], v[80:83], a[16:31]
  v_mfma_f32_32x32x16_bf16 a[32:47], v[72:75], v[80:83], a[32:47]
  v_mfma_f32_32x32x16_bf16 a[48:63], v[76:79], v[80:83], a[48:63]
  s_nop 11
  s_lshl_b32 s85, s84, 24
  s_add_u32 s85, s85, 8388608
  s_lshl_b32 s89, s83, 1
  s_add_u32 s89, s89, s59
  s_lshl_b32 s89, s89, 13
  s_add_u32 s85, s85, s89
  s_mul_i32 s89, s82, 2
  s_mul_i32 s86, s60, 1
  s_add_u32 s89, s89, s86
  s_lshl_b32 s89, s89, 18
  s_add_u32 s85, s85, s89
  v_bfe_u32 v26, v1, 4, 1
  v_lshlrev_b32 v26, 12, v26
  v_lshrrev_b32 v27, 5, v1
  v_lshl_add_u32 v26, v27, 8, v26
  v_and_b32 v27, 15, v1
  v_lshl_add_u32 v26, v27, 4, v26
  v_accvgpr_read_b32 v160, a0
  v_accvgpr_read_b32 v161, a1
  v_accvgpr_read_b32 v162, a2
  v_accvgpr_read_b32 v163, a3
  v_accvgpr_read_b32 v164, a4
  v_accvgpr_read_b32 v165, a5
  v_accvgpr_read_b32 v166, a6
  v_accvgpr_read_b32 v167, a7
  v_accvgpr_read_b32 v168, a8
  v_accvgpr_read_b32 v169, a9
  v_accvgpr_read_b32 v170, a10
  v_accvgpr_read_b32 v171, a11
  v_accvgpr_read_b32 v172, a12
  v_accvgpr_read_b32 v173, a13
  v_accvgpr_read_b32 v174, a14
  v_accvgpr_read_b32 v175, a15
  v_cvt_pk_bf16_f32 v96, v160, v161
  v_cvt_pk_bf16_f32 v97, v162, v163
  v_cvt_pk_bf16_f32 v98, v164, v165
  v_cvt_pk_bf16_f32 v99, v166, v167
  v_cvt_pk_bf16_f32 v100, v168, v169
  v_cvt_pk_bf16_f32 v101, v170, v171
  v_cvt_pk_bf16_f32 v102, v172, v173
  v_cvt_pk_bf16_f32 v103, v174, v175
  v_permlane32_swap_b32 v96, v98
  v_permlane32_swap_b32 v97, v99
  v_permlane32_swap_b32 v100, v102
  v_permlane32_swap_b32 v101, v103
  buffer_store_dwordx4 v[96:99], v26, s[28:31], s85 offen offset:0 sc1
  buffer_store_dwordx4 v[100:103], v26, s[28:31], s85 offen offset:512 sc1
  v_accvgpr_read_b32 v160, a16
  v_accvgpr_read_b32 v161, a17
  v_accvgpr_read_b32 v162, a18
  v_accvgpr_read_b32 v163, a19
  v_accvgpr_read_b32 v164, a20
  v_accvgpr_read_b32 v165, a21
  v_accvgpr_read_b32 v166, a22
  v_accvgpr_read_b32 v167, a23
  v_accvgpr_read_b32 v168, a24
  v_accvgpr_read_b32 v169, a25
  v_accvgpr_read_b32 v170, a26
  v_accvgpr_read_b32 v171, a27
  v_accvgpr_read_b32 v172, a28
  v_accvgpr_read_b32 v173, a29
  v_accvgpr_read_b32 v174, a30
  v_accvgpr_read_b32 v175, a31
  v_cvt_pk_bf16_f32 v104, v160, v161
  v_cvt_pk_bf16_f32 v105, v162, v163
  v_cvt_pk_bf16_f32 v106, v164, v165
  v_cvt_pk_bf16_f32 v107, v166, v167
  v_cvt_pk_bf16_f32 v108, v168, v169
  v_cvt_pk_bf16_f32 v109, v170, v171
  v_cvt_pk_bf16_f32 v110, v172, v173
  v_cvt_pk_bf16_f32 v111, v174, v175
  v_permlane32_swap_b32 v104, v106
  v_permlane32_swap_b32 v105, v107
  v_permlane32_swap_b32 v108, v110
  v_permlane32_swap_b32 v109, v111
  buffer_store_dwordx4 v[104:107], v26, s[28:31], s85 offen offset:1024 sc1
  buffer_store_dwordx4 v[108:111], v26, s[28:31], s85 offen offset:1536 sc1
  v_accvgpr_read_b32 v160, a32
  v_accvgpr_read_b32 v161, a33
  v_accvgpr_read_b32 v162, a34
  v_accvgpr_read_b32 v163, a35
  v_accvgpr_read_b32 v164, a36
  v_accvgpr_read_b32 v165, a37
  v_accvgpr_read_b32 v166, a38
  v_accvgpr_read_b32 v167, a39
  v_accvgpr_read_b32 v168, a40
  v_accvgpr_read_b32 v169, a41
  v_accvgpr_read_b32 v170, a42
  v_accvgpr_read_b32 v171, a43
  v_accvgpr_read_b32 v172, a44
  v_accvgpr_read_b32 v173, a45
  v_accvgpr_read_b32 v174, a46
  v_accvgpr_read_b32 v175, a47
  v_cvt_pk_bf16_f32 v112, v160, v161
  v_cvt_pk_bf16_f32 v113, v162, v163
  v_cvt_pk_bf16_f32 v114, v164, v165
  v_cvt_pk_bf16_f32 v115, v166, v167
  v_cvt_pk_bf16_f32 v116, v168, v169
  v_cvt_pk_bf16_f32 v117, v170, v171
  v_cvt_pk_bf16_f32 v118, v172, v173
  v_cvt_pk_bf16_f32 v119, v174, v175
  v_permlane32_swap_b32 v112, v114
  v_permlane32_swap_b32 v113, v115
  v_permlane32_swap_b32 v116, v118
  v_permlane32_swap_b32 v117, v119
  buffer_store_dwordx4 v[112:115], v26, s[28:31], s85 offen offset:2048 sc1
  buffer_store_dwordx4 v[116:119], v26, s[28:31], s85 offen offset:2560 sc1
  v_accvgpr_read_b32 v160, a48
  v_accvgpr_read_b32 v161, a49
  v_accvgpr_read_b32 v162, a50
  v_accvgpr_read_b32 v163, a51
  v_accvgpr_read_b32 v164, a52
  v_accvgpr_read_b32 v165, a53
  v_accvgpr_read_b32 v166, a54
  v_accvgpr_read_b32 v167, a55
  v_accvgpr_read_b32 v168, a56
  v_accvgpr_read_b32 v169, a57
  v_accvgpr_read_b32 v170, a58
  v_accvgpr_read_b32 v171, a59
  v_accvgpr_read_b32 v172, a60
  v_accvgpr_read_b32 v173, a61
  v_accvgpr_read_b32 v174, a62
  v_accvgpr_read_b32 v175, a63
  v_cvt_pk_bf16_f32 v120, v160, v161
  v_cvt_pk_bf16_f32 v121, v162, v163
  v_cvt_pk_bf16_f32 v122, v164, v165
  v_cvt_pk_bf16_f32 v123, v166, v167
  v_cvt_pk_bf16_f32 v124, v168, v169
  v_cvt_pk_bf16_f32 v125, v170, v171
  v_cvt_pk_bf16_f32 v126, v172, v173
  v_cvt_pk_bf16_f32 v127, v174, v175
  v_permlane32_swap_b32 v120, v122
  v_permlane32_swap_b32 v121, v123
  v_permlane32_swap_b32 v124, v126
  v_permlane32_swap_b32 v125, v127
  buffer_store_dwordx4 v[120:123], v26, s[28:31], s85 offen offset:3072 sc1
  buffer_store_dwordx4 v[124:127], v26, s[28:31], s85 offen offset:3584 sc1
  s_lshr_b32 s86, s82, 1
  s_add_u32 s86, s86, 0
  s_cmp_eq_u32 s82, 0
  s_cselect_b32 s87, 36, 38
  s_load_dwordx2 s[64:65], s[0:1], 104
  v_and_b32 v96, 63, v0
  s_waitcnt lgkmcnt(0)
  s_mov_b32 s66, 256
  s_mov_b32 s67, 0x20000
  v_lshlrev_b32 v98, 2, v96
  v_lshrrev_b32 v99, 6, v0
  s_mov_b32 s68, 0x10001
  v_readfirstlane_b32 s69, v99
  s_nop 3
  s_cmp_lg_u32 s69, 0
  s_cbranch_scc1 p0w_52_ok
p0w_52:
  buffer_load_dword v99, v98, s[64:67], 0 offen sc1
  s_waitcnt vmcnt(0)
  v_cmp_ne_u32 vcc, 32, v99
  s_nop 3
  s_and_b32 vcc_lo, vcc_lo, s68
  s_and_b32 vcc_hi, vcc_hi, s68
  s_or_b32 s69, vcc_lo, vcc_hi
  s_cmp_eq_u32 s69, 0
  s_cbranch_scc1 p0w_52_ok
  s_sub_u32 s88, s88, 1
  s_cselect_b32 s88, 0, s88
  s_cbranch_scc1 p0w_52_ok
  s_sleep 2
  s_branch p0w_52
p0w_52_ok:
  s_barrier
  s_nop 0
  s_waitcnt vmcnt(0)
  s_barrier
  s_cmp_lg_u32 s58, 0
  s_cbranch_scc1 sg_53
  v_mov_b32 v26, 1
  s_mov_b64 exec, 1
  s_lshl_b32 s61, s86, 7
  s_add_u32 s61, s61, 99614720
  buffer_atomic_add v26, v255, s[28:31], s61 offen sc1
  s_lshl_b32 s61, s87, 7
  s_add_u32 s61, s61, 99614720
  buffer_atomic_add v26, v255, s[28:31], s61 offen sc1
  s_mov_b64 exec, -1
sg_53:
  s_nop 0
  s_branch w_next
w_ln2:
  s_mov_b32 s64, 0x3a800000
  s_mov_b32 s66, 0x3727c5ac
  v_lshlrev_b32 v97, 4, v1
  s_lshl_b32 s67, s82, 5
  s_lshl_b32 s68, s58, 3
  s_add_u32 s67, s67, s68
  s_lshl_b32 s67, s67, 11
  s_add_u32 s68, s67, 0
  s_add_u32 s69, s68, 4096
  buffer_load_dwordx4 v[104:107], v97, s[28:31], s68 offen offset:0 sc1
  buffer_load_dwordx4 v[108:111], v97, s[28:31], s68 offen offset:1024 sc1
  buffer_load_dwordx4 v[112:115], v97, s[28:31], s68 offen offset:2048 sc1
  buffer_load_dwordx4 v[116:119], v97, s[28:31], s68 offen offset:3072 sc1
  buffer_load_dwordx4 v[120:123], v97, s[28:31], s69 offen offset:0 sc1
  buffer_load_dwordx4 v[124:127], v97, s[28:31], s69 offen offset:1024 sc1
  buffer_load_dwordx4 v[128:131], v97, s[28:31], s69 offen offset:2048 sc1
  buffer_load_dwordx4 v[132:135], v97, s[28:31], s69 offen offset:3072 sc1
  s_waitcnt vmcnt(0)
  v_lshlrev_b32 v136, 16, v104
  v_and_b32 v137, 0xffff0000, v104
  v_lshlrev_b32 v138, 16, v105
  v_and_b32 v139, 0xffff0000, v105
  v_lshlrev_b32 v140, 16, v106
  v_and_b32 v141, 0xffff0000, v106
  v_lshlrev_b32 v142, 16, v107
  v_and_b32 v143, 0xffff0000, v107
  v_lshlrev_b32 v144, 16, v108
  v_and_b32 v145, 0xffff0000, v108
  v_lshlrev_b32 v146, 16, v109
  v_and_b32 v147, 0xffff0000, v109
  v_lshlrev_b32 v148, 16, v110
  v_and_b32 v149, 0xffff0000, v110
  v_lshlrev_b32 v150, 16, v111
  v_and_b32 v151, 0xffff0000, v111
  v_lshlrev_b32 v152, 16, v112
  v_and_b32 v153, 0xffff0000, v112
  v_lshlrev_b32 v154, 16, v113
  v_and_b32 v155, 0xffff0000, v113
  v_lshlrev_b32 v156, 16, v114
  v_and_b32 v157, 0xffff0000, v114
  v_lshlrev_b32 v158, 16, v115
  v_and_b32 v159, 0xffff0000, v115
  v_lshlrev_b32 v160, 16, v116
  v_and_b32 v161, 0xffff0000, v116
  v_lshlrev_b32 v162, 16, v117
  v_and_b32 v163, 0xffff0000, v117
  v_lshlrev_b32 v164, 16, v118
  v_and_b32 v165, 0xffff0000, v118
  v_lshlrev_b32 v166, 16, v119
  v_and_b32 v167, 0xffff0000, v119
  v_lshlrev_b32 v208, 16, v120
  v_and_b32 v209, 0xffff0000, v120
  v_lshlrev_b32 v210, 16, v121
  v_and_b32 v211, 0xffff0000, v121
  v_lshlrev_b32 v212, 16, v122
  v_and_b32 v213, 0xffff0000, v122
  v_lshlrev_b32 v214, 16, v123
  v_and_b32 v215, 0xffff0000, v123
  v_lshlrev_b32 v216, 16, v124
  v_and_b32 v217, 0xffff0000, v124
  v_lshlrev_b32 v218, 16, v125
  v_and_b32 v219, 0xffff0000, v125
  v_lshlrev_b32 v220, 16, v126
  v_and_b32 v221, 0xffff0000, v126
  v_lshlrev_b32 v222, 16, v127
  v_and_b32 v223, 0xffff0000, v127
  v_lshlrev_b32 v224, 16, v128
  v_and_b32 v225, 0xffff0000, v128
  v_lshlrev_b32 v226, 16, v129
  v_and_b32 v227, 0xffff0000, v129
  v_lshlrev_b32 v228, 16, v130
  v_and_b32 v229, 0xffff0000, v130
  v_lshlrev_b32 v230, 16, v131
  v_and_b32 v231, 0xffff0000, v131
  v_lshlrev_b32 v232, 16, v132
  v_and_b32 v233, 0xffff0000, v132
  v_lshlrev_b32 v234, 16, v133
  v_and_b32 v235, 0xffff0000, v133
  v_lshlrev_b32 v236, 16, v134
  v_and_b32 v237, 0xffff0000, v134
  v_lshlrev_b32 v238, 16, v135
  v_and_b32 v239, 0xffff0000, v135
  s_add_u32 s68, s67, 4194304
  v_pk_add_f32 v[168:169], v[136:137], v[138:139]
  v_pk_add_f32 v[184:185], v[152:153], v[154:155]
  v_pk_add_f32 v[168:169], v[168:169], v[140:141]
  v_pk_add_f32 v[184:185], v[184:185], v[156:157]
  v_pk_add_f32 v[168:169], v[168:169], v[142:143]
  v_pk_add_f32 v[184:185], v[184:185], v[158:159]
  v_pk_add_f32 v[168:169], v[168:169], v[144:145]
  v_pk_add_f32 v[184:185], v[184:185], v[160:161]
  v_pk_add_f32 v[168:169], v[168:169], v[146:147]
  v_pk_add_f32 v[184:185], v[184:185], v[162:163]
  v_pk_add_f32 v[168:169], v[168:169], v[148:149]
  v_pk_add_f32 v[184:185], v[184:185], v[164:165]
  v_pk_add_f32 v[168:169], v[168:169], v[150:151]
  v_pk_add_f32 v[184:185], v[184:185], v[166:167]
  v_add_f32 v168, v168, v169
  v_add_f32 v184, v184, v185
  s_nop 0
  v_add_f32_dpp v168, v168, v168 quad_perm:[1,0,3,2] row_mask:0xf bank_mask:0xf
  v_add_f32_dpp v184, v184, v184 quad_perm:[1,0,3,2] row_mask:0xf bank_mask:0xf
  s_nop 0
  v_add_f32_dpp v168, v168, v168 quad_perm:[2,3,0,1] row_mask:0xf bank_mask:0xf
  v_add_f32_dpp v184, v184, v184 quad_perm:[2,3,0,1] row_mask:0xf bank_mask:0xf
  s_nop 0
  v_add_f32_dpp v168, v168, v168 row_half_mirror row_mask:0xf bank_mask:0xf
  v_add_f32_dpp v184, v184, v184 row_half_mirror row_mask:0xf bank_mask:0xf
  s_nop 0
  v_add_f32_dpp v168, v168, v168 row_mirror row_mask:0xf bank_mask:0xf
  v_add_f32_dpp v184, v184, v184 row_mirror row_mask:0xf bank_mask:0xf
  v_mov_b32 v170, v168
  v_mov_b32 v186, v184
  s_nop 0
  v_permlane16_swap_b32 v168, v170
  v_permlane16_swap_b32 v184, v186
  v_add_f32 v168, v168, v170
  v_add_f32 v184, v184, v186
  v_mov_b32 v170, v168
  v_mov_b32 v186, v184
  s_nop 0
  v_permlane32_swap_b32 v168, v170
  v_permlane32_swap_b32 v184, v186
  v_add_f32 v168, v168, v170
  v_add_f32 v184, v184, v186
  v_mul_f32 v172, s64, v168
  v_mul_f32 v188, s64, v184
  v_pk_add_f32 v[170:171], v[136:137], v[172:173] op_sel_hi:[1,0] neg_lo:[0,1] neg_hi:[0,1]
  v_pk_add_f32 v[186:187], v[152:153], v[188:189] op_sel_hi:[1,0] neg_lo:[0,1] neg_hi:[0,1]
  v_pk_mul_f32 v[168:169], v[170:171], v[170:171]
  v_pk_mul_f32 v[184:185], v[186:187], v[186:187]
  v_pk_add_f32 v[170:171], v[138:139], v[172:173] op_sel_hi:[1,0] neg_lo:[0,1] neg_hi:[0,1]
  v_pk_add_f32 v[186:187], v[154:155], v[188:189] op_sel_hi:[1,0] neg_lo:[0,1] neg_hi:[0,1]
  v_pk_fma_f32 v[168:169], v[170:171], v[170:171], v[168:169]
  v_pk_fma_f32 v[184:185], v[186:187], v[186:187], v[184:185]
  v_pk_add_f32 v[170:171], v[140:141], v[172:173] op_sel_hi:[1,0] neg_lo:[0,1] neg_hi:[0,1]
  v_pk_add_f32 v[186:187], v[156:157], v[188:189] op_sel_hi:[1,0] neg_lo:[0,1] neg_hi:[0,1]
  v_pk_fma_f32 v[168:169], v[170:171], v[170:171], v[168:169]
  v_pk_fma_f32 v[184:185], v[186:187], v[186:187], v[184:185]
  v_pk_add_f32 v[170:171], v[142:143], v[172:173] op_sel_hi:[1,0] neg_lo:[0,1] neg_hi:[0,1]
  v_pk_add_f32 v[186:187], v[158:159], v[188:189] op_sel_hi:[1,0] neg_lo:[0,1] neg_hi:[0,1]
  v_pk_fma_f32 v[168:169], v[170:171], v[170:171], v[168:169]
  v_pk_fma_f32 v[184:185], v[186:187], v[186:187], v[184:185]
  v_pk_add_f32 v[170:171], v[144:145], v[172:173] op_sel_hi:[1,0] neg_lo:[0,1] neg_hi:[0,1]
  v_pk_add_f32 v[186:187], v[160:161], v[188:189] op_sel_hi:[1,0] neg_lo:[0,1] neg_hi:[0,1]
  v_pk_fma_f32 v[168:169], v[170:171], v[170:171], v[168:169]
  v_pk_fma_f32 v[184:185], v[186:187], v[186:187], v[184:185]
  v_pk_add_f32 v[170:171], v[146:147], v[172:173] op_sel_hi:[1,0] neg_lo:[0,1] neg_hi:[0,1]
  v_pk_add_f32 v[186:187], v[162:163], v[188:189] op_sel_hi:[1,0] neg_lo:[0,1] neg_hi:[0,1]
  v_pk_fma_f32 v[168:169], v[170:171], v[170:171], v[168:169]
  v_pk_fma_f32 v[184:185], v[186:187], v[186:187], v[184:185]
  v_pk_add_f32 v[170:171], v[148:149], v[172:173] op_sel_hi:[1,0] neg_lo:[0,1] neg_hi:[0,1]
  v_pk_add_f32 v[186:187], v[164:165], v[188:189] op_sel_hi:[1,0] neg_lo:[0,1] neg_hi:[0,1]
  v_pk_fma_f32 v[168:169], v[170:171], v[170:171], v[168:169]
  v_pk_fma_f32 v[184:185], v[186:187], v[186:187], v[184:185]
  v_pk_add_f32 v[170:171], v[150:151], v[172:173] op_sel_hi:[1,0] neg_lo:[0,1] neg_hi:[0,1]
  v_pk_add_f32 v[186:187], v[166:167], v[188:189] op_sel_hi:[1,0] neg_lo:[0,1] neg_hi:[0,1]
  v_pk_fma_f32 v[168:169], v[170:171], v[170:171], v[168:169]
  v_pk_fma_f32 v[184:185], v[186:187], v[186:187], v[184:185]
  v_add_f32 v168, v168, v169
  v_add_f32 v184, v184, v185
  s_nop 0
  v_add_f32_dpp v168, v168, v168 quad_perm:[1,0,3,2] row_mask:0xf bank_mask:0xf
  v_add_f32_dpp v184, v184, v184 quad_perm:[1,0,3,2] row_mask:0xf bank_mask:0xf
  s_nop 0
  v_add_f32_dpp v168, v168, v168 quad_perm:[2,3,0,1] row_mask:0xf bank_mask:0xf
  v_add_f32_dpp v184, v184, v184 quad_perm:[2,3,0,1] row_mask:0xf bank_mask:0xf
  s_nop 0
  v_add_f32_dpp v168, v168, v168 row_half_mirror row_mask:0xf bank_mask:0xf
  v_add_f32_dpp v184, v184, v184 row_half_mirror row_mask:0xf bank_mask:0xf
  s_nop 0
  v_add_f32_dpp v168, v168, v168 row_mirror row_mask:0xf bank_mask:0xf
  v_add_f32_dpp v184, v184, v184 row_mirror row_mask:0xf bank_mask:0xf
  v_mov_b32 v170, v168
  v_mov_b32 v186, v184
  s_nop 0
  v_permlane16_swap_b32 v168, v170
  v_permlane16_swap_b32 v184, v186
  v_add_f32 v168, v168, v170
  v_add_f32 v184, v184, v186
  v_mov_b32 v170, v168
  v_mov_b32 v186, v184
  s_nop 0
  v_permlane32_swap_b32 v168, v170
  v_permlane32_swap_b32 v184, v186
  v_add_f32 v168, v168, v170
  v_add_f32 v184, v184, v186
  v_mul_f32 v168, s64, v168
  v_mul_f32 v184, s64, v184
  v_cvt_pk_bf16_f32 v170, v168, v168
  v_cvt_pk_bf16_f32 v186, v184, v184
  v_lshlrev_b32 v168, 16, v170
  v_lshlrev_b32 v184, 16, v186
  v_add_f32 v168, s66, v168
  v_add_f32 v184, s66, v184
  v_cvt_pk_bf16_f32 v170, v168, v168
  v_cvt_pk_bf16_f32 v186, v184, v184
  v_lshlrev_b32 v168, 16, v170
  v_lshlrev_b32 v184, 16, v186
  v_sqrt_f32 v168, v168
  v_sqrt_f32 v184, v184
  v_cvt_pk_bf16_f32 v170, v168, v168
  v_cvt_pk_bf16_f32 v186, v184, v184
  v_lshlrev_b32 v168, 16, v170
  v_lshlrev_b32 v184, 16, v186
  v_rcp_f32 v168, v168
  v_rcp_f32 v184, v184
  v_cvt_pk_bf16_f32 v170, v172, v172
  v_cvt_pk_bf16_f32 v186, v188, v188
  v_lshlrev_b32 v172, 16, v170
  v_lshlrev_b32 v188, 16, v186
  v_pk_add_f32 v[136:137], v[136:137], v[172:173] op_sel_hi:[1,0] neg_lo:[0,1] neg_hi:[0,1]
  v_pk_add_f32 v[152:153], v[152:153], v[188:189] op_sel_hi:[1,0] neg_lo:[0,1] neg_hi:[0,1]
  v_cvt_pk_bf16_f32 v170, v136, v137
  v_cvt_pk_bf16_f32 v186, v152, v153
  v_lshlrev_b32 v136, 16, v170
  v_lshlrev_b32 v152, 16, v186
  v_and_b32 v137, 0xffff0000, v170
  v_and_b32 v153, 0xffff0000, v186
  v_pk_mul_f32 v[136:137], v[136:137], v[168:169] op_sel_hi:[1,0]
  v_pk_mul_f32 v[152:153], v[152:153], v[184:185] op_sel_hi:[1,0]
  v_cvt_pk_bf16_f32 v176, v136, v137
  v_cvt_pk_bf16_f32 v192, v152, v153
  v_pk_add_f32 v[138:139], v[138:139], v[172:173] op_sel_hi:[1,0] neg_lo:[0,1] neg_hi:[0,1]
  v_pk_add_f32 v[154:155], v[154:155], v[188:189] op_sel_hi:[1,0] neg_lo:[0,1] neg_hi:[0,1]
  v_cvt_pk_bf16_f32 v170, v138, v139
  v_cvt_pk_bf16_f32 v186, v154, v155
  v_lshlrev_b32 v138, 16, v170
  v_lshlrev_b32 v154, 16, v186
  v_and_b32 v139, 0xffff0000, v170
  v_and_b32 v155, 0xffff0000, v186
  v_pk_mul_f32 v[138:139], v[138:139], v[168:169] op_sel_hi:[1,0]
  v_pk_mul_f32 v[154:155], v[154:155], v[184:185] op_sel_hi:[1,0]
  v_cvt_pk_bf16_f32 v177, v138, v139
  v_cvt_pk_bf16_f32 v193, v154, v155
  v_pk_add_f32 v[140:141], v[140:141], v[172:173] op_sel_hi:[1,0] neg_lo:[0,1] neg_hi:[0,1]
  v_pk_add_f32 v[156:157], v[156:157], v[188:189] op_sel_hi:[1,0] neg_lo:[0,1] neg_hi:[0,1]
  v_cvt_pk_bf16_f32 v170, v140, v141
  v_cvt_pk_bf16_f32 v186, v156, v157
  v_lshlrev_b32 v140, 16, v170
  v_lshlrev_b32 v156, 16, v186
  v_and_b32 v141, 0xffff0000, v170
  v_and_b32 v157, 0xffff0000, v186
  v_pk_mul_f32 v[140:141], v[140:141], v[168:169] op_sel_hi:[1,0]
  v_pk_mul_f32 v[156:157], v[156:157], v[184:185] op_sel_hi:[1,0]
  v_cvt_pk_bf16_f32 v178, v140, v141
  v_cvt_pk_bf16_f32 v194, v156, v157
  v_pk_add_f32 v[142:143], v[142:143], v[172:173] op_sel_hi:[1,0] neg_lo:[0,1] neg_hi:[0,1]
  v_pk_add_f32 v[158:159], v[158:159], v[188:189] op_sel_hi:[1,0] neg_lo:[0,1] neg_hi:[0,1]
  v_cvt_pk_bf16_f32 v170, v142, v143
  v_cvt_pk_bf16_f32 v186, v158, v159
  v_lshlrev_b32 v142, 16, v170
  v_lshlrev_b32 v158, 16, v186
  v_and_b32 v143, 0xffff0000, v170
  v_and_b32 v159, 0xffff0000, v186
  v_pk_mul_f32 v[142:143], v[142:143], v[168:169] op_sel_hi:[1,0]
  v_pk_mul_f32 v[158:159], v[158:159], v[184:185] op_sel_hi:[1,0]
  v_cvt_pk_bf16_f32 v179, v142, v143
  v_cvt_pk_bf16_f32 v195, v158, v159
  v_pk_add_f32 v[144:145], v[144:145], v[172:173] op_sel_hi:[1,0] neg_lo:[0,1] neg_hi:[0,1]
  v_pk_add_f32 v[160:161], v[160:161], v[188:189] op_sel_hi:[1,0] neg_lo:[0,1] neg_hi:[0,1]
  v_cvt_pk_bf16_f32 v170, v144, v145
  v_cvt_pk_bf16_f32 v186, v160, v161
  v_lshlrev_b32 v144, 16, v170
  v_lshlrev_b32 v160, 16, v186
  v_and_b32 v145, 0xffff0000, v170
  v_and_b32 v161, 0xffff0000, v186
  v_pk_mul_f32 v[144:145], v[144:145], v[168:169] op_sel_hi:[1,0]
  v_pk_mul_f32 v[160:161], v[160:161], v[184:185] op_sel_hi:[1,0]
  v_cvt_pk_bf16_f32 v180, v144, v145
  v_cvt_pk_bf16_f32 v196, v160, v161
  v_pk_add_f32 v[146:147], v[146:147], v[172:173] op_sel_hi:[1,0] neg_lo:[0,1] neg_hi:[0,1]
  v_pk_add_f32 v[162:163], v[162:163], v[188:189] op_sel_hi:[1,0] neg_lo:[0,1] neg_hi:[0,1]
  v_cvt_pk_bf16_f32 v170, v146, v147
  v_cvt_pk_bf16_f32 v186, v162, v163
  v_lshlrev_b32 v146, 16, v170
  v_lshlrev_b32 v162, 16, v186
  v_and_b32 v147, 0xffff0000, v170
  v_and_b32 v163, 0xffff0000, v186
  v_pk_mul_f32 v[146:147], v[146:147], v[168:169] op_sel_hi:[1,0]
  v_pk_mul_f32 v[162:163], v[162:163], v[184:185] op_sel_hi:[1,0]
  v_cvt_pk_bf16_f32 v181, v146, v147
  v_cvt_pk_bf16_f32 v197, v162, v163
  v_pk_add_f32 v[148:149], v[148:149], v[172:173] op_sel_hi:[1,0] neg_lo:[0,1] neg_hi:[0,1]
  v_pk_add_f32 v[164:165], v[164:165], v[188:189] op_sel_hi:[1,0] neg_lo:[0,1] neg_hi:[0,1]
  v_cvt_pk_bf16_f32 v170, v148, v149
  v_cvt_pk_bf16_f32 v186, v164, v165
  v_lshlrev_b32 v148, 16, v170
  v_lshlrev_b32 v164, 16, v186
  v_and_b32 v149, 0xffff0000, v170
  v_and_b32 v165, 0xffff0000, v186
  v_pk_mul_f32 v[148:149], v[148:149], v[168:169] op_sel_hi:[1,0]
  v_pk_mul_f32 v[164:165], v[164:165], v[184:185] op_sel_hi:[1,0]
  v_cvt_pk_bf16_f32 v182, v148, v149
  v_cvt_pk_bf16_f32 v198, v164, v165
  v_pk_add_f32 v[150:151], v[150:151], v[172:173] op_sel_hi:[1,0] neg_lo:[0,1] neg_hi:[0,1]
  v_pk_add_f32 v[166:167], v[166:167], v[188:189] op_sel_hi:[1,0] neg_lo:[0,1] neg_hi:[0,1]
  v_cvt_pk_bf16_f32 v170, v150, v151
  v_cvt_pk_bf16_f32 v186, v166, v167
  v_lshlrev_b32 v150, 16, v170
  v_lshlrev_b32 v166, 16, v186
  v_and_b32 v151, 0xffff0000, v170
  v_and_b32 v167, 0xffff0000, v186
  v_pk_mul_f32 v[150:151], v[150:151], v[168:169] op_sel_hi:[1,0]
  v_pk_mul_f32 v[166:167], v[166:167], v[184:185] op_sel_hi:[1,0]
  v_cvt_pk_bf16_f32 v183, v150, v151
  v_cvt_pk_bf16_f32 v199, v166, v167
  buffer_store_dwordx4 v[176:179], v97, s[28:31], s68 offen offset:0 sc1
  buffer_store_dwordx4 v[180:183], v97, s[28:31], s68 offen offset:1024 sc1
  buffer_store_dwordx4 v[192:195], v97, s[28:31], s68 offen offset:2048 sc1
  buffer_store_dwordx4 v[196:199], v97, s[28:31], s68 offen offset:3072 sc1
  s_nop 1
  s_add_u32 s68, s67, 4198400
  v_pk_add_f32 v[168:169], v[208:209], v[210:211]
  v_pk_add_f32 v[184:185], v[224:225], v[226:227]
  v_pk_add_f32 v[168:169], v[168:169], v[212:213]
  v_pk_add_f32 v[184:185], v[184:185], v[228:229]
  v_pk_add_f32 v[168:169], v[168:169], v[214:215]
  v_pk_add_f32 v[184:185], v[184:185], v[230:231]
  v_pk_add_f32 v[168:169], v[168:169], v[216:217]
  v_pk_add_f32 v[184:185], v[184:185], v[232:233]
  v_pk_add_f32 v[168:169], v[168:169], v[218:219]
  v_pk_add_f32 v[184:185], v[184:185], v[234:235]
  v_pk_add_f32 v[168:169], v[168:169], v[220:221]
  v_pk_add_f32 v[184:185], v[184:185], v[236:237]
  v_pk_add_f32 v[168:169], v[168:169], v[222:223]
  v_pk_add_f32 v[184:185], v[184:185], v[238:239]
  v_add_f32 v168, v168, v169
  v_add_f32 v184, v184, v185
  s_nop 0
  v_add_f32_dpp v168, v168, v168 quad_perm:[1,0,3,2] row_mask:0xf bank_mask:0xf
  v_add_f32_dpp v184, v184, v184 quad_perm:[1,0,3,2] row_mask:0xf bank_mask:0xf
  s_nop 0
  v_add_f32_dpp v168, v168, v168 quad_perm:[2,3,0,1] row_mask:0xf bank_mask:0xf
  v_add_f32_dpp v184, v184, v184 quad_perm:[2,3,0,1] row_mask:0xf bank_mask:0xf
  s_nop 0
  v_add_f32_dpp v168, v168, v168 row_half_mirror row_mask:0xf bank_mask:0xf
  v_add_f32_dpp v184, v184, v184 row_half_mirror row_mask:0xf bank_mask:0xf
  s_nop 0
  v_add_f32_dpp v168, v168, v168 row_mirror row_mask:0xf bank_mask:0xf
  v_add_f32_dpp v184, v184, v184 row_mirror row_mask:0xf bank_mask:0xf
  v_mov_b32 v170, v168
  v_mov_b32 v186, v184
  s_nop 0
  v_permlane16_swap_b32 v168, v170
  v_permlane16_swap_b32 v184, v186
  v_add_f32 v168, v168, v170
  v_add_f32 v184, v184, v186
  v_mov_b32 v170, v168
  v_mov_b32 v186, v184
  s_nop 0
  v_permlane32_swap_b32 v168, v170
  v_permlane32_swap_b32 v184, v186
  v_add_f32 v168, v168, v170
  v_add_f32 v184, v184, v186
  v_mul_f32 v172, s64, v168
  v_mul_f32 v188, s64, v184
  v_pk_add_f32 v[170:171], v[208:209], v[172:173] op_sel_hi:[1,0] neg_lo:[0,1] neg_hi:[0,1]
  v_pk_add_f32 v[186:187], v[224:225], v[188:189] op_sel_hi:[1,0] neg_lo:[0,1] neg_hi:[0,1]
  v_pk_mul_f32 v[168:169], v[170:171], v[170:171]
  v_pk_mul_f32 v[184:185], v[186:187], v[186:187]
  v_pk_add_f32 v[170:171], v[210:211], v[172:173] op_sel_hi:[1,0] neg_lo:[0,1] neg_hi:[0,1]
  v_pk_add_f32 v[186:187], v[226:227], v[188:189] op_sel_hi:[1,0] neg_lo:[0,1] neg_hi:[0,1]
  v_pk_fma_f32 v[168:169], v[170:171], v[170:171], v[168:169]
  v_pk_fma_f32 v[184:185], v[186:187], v[186:187], v[184:185]
  v_pk_add_f32 v[170:171], v[212:213], v[172:173] op_sel_hi:[1,0] neg_lo:[0,1] neg_hi:[0,1]
  v_pk_add_f32 v[186:187], v[228:229], v[188:189] op_sel_hi:[1,0] neg_lo:[0,1] neg_hi:[0,1]
  v_pk_fma_f32 v[168:169], v[170:171], v[170:171], v[168:169]
  v_pk_fma_f32 v[184:185], v[186:187], v[186:187], v[184:185]
  v_pk_add_f32 v[170:171], v[214:215], v[172:173] op_sel_hi:[1,0] neg_lo:[0,1] neg_hi:[0,1]
  v_pk_add_f32 v[186:187], v[230:231], v[188:189] op_sel_hi:[1,0] neg_lo:[0,1] neg_hi:[0,1]
  v_pk_fma_f32 v[168:169], v[170:171], v[170:171], v[168:169]
  v_pk_fma_f32 v[184:185], v[186:187], v[186:187], v[184:185]
  v_pk_add_f32 v[170:171], v[216:217], v[172:173] op_sel_hi:[1,0] neg_lo:[0,1] neg_hi:[0,1]
  v_pk_add_f32 v[186:187], v[232:233], v[188:189] op_sel_hi:[1,0] neg_lo:[0,1] neg_hi:[0,1]
  v_pk_fma_f32 v[168:169], v[170:171], v[170:171], v[168:169]
  v_pk_fma_f32 v[184:185], v[186:187], v[186:187], v[184:185]
  v_pk_add_f32 v[170:171], v[218:219], v[172:173] op_sel_hi:[1,0] neg_lo:[0,1] neg_hi:[0,1]
  v_pk_add_f32 v[186:187], v[234:235], v[188:189] op_sel_hi:[1,0] neg_lo:[0,1] neg_hi:[0,1]
  v_pk_fma_f32 v[168:169], v[170:171], v[170:171], v[168:169]
  v_pk_fma_f32 v[184:185], v[186:187], v[186:187], v[184:185]
  v_pk_add_f32 v[170:171], v[220:221], v[172:173] op_sel_hi:[1,0] neg_lo:[0,1] neg_hi:[0,1]
  v_pk_add_f32 v[186:187], v[236:237], v[188:189] op_sel_hi:[1,0] neg_lo:[0,1] neg_hi:[0,1]
  v_pk_fma_f32 v[168:169], v[170:171], v[170:171], v[168:169]
  v_pk_fma_f32 v[184:185], v[186:187], v[186:187], v[184:185]
  v_pk_add_f32 v[170:171], v[222:223], v[172:173] op_sel_hi:[1,0] neg_lo:[0,1] neg_hi:[0,1]
  v_pk_add_f32 v[186:187], v[238:239], v[188:189] op_sel_hi:[1,0] neg_lo:[0,1] neg_hi:[0,1]
  v_pk_fma_f32 v[168:169], v[170:171], v[170:171], v[168:169]
  v_pk_fma_f32 v[184:185], v[186:187], v[186:187], v[184:185]
  v_add_f32 v168, v168, v169
  v_add_f32 v184, v184, v185
  s_nop 0
  v_add_f32_dpp v168, v168, v168 quad_perm:[1,0,3,2] row_mask:0xf bank_mask:0xf
  v_add_f32_dpp v184, v184, v184 quad_perm:[1,0,3,2] row_mask:0xf bank_mask:0xf
  s_nop 0
  v_add_f32_dpp v168, v168, v168 quad_perm:[2,3,0,1] row_mask:0xf bank_mask:0xf
  v_add_f32_dpp v184, v184, v184 quad_perm:[2,3,0,1] row_mask:0xf bank_mask:0xf
  s_nop 0
  v_add_f32_dpp v168, v168, v168 row_half_mirror row_mask:0xf bank_mask:0xf
  v_add_f32_dpp v184, v184, v184 row_half_mirror row_mask:0xf bank_mask:0xf
  s_nop 0
  v_add_f32_dpp v168, v168, v168 row_mirror row_mask:0xf bank_mask:0xf
  v_add_f32_dpp v184, v184, v184 row_mirror row_mask:0xf bank_mask:0xf
  v_mov_b32 v170, v168
  v_mov_b32 v186, v184
  s_nop 0
  v_permlane16_swap_b32 v168, v170
  v_permlane16_swap_b32 v184, v186
  v_add_f32 v168, v168, v170
  v_add_f32 v184, v184, v186
  v_mov_b32 v170, v168
  v_mov_b32 v186, v184
  s_nop 0
  v_permlane32_swap_b32 v168, v170
  v_permlane32_swap_b32 v184, v186
  v_add_f32 v168, v168, v170
  v_add_f32 v184, v184, v186
  v_mul_f32 v168, s64, v168
  v_mul_f32 v184, s64, v184
  v_cvt_pk_bf16_f32 v170, v168, v168
  v_cvt_pk_bf16_f32 v186, v184, v184
  v_lshlrev_b32 v168, 16, v170
  v_lshlrev_b32 v184, 16, v186
  v_add_f32 v168, s66, v168
  v_add_f32 v184, s66, v184
  v_cvt_pk_bf16_f32 v170, v168, v168
  v_cvt_pk_bf16_f32 v186, v184, v184
  v_lshlrev_b32 v168, 16, v170
  v_lshlrev_b32 v184, 16, v186
  v_sqrt_f32 v168, v168
  v_sqrt_f32 v184, v184
  v_cvt_pk_bf16_f32 v170, v168, v168
  v_cvt_pk_bf16_f32 v186, v184, v184
  v_lshlrev_b32 v168, 16, v170
  v_lshlrev_b32 v184, 16, v186
  v_rcp_f32 v168, v168
  v_rcp_f32 v184, v184
  v_cvt_pk_bf16_f32 v170, v172, v172
  v_cvt_pk_bf16_f32 v186, v188, v188
  v_lshlrev_b32 v172, 16, v170
  v_lshlrev_b32 v188, 16, v186
  v_pk_add_f32 v[208:209], v[208:209], v[172:173] op_sel_hi:[1,0] neg_lo:[0,1] neg_hi:[0,1]
  v_pk_add_f32 v[224:225], v[224:225], v[188:189] op_sel_hi:[1,0] neg_lo:[0,1] neg_hi:[0,1]
  v_cvt_pk_bf16_f32 v170, v208, v209
  v_cvt_pk_bf16_f32 v186, v224, v225
  v_lshlrev_b32 v208, 16, v170
  v_lshlrev_b32 v224, 16, v186
  v_and_b32 v209, 0xffff0000, v170
  v_and_b32 v225, 0xffff0000, v186
  v_pk_mul_f32 v[208:209], v[208:209], v[168:169] op_sel_hi:[1,0]
  v_pk_mul_f32 v[224:225], v[224:225], v[184:185] op_sel_hi:[1,0]
  v_cvt_pk_bf16_f32 v176, v208, v209
  v_cvt_pk_bf16_f32 v192, v224, v225
  v_pk_add_f32 v[210:211], v[210:211], v[172:173] op_sel_hi:[1,0] neg_lo:[0,1] neg_hi:[0,1]
  v_pk_add_f32 v[226:227], v[226:227], v[188:189] op_sel_hi:[1,0] neg_lo:[0,1] neg_hi:[0,1]
  v_cvt_pk_bf16_f32 v170, v210, v211
  v_cvt_pk_bf16_f32 v186, v226, v227
  v_lshlrev_b32 v210, 16, v170
  v_lshlrev_b32 v226, 16, v186
  v_and_b32 v211, 0xffff0000, v170
  v_and_b32 v227, 0xffff0000, v186
  v_pk_mul_f32 v[210:211], v[210:211], v[168:169] op_sel_hi:[1,0]
  v_pk_mul_f32 v[226:227], v[226:227], v[184:185] op_sel_hi:[1,0]
  v_cvt_pk_bf16_f32 v177, v210, v211
  v_cvt_pk_bf16_f32 v193, v226, v227
  v_pk_add_f32 v[212:213], v[212:213], v[172:173] op_sel_hi:[1,0] neg_lo:[0,1] neg_hi:[0,1]
  v_pk_add_f32 v[228:229], v[228:229], v[188:189] op_sel_hi:[1,0] neg_lo:[0,1] neg_hi:[0,1]
  v_cvt_pk_bf16_f32 v170, v212, v213
  v_cvt_pk_bf16_f32 v186, v228, v229
  v_lshlrev_b32 v212, 16, v170
  v_lshlrev_b32 v228, 16, v186
  v_and_b32 v213, 0xffff0000, v170
  v_and_b32 v229, 0xffff0000, v186
  v_pk_mul_f32 v[212:213], v[212:213], v[168:169] op_sel_hi:[1,0]
  v_pk_mul_f32 v[228:229], v[228:229], v[184:185] op_sel_hi:[1,0]
  v_cvt_pk_bf16_f32 v178, v212, v213
  v_cvt_pk_bf16_f32 v194, v228, v229
  v_pk_add_f32 v[214:215], v[214:215], v[172:173] op_sel_hi:[1,0] neg_lo:[0,1] neg_hi:[0,1]
  v_pk_add_f32 v[230:231], v[230:231], v[188:189] op_sel_hi:[1,0] neg_lo:[0,1] neg_hi:[0,1]
  v_cvt_pk_bf16_f32 v170, v214, v215
  v_cvt_pk_bf16_f32 v186, v230, v231
  v_lshlrev_b32 v214, 16, v170
  v_lshlrev_b32 v230, 16, v186
  v_and_b32 v215, 0xffff0000, v170
  v_and_b32 v231, 0xffff0000, v186
  v_pk_mul_f32 v[214:215], v[214:215], v[168:169] op_sel_hi:[1,0]
  v_pk_mul_f32 v[230:231], v[230:231], v[184:185] op_sel_hi:[1,0]
  v_cvt_pk_bf16_f32 v179, v214, v215
  v_cvt_pk_bf16_f32 v195, v230, v231
  v_pk_add_f32 v[216:217], v[216:217], v[172:173] op_sel_hi:[1,0] neg_lo:[0,1] neg_hi:[0,1]
  v_pk_add_f32 v[232:233], v[232:233], v[188:189] op_sel_hi:[1,0] neg_lo:[0,1] neg_hi:[0,1]
  v_cvt_pk_bf16_f32 v170, v216, v217
  v_cvt_pk_bf16_f32 v186, v232, v233
  v_lshlrev_b32 v216, 16, v170
  v_lshlrev_b32 v232, 16, v186
  v_and_b32 v217, 0xffff0000, v170
  v_and_b32 v233, 0xffff0000, v186
  v_pk_mul_f32 v[216:217], v[216:217], v[168:169] op_sel_hi:[1,0]
  v_pk_mul_f32 v[232:233], v[232:233], v[184:185] op_sel_hi:[1,0]
  v_cvt_pk_bf16_f32 v180, v216, v217
  v_cvt_pk_bf16_f32 v196, v232, v233
  v_pk_add_f32 v[218:219], v[218:219], v[172:173] op_sel_hi:[1,0] neg_lo:[0,1] neg_hi:[0,1]
  v_pk_add_f32 v[234:235], v[234:235], v[188:189] op_sel_hi:[1,0] neg_lo:[0,1] neg_hi:[0,1]
  v_cvt_pk_bf16_f32 v170, v218, v219
  v_cvt_pk_bf16_f32 v186, v234, v235
  v_lshlrev_b32 v218, 16, v170
  v_lshlrev_b32 v234, 16, v186
  v_and_b32 v219, 0xffff0000, v170
  v_and_b32 v235, 0xffff0000, v186
  v_pk_mul_f32 v[218:219], v[218:219], v[168:169] op_sel_hi:[1,0]
  v_pk_mul_f32 v[234:235], v[234:235], v[184:185] op_sel_hi:[1,0]
  v_cvt_pk_bf16_f32 v181, v218, v219
  v_cvt_pk_bf16_f32 v197, v234, v235
  v_pk_add_f32 v[220:221], v[220:221], v[172:173] op_sel_hi:[1,0] neg_lo:[0,1] neg_hi:[0,1]
  v_pk_add_f32 v[236:237], v[236:237], v[188:189] op_sel_hi:[1,0] neg_lo:[0,1] neg_hi:[0,1]
  v_cvt_pk_bf16_f32 v170, v220, v221
  v_cvt_pk_bf16_f32 v186, v236, v237
  v_lshlrev_b32 v220, 16, v170
  v_lshlrev_b32 v236, 16, v186
  v_and_b32 v221, 0xffff0000, v170
  v_and_b32 v237, 0xffff0000, v186
  v_pk_mul_f32 v[220:221], v[220:221], v[168:169] op_sel_hi:[1,0]
  v_pk_mul_f32 v[236:237], v[236:237], v[184:185] op_sel_hi:[1,0]
  v_cvt_pk_bf16_f32 v182, v220, v221
  v_cvt_pk_bf16_f32 v198, v236, v237
  v_pk_add_f32 v[222:223], v[222:223], v[172:173] op_sel_hi:[1,0] neg_lo:[0,1] neg_hi:[0,1]
  v_pk_add_f32 v[238:239], v[238:239], v[188:189] op_sel_hi:[1,0] neg_lo:[0,1] neg_hi:[0,1]
  v_cvt_pk_bf16_f32 v170, v222, v223
  v_cvt_pk_bf16_f32 v186, v238, v239
  v_lshlrev_b32 v222, 16, v170
  v_lshlrev_b32 v238, 16, v186
  v_and_b32 v223, 0xffff0000, v170
  v_and_b32 v239, 0xffff0000, v186
  v_pk_mul_f32 v[222:223], v[222:223], v[168:169] op_sel_hi:[1,0]
  v_pk_mul_f32 v[238:239], v[238:239], v[184:185] op_sel_hi:[1,0]
  v_cvt_pk_bf16_f32 v183, v222, v223
  v_cvt_pk_bf16_f32 v199, v238, v239
  buffer_store_dwordx4 v[176:179], v97, s[28:31], s68 offen offset:0 sc1
  buffer_store_dwordx4 v[180:183], v97, s[28:31], s68 offen offset:1024 sc1
  buffer_store_dwordx4 v[192:195], v97, s[28:31], s68 offen offset:2048 sc1
  buffer_store_dwordx4 v[196:199], v97, s[28:31], s68 offen offset:3072 sc1
  s_nop 1
  s_add_u32 s68, s67, 8192
  s_add_u32 s69, s68, 4096
  buffer_load_dwordx4 v[104:107], v97, s[28:31], s68 offen offset:0 sc1
  buffer_load_dwordx4 v[108:111], v97, s[28:31], s68 offen offset:1024 sc1
  buffer_load_dwordx4 v[112:115], v97, s[28:31], s68 offen offset:2048 sc1
  buffer_load_dwordx4 v[116:119], v97, s[28:31], s68 offen offset:3072 sc1
  buffer_load_dwordx4 v[120:123], v97, s[28:31], s69 offen offset:0 sc1
  buffer_load_dwordx4 v[124:127], v97, s[28:31], s69 offen offset:1024 sc1
  buffer_load_dwordx4 v[128:131], v97, s[28:31], s69 offen offset:2048 sc1
  buffer_load_dwordx4 v[132:135], v97, s[28:31], s69 offen offset:3072 sc1
  s_waitcnt vmcnt(0)
  v_lshlrev_b32 v136, 16, v104
  v_and_b32 v137, 0xffff0000, v104
  v_lshlrev_b32 v138, 16, v105
  v_and_b32 v139, 0xffff0000, v105
  v_lshlrev_b32 v140, 16, v106
  v_and_b32 v141, 0xffff0000, v106
  v_lshlrev_b32 v142, 16, v107
  v_and_b32 v143, 0xffff0000, v107
  v_lshlrev_b32 v144, 16, v108
  v_and_b32 v145, 0xffff0000, v108
  v_lshlrev_b32 v146, 16, v109
  v_and_b32 v147, 0xffff0000, v109
  v_lshlrev_b32 v148, 16, v110
  v_and_b32 v149, 0xffff0000, v110
  v_lshlrev_b32 v150, 16, v111
  v_and_b32 v151, 0xffff0000, v111
  v_lshlrev_b32 v152, 16, v112
  v_and_b32 v153, 0xffff0000, v112
  v_lshlrev_b32 v154, 16, v113
  v_and_b32 v155, 0xffff0000, v113
  v_lshlrev_b32 v156, 16, v114
  v_and_b32 v157, 0xffff0000, v114
  v_lshlrev_b32 v158, 16, v115
  v_and_b32 v159, 0xffff0000, v115
  v_lshlrev_b32 v160, 16, v116
  v_and_b32 v161, 0xffff0000, v116
  v_lshlrev_b32 v162, 16, v117
  v_and_b32 v163, 0xffff0000, v117
  v_lshlrev_b32 v164, 16, v118
  v_and_b32 v165, 0xffff0000, v118
  v_lshlrev_b32 v166, 16, v119
  v_and_b32 v167, 0xffff0000, v119
  v_lshlrev_b32 v208, 16, v120
  v_and_b32 v209, 0xffff0000, v120
  v_lshlrev_b32 v210, 16, v121
  v_and_b32 v211, 0xffff0000, v121
  v_lshlrev_b32 v212, 16, v122
  v_and_b32 v213, 0xffff0000, v122
  v_lshlrev_b32 v214, 16, v123
  v_and_b32 v215, 0xffff0000, v123
  v_lshlrev_b32 v216, 16, v124
  v_and_b32 v217, 0xffff0000, v124
  v_lshlrev_b32 v218, 16, v125
  v_and_b32 v219, 0xffff0000, v125
  v_lshlrev_b32 v220, 16, v126
  v_and_b32 v221, 0xffff0000, v126
  v_lshlrev_b32 v222, 16, v127
  v_and_b32 v223, 0xffff0000, v127
  v_lshlrev_b32 v224, 16, v128
  v_and_b32 v225, 0xffff0000, v128
  v_lshlrev_b32 v226, 16, v129
  v_and_b32 v227, 0xffff0000, v129
  v_lshlrev_b32 v228, 16, v130
  v_and_b32 v229, 0xffff0000, v130
  v_lshlrev_b32 v230, 16, v131
  v_and_b32 v231, 0xffff0000, v131
  v_lshlrev_b32 v232, 16, v132
  v_and_b32 v233, 0xffff0000, v132
  v_lshlrev_b32 v234, 16, v133
  v_and_b32 v235, 0xffff0000, v133
  v_lshlrev_b32 v236, 16, v134
  v_and_b32 v237, 0xffff0000, v134
  v_lshlrev_b32 v238, 16, v135
  v_and_b32 v239, 0xffff0000, v135
  s_add_u32 s68, s67, 4202496
  v_pk_add_f32 v[168:169], v[136:137], v[138:139]
  v_pk_add_f32 v[184:185], v[152:153], v[154:155]
  v_pk_add_f32 v[168:169], v[168:169], v[140:141]
  v_pk_add_f32 v[184:185], v[184:185], v[156:157]
  v_pk_add_f32 v[168:169], v[168:169], v[142:143]
  v_pk_add_f32 v[184:185], v[184:185], v[158:159]
  v_pk_add_f32 v[168:169], v[168:169], v[144:145]
  v_pk_add_f32 v[184:185], v[184:185], v[160:161]
  v_pk_add_f32 v[168:169], v[168:169], v[146:147]
  v_pk_add_f32 v[184:185], v[184:185], v[162:163]
  v_pk_add_f32 v[168:169], v[168:169], v[148:149]
  v_pk_add_f32 v[184:185], v[184:185], v[164:165]
  v_pk_add_f32 v[168:169], v[168:169], v[150:151]
  v_pk_add_f32 v[184:185], v[184:185], v[166:167]
  v_add_f32 v168, v168, v169
  v_add_f32 v184, v184, v185
  s_nop 0
  v_add_f32_dpp v168, v168, v168 quad_perm:[1,0,3,2] row_mask:0xf bank_mask:0xf
  v_add_f32_dpp v184, v184, v184 quad_perm:[1,0,3,2] row_mask:0xf bank_mask:0xf
  s_nop 0
  v_add_f32_dpp v168, v168, v168 quad_perm:[2,3,0,1] row_mask:0xf bank_mask:0xf
  v_add_f32_dpp v184, v184, v184 quad_perm:[2,3,0,1] row_mask:0xf bank_mask:0xf
  s_nop 0
  v_add_f32_dpp v168, v168, v168 row_half_mirror row_mask:0xf bank_mask:0xf
  v_add_f32_dpp v184, v184, v184 row_half_mirror row_mask:0xf bank_mask:0xf
  s_nop 0
  v_add_f32_dpp v168, v168, v168 row_mirror row_mask:0xf bank_mask:0xf
  v_add_f32_dpp v184, v184, v184 row_mirror row_mask:0xf bank_mask:0xf
  v_mov_b32 v170, v168
  v_mov_b32 v186, v184
  s_nop 0
  v_permlane16_swap_b32 v168, v170
  v_permlane16_swap_b32 v184, v186
  v_add_f32 v168, v168, v170
  v_add_f32 v184, v184, v186
  v_mov_b32 v170, v168
  v_mov_b32 v186, v184
  s_nop 0
  v_permlane32_swap_b32 v168, v170
  v_permlane32_swap_b32 v184, v186
  v_add_f32 v168, v168, v170
  v_add_f32 v184, v184, v186
  v_mul_f32 v172, s64, v168
  v_mul_f32 v188, s64, v184
  v_pk_add_f32 v[170:171], v[136:137], v[172:173] op_sel_hi:[1,0] neg_lo:[0,1] neg_hi:[0,1]
  v_pk_add_f32 v[186:187], v[152:153], v[188:189] op_sel_hi:[1,0] neg_lo:[0,1] neg_hi:[0,1]
  v_pk_mul_f32 v[168:169], v[170:171], v[170:171]
  v_pk_mul_f32 v[184:185], v[186:187], v[186:187]
  v_pk_add_f32 v[170:171], v[138:139], v[172:173] op_sel_hi:[1,0] neg_lo:[0,1] neg_hi:[0,1]
  v_pk_add_f32 v[186:187], v[154:155], v[188:189] op_sel_hi:[1,0] neg_lo:[0,1] neg_hi:[0,1]
  v_pk_fma_f32 v[168:169], v[170:171], v[170:171], v[168:169]
  v_pk_fma_f32 v[184:185], v[186:187], v[186:187], v[184:185]
  v_pk_add_f32 v[170:171], v[140:141], v[172:173] op_sel_hi:[1,0] neg_lo:[0,1] neg_hi:[0,1]
  v_pk_add_f32 v[186:187], v[156:157], v[188:189] op_sel_hi:[1,0] neg_lo:[0,1] neg_hi:[0,1]
  v_pk_fma_f32 v[168:169], v[170:171], v[170:171], v[168:169]
  v_pk_fma_f32 v[184:185], v[186:187], v[186:187], v[184:185]
  v_pk_add_f32 v[170:171], v[142:143], v[172:173] op_sel_hi:[1,0] neg_lo:[0,1] neg_hi:[0,1]
  v_pk_add_f32 v[186:187], v[158:159], v[188:189] op_sel_hi:[1,0] neg_lo:[0,1] neg_hi:[0,1]
  v_pk_fma_f32 v[168:169], v[170:171], v[170:171], v[168:169]
  v_pk_fma_f32 v[184:185], v[186:187], v[186:187], v[184:185]
  v_pk_add_f32 v[170:171], v[144:145], v[172:173] op_sel_hi:[1,0] neg_lo:[0,1] neg_hi:[0,1]
  v_pk_add_f32 v[186:187], v[160:161], v[188:189] op_sel_hi:[1,0] neg_lo:[0,1] neg_hi:[0,1]
  v_pk_fma_f32 v[168:169], v[170:171], v[170:171], v[168:169]
  v_pk_fma_f32 v[184:185], v[186:187], v[186:187], v[184:185]
  v_pk_add_f32 v[170:171], v[146:147], v[172:173] op_sel_hi:[1,0] neg_lo:[0,1] neg_hi:[0,1]
  v_pk_add_f32 v[186:187], v[162:163], v[188:189] op_sel_hi:[1,0] neg_lo:[0,1] neg_hi:[0,1]
  v_pk_fma_f32 v[168:169], v[170:171], v[170:171], v[168:169]
  v_pk_fma_f32 v[184:185], v[186:187], v[186:187], v[184:185]
  v_pk_add_f32 v[170:171], v[148:149], v[172:173] op_sel_hi:[1,0] neg_lo:[0,1] neg_hi:[0,1]
  v_pk_add_f32 v[186:187], v[164:165], v[188:189] op_sel_hi:[1,0] neg_lo:[0,1] neg_hi:[0,1]
  v_pk_fma_f32 v[168:169], v[170:171], v[170:171], v[168:169]
  v_pk_fma_f32 v[184:185], v[186:187], v[186:187], v[184:185]
  v_pk_add_f32 v[170:171], v[150:151], v[172:173] op_sel_hi:[1,0] neg_lo:[0,1] neg_hi:[0,1]
  v_pk_add_f32 v[186:187], v[166:167], v[188:189] op_sel_hi:[1,0] neg_lo:[0,1] neg_hi:[0,1]
  v_pk_fma_f32 v[168:169], v[170:171], v[170:171], v[168:169]
  v_pk_fma_f32 v[184:185], v[186:187], v[186:187], v[184:185]
  v_add_f32 v168, v168, v169
  v_add_f32 v184, v184, v185
  s_nop 0
  v_add_f32_dpp v168, v168, v168 quad_perm:[1,0,3,2] row_mask:0xf bank_mask:0xf
  v_add_f32_dpp v184, v184, v184 quad_perm:[1,0,3,2] row_mask:0xf bank_mask:0xf
  s_nop 0
  v_add_f32_dpp v168, v168, v168 quad_perm:[2,3,0,1] row_mask:0xf bank_mask:0xf
  v_add_f32_dpp v184, v184, v184 quad_perm:[2,3,0,1] row_mask:0xf bank_mask:0xf
  s_nop 0
  v_add_f32_dpp v168, v168, v168 row_half_mirror row_mask:0xf bank_mask:0xf
  v_add_f32_dpp v184, v184, v184 row_half_mirror row_mask:0xf bank_mask:0xf
  s_nop 0
  v_add_f32_dpp v168, v168, v168 row_mirror row_mask:0xf bank_mask:0xf
  v_add_f32_dpp v184, v184, v184 row_mirror row_mask:0xf bank_mask:0xf
  v_mov_b32 v170, v168
  v_mov_b32 v186, v184
  s_nop 0
  v_permlane16_swap_b32 v168, v170
  v_permlane16_swap_b32 v184, v186
  v_add_f32 v168, v168, v170
  v_add_f32 v184, v184, v186
  v_mov_b32 v170, v168
  v_mov_b32 v186, v184
  s_nop 0
  v_permlane32_swap_b32 v168, v170
  v_permlane32_swap_b32 v184, v186
  v_add_f32 v168, v168, v170
  v_add_f32 v184, v184, v186
  v_mul_f32 v168, s64, v168
  v_mul_f32 v184, s64, v184
  v_cvt_pk_bf16_f32 v170, v168, v168
  v_cvt_pk_bf16_f32 v186, v184, v184
  v_lshlrev_b32 v168, 16, v170
  v_lshlrev_b32 v184, 16, v186
  v_add_f32 v168, s66, v168
  v_add_f32 v184, s66, v184
  v_cvt_pk_bf16_f32 v170, v168, v168
  v_cvt_pk_bf16_f32 v186, v184, v184
  v_lshlrev_b32 v168, 16, v170
  v_lshlrev_b32 v184, 16, v186
  v_sqrt_f32 v168, v168
  v_sqrt_f32 v184, v184
  v_cvt_pk_bf16_f32 v170, v168, v168
  v_cvt_pk_bf16_f32 v186, v184, v184
  v_lshlrev_b32 v168, 16, v170
  v_lshlrev_b32 v184, 16, v186
  v_rcp_f32 v168, v168
  v_rcp_f32 v184, v184
  v_cvt_pk_bf16_f32 v170, v172, v172
  v_cvt_pk_bf16_f32 v186, v188, v188
  v_lshlrev_b32 v172, 16, v170
  v_lshlrev_b32 v188, 16, v186
  v_pk_add_f32 v[136:137], v[136:137], v[172:173] op_sel_hi:[1,0] neg_lo:[0,1] neg_hi:[0,1]
  v_pk_add_f32 v[152:153], v[152:153], v[188:189] op_sel_hi:[1,0] neg_lo:[0,1] neg_hi:[0,1]
  v_cvt_pk_bf16_f32 v170, v136, v137
  v_cvt_pk_bf16_f32 v186, v152, v153
  v_lshlrev_b32 v136, 16, v170
  v_lshlrev_b32 v152, 16, v186
  v_and_b32 v137, 0xffff0000, v170
  v_and_b32 v153, 0xffff0000, v186
  v_pk_mul_f32 v[136:137], v[136:137], v[168:169] op_sel_hi:[1,0]
  v_pk_mul_f32 v[152:153], v[152:153], v[184:185] op_sel_hi:[1,0]
  v_cvt_pk_bf16_f32 v176, v136, v137
  v_cvt_pk_bf16_f32 v192, v152, v153
  v_pk_add_f32 v[138:139], v[138:139], v[172:173] op_sel_hi:[1,0] neg_lo:[0,1] neg_hi:[0,1]
  v_pk_add_f32 v[154:155], v[154:155], v[188:189] op_sel_hi:[1,0] neg_lo:[0,1] neg_hi:[0,1]
  v_cvt_pk_bf16_f32 v170, v138, v139
  v_cvt_pk_bf16_f32 v186, v154, v155
  v_lshlrev_b32 v138, 16, v170
  v_lshlrev_b32 v154, 16, v186
  v_and_b32 v139, 0xffff0000, v170
  v_and_b32 v155, 0xffff0000, v186
  v_pk_mul_f32 v[138:139], v[138:139], v[168:169] op_sel_hi:[1,0]
  v_pk_mul_f32 v[154:155], v[154:155], v[184:185] op_sel_hi:[1,0]
  v_cvt_pk_bf16_f32 v177, v138, v139
  v_cvt_pk_bf16_f32 v193, v154, v155
  v_pk_add_f32 v[140:141], v[140:141], v[172:173] op_sel_hi:[1,0] neg_lo:[0,1] neg_hi:[0,1]
  v_pk_add_f32 v[156:157], v[156:157], v[188:189] op_sel_hi:[1,0] neg_lo:[0,1] neg_hi:[0,1]
  v_cvt_pk_bf16_f32 v170, v140, v141
  v_cvt_pk_bf16_f32 v186, v156, v157
  v_lshlrev_b32 v140, 16, v170
  v_lshlrev_b32 v156, 16, v186
  v_and_b32 v141, 0xffff0000, v170
  v_and_b32 v157, 0xffff0000, v186
  v_pk_mul_f32 v[140:141], v[140:141], v[168:169] op_sel_hi:[1,0]
  v_pk_mul_f32 v[156:157], v[156:157], v[184:185] op_sel_hi:[1,0]
  v_cvt_pk_bf16_f32 v178, v140, v141
  v_cvt_pk_bf16_f32 v194, v156, v157
  v_pk_add_f32 v[142:143], v[142:143], v[172:173] op_sel_hi:[1,0] neg_lo:[0,1] neg_hi:[0,1]
  v_pk_add_f32 v[158:159], v[158:159], v[188:189] op_sel_hi:[1,0] neg_lo:[0,1] neg_hi:[0,1]
  v_cvt_pk_bf16_f32 v170, v142, v143
  v_cvt_pk_bf16_f32 v186, v158, v159
  v_lshlrev_b32 v142, 16, v170
  v_lshlrev_b32 v158, 16, v186
  v_and_b32 v143, 0xffff0000, v170
  v_and_b32 v159, 0xffff0000, v186
  v_pk_mul_f32 v[142:143], v[142:143], v[168:169] op_sel_hi:[1,0]
  v_pk_mul_f32 v[158:159], v[158:159], v[184:185] op_sel_hi:[1,0]
  v_cvt_pk_bf16_f32 v179, v142, v143
  v_cvt_pk_bf16_f32 v195, v158, v159
  v_pk_add_f32 v[144:145], v[144:145], v[172:173] op_sel_hi:[1,0] neg_lo:[0,1] neg_hi:[0,1]
  v_pk_add_f32 v[160:161], v[160:161], v[188:189] op_sel_hi:[1,0] neg_lo:[0,1] neg_hi:[0,1]
  v_cvt_pk_bf16_f32 v170, v144, v145
  v_cvt_pk_bf16_f32 v186, v160, v161
  v_lshlrev_b32 v144, 16, v170
  v_lshlrev_b32 v160, 16, v186
  v_and_b32 v145, 0xffff0000, v170
  v_and_b32 v161, 0xffff0000, v186
  v_pk_mul_f32 v[144:145], v[144:145], v[168:169] op_sel_hi:[1,0]
  v_pk_mul_f32 v[160:161], v[160:161], v[184:185] op_sel_hi:[1,0]
  v_cvt_pk_bf16_f32 v180, v144, v145
  v_cvt_pk_bf16_f32 v196, v160, v161
  v_pk_add_f32 v[146:147], v[146:147], v[172:173] op_sel_hi:[1,0] neg_lo:[0,1] neg_hi:[0,1]
  v_pk_add_f32 v[162:163], v[162:163], v[188:189] op_sel_hi:[1,0] neg_lo:[0,1] neg_hi:[0,1]
  v_cvt_pk_bf16_f32 v170, v146, v147
  v_cvt_pk_bf16_f32 v186, v162, v163
  v_lshlrev_b32 v146, 16, v170
  v_lshlrev_b32 v162, 16, v186
  v_and_b32 v147, 0xffff0000, v170
  v_and_b32 v163, 0xffff0000, v186
  v_pk_mul_f32 v[146:147], v[146:147], v[168:169] op_sel_hi:[1,0]
  v_pk_mul_f32 v[162:163], v[162:163], v[184:185] op_sel_hi:[1,0]
  v_cvt_pk_bf16_f32 v181, v146, v147
  v_cvt_pk_bf16_f32 v197, v162, v163
  v_pk_add_f32 v[148:149], v[148:149], v[172:173] op_sel_hi:[1,0] neg_lo:[0,1] neg_hi:[0,1]
  v_pk_add_f32 v[164:165], v[164:165], v[188:189] op_sel_hi:[1,0] neg_lo:[0,1] neg_hi:[0,1]
  v_cvt_pk_bf16_f32 v170, v148, v149
  v_cvt_pk_bf16_f32 v186, v164, v165
  v_lshlrev_b32 v148, 16, v170
  v_lshlrev_b32 v164, 16, v186
  v_and_b32 v149, 0xffff0000, v170
  v_and_b32 v165, 0xffff0000, v186
  v_pk_mul_f32 v[148:149], v[148:149], v[168:169] op_sel_hi:[1,0]
  v_pk_mul_f32 v[164:165], v[164:165], v[184:185] op_sel_hi:[1,0]
  v_cvt_pk_bf16_f32 v182, v148, v149
  v_cvt_pk_bf16_f32 v198, v164, v165
  v_pk_add_f32 v[150:151], v[150:151], v[172:173] op_sel_hi:[1,0] neg_lo:[0,1] neg_hi:[0,1]
  v_pk_add_f32 v[166:167], v[166:167], v[188:189] op_sel_hi:[1,0] neg_lo:[0,1] neg_hi:[0,1]
  v_cvt_pk_bf16_f32 v170, v150, v151
  v_cvt_pk_bf16_f32 v186, v166, v167
  v_lshlrev_b32 v150, 16, v170
  v_lshlrev_b32 v166, 16, v186
  v_and_b32 v151, 0xffff0000, v170
  v_and_b32 v167, 0xffff0000, v186
  v_pk_mul_f32 v[150:151], v[150:151], v[168:169] op_sel_hi:[1,0]
  v_pk_mul_f32 v[166:167], v[166:167], v[184:185] op_sel_hi:[1,0]
  v_cvt_pk_bf16_f32 v183, v150, v151
  v_cvt_pk_bf16_f32 v199, v166, v167
  buffer_store_dwordx4 v[176:179], v97, s[28:31], s68 offen offset:0 sc1
  buffer_store_dwordx4 v[180:183], v97, s[28:31], s68 offen offset:1024 sc1
  buffer_store_dwordx4 v[192:195], v97, s[28:31], s68 offen offset:2048 sc1
  buffer_store_dwordx4 v[196:199], v97, s[28:31], s68 offen offset:3072 sc1
  s_nop 1
  s_add_u32 s68, s67, 4206592
  v_pk_add_f32 v[168:169], v[208:209], v[210:211]
  v_pk_add_f32 v[184:185], v[224:225], v[226:227]
  v_pk_add_f32 v[168:169], v[168:169], v[212:213]
  v_pk_add_f32 v[184:185], v[184:185], v[228:229]
  v_pk_add_f32 v[168:169], v[168:169], v[214:215]
  v_pk_add_f32 v[184:185], v[184:185], v[230:231]
  v_pk_add_f32 v[168:169], v[168:169], v[216:217]
  v_pk_add_f32 v[184:185], v[184:185], v[232:233]
  v_pk_add_f32 v[168:169], v[168:169], v[218:219]
  v_pk_add_f32 v[184:185], v[184:185], v[234:235]
  v_pk_add_f32 v[168:169], v[168:169], v[220:221]
  v_pk_add_f32 v[184:185], v[184:185], v[236:237]
  v_pk_add_f32 v[168:169], v[168:169], v[222:223]
  v_pk_add_f32 v[184:185], v[184:185], v[238:239]
  v_add_f32 v168, v168, v169
  v_add_f32 v184, v184, v185
  s_nop 0
  v_add_f32_dpp v168, v168, v168 quad_perm:[1,0,3,2] row_mask:0xf bank_mask:0xf
  v_add_f32_dpp v184, v184, v184 quad_perm:[1,0,3,2] row_mask:0xf bank_mask:0xf
  s_nop 0
  v_add_f32_dpp v168, v168, v168 quad_perm:[2,3,0,1] row_mask:0xf bank_mask:0xf
  v_add_f32_dpp v184, v184, v184 quad_perm:[2,3,0,1] row_mask:0xf bank_mask:0xf
  s_nop 0
  v_add_f32_dpp v168, v168, v168 row_half_mirror row_mask:0xf bank_mask:0xf
  v_add_f32_dpp v184, v184, v184 row_half_mirror row_mask:0xf bank_mask:0xf
  s_nop 0
  v_add_f32_dpp v168, v168, v168 row_mirror row_mask:0xf bank_mask:0xf
  v_add_f32_dpp v184, v184, v184 row_mirror row_mask:0xf bank_mask:0xf
  v_mov_b32 v170, v168
  v_mov_b32 v186, v184
  s_nop 0
  v_permlane16_swap_b32 v168, v170
  v_permlane16_swap_b32 v184, v186
  v_add_f32 v168, v168, v170
  v_add_f32 v184, v184, v186
  v_mov_b32 v170, v168
  v_mov_b32 v186, v184
  s_nop 0
  v_permlane32_swap_b32 v168, v170
  v_permlane32_swap_b32 v184, v186
  v_add_f32 v168, v168, v170
  v_add_f32 v184, v184, v186
  v_mul_f32 v172, s64, v168
  v_mul_f32 v188, s64, v184
  v_pk_add_f32 v[170:171], v[208:209], v[172:173] op_sel_hi:[1,0] neg_lo:[0,1] neg_hi:[0,1]
  v_pk_add_f32 v[186:187], v[224:225], v[188:189] op_sel_hi:[1,0] neg_lo:[0,1] neg_hi:[0,1]
  v_pk_mul_f32 v[168:169], v[170:171], v[170:171]
  v_pk_mul_f32 v[184:185], v[186:187], v[186:187]
  v_pk_add_f32 v[170:171], v[210:211], v[172:173] op_sel_hi:[1,0] neg_lo:[0,1] neg_hi:[0,1]
  v_pk_add_f32 v[186:187], v[226:227], v[188:189] op_sel_hi:[1,0] neg_lo:[0,1] neg_hi:[0,1]
  v_pk_fma_f32 v[168:169], v[170:171], v[170:171], v[168:169]
  v_pk_fma_f32 v[184:185], v[186:187], v[186:187], v[184:185]
  v_pk_add_f32 v[170:171], v[212:213], v[172:173] op_sel_hi:[1,0] neg_lo:[0,1] neg_hi:[0,1]
  v_pk_add_f32 v[186:187], v[228:229], v[188:189] op_sel_hi:[1,0] neg_lo:[0,1] neg_hi:[0,1]
  v_pk_fma_f32 v[168:169], v[170:171], v[170:171], v[168:169]
  v_pk_fma_f32 v[184:185], v[186:187], v[186:187], v[184:185]
  v_pk_add_f32 v[170:171], v[214:215], v[172:173] op_sel_hi:[1,0] neg_lo:[0,1] neg_hi:[0,1]
  v_pk_add_f32 v[186:187], v[230:231], v[188:189] op_sel_hi:[1,0] neg_lo:[0,1] neg_hi:[0,1]
  v_pk_fma_f32 v[168:169], v[170:171], v[170:171], v[168:169]
  v_pk_fma_f32 v[184:185], v[186:187], v[186:187], v[184:185]
  v_pk_add_f32 v[170:171], v[216:217], v[172:173] op_sel_hi:[1,0] neg_lo:[0,1] neg_hi:[0,1]
  v_pk_add_f32 v[186:187], v[232:233], v[188:189] op_sel_hi:[1,0] neg_lo:[0,1] neg_hi:[0,1]
  v_pk_fma_f32 v[168:169], v[170:171], v[170:171], v[168:169]
  v_pk_fma_f32 v[184:185], v[186:187], v[186:187], v[184:185]
  v_pk_add_f32 v[170:171], v[218:219], v[172:173] op_sel_hi:[1,0] neg_lo:[0,1] neg_hi:[0,1]
  v_pk_add_f32 v[186:187], v[234:235], v[188:189] op_sel_hi:[1,0] neg_lo:[0,1] neg_hi:[0,1]
  v_pk_fma_f32 v[168:169], v[170:171], v[170:171], v[168:169]
  v_pk_fma_f32 v[184:185], v[186:187], v[186:187], v[184:185]
  v_pk_add_f32 v[170:171], v[220:221], v[172:173] op_sel_hi:[1,0] neg_lo:[0,1] neg_hi:[0,1]
  v_pk_add_f32 v[186:187], v[236:237], v[188:189] op_sel_hi:[1,0] neg_lo:[0,1] neg_hi:[0,1]
  v_pk_fma_f32 v[168:169], v[170:171], v[170:171], v[168:169]
  v_pk_fma_f32 v[184:185], v[186:187], v[186:187], v[184:185]
  v_pk_add_f32 v[170:171], v[222:223], v[172:173] op_sel_hi:[1,0] neg_lo:[0,1] neg_hi:[0,1]
  v_pk_add_f32 v[186:187], v[238:239], v[188:189] op_sel_hi:[1,0] neg_lo:[0,1] neg_hi:[0,1]
  v_pk_fma_f32 v[168:169], v[170:171], v[170:171], v[168:169]
  v_pk_fma_f32 v[184:185], v[186:187], v[186:187], v[184:185]
  v_add_f32 v168, v168, v169
  v_add_f32 v184, v184, v185
  s_nop 0
  v_add_f32_dpp v168, v168, v168 quad_perm:[1,0,3,2] row_mask:0xf bank_mask:0xf
  v_add_f32_dpp v184, v184, v184 quad_perm:[1,0,3,2] row_mask:0xf bank_mask:0xf
  s_nop 0
  v_add_f32_dpp v168, v168, v168 quad_perm:[2,3,0,1] row_mask:0xf bank_mask:0xf
  v_add_f32_dpp v184, v184, v184 quad_perm:[2,3,0,1] row_mask:0xf bank_mask:0xf
  s_nop 0
  v_add_f32_dpp v168, v168, v168 row_half_mirror row_mask:0xf bank_mask:0xf
  v_add_f32_dpp v184, v184, v184 row_half_mirror row_mask:0xf bank_mask:0xf
  s_nop 0
  v_add_f32_dpp v168, v168, v168 row_mirror row_mask:0xf bank_mask:0xf
  v_add_f32_dpp v184, v184, v184 row_mirror row_mask:0xf bank_mask:0xf
  v_mov_b32 v170, v168
  v_mov_b32 v186, v184
  s_nop 0
  v_permlane16_swap_b32 v168, v170
  v_permlane16_swap_b32 v184, v186
  v_add_f32 v168, v168, v170
  v_add_f32 v184, v184, v186
  v_mov_b32 v170, v168
  v_mov_b32 v186, v184
  s_nop 0
  v_permlane32_swap_b32 v168, v170
  v_permlane32_swap_b32 v184, v186
  v_add_f32 v168, v168, v170
  v_add_f32 v184, v184, v186
  v_mul_f32 v168, s64, v168
  v_mul_f32 v184, s64, v184
  v_cvt_pk_bf16_f32 v170, v168, v168
  v_cvt_pk_bf16_f32 v186, v184, v184
  v_lshlrev_b32 v168, 16, v170
  v_lshlrev_b32 v184, 16, v186
  v_add_f32 v168, s66, v168
  v_add_f32 v184, s66, v184
  v_cvt_pk_bf16_f32 v170, v168, v168
  v_cvt_pk_bf16_f32 v186, v184, v184
  v_lshlrev_b32 v168, 16, v170
  v_lshlrev_b32 v184, 16, v186
  v_sqrt_f32 v168, v168
  v_sqrt_f32 v184, v184
  v_cvt_pk_bf16_f32 v170, v168, v168
  v_cvt_pk_bf16_f32 v186, v184, v184
  v_lshlrev_b32 v168, 16, v170
  v_lshlrev_b32 v184, 16, v186
  v_rcp_f32 v168, v168
  v_rcp_f32 v184, v184
  v_cvt_pk_bf16_f32 v170, v172, v172
  v_cvt_pk_bf16_f32 v186, v188, v188
  v_lshlrev_b32 v172, 16, v170
  v_lshlrev_b32 v188, 16, v186
  v_pk_add_f32 v[208:209], v[208:209], v[172:173] op_sel_hi:[1,0] neg_lo:[0,1] neg_hi:[0,1]
  v_pk_add_f32 v[224:225], v[224:225], v[188:189] op_sel_hi:[1,0] neg_lo:[0,1] neg_hi:[0,1]
  v_cvt_pk_bf16_f32 v170, v208, v209
  v_cvt_pk_bf16_f32 v186, v224, v225
  v_lshlrev_b32 v208, 16, v170
  v_lshlrev_b32 v224, 16, v186
  v_and_b32 v209, 0xffff0000, v170
  v_and_b32 v225, 0xffff0000, v186
  v_pk_mul_f32 v[208:209], v[208:209], v[168:169] op_sel_hi:[1,0]
  v_pk_mul_f32 v[224:225], v[224:225], v[184:185] op_sel_hi:[1,0]
  v_cvt_pk_bf16_f32 v176, v208, v209
  v_cvt_pk_bf16_f32 v192, v224, v225
  v_pk_add_f32 v[210:211], v[210:211], v[172:173] op_sel_hi:[1,0] neg_lo:[0,1] neg_hi:[0,1]
  v_pk_add_f32 v[226:227], v[226:227], v[188:189] op_sel_hi:[1,0] neg_lo:[0,1] neg_hi:[0,1]
  v_cvt_pk_bf16_f32 v170, v210, v211
  v_cvt_pk_bf16_f32 v186, v226, v227
  v_lshlrev_b32 v210, 16, v170
  v_lshlrev_b32 v226, 16, v186
  v_and_b32 v211, 0xffff0000, v170
  v_and_b32 v227, 0xffff0000, v186
  v_pk_mul_f32 v[210:211], v[210:211], v[168:169] op_sel_hi:[1,0]
  v_pk_mul_f32 v[226:227], v[226:227], v[184:185] op_sel_hi:[1,0]
  v_cvt_pk_bf16_f32 v177, v210, v211
  v_cvt_pk_bf16_f32 v193, v226, v227
  v_pk_add_f32 v[212:213], v[212:213], v[172:173] op_sel_hi:[1,0] neg_lo:[0,1] neg_hi:[0,1]
  v_pk_add_f32 v[228:229], v[228:229], v[188:189] op_sel_hi:[1,0] neg_lo:[0,1] neg_hi:[0,1]
  v_cvt_pk_bf16_f32 v170, v212, v213
  v_cvt_pk_bf16_f32 v186, v228, v229
  v_lshlrev_b32 v212, 16, v170
  v_lshlrev_b32 v228, 16, v186
  v_and_b32 v213, 0xffff0000, v170
  v_and_b32 v229, 0xffff0000, v186
  v_pk_mul_f32 v[212:213], v[212:213], v[168:169] op_sel_hi:[1,0]
  v_pk_mul_f32 v[228:229], v[228:229], v[184:185] op_sel_hi:[1,0]
  v_cvt_pk_bf16_f32 v178, v212, v213
  v_cvt_pk_bf16_f32 v194, v228, v229
  v_pk_add_f32 v[214:215], v[214:215], v[172:173] op_sel_hi:[1,0] neg_lo:[0,1] neg_hi:[0,1]
  v_pk_add_f32 v[230:231], v[230:231], v[188:189] op_sel_hi:[1,0] neg_lo:[0,1] neg_hi:[0,1]
  v_cvt_pk_bf16_f32 v170, v214, v215
  v_cvt_pk_bf16_f32 v186, v230, v231
  v_lshlrev_b32 v214, 16, v170
  v_lshlrev_b32 v230, 16, v186
  v_and_b32 v215, 0xffff0000, v170
  v_and_b32 v231, 0xffff0000, v186
  v_pk_mul_f32 v[214:215], v[214:215], v[168:169] op_sel_hi:[1,0]
  v_pk_mul_f32 v[230:231], v[230:231], v[184:185] op_sel_hi:[1,0]
  v_cvt_pk_bf16_f32 v179, v214, v215
  v_cvt_pk_bf16_f32 v195, v230, v231
  v_pk_add_f32 v[216:217], v[216:217], v[172:173] op_sel_hi:[1,0] neg_lo:[0,1] neg_hi:[0,1]
  v_pk_add_f32 v[232:233], v[232:233], v[188:189] op_sel_hi:[1,0] neg_lo:[0,1] neg_hi:[0,1]
  v_cvt_pk_bf16_f32 v170, v216, v217
  v_cvt_pk_bf16_f32 v186, v232, v233
  v_lshlrev_b32 v216, 16, v170
  v_lshlrev_b32 v232, 16, v186
  v_and_b32 v217, 0xffff0000, v170
  v_and_b32 v233, 0xffff0000, v186
  v_pk_mul_f32 v[216:217], v[216:217], v[168:169] op_sel_hi:[1,0]
  v_pk_mul_f32 v[232:233], v[232:233], v[184:185] op_sel_hi:[1,0]
  v_cvt_pk_bf16_f32 v180, v216, v217
  v_cvt_pk_bf16_f32 v196, v232, v233
  v_pk_add_f32 v[218:219], v[218:219], v[172:173] op_sel_hi:[1,0] neg_lo:[0,1] neg_hi:[0,1]
  v_pk_add_f32 v[234:235], v[234:235], v[188:189] op_sel_hi:[1,0] neg_lo:[0,1] neg_hi:[0,1]
  v_cvt_pk_bf16_f32 v170, v218, v219
  v_cvt_pk_bf16_f32 v186, v234, v235
  v_lshlrev_b32 v218, 16, v170
  v_lshlrev_b32 v234, 16, v186
  v_and_b32 v219, 0xffff0000, v170
  v_and_b32 v235, 0xffff0000, v186
  v_pk_mul_f32 v[218:219], v[218:219], v[168:169] op_sel_hi:[1,0]
  v_pk_mul_f32 v[234:235], v[234:235], v[184:185] op_sel_hi:[1,0]
  v_cvt_pk_bf16_f32 v181, v218, v219
  v_cvt_pk_bf16_f32 v197, v234, v235
  v_pk_add_f32 v[220:221], v[220:221], v[172:173] op_sel_hi:[1,0] neg_lo:[0,1] neg_hi:[0,1]
  v_pk_add_f32 v[236:237], v[236:237], v[188:189] op_sel_hi:[1,0] neg_lo:[0,1] neg_hi:[0,1]
  v_cvt_pk_bf16_f32 v170, v220, v221
  v_cvt_pk_bf16_f32 v186, v236, v237
  v_lshlrev_b32 v220, 16, v170
  v_lshlrev_b32 v236, 16, v186
  v_and_b32 v221, 0xffff0000, v170
  v_and_b32 v237, 0xffff0000, v186
  v_pk_mul_f32 v[220:221], v[220:221], v[168:169] op_sel_hi:[1,0]
  v_pk_mul_f32 v[236:237], v[236:237], v[184:185] op_sel_hi:[1,0]
  v_cvt_pk_bf16_f32 v182, v220, v221
  v_cvt_pk_bf16_f32 v198, v236, v237
  v_pk_add_f32 v[222:223], v[222:223], v[172:173] op_sel_hi:[1,0] neg_lo:[0,1] neg_hi:[0,1]
  v_pk_add_f32 v[238:239], v[238:239], v[188:189] op_sel_hi:[1,0] neg_lo:[0,1] neg_hi:[0,1]
  v_cvt_pk_bf16_f32 v170, v222, v223
  v_cvt_pk_bf16_f32 v186, v238, v239
  v_lshlrev_b32 v222, 16, v170
  v_lshlrev_b32 v238, 16, v186
  v_and_b32 v223, 0xffff0000, v170
  v_and_b32 v239, 0xffff0000, v186
  v_pk_mul_f32 v[222:223], v[222:223], v[168:169] op_sel_hi:[1,0]
  v_pk_mul_f32 v[238:239], v[238:239], v[184:185] op_sel_hi:[1,0]
  v_cvt_pk_bf16_f32 v183, v222, v223
  v_cvt_pk_bf16_f32 v199, v238, v239
  buffer_store_dwordx4 v[176:179], v97, s[28:31], s68 offen offset:0 sc1
  buffer_store_dwordx4 v[180:183], v97, s[28:31], s68 offen offset:1024 sc1
  buffer_store_dwordx4 v[192:195], v97, s[28:31], s68 offen offset:2048 sc1
  buffer_store_dwordx4 v[196:199], v97, s[28:31], s68 offen offset:3072 sc1
  s_nop 1
  s_mov_b32 s86, 37
  s_waitcnt vmcnt(0)
  s_barrier
  s_cmp_lg_u32 s58, 0
  s_cbranch_scc1 sg_54
  v_mov_b32 v26, 1
  s_mov_b64 exec, 1
  s_lshl_b32 s61, s86, 7
  s_add_u32 s61, s61, 99614720
  buffer_atomic_add v26, v255, s[28:31], s61 offen sc1
  s_mov_b64 exec, -1
sg_54:
  s_nop 0
  s_branch w_next
w_qf_pre:
  s_mov_b32 s79, 0
  s_mov_b32 s51, 7
  s_branch w_f_pre
w_qf:
  s_lshl_b32 s89, s82, 19
  s_add_u32 s89, s89, 0
  s_add_u32 s40, s14, s89
  s_addc_u32 s41, s15, 0
  s_sub_u32 s40, s40, 4096
  s_subb_u32 s41, s41, 0
  s_sub_u32 s42, 268439552, s89
  s_mov_b32 s43, 0x20000
  s_mov_b32 s56, 2048
  s_mov_b32 s75, 3
  s_mov_b32 s76, 0
  s_mov_b32 s77, 128
  s_branch w_f0
w_g3:
  s_mov_b32 s86, 37
  s_lshl_b32 s61, s86, 7
  s_add_u32 s61, s61, 99614720
  s_cmp_lg_u32 s58, 0
  s_cbranch_scc1 wf_55_ok
wf_55:
  buffer_load_dword v26, v255, s[28:31], s61 offen sc1
  s_waitcnt vmcnt(0)
  v_readfirstlane_b32 s62, v26
  s_nop 3
  s_cmp_ge_u32 s62, 64
  s_cbranch_scc1 wf_55_ok
  s_sub_u32 s88, s88, 1
  s_cselect_b32 s88, 0, s88
  s_cbranch_scc1 wf_55_ok
  s_sleep 3
  s_branch wf_55
wf_55_ok:
  s_barrier
  s_nop 0
  s_lshl_b32 s89, s83, 9
  s_add_u32 s44, s16, s89
  s_addc_u32 s45, s17, 0
  s_sub_u32 s46, 14680064, s89
  s_mov_b32 s47, 0x20000
  s_lshl_b32 s89, s82, 9
  s_add_u32 s89, s89, 4194304
  s_add_u32 s40, s14, s89
  s_addc_u32 s41, s15, 0
  s_sub_u32 s42, 268435456, s89
  s_mov_b32 s43, 0x20000
  s_mov_b32 s56, 2048
  s_mov_b32 s57, 7168
  s_mov_b32 s51, 15
  v_lshrrev_b32 v26, 5, v1
  v_lshlrev_b32 v26, 3, v26
  v_bfe_u32 v27, v1, 2, 2
  v_add_u32 v26, v26, v27
  v_lshlrev_b32 v26, 9, v26
  v_bfe_u32 v14, v1, 4, 1
  v_lshlrev_b32 v14, 5, v14
  v_add_u32 v26, v26, v14
  v_and_b32 v14, 3, v1
  v_lshlrev_b32 v14, 3, v14
  v_add_u32 v26, v26, v14
  s_lshl_b32 s61, s60, 8
  v_add_u32 v26, s61, v26
  v_xor_b32 v14, 0, v27
  v_lshl_add_u32 v18, v14, 6, v26
  v_xor_b32 v14, 1, v27
  v_lshl_add_u32 v19, v14, 6, v26
  v_xor_b32 v14, 2, v27
  v_lshl_add_u32 v20, v14, 6, v26
  v_xor_b32 v14, 3, v27
  v_lshl_add_u32 v21, v14, 6, v26
  v_lshrrev_b32 v27, 5, v1
  s_lshl_b32 s61, s58, 3
  v_add_u32 v26, s61, v27
  v_mul_lo_u32 v26, v26, s57
  v_and_b32 v14, 31, v1
  s_lshl_b32 s62, s57, 1
  v_add_u32 v15, 0, v27
  v_lshlrev_b32 v15, 2, v15
  v_xor_b32 v15, v15, v14
  v_lshl_add_u32 v10, v15, 4, v26
  v_add_u32 v26, s62, v26
  v_add_u32 v15, 2, v27
  v_lshlrev_b32 v15, 2, v15
  v_xor_b32 v15, v15, v14
  v_lshl_add_u32 v11, v15, 4, v26
  v_subrev_u32 v11, 1024, v11
  v_add_u32 v26, s62, v26
  v_add_u32 v15, 0, v27
  v_lshlrev_b32 v15, 2, v15
  v_xor_b32 v15, v15, v14
  v_lshl_add_u32 v12, v15, 4, v26
  v_subrev_u32 v12, 2048, v12
  v_add_u32 v26, s62, v26
  v_add_u32 v15, 2, v27
  v_lshlrev_b32 v15, 2, v15
  v_xor_b32 v15, v15, v14
  v_lshl_add_u32 v13, v15, 4, v26
  v_subrev_u32 v13, 3072, v13
  v_lshrrev_b32 v27, 5, v1
  s_lshl_b32 s61, s58, 3
  v_add_u32 v26, s61, v27
  v_mul_lo_u32 v26, v26, s56
  v_and_b32 v14, 31, v1
  s_lshl_b32 s62, s56, 1
  v_add_u32 v15, 0, v27
  v_lshlrev_b32 v15, 2, v15
  v_xor_b32 v15, v15, v14
  v_lshl_add_u32 v2, v15, 4, v26
  v_add_u32 v26, s62, v26
  v_add_u32 v15, 2, v27
  v_lshlrev_b32 v15, 2, v15
  v_xor_b32 v15, v15, v14
  v_lshl_add_u32 v3, v15, 4, v26
  v_subrev_u32 v3, 1024, v3
  v_add_u32 v26, s62, v26
  v_add_u32 v15, 0, v27
  v_lshlrev_b32 v15, 2, v15
  v_xor_b32 v15, v15, v14
  v_lshl_add_u32 v4, v15, 4, v26
  v_subrev_u32 v4, 2048, v4
  v_add_u32 v26, s62, v26
  v_add_u32 v15, 2, v27
  v_lshlrev_b32 v15, 2, v15
  v_xor_b32 v15, v15, v14
  v_lshl_add_u32 v5, v15, 4, v26
  v_subrev_u32 v5, 3072, v5
  s_lshl_b32 s50, s57, 5
  s_lshl_b32 s52, s56, 5
  s_lshl_b32 s54, s58, 12
  s_mov_b32 s48, 0
  s_mov_b32 s49, 0
  s_add_u32 m0, s55, 0
  s_nop 0
  buffer_load_dwordx4 v10, s[44:47], s49 offen offset:0 lds
  buffer_load_dwordx4 v11, s[44:47], s49 offen offset:1024 lds
  buffer_load_dwordx4 v12, s[44:47], s49 offen offset:2048 lds
  buffer_load_dwordx4 v13, s[44:47], s49 offen offset:3072 lds
  s_add_u32 s49, s49, s50
  s_add_u32 m0, s54, 0
  s_nop 0
  buffer_load_dwordx4 v2, s[40:43], s48 offen offset:0 sc1 lds
  buffer_load_dwordx4 v3, s[40:43], s48 offen offset:1024 sc1 lds
  buffer_load_dwordx4 v4, s[40:43], s48 offen offset:2048 sc1 lds
  buffer_load_dwordx4 v5, s[40:43], s48 offen offset:3072 sc1 lds
  s_add_u32 s48, s48, s52
  s_add_u32 m0, s55, 16384
  s_nop 0
  buffer_load_dwordx4 v10, s[44:47], s49 offen offset:0 lds
  buffer_load_dwordx4 v11, s[44:47], s49 offen offset:1024 lds
  buffer_load_dwordx4 v12, s[44:47], s49 offen offset:2048 lds
  buffer_load_dwordx4 v13, s[44:47], s49 offen offset:3072 lds
  s_add_u32 s49, s49, s50
  s_add_u32 m0, s54, 16384
  s_nop 0
  buffer_load_dwordx4 v2, s[40:43], s48 offen offset:0 sc1 lds
  buffer_load_dwordx4 v3, s[40:43], s48 offen offset:1024 sc1 lds
  buffer_load_dwordx4 v4, s[40:43], s48 offen offset:2048 sc1 lds
  buffer_load_dwordx4 v5, s[40:43], s48 offen offset:3072 sc1 lds
  s_add_u32 s48, s48, s52
  s_add_u32 m0, s55, 32768
  s_nop 0
  buffer_load_dwordx4 v10, s[44:47], s49 offen offset:0 lds
  buffer_load_dwordx4 v11, s[44:47], s49 offen offset:1024 lds
  buffer_load_dwordx4 v12, s[44:47], s49 offen offset:2048 lds
  buffer_load_dwordx4 v13, s[44:47], s49 offen offset:3072 lds
  s_add_u32 s49, s49, s50
  s_add_u32 m0, s54, 32768
  s_nop 0
  buffer_load_dwordx4 v2, s[40:43], s48 offen offset:0 sc1 lds
  buffer_load_dwordx4 v3, s[40:43], s48 offen offset:1024 sc1 lds
  buffer_load_dwordx4 v4, s[40:43], s48 offen offset:2048 sc1 lds
  buffer_load_dwordx4 v5, s[40:43], s48 offen offset:3072 sc1 lds
  s_add_u32 s48, s48, s52
  s_add_u32 m0, s55, 49152
  s_nop 0
  buffer_load_dwordx4 v10, s[44:47], s49 offen offset:0 lds
  buffer_load_dwordx4 v11, s[44:47], s49 offen offset:1024 lds
  buffer_load_dwordx4 v12, s[44:47], s49 offen offset:2048 lds
  buffer_load_dwordx4 v13, s[44:47], s49 offen offset:3072 lds
  s_add_u32 s49, s49, s50
  s_add_u32 m0, s54, 49152
  s_nop 0
  buffer_load_dwordx4 v2, s[40:43], s48 offen offset:0 sc1 lds
  buffer_load_dwordx4 v3, s[40:43], s48 offen offset:1024 sc1 lds
  buffer_load_dwordx4 v4, s[40:43], s48 offen offset:2048 sc1 lds
  buffer_load_dwordx4 v5, s[40:43], s48 offen offset:3072 sc1 lds
  s_add_u32 s48, s48, s52
  s_waitcnt vmcnt(24)
  s_barrier
  ds_read_b64_tr_b16 v[48:49], v18 offset:0
  ds_read_b64_tr_b16 v[50:51], v18 offset:2048
  ds_read_b64_tr_b16 v[32:33], v22 offset:0
  ds_read_b64_tr_b16 v[34:35], v22 offset:2048
  ds_read_b64_tr_b16 v[52:53], v19 offset:0
  ds_read_b64_tr_b16 v[54:55], v19 offset:2048
  ds_read_b64_tr_b16 v[36:37], v23 offset:0
  ds_read_b64_tr_b16 v[38:39], v23 offset:2048
  ds_read_b64_tr_b16 v[56:57], v20 offset:0
  ds_read_b64_tr_b16 v[58:59], v20 offset:2048
  ds_read_b64_tr_b16 v[40:41], v24 offset:0
  ds_read_b64_tr_b16 v[42:43], v24 offset:2048
  ds_read_b64_tr_b16 v[60:61], v21 offset:0
  ds_read_b64_tr_b16 v[62:63], v21 offset:2048
  ds_read_b64_tr_b16 v[44:45], v25 offset:0
  ds_read_b64_tr_b16 v[46:47], v25 offset:2048
  s_waitcnt lgkmcnt(0)
  v_mfma_f32_32x32x16_bf16 a[0:15], v[32:35], v[48:51], 0
  ds_read_b64_tr_b16 v[80:81], v18 offset:8192
  ds_read_b64_tr_b16 v[82:83], v18 offset:10240
  v_mfma_f32_32x32x16_bf16 a[16:31], v[32:35], v[52:55], 0
  ds_read_b64_tr_b16 v[64:65], v22 offset:8192
  ds_read_b64_tr_b16 v[66:67], v22 offset:10240
  v_mfma_f32_32x32x16_bf16 a[32:47], v[32:35], v[56:59], 0
  ds_read_b64_tr_b16 v[84:85], v19 offset:8192
  ds_read_b64_tr_b16 v[86:87], v19 offset:10240
  v_mfma_f32_32x32x16_bf16 a[48:63], v[32:35], v[60:63], 0
  ds_read_b64_tr_b16 v[68:69], v23 offset:8192
  ds_read_b64_tr_b16 v[70:71], v23 offset:10240
  v_mfma_f32_32x32x16_bf16 a[64:79], v[36:39], v[48:51], 0
  ds_read_b64_tr_b16 v[88:89], v20 offset:8192
  ds_read_b64_tr_b16 v[90:91], v20 offset:10240
  v_mfma_f32_32x32x16_bf16 a[80:95], v[36:39], v[52:55], 0
  ds_read_b64_tr_b16 v[72:73], v24 offset:8192
  ds_read_b64_tr_b16 v[74:75], v24 offset:10240
  v_mfma_f32_32x32x16_bf16 a[96:111], v[36:39], v[56:59], 0
  ds_read_b64_tr_b16 v[92:93], v21 offset:8192
  ds_read_b64_tr_b16 v[94:95], v21 offset:10240
  v_mfma_f32_32x32x16_bf16 a[112:127], v[36:39], v[60:63], 0
  ds_read_b64_tr_b16 v[76:77], v25 offset:8192
  ds_read_b64_tr_b16 v[78:79], v25 offset:10240
  v_mfma_f32_32x32x16_bf16 a[128:143], v[40:43], v[48:51], 0
  v_mfma_f32_32x32x16_bf16 a[144:159], v[40:43], v[52:55], 0
  v_mfma_f32_32x32x16_bf16 a[160:175], v[40:43], v[56:59], 0
  v_mfma_f32_32x32x16_bf16 a[176:191], v[40:43], v[60:63], 0
  v_mfma_f32_32x32x16_bf16 a[192:207], v[44:47], v[48:51], 0
  v_mfma_f32_32x32x16_bf16 a[208:223], v[44:47], v[52:55], 0
  v_mfma_f32_32x32x16_bf16 a[224:239], v[44:47], v[56:59], 0
  v_mfma_f32_32x32x16_bf16 a[240:255], v[44:47], v[60:63], 0
  s_branch gm_t
  s_nop 10
gl_t:
  s_waitcnt lgkmcnt(0)
  v_mfma_f32_32x32x16_bf16 a[0:15], v[32:35], v[48:51], a[0:15]
  ds_read_b64_tr_b16 v[80:81], v18 offset:8192
  ds_read_b64_tr_b16 v[82:83], v18 offset:10240
  v_mfma_f32_32x32x16_bf16 a[16:31], v[32:35], v[52:55], a[16:31]
  ds_read_b64_tr_b16 v[64:65], v22 offset:8192
  ds_read_b64_tr_b16 v[66:67], v22 offset:10240
  v_mfma_f32_32x32x16_bf16 a[32:47], v[32:35], v[56:59], a[32:47]
  ds_read_b64_tr_b16 v[84:85], v19 offset:8192
  ds_read_b64_tr_b16 v[86:87], v19 offset:10240
  v_mfma_f32_32x32x16_bf16 a[48:63], v[32:35], v[60:63], a[48:63]
  ds_read_b64_tr_b16 v[68:69], v23 offset:8192
  ds_read_b64_tr_b16 v[70:71], v23 offset:10240
  v_mfma_f32_32x32x16_bf16 a[64:79], v[36:39], v[48:51], a[64:79]
  ds_read_b64_tr_b16 v[88:89], v20 offset:8192
  ds_read_b64_tr_b16 v[90:91], v20 offset:10240
  v_mfma_f32_32x32x16_bf16 a[80:95], v[36:39], v[52:55], a[80:95]
  ds_read_b64_tr_b16 v[72:73], v24 offset:8192
  ds_read_b64_tr_b16 v[74:75], v24 offset:10240
  v_mfma_f32_32x32x16_bf16 a[96:111], v[36:39], v[56:59], a[96:111]
  ds_read_b64_tr_b16 v[92:93], v21 offset:8192
  ds_read_b64_tr_b16 v[94:95], v21 offset:10240
  v_mfma_f32_32x32x16_bf16 a[112:127], v[36:39], v[60:63], a[112:127]
  ds_read_b64_tr_b16 v[76:77], v25 offset:8192
  ds_read_b64_tr_b16 v[78:79], v25 offset:10240
  v_mfma_f32_32x32x16_bf16 a[128:143], v[40:43], v[48:51], a[128:143]
  v_mfma_f32_32x32x16_bf16 a[144:159], v[40:43], v[52:55], a[144:159]
  v_mfma_f32_32x32x16_bf16 a[160:175], v[40:43], v[56:59], a[160:175]
  v_mfma_f32_32x32x16_bf16 a[176:191], v[40:43], v[60:63], a[176:191]
  v_mfma_f32_32x32x16_bf16 a[192:207], v[44:47], v[48:51], a[192:207]
  v_mfma_f32_32x32x16_bf16 a[208:223], v[44:47], v[52:55], a[208:223]
  v_mfma_f32_32x32x16_bf16 a[224:239], v[44:47], v[56:59], a[224:239]
  v_mfma_f32_32x32x16_bf16 a[240:255], v[44:47], v[60:63], a[240:255]
gm_t:
  s_waitcnt lgkmcnt(0)
  v_mfma_f32_32x32x16_bf16 a[0:15], v[64:67], v[80:83], a[0:15]
  v_mfma_f32_32x32x16_bf16 a[16:31], v[64:67], v[84:87], a[16:31]
  s_waitcnt vmcnt(16)
  s_barrier
  v_mfma_f32_32x32x16_bf16 a[32:47], v[64:67], v[88:91], a[32:47]
  ds_read_b64_tr_b16 v[48:49], v18 offset:16384
  s_add_u32 m0, s55, 0
  ds_read_b64_tr_b16 v[50:51], v18 offset:18432
  v_mfma_f32_32x32x16_bf16 a[48:63], v[64:67], v[92:95], a[48:63]
  buffer_load_dwordx4 v10, s[44:47], s49 offen offset:0 lds
  ds_read_b64_tr_b16 v[32:33], v22 offset:16384
  buffer_load_dwordx4 v11, s[44:47], s49 offen offset:1024 lds
  v_mfma_f32_32x32x16_bf16 a[64:79], v[68:71], v[80:83], a[64:79]
  ds_read_b64_tr_b16 v[34:35], v22 offset:18432
  buffer_load_dwordx4 v12, s[44:47], s49 offen offset:2048 lds
  ds_read_b64_tr_b16 v[52:53], v19 offset:16384
  v_mfma_f32_32x32x16_bf16 a[80:95], v[68:71], v[84:87], a[80:95]
  buffer_load_dwordx4 v13, s[44:47], s49 offen offset:3072 lds
  ds_read_b64_tr_b16 v[54:55], v19 offset:18432
  s_add_u32 s49, s49, s50
  v_mfma_f32_32x32x16_bf16 a[96:111], v[68:71], v[88:91], a[96:111]
  ds_read_b64_tr_b16 v[36:37], v23 offset:16384
  s_add_u32 m0, s54, 0
  ds_read_b64_tr_b16 v[38:39], v23 offset:18432
  v_mfma_f32_32x32x16_bf16 a[112:127], v[68:71], v[92:95], a[112:127]
  buffer_load_dwordx4 v2, s[40:43], s48 offen offset:0 sc1 lds
  ds_read_b64_tr_b16 v[56:57], v20 offset:16384
  buffer_load_dwordx4 v3, s[40:43], s48 offen offset:1024 sc1 lds
  v_mfma_f32_32x32x16_bf16 a[128:143], v[72:75], v[80:83], a[128:143]
  ds_read_b64_tr_b16 v[58:59], v20 offset:18432
  buffer_load_dwordx4 v4, s[40:43], s48 offen offset:2048 sc1 lds
  ds_read_b64_tr_b16 v[40:41], v24 offset:16384
  v_mfma_f32_32x32x16_bf16 a[144:159], v[72:75], v[84:87], a[144:159]
  buffer_load_dwordx4 v5, s[40:43], s48 offen offset:3072 sc1 lds
  ds_read_b64_tr_b16 v[42:43], v24 offset:18432
  s_add_u32 s48, s48, s52
  v_mfma_f32_32x32x16_bf16 a[160:175], v[72:75], v[88:91], a[160:175]
  ds_read_b64_tr_b16 v[60:61], v21 offset:16384
  ds_read_b64_tr_b16 v[62:63], v21 offset:18432
  ds_read_b64_tr_b16 v[44:45], v25 offset:16384
  v_mfma_f32_32x32x16_bf16 a[176:191], v[72:75], v[92:95], a[176:191]
  ds_read_b64_tr_b16 v[46:47], v25 offset:18432
  v_mfma_f32_32x32x16_bf16 a[192:207], v[76:79], v[80:83], a[192:207]
  v_mfma_f32_32x32x16_bf16 a[208:223], v[76:79], v[84:87], a[208:223]
  v_mfma_f32_32x32x16_bf16 a[224:239], v[76:79], v[88:91], a[224:239]
  v_mfma_f32_32x32x16_bf16 a[240:255], v[76:79], v[92:95], a[240:255]
  s_waitcnt lgkmcnt(0)
  v_mfma_f32_32x32x16_bf16 a[0:15], v[32:35], v[48:51], a[0:15]
  ds_read_b64_tr_b16 v[80:81], v18 offset:24576
  ds_read_b64_tr_b16 v[82:83], v18 offset:26624
  v_mfma_f32_32x32x16_bf16 a[16:31], v[32:35], v[52:55], a[16:31]
  ds_read_b64_tr_b16 v[64:65], v22 offset:24576
  ds_read_b64_tr_b16 v[66:67], v22 offset:26624
  v_mfma_f32_32x32x16_bf16 a[32:47], v[32:35], v[56:59], a[32:47]
  ds_read_b64_tr_b16 v[84:85], v19 offset:24576
  ds_read_b64_tr_b16 v[86:87], v19 offset:26624
  v_mfma_f32_32x32x16_bf16 a[48:63], v[32:35], v[60:63], a[48:63]
  ds_read_b64_tr_b16 v[68:69], v23 offset:24576
  ds_read_b64_tr_b16 v[70:71], v23 offset:26624
  v_mfma_f32_32x32x16_bf16 a[64:79], v[36:39], v[48:51], a[64:79]
  ds_read_b64_tr_b16 v[88:89], v20 offset:24576
  ds_read_b64_tr_b16 v[90:91], v20 offset:26624
  v_mfma_f32_32x32x16_bf16 a[80:95], v[36:39], v[52:55], a[80:95]
  ds_read_b64_tr_b16 v[72:73], v24 offset:24576
  ds_read_b64_tr_b16 v[74:75], v24 offset:26624
  v_mfma_f32_32x32x16_bf16 a[96:111], v[36:39], v[56:59], a[96:111]
  ds_read_b64_tr_b16 v[92:93], v21 offset:24576
  ds_read_b64_tr_b16 v[94:95], v21 offset:26624
  v_mfma_f32_32x32x16_bf16 a[112:127], v[36:39], v[60:63], a[112:127]
  ds_read_b64_tr_b16 v[76:77], v25 offset:24576
  ds_read_b64_tr_b16 v[78:79], v25 offset:26624
  v_mfma_f32_32x32x16_bf16 a[128:143], v[40:43], v[48:51], a[128:143]
  v_mfma_f32_32x32x16_bf16 a[144:159], v[40:43], v[52:55], a[144:159]
  v_mfma_f32_32x32x16_bf16 a[160:175], v[40:43], v[56:59], a[160:175]
  v_mfma_f32_32x32x16_bf16 a[176:191], v[40:43], v[60:63], a[176:191]
  v_mfma_f32_32x32x16_bf16 a[192:207], v[44:47], v[48:51], a[192:207]
  v_mfma_f32_32x32x16_bf16 a[208:223], v[44:47], v[52:55], a[208:223]
  v_mfma_f32_32x32x16_bf16 a[224:239], v[44:47], v[56:59], a[224:239]
  v_mfma_f32_32x32x16_bf16 a[240:255], v[44:47], v[60:63], a[240:255]
  s_waitcnt lgkmcnt(0)
  v_mfma_f32_32x32x16_bf16 a[0:15], v[64:67], v[80:83], a[0:15]
  v_mfma_f32_32x32x16_bf16 a[16:31], v[64:67], v[84:87], a[16:31]
  s_waitcnt vmcnt(16)
  s_barrier
  v_mfma_f32_32x32x16_bf16 a[32:47], v[64:67], v[88:91], a[32:47]
  ds_read_b64_tr_b16 v[48:49], v18 offset:32768
  s_add_u32 m0, s55, 16384
  ds_read_b64_tr_b16 v[50:51], v18 offset:34816
  v_mfma_f32_32x32x16_bf16 a[48:63], v[64:67], v[92:95], a[48:63]
  buffer_load_dwordx4 v10, s[44:47], s49 offen offset:0 lds
  ds_read_b64_tr_b16 v[32:33], v22 offset:32768
  buffer_load_dwordx4 v11, s[44:47], s49 offen offset:1024 lds
  v_mfma_f32_32x32x16_bf16 a[64:79], v[68:71], v[80:83], a[64:79]
  ds_read_b64_tr_b16 v[34:35], v22 offset:34816
  buffer_load_dwordx4 v12, s[44:47], s49 offen offset:2048 lds
  ds_read_b64_tr_b16 v[52:53], v19 offset:32768
  v_mfma_f32_32x32x16_bf16 a[80:95], v[68:71], v[84:87], a[80:95]
  buffer_load_dwordx4 v13, s[44:47], s49 offen offset:3072 lds
  ds_read_b64_tr_b16 v[54:55], v19 offset:34816
  s_add_u32 s49, s49, s50
  v_mfma_f32_32x32x16_bf16 a[96:111], v[68:71], v[88:91], a[96:111]
  ds_read_b64_tr_b16 v[36:37], v23 offset:32768
  s_add_u32 m0, s54, 16384
  ds_read_b64_tr_b16 v[38:39], v23 offset:34816
  v_mfma_f32_32x32x16_bf16 a[112:127], v[68:71], v[92:95], a[112:127]
  buffer_load_dwordx4 v2, s[40:43], s48 offen offset:0 sc1 lds
  ds_read_b64_tr_b16 v[56:57], v20 offset:32768
  buffer_load_dwordx4 v3, s[40:43], s48 offen offset:1024 sc1 lds
  v_mfma_f32_32x32x16_bf16 a[128:143], v[72:75], v[80:83], a[128:143]
  ds_read_b64_tr_b16 v[58:59], v20 offset:34816
  buffer_load_dwordx4 v4, s[40:43], s48 offen offset:2048 sc1 lds
  ds_read_b64_tr_b16 v[40:41], v24 offset:32768
  v_mfma_f32_32x32x16_bf16 a[144:159], v[72:75], v[84:87], a[144:159]
  buffer_load_dwordx4 v5, s[40:43], s48 offen offset:3072 sc1 lds
  ds_read_b64_tr_b16 v[42:43], v24 offset:34816
  s_add_u32 s48, s48, s52
  v_mfma_f32_32x32x16_bf16 a[160:175], v[72:75], v[88:91], a[160:175]
  ds_read_b64_tr_b16 v[60:61], v21 offset:32768
  ds_read_b64_tr_b16 v[62:63], v21 offset:34816
  ds_read_b64_tr_b16 v[44:45], v25 offset:32768
  v_mfma_f32_32x32x16_bf16 a[176:191], v[72:75], v[92:95], a[176:191]
  ds_read_b64_tr_b16 v[46:47], v25 offset:34816
  v_mfma_f32_32x32x16_bf16 a[192:207], v[76:79], v[80:83], a[192:207]
  v_mfma_f32_32x32x16_bf16 a[208:223], v[76:79], v[84:87], a[208:223]
  v_mfma_f32_32x32x16_bf16 a[224:239], v[76:79], v[88:91], a[224:239]
  v_mfma_f32_32x32x16_bf16 a[240:255], v[76:79], v[92:95], a[240:255]
  s_waitcnt lgkmcnt(0)
  v_mfma_f32_32x32x16_bf16 a[0:15], v[32:35], v[48:51], a[0:15]
  ds_read_b64_tr_b16 v[80:81], v18 offset:40960
  ds_read_b64_tr_b16 v[82:83], v18 offset:43008
  v_mfma_f32_32x32x16_bf16 a[16:31], v[32:35], v[52:55], a[16:31]
  ds_read_b64_tr_b16 v[64:65], v22 offset:40960
  ds_read_b64_tr_b16 v[66:67], v22 offset:43008
  v_mfma_f32_32x32x16_bf16 a[32:47], v[32:35], v[56:59], a[32:47]
  ds_read_b64_tr_b16 v[84:85], v19 offset:40960
  ds_read_b64_tr_b16 v[86:87], v19 offset:43008
  v_mfma_f32_32x32x16_bf16 a[48:63], v[32:35], v[60:63], a[48:63]
  ds_read_b64_tr_b16 v[68:69], v23 offset:40960
  ds_read_b64_tr_b16 v[70:71], v23 offset:43008
  v_mfma_f32_32x32x16_bf16 a[64:79], v[36:39], v[48:51], a[64:79]
  ds_read_b64_tr_b16 v[88:89], v20 offset:40960
  ds_read_b64_tr_b16 v[90:91], v20 offset:43008
  v_mfma_f32_32x32x16_bf16 a[80:95], v[36:39], v[52:55], a[80:95]
  ds_read_b64_tr_b16 v[72:73], v24 offset:40960
  ds_read_b64_tr_b16 v[74:75], v24 offset:43008
  v_mfma_f32_32x32x16_bf16 a[96:111], v[36:39], v[56:59], a[96:111]
  ds_read_b64_tr_b16 v[92:93], v21 offset:40960
  ds_read_b64_tr_b16 v[94:95], v21 offset:43008
  v_mfma_f32_32x32x16_bf16 a[112:127], v[36:39], v[60:63], a[112:127]
  ds_read_b64_tr_b16 v[76:77], v25 offset:40960
  ds_read_b64_tr_b16 v[78:79], v25 offset:43008
  v_mfma_f32_32x32x16_bf16 a[128:143], v[40:43], v[48:51], a[128:143]
  v_mfma_f32_32x32x16_bf16 a[144:159], v[40:43], v[52:55], a[144:159]
  v_mfma_f32_32x32x16_bf16 a[160:175], v[40:43], v[56:59], a[160:175]
  v_mfma_f32_32x32x16_bf16 a[176:191], v[40:43], v[60:63], a[176:191]
  v_mfma_f32_32x32x16_bf16 a[192:207], v[44:47], v[48:51], a[192:207]
  v_mfma_f32_32x32x16_bf16 a[208:223], v[44:47], v[52:55], a[208:223]
  v_mfma_f32_32x32x16_bf16 a[224:239], v[44:47], v[56:59], a[224:239]
  v_mfma_f32_32x32x16_bf16 a[240:255], v[44:47], v[60:63], a[240:255]
  s_waitcnt lgkmcnt(0)
  v_mfma_f32_32x32x16_bf16 a[0:15], v[64:67], v[80:83], a[0:15]
  v_mfma_f32_32x32x16_bf16 a[16:31], v[64:67], v[84:87], a[16:31]
  s_waitcnt vmcnt(16)
  s_barrier
  v_mfma_f32_32x32x16_bf16 a[32:47], v[64:67], v[88:91], a[32:47]
  ds_read_b64_tr_b16 v[48:49], v18 offset:49152
  s_add_u32 m0, s55, 32768
  ds_read_b64_tr_b16 v[50:51], v18 offset:51200
  v_mfma_f32_32x32x16_bf16 a[48:63], v[64:67], v[92:95], a[48:63]
  buffer_load_dwordx4 v10, s[44:47], s49 offen offset:0 lds
  ds_read_b64_tr_b16 v[32:33], v22 offset:49152
  buffer_load_dwordx4 v11, s[44:47], s49 offen offset:1024 lds
  v_mfma_f32_32x32x16_bf16 a[64:79], v[68:71], v[80:83], a[64:79]
  ds_read_b64_tr_b16 v[34:35], v22 offset:51200
  buffer_load_dwordx4 v12, s[44:47], s49 offen offset:2048 lds
  ds_read_b64_tr_b16 v[52:53], v19 offset:49152
  v_mfma_f32_32x32x16_bf16 a[80:95], v[68:71], v[84:87], a[80:95]
  buffer_load_dwordx4 v13, s[44:47], s49 offen offset:3072 lds
  ds_read_b64_tr_b16 v[54:55], v19 offset:51200
  s_add_u32 s49, s49, s50
  v_mfma_f32_32x32x16_bf16 a[96:111], v[68:71], v[88:91], a[96:111]
  ds_read_b64_tr_b16 v[36:37], v23 offset:49152
  s_add_u32 m0, s54, 32768
  ds_read_b64_tr_b16 v[38:39], v23 offset:51200
  v_mfma_f32_32x32x16_bf16 a[112:127], v[68:71], v[92:95], a[112:127]
  buffer_load_dwordx4 v2, s[40:43], s48 offen offset:0 sc1 lds
  ds_read_b64_tr_b16 v[56:57], v20 offset:49152
  buffer_load_dwordx4 v3, s[40:43], s48 offen offset:1024 sc1 lds
  v_mfma_f32_32x32x16_bf16 a[128:143], v[72:75], v[80:83], a[128:143]
  ds_read_b64_tr_b16 v[58:59], v20 offset:51200
  buffer_load_dwordx4 v4, s[40:43], s48 offen offset:2048 sc1 lds
  ds_read_b64_tr_b16 v[40:41], v24 offset:49152
  v_mfma_f32_32x32x16_bf16 a[144:159], v[72:75], v[84:87], a[144:159]
  buffer_load_dwordx4 v5, s[40:43], s48 offen offset:3072 sc1 lds
  ds_read_b64_tr_b16 v[42:43], v24 offset:51200
  s_add_u32 s48, s48, s52
  v_mfma_f32_32x32x16_bf16 a[160:175], v[72:75], v[88:91], a[160:175]
  ds_read_b64_tr_b16 v[60:61], v21 offset:49152
  ds_read_b64_tr_b16 v[62:63], v21 offset:51200
  ds_read_b64_tr_b16 v[44:45], v25 offset:49152
  v_mfma_f32_32x32x16_bf16 a[176:191], v[72:75], v[92:95], a[176:191]
  ds_read_b64_tr_b16 v[46:47], v25 offset:51200
  v_mfma_f32_32x32x16_bf16 a[192:207], v[76:79], v[80:83], a[192:207]
  v_mfma_f32_32x32x16_bf16 a[208:223], v[76:79], v[84:87], a[208:223]
  v_mfma_f32_32x32x16_bf16 a[224:239], v[76:79], v[88:91], a[224:239]
  v_mfma_f32_32x32x16_bf16 a[240:255], v[76:79], v[92:95], a[240:255]
  s_waitcnt lgkmcnt(0)
  v_mfma_f32_32x32x16_bf16 a[0:15], v[32:35], v[48:51], a[0:15]
  ds_read_b64_tr_b16 v[80:81], v18 offset:57344
  ds_read_b64_tr_b16 v[82:83], v18 offset:59392
  v_mfma_f32_32x32x16_bf16 a[16:31], v[32:35], v[52:55], a[16:31]
  ds_read_b64_tr_b16 v[64:65], v22 offset:57344
  ds_read_b64_tr_b16 v[66:67], v22 offset:59392
  v_mfma_f32_32x32x16_bf16 a[32:47], v[32:35], v[56:59], a[32:47]
  ds_read_b64_tr_b16 v[84:85], v19 offset:57344
  ds_read_b64_tr_b16 v[86:87], v19 offset:59392
  v_mfma_f32_32x32x16_bf16 a[48:63], v[32:35], v[60:63], a[48:63]
  ds_read_b64_tr_b16 v[68:69], v23 offset:57344
  ds_read_b64_tr_b16 v[70:71], v23 offset:59392
  v_mfma_f32_32x32x16_bf16 a[64:79], v[36:39], v[48:51], a[64:79]
  ds_read_b64_tr_b16 v[88:89], v20 offset:57344
  ds_read_b64_tr_b16 v[90:91], v20 offset:59392
  v_mfma_f32_32x32x16_bf16 a[80:95], v[36:39], v[52:55], a[80:95]
  ds_read_b64_tr_b16 v[72:73], v24 offset:57344
  ds_read_b64_tr_b16 v[74:75], v24 offset:59392
  v_mfma_f32_32x32x16_bf16 a[96:111], v[36:39], v[56:59], a[96:111]
  ds_read_b64_tr_b16 v[92:93], v21 offset:57344
  ds_read_b64_tr_b16 v[94:95], v21 offset:59392
  v_mfma_f32_32x32x16_bf16 a[112:127], v[36:39], v[60:63], a[112:127]
  ds_read_b64_tr_b16 v[76:77], v25 offset:57344
  ds_read_b64_tr_b16 v[78:79], v25 offset:59392
  v_mfma_f32_32x32x16_bf16 a[128:143], v[40:43], v[48:51], a[128:143]
  v_mfma_f32_32x32x16_bf16 a[144:159], v[40:43], v[52:55], a[144:159]
  v_mfma_f32_32x32x16_bf16 a[160:175], v[40:43], v[56:59], a[160:175]
  v_mfma_f32_32x32x16_bf16 a[176:191], v[40:43], v[60:63], a[176:191]
  v_mfma_f32_32x32x16_bf16 a[192:207], v[44:47], v[48:51], a[192:207]
  v_mfma_f32_32x32x16_bf16 a[208:223], v[44:47], v[52:55], a[208:223]
  v_mfma_f32_32x32x16_bf16 a[224:239], v[44:47], v[56:59], a[224:239]
  v_mfma_f32_32x32x16_bf16 a[240:255], v[44:47], v[60:63], a[240:255]
  s_waitcnt lgkmcnt(0)
  v_mfma_f32_32x32x16_bf16 a[0:15], v[64:67], v[80:83], a[0:15]
  v_mfma_f32_32x32x16_bf16 a[16:31], v[64:67], v[84:87], a[16:31]
  s_waitcnt vmcnt(16)
  s_barrier
  v_mfma_f32_32x32x16_bf16 a[32:47], v[64:67], v[88:91], a[32:47]
  ds_read_b64_tr_b16 v[48:49], v18 offset:0
  s_add_u32 m0, s55, 49152
  ds_read_b64_tr_b16 v[50:51], v18 offset:2048
  v_mfma_f32_32x32x16_bf16 a[48:63], v[64:67], v[92:95], a[48:63]
  buffer_load_dwordx4 v10, s[44:47], s49 offen offset:0 lds
  ds_read_b64_tr_b16 v[32:33], v22 offset:0
  buffer_load_dwordx4 v11, s[44:47], s49 offen offset:1024 lds
  v_mfma_f32_32x32x16_bf16 a[64:79], v[68:71], v[80:83], a[64:79]
  ds_read_b64_tr_b16 v[34:35], v22 offset:2048
  buffer_load_dwordx4 v12, s[44:47], s49 offen offset:2048 lds
  ds_read_b64_tr_b16 v[52:53], v19 offset:0
  v_mfma_f32_32x32x16_bf16 a[80:95], v[68:71], v[84:87], a[80:95]
  buffer_load_dwordx4 v13, s[44:47], s49 offen offset:3072 lds
  ds_read_b64_tr_b16 v[54:55], v19 offset:2048
  s_add_u32 s49, s49, s50
  v_mfma_f32_32x32x16_bf16 a[96:111], v[68:71], v[88:91], a[96:111]
  ds_read_b64_tr_b16 v[36:37], v23 offset:0
  s_add_u32 m0, s54, 49152
  ds_read_b64_tr_b16 v[38:39], v23 offset:2048
  v_mfma_f32_32x32x16_bf16 a[112:127], v[68:71], v[92:95], a[112:127]
  buffer_load_dwordx4 v2, s[40:43], s48 offen offset:0 sc1 lds
  ds_read_b64_tr_b16 v[56:57], v20 offset:0
  buffer_load_dwordx4 v3, s[40:43], s48 offen offset:1024 sc1 lds
  v_mfma_f32_32x32x16_bf16 a[128:143], v[72:75], v[80:83], a[128:143]
  ds_read_b64_tr_b16 v[58:59], v20 offset:2048
  buffer_load_dwordx4 v4, s[40:43], s48 offen offset:2048 sc1 lds
  ds_read_b64_tr_b16 v[40:41], v24 offset:0
  v_mfma_f32_32x32x16_bf16 a[144:159], v[72:75], v[84:87], a[144:159]
  buffer_load_dwordx4 v5, s[40:43], s48 offen offset:3072 sc1 lds
  ds_read_b64_tr_b16 v[42:43], v24 offset:2048
  s_add_u32 s48, s48, s52
  v_mfma_f32_32x32x16_bf16 a[160:175], v[72:75], v[88:91], a[160:175]
  ds_read_b64_tr_b16 v[60:61], v21 offset:0
  ds_read_b64_tr_b16 v[62:63], v21 offset:2048
  ds_read_b64_tr_b16 v[44:45], v25 offset:0
  v_mfma_f32_32x32x16_bf16 a[176:191], v[72:75], v[92:95], a[176:191]
  ds_read_b64_tr_b16 v[46:47], v25 offset:2048
  v_mfma_f32_32x32x16_bf16 a[192:207], v[76:79], v[80:83], a[192:207]
  v_mfma_f32_32x32x16_bf16 a[208:223], v[76:79], v[84:87], a[208:223]
  v_mfma_f32_32x32x16_bf16 a[224:239], v[76:79], v[88:91], a[224:239]
  v_mfma_f32_32x32x16_bf16 a[240:255], v[76:79], v[92:95], a[240:255]
  s_sub_u32 s51, s51, 1
  s_cmp_lg_u32 s51, 0
  s_cbranch_scc1 gl_t
  s_waitcnt lgkmcnt(0)
  v_mfma_f32_32x32x16_bf16 a[0:15], v[32:35], v[48:51], a[0:15]
  ds_read_b64_tr_b16 v[80:81], v18 offset:8192
  ds_read_b64_tr_b16 v[82:83], v18 offset:10240
  v_mfma_f32_32x32x16_bf16 a[16:31], v[32:35], v[52:55], a[16:31]
  ds_read_b64_tr_b16 v[64:65], v22 offset:8192
  ds_read_b64_tr_b16 v[66:67], v22 offset:10240
  v_mfma_f32_32x32x16_bf16 a[32:47], v[32:35], v[56:59], a[32:47]
  ds_read_b64_tr_b16 v[84:85], v19 offset:8192
  ds_read_b64_tr_b16 v[86:87], v19 offset:10240
  v_mfma_f32_32x32x16_bf16 a[48:63], v[32:35], v[60:63], a[48:63]
  ds_read_b64_tr_b16 v[68:69], v23 offset:8192
  ds_read_b64_tr_b16 v[70:71], v23 offset:10240
  v_mfma_f32_32x32x16_bf16 a[64:79], v[36:39], v[48:51], a[64:79]
  ds_read_b64_tr_b16 v[88:89], v20 offset:8192
  ds_read_b64_tr_b16 v[90:91], v20 offset:10240
  v_mfma_f32_32x32x16_bf16 a[80:95], v[36:39], v[52:55], a[80:95]
  ds_read_b64_tr_b16 v[72:73], v24 offset:8192
  ds_read_b64_tr_b16 v[74:75], v24 offset:10240
  v_mfma_f32_32x32x16_bf16 a[96:111], v[36:39], v[56:59], a[96:111]
  ds_read_b64_tr_b16 v[92:93], v21 offset:8192
  ds_read_b64_tr_b16 v[94:95], v21 offset:10240
  v_mfma_f32_32x32x16_bf16 a[112:127], v[36:39], v[60:63], a[112:127]
  ds_read_b64_tr_b16 v[76:77], v25 offset:8192
  ds_read_b64_tr_b16 v[78:79], v25 offset:10240
  v_mfma_f32_32x32x16_bf16 a[128:143], v[40:43], v[48:51], a[128:143]
  v_mfma_f32_32x32x16_bf16 a[144:159], v[40:43], v[52:55], a[144:159]
  v_mfma_f32_32x32x16_bf16 a[160:175], v[40:43], v[56:59], a[160:175]
  v_mfma_f32_32x32x16_bf16 a[176:191], v[40:43], v[60:63], a[176:191]
  v_mfma_f32_32x32x16_bf16 a[192:207], v[44:47], v[48:51], a[192:207]
  v_mfma_f32_32x32x16_bf16 a[208:223], v[44:47], v[52:55], a[208:223]
  v_mfma_f32_32x32x16_bf16 a[224:239], v[44:47], v[56:59], a[224:239]
  v_mfma_f32_32x32x16_bf16 a[240:255], v[44:47], v[60:63], a[240:255]
  s_waitcnt lgkmcnt(0)
  v_mfma_f32_32x32x16_bf16 a[0:15], v[64:67], v[80:83], a[0:15]
  v_mfma_f32_32x32x16_bf16 a[16:31], v[64:67], v[84:87], a[16:31]
  s_waitcnt vmcnt(16)
  s_barrier
  v_mfma_f32_32x32x16_bf16 a[32:47], v[64:67], v[88:91], a[32:47]
  ds_read_b64_tr_b16 v[48:49], v18 offset:16384
  ds_read_b64_tr_b16 v[50:51], v18 offset:18432
  v_mfma_f32_32x32x16_bf16 a[48:63], v[64:67], v[92:95], a[48:63]
  ds_read_b64_tr_b16 v[32:33], v22 offset:16384
  ds_read_b64_tr_b16 v[34:35], v22 offset:18432
  v_mfma_f32_32x32x16_bf16 a[64:79], v[68:71], v[80:83], a[64:79]
  ds_read_b64_tr_b16 v[52:53], v19 offset:16384
  ds_read_b64_tr_b16 v[54:55], v19 offset:18432
  v_mfma_f32_32x32x16_bf16 a[80:95], v[68:71], v[84:87], a[80:95]
  ds_read_b64_tr_b16 v[36:37], v23 offset:16384
  ds_read_b64_tr_b16 v[38:39], v23 offset:18432
  v_mfma_f32_32x32x16_bf16 a[96:111], v[68:71], v[88:91], a[96:111]
  ds_read_b64_tr_b16 v[56:57], v20 offset:16384
  ds_read_b64_tr_b16 v[58:59], v20 offset:18432
  v_mfma_f32_32x32x16_bf16 a[112:127], v[68:71], v[92:95], a[112:127]
  ds_read_b64_tr_b16 v[40:41], v24 offset:16384
  ds_read_b64_tr_b16 v[42:43], v24 offset:18432
  v_mfma_f32_32x32x16_bf16 a[128:143], v[72:75], v[80:83], a[128:143]
  ds_read_b64_tr_b16 v[60:61], v21 offset:16384
  ds_read_b64_tr_b16 v[62:63], v21 offset:18432
  v_mfma_f32_32x32x16_bf16 a[144:159], v[72:75], v[84:87], a[144:159]
  ds_read_b64_tr_b16 v[44:45], v25 offset:16384
  ds_read_b64_tr_b16 v[46:47], v25 offset:18432
  v_mfma_f32_32x32x16_bf16 a[160:175], v[72:75], v[88:91], a[160:175]
  v_mfma_f32_32x32x16_bf16 a[176:191], v[72:75], v[92:95], a[176:191]
  v_mfma_f32_32x32x16_bf16 a[192:207], v[76:79], v[80:83], a[192:207]
  v_mfma_f32_32x32x16_bf16 a[208:223], v[76:79], v[84:87], a[208:223]
  v_mfma_f32_32x32x16_bf16 a[224:239], v[76:79], v[88:91], a[224:239]
  v_mfma_f32_32x32x16_bf16 a[240:255], v[76:79], v[92:95], a[240:255]
  s_waitcnt lgkmcnt(0)
  v_mfma_f32_32x32x16_bf16 a[0:15], v[32:35], v[48:51], a[0:15]
  ds_read_b64_tr_b16 v[80:81], v18 offset:24576
  ds_read_b64_tr_b16 v[82:83], v18 offset:26624
  v_mfma_f32_32x32x16_bf16 a[16:31], v[32:35], v[52:55], a[16:31]
  ds_read_b64_tr_b16 v[64:65], v22 offset:24576
  ds_read_b64_tr_b16 v[66:67], v22 offset:26624
  v_mfma_f32_32x32x16_bf16 a[32:47], v[32:35], v[56:59], a[32:47]
  ds_read_b64_tr_b16 v[84:85], v19 offset:24576
  ds_read_b64_tr_b16 v[86:87], v19 offset:26624
  v_mfma_f32_32x32x16_bf16 a[48:63], v[32:35], v[60:63], a[48:63]
  ds_read_b64_tr_b16 v[68:69], v23 offset:24576
  ds_read_b64_tr_b16 v[70:71], v23 offset:26624
  v_mfma_f32_32x32x16_bf16 a[64:79], v[36:39], v[48:51], a[64:79]
  ds_read_b64_tr_b16 v[88:89], v20 offset:24576
  ds_read_b64_tr_b16 v[90:91], v20 offset:26624
  v_mfma_f32_32x32x16_bf16 a[80:95], v[36:39], v[52:55], a[80:95]
  ds_read_b64_tr_b16 v[72:73], v24 offset:24576
  ds_read_b64_tr_b16 v[74:75], v24 offset:26624
  v_mfma_f32_32x32x16_bf16 a[96:111], v[36:39], v[56:59], a[96:111]
  ds_read_b64_tr_b16 v[92:93], v21 offset:24576
  ds_read_b64_tr_b16 v[94:95], v21 offset:26624
  v_mfma_f32_32x32x16_bf16 a[112:127], v[36:39], v[60:63], a[112:127]
  ds_read_b64_tr_b16 v[76:77], v25 offset:24576
  ds_read_b64_tr_b16 v[78:79], v25 offset:26624
  v_mfma_f32_32x32x16_bf16 a[128:143], v[40:43], v[48:51], a[128:143]
  v_mfma_f32_32x32x16_bf16 a[144:159], v[40:43], v[52:55], a[144:159]
  v_mfma_f32_32x32x16_bf16 a[160:175], v[40:43], v[56:59], a[160:175]
  v_mfma_f32_32x32x16_bf16 a[176:191], v[40:43], v[60:63], a[176:191]
  v_mfma_f32_32x32x16_bf16 a[192:207], v[44:47], v[48:51], a[192:207]
  v_mfma_f32_32x32x16_bf16 a[208:223], v[44:47], v[52:55], a[208:223]
  v_mfma_f32_32x32x16_bf16 a[224:239], v[44:47], v[56:59], a[224:239]
  v_mfma_f32_32x32x16_bf16 a[240:255], v[44:47], v[60:63], a[240:255]
  s_waitcnt lgkmcnt(0)
  v_mfma_f32_32x32x16_bf16 a[0:15], v[64:67], v[80:83], a[0:15]
  v_mfma_f32_32x32x16_bf16 a[16:31], v[64:67], v[84:87], a[16:31]
  s_waitcnt vmcnt(8)
  s_barrier
  v_mfma_f32_32x32x16_bf16 a[32:47], v[64:67], v[88:91], a[32:47]
  ds_read_b64_tr_b16 v[48:49], v18 offset:32768
  ds_read_b64_tr_b16 v[50:51], v18 offset:34816
  v_mfma_f32_32x32x16_bf16 a[48:63], v[64:67], v[92:95], a[48:63]
  ds_read_b64_tr_b16 v[32:33], v22 offset:32768
  ds_read_b64_tr_b16 v[34:35], v22 offset:34816
  v_mfma_f32_32x32x16_bf16 a[64:79], v[68:71], v[80:83], a[64:79]
  ds_read_b64_tr_b16 v[52:53], v19 offset:32768
  ds_read_b64_tr_b16 v[54:55], v19 offset:34816
  v_mfma_f32_32x32x16_bf16 a[80:95], v[68:71], v[84:87], a[80:95]
  ds_read_b64_tr_b16 v[36:37], v23 offset:32768
  ds_read_b64_tr_b16 v[38:39], v23 offset:34816
  v_mfma_f32_32x32x16_bf16 a[96:111], v[68:71], v[88:91], a[96:111]
  ds_read_b64_tr_b16 v[56:57], v20 offset:32768
  ds_read_b64_tr_b16 v[58:59], v20 offset:34816
  v_mfma_f32_32x32x16_bf16 a[112:127], v[68:71], v[92:95], a[112:127]
  ds_read_b64_tr_b16 v[40:41], v24 offset:32768
  ds_read_b64_tr_b16 v[42:43], v24 offset:34816
  v_mfma_f32_32x32x16_bf16 a[128:143], v[72:75], v[80:83], a[128:143]
  ds_read_b64_tr_b16 v[60:61], v21 offset:32768
  ds_read_b64_tr_b16 v[62:63], v21 offset:34816
  v_mfma_f32_32x32x16_bf16 a[144:159], v[72:75], v[84:87], a[144:159]
  ds_read_b64_tr_b16 v[44:45], v25 offset:32768
  ds_read_b64_tr_b16 v[46:47], v25 offset:34816
  v_mfma_f32_32x32x16_bf16 a[160:175], v[72:75], v[88:91], a[160:175]
  v_mfma_f32_32x32x16_bf16 a[176:191], v[72:75], v[92:95], a[176:191]
  v_mfma_f32_32x32x16_bf16 a[192:207], v[76:79], v[80:83], a[192:207]
  v_mfma_f32_32x32x16_bf16 a[208:223], v[76:79], v[84:87], a[208:223]
  v_mfma_f32_32x32x16_bf16 a[224:239], v[76:79], v[88:91], a[224:239]
  v_mfma_f32_32x32x16_bf16 a[240:255], v[76:79], v[92:95], a[240:255]
  s_waitcnt lgkmcnt(0)
  v_mfma_f32_32x32x16_bf16 a[0:15], v[32:35], v[48:51], a[0:15]
  ds_read_b64_tr_b16 v[80:81], v18 offset:40960
  ds_read_b64_tr_b16 v[82:83], v18 offset:43008
  v_mfma_f32_32x32x16_bf16 a[16:31], v[32:35], v[52:55], a[16:31]
  ds_read_b64_tr_b16 v[64:65], v22 offset:40960
  ds_read_b64_tr_b16 v[66:67], v22 offset:43008
  v_mfma_f32_32x32x16_bf16 a[32:47], v[32:35], v[56:59], a[32:47]
  ds_read_b64_tr_b16 v[84:85], v19 offset:40960
  ds_read_b64_tr_b16 v[86:87], v19 offset:43008
  v_mfma_f32_32x32x16_bf16 a[48:63], v[32:35], v[60:63], a[48:63]
  ds_read_b64_tr_b16 v[68:69], v23 offset:40960
  ds_read_b64_tr_b16 v[70:71], v23 offset:43008
  v_mfma_f32_32x32x16_bf16 a[64:79], v[36:39], v[48:51], a[64:79]
  ds_read_b64_tr_b16 v[88:89], v20 offset:40960
  ds_read_b64_tr_b16 v[90:91], v20 offset:43008
  v_mfma_f32_32x32x16_bf16 a[80:95], v[36:39], v[52:55], a[80:95]
  ds_read_b64_tr_b16 v[72:73], v24 offset:40960
  ds_read_b64_tr_b16 v[74:75], v24 offset:43008
  v_mfma_f32_32x32x16_bf16 a[96:111], v[36:39], v[56:59], a[96:111]
  ds_read_b64_tr_b16 v[92:93], v21 offset:40960
  ds_read_b64_tr_b16 v[94:95], v21 offset:43008
  v_mfma_f32_32x32x16_bf16 a[112:127], v[36:39], v[60:63], a[112:127]
  ds_read_b64_tr_b16 v[76:77], v25 offset:40960
  ds_read_b64_tr_b16 v[78:79], v25 offset:43008
  v_mfma_f32_32x32x16_bf16 a[128:143], v[40:43], v[48:51], a[128:143]
  v_mfma_f32_32x32x16_bf16 a[144:159], v[40:43], v[52:55], a[144:159]
  v_mfma_f32_32x32x16_bf16 a[160:175], v[40:43], v[56:59], a[160:175]
  v_mfma_f32_32x32x16_bf16 a[176:191], v[40:43], v[60:63], a[176:191]
  v_mfma_f32_32x32x16_bf16 a[192:207], v[44:47], v[48:51], a[192:207]
  v_mfma_f32_32x32x16_bf16 a[208:223], v[44:47], v[52:55], a[208:223]
  v_mfma_f32_32x32x16_bf16 a[224:239], v[44:47], v[56:59], a[224:239]
  v_mfma_f32_32x32x16_bf16 a[240:255], v[44:47], v[60:63], a[240:255]
  s_waitcnt lgkmcnt(0)
  v_mfma_f32_32x32x16_bf16 a[0:15], v[64:67], v[80:83], a[0:15]
  v_mfma_f32_32x32x16_bf16 a[16:31], v[64:67], v[84:87], a[16:31]
  s_waitcnt vmcnt(0)
  s_barrier
  v_mfma_f32_32x32x16_bf16 a[32:47], v[64:67], v[88:91], a[32:47]
  ds_read_b64_tr_b16 v[48:49], v18 offset:49152
  ds_read_b64_tr_b16 v[50:51], v18 offset:51200
  v_mfma_f32_32x32x16_bf16 a[48:63], v[64:67], v[92:95], a[48:63]
  ds_read_b64_tr_b16 v[32:33], v22 offset:49152
  ds_read_b64_tr_b16 v[34:35], v22 offset:51200
  v_mfma_f32_32x32x16_bf16 a[64:79], v[68:71], v[80:83], a[64:79]
  ds_read_b64_tr_b16 v[52:53], v19 offset:49152
  ds_read_b64_tr_b16 v[54:55], v19 offset:51200
  v_mfma_f32_32x32x16_bf16 a[80:95], v[68:71], v[84:87], a[80:95]
  ds_read_b64_tr_b16 v[36:37], v23 offset:49152
  ds_read_b64_tr_b16 v[38:39], v23 offset:51200
  v_mfma_f32_32x32x16_bf16 a[96:111], v[68:71], v[88:91], a[96:111]
  ds_read_b64_tr_b16 v[56:57], v20 offset:49152
  ds_read_b64_tr_b16 v[58:59], v20 offset:51200
  v_mfma_f32_32x32x16_bf16 a[112:127], v[68:71], v[92:95], a[112:127]
  ds_read_b64_tr_b16 v[40:41], v24 offset:49152
  ds_read_b64_tr_b16 v[42:43], v24 offset:51200
  v_mfma_f32_32x32x16_bf16 a[128:143], v[72:75], v[80:83], a[128:143]
  ds_read_b64_tr_b16 v[60:61], v21 offset:49152
  ds_read_b64_tr_b16 v[62:63], v21 offset:51200
  v_mfma_f32_32x32x16_bf16 a[144:159], v[72:75], v[84:87], a[144:159]
  ds_read_b64_tr_b16 v[44:45], v25 offset:49152
  ds_read_b64_tr_b16 v[46:47], v25 offset:51200
  v_mfma_f32_32x32x16_bf16 a[160:175], v[72:75], v[88:91], a[160:175]
  v_mfma_f32_32x32x16_bf16 a[176:191], v[72:75], v[92:95], a[176:191]
  v_mfma_f32_32x32x16_bf16 a[192:207], v[76:79], v[80:83], a[192:207]
  v_mfma_f32_32x32x16_bf16 a[208:223], v[76:79], v[84:87], a[208:223]
  v_mfma_f32_32x32x16_bf16 a[224:239], v[76:79], v[88:91], a[224:239]
  v_mfma_f32_32x32x16_bf16 a[240:255], v[76:79], v[92:95], a[240:255]
  s_waitcnt lgkmcnt(0)
  v_mfma_f32_32x32x16_bf16 a[0:15], v[32:35], v[48:51], a[0:15]
  ds_read_b64_tr_b16 v[80:81], v18 offset:57344
  ds_read_b64_tr_b16 v[82:83], v18 offset:59392
  v_mfma_f32_32x32x16_bf16 a[16:31], v[32:35], v[52:55], a[16:31]
  ds_read_b64_tr_b16 v[64:65], v22 offset:57344
  ds_read_b64_tr_b16 v[66:67], v22 offset:59392
  v_mfma_f32_32x32x16_bf16 a[32:47], v[32:35], v[56:59], a[32:47]
  ds_read_b64_tr_b16 v[84:85], v19 offset:57344
  ds_read_b64_tr_b16 v[86:87], v19 offset:59392
  v_mfma_f32_32x32x16_bf16 a[48:63], v[32:35], v[60:63], a[48:63]
  ds_read_b64_tr_b16 v[68:69], v23 offset:57344
  ds_read_b64_tr_b16 v[70:71], v23 offset:59392
  v_mfma_f32_32x32x16_bf16 a[64:79], v[36:39], v[48:51], a[64:79]
  ds_read_b64_tr_b16 v[88:89], v20 offset:57344
  ds_read_b64_tr_b16 v[90:91], v20 offset:59392
  v_mfma_f32_32x32x16_bf16 a[80:95], v[36:39], v[52:55], a[80:95]
  ds_read_b64_tr_b16 v[72:73], v24 offset:57344
  ds_read_b64_tr_b16 v[74:75], v24 offset:59392
  v_mfma_f32_32x32x16_bf16 a[96:111], v[36:39], v[56:59], a[96:111]
  ds_read_b64_tr_b16 v[92:93], v21 offset:57344
  ds_read_b64_tr_b16 v[94:95], v21 offset:59392
  v_mfma_f32_32x32x16_bf16 a[112:127], v[36:39], v[60:63], a[112:127]
  ds_read_b64_tr_b16 v[76:77], v25 offset:57344
  ds_read_b64_tr_b16 v[78:79], v25 offset:59392
  v_mfma_f32_32x32x16_bf16 a[128:143], v[40:43], v[48:51], a[128:143]
  v_mfma_f32_32x32x16_bf16 a[144:159], v[40:43], v[52:55], a[144:159]
  v_mfma_f32_32x32x16_bf16 a[160:175], v[40:43], v[56:59], a[160:175]
  v_mfma_f32_32x32x16_bf16 a[176:191], v[40:43], v[60:63], a[176:191]
  v_mfma_f32_32x32x16_bf16 a[192:207], v[44:47], v[48:51], a[192:207]
  v_mfma_f32_32x32x16_bf16 a[208:223], v[44:47], v[52:55], a[208:223]
  v_mfma_f32_32x32x16_bf16 a[224:239], v[44:47], v[56:59], a[224:239]
  v_mfma_f32_32x32x16_bf16 a[240:255], v[44:47], v[60:63], a[240:255]
  s_waitcnt lgkmcnt(0)
  v_mfma_f32_32x32x16_bf16 a[0:15], v[64:67], v[80:83], a[0:15]
  v_mfma_f32_32x32x16_bf16 a[16:31], v[64:67], v[84:87], a[16:31]
  v_mfma_f32_32x32x16_bf16 a[32:47], v[64:67], v[88:91], a[32:47]
  v_mfma_f32_32x32x16_bf16 a[48:63], v[64:67], v[92:95], a[48:63]
  v_mfma_f32_32x32x16_bf16 a[64:79], v[68:71], v[80:83], a[64:79]
  v_mfma_f32_32x32x16_bf16 a[80:95], v[68:71], v[84:87], a[80:95]
  v_mfma_f32_32x32x16_bf16 a[96:111], v[68:71], v[88:91], a[96:111]
  v_mfma_f32_32x32x16_bf16 a[112:127], v[68:71], v[92:95], a[112:127]
  v_mfma_f32_32x32x16_bf16 a[128:143], v[72:75], v[80:83], a[128:143]
  v_mfma_f32_32x32x16_bf16 a[144:159], v[72:75], v[84:87], a[144:159]
  v_mfma_f32_32x32x16_bf16 a[160:175], v[72:75], v[88:91], a[160:175]
  v_mfma_f32_32x32x16_bf16 a[176:191], v[72:75], v[92:95], a[176:191]
  v_mfma_f32_32x32x16_bf16 a[192:207], v[76:79], v[80:83], a[192:207]
  v_mfma_f32_32x32x16_bf16 a[208:223], v[76:79], v[84:87], a[208:223]
  v_mfma_f32_32x32x16_bf16 a[224:239], v[76:79], v[88:91], a[224:239]
  v_mfma_f32_32x32x16_bf16 a[240:255], v[76:79], v[92:95], a[240:255]
  s_nop 11
  s_branch w_g3e
w_g5:
  s_lshl_b32 s86, s82, 1
  s_add_u32 s86, s86, 48
  s_lshl_b32 s61, s86, 7
  s_add_u32 s61, s61, 99614720
  s_cmp_lg_u32 s58, 0
  s_cbranch_scc1 wf_56_ok
wf_56:
  buffer_load_dword v26, v255, s[28:31], s61 offen sc1
  s_waitcnt vmcnt(0)
  v_readfirstlane_b32 s62, v26
  s_nop 3
  s_cmp_ge_u32 s62, 32
  s_cbranch_scc1 wf_56_ok
  s_sub_u32 s88, s88, 1
  s_cselect_b32 s88, 0, s88
  s_cbranch_scc1 wf_56_ok
  s_sleep 3
  s_branch wf_56
wf_56_ok:
  s_barrier
  s_nop 0
  s_add_u32 s86, s86, 1
  s_lshl_b32 s61, s86, 7
  s_add_u32 s61, s61, 99614720
  s_cmp_lg_u32 s58, 0
  s_cbranch_scc1 wf_57_ok
wf_57:
  buffer_load_dword v26, v255, s[28:31], s61 offen sc1
  s_waitcnt vmcnt(0)
  v_readfirstlane_b32 s62, v26
  s_nop 3
  s_cmp_ge_u32 s62, 32
  s_cbranch_scc1 wf_57_ok
  s_sub_u32 s88, s88, 1
  s_cselect_b32 s88, 0, s88
  s_cbranch_scc1 wf_57_ok
  s_sleep 3
  s_branch wf_57
wf_57_ok:
  s_barrier
  s_nop 0
  s_lshl_b32 s89, s83, 9
  s_add_u32 s44, s12, s89
  s_addc_u32 s45, s13, 0
  s_sub_u32 s46, 8388608, s89
  s_mov_b32 s47, 0x20000
  s_lshl_b32 s89, s82, 14
  s_add_u32 s89, s89, 71303168
  s_add_u32 s40, s14, s89
  s_addc_u32 s41, s15, 0
  s_sub_u32 s40, s40, 4096
  s_subb_u32 s41, s41, 0
  s_sub_u32 s42, 268439552, s89
  s_mov_b32 s43, 0x20000
  s_mov_b32 s56, 64
  s_mov_b32 s75, 2
  s_mov_b32 s76, 131072
  s_mov_b32 s77, 262144
  s_mov_b32 s56, 64
  s_mov_b32 s57, 2048
  s_mov_b32 s51, 31
w_f0:
  v_and_b32 v26, 31, v1
  s_mul_i32 s61, s60, 128
  v_add_u32 v27, s61, v26
  v_lshlrev_b32 v27, 7, v27
  v_bfe_u32 v26, v1, 1, 3
  v_lshrrev_b32 v18, 5, v1
  v_add_u32 v19, 0, v18
  v_xor_b32 v19, v19, v26
  v_lshl_add_u32 v14, v19, 4, v27
  v_add_u32 v19, 2, v18
  v_xor_b32 v19, v19, v26
  v_lshl_add_u32 v15, v19, 4, v27
  v_add_u32 v19, 4, v18
  v_xor_b32 v19, v19, v26
  v_lshl_add_u32 v16, v19, 4, v27
  v_add_u32 v19, 6, v18
  v_xor_b32 v19, v19, v26
  v_lshl_add_u32 v17, v19, 4, v27
  v_lshrrev_b32 v26, 3, v1
  s_mul_i32 s61, s58, 64
  v_add_u32 v26, s61, v26
  v_mul_lo_u32 v26, v26, s56
  v_lshrrev_b32 v27, 4, v1
  v_and_b32 v18, 7, v1
  s_lshl_b32 s62, s56, 3
  s_lshl_b32 s54, 1, s75
  s_sub_u32 s54, s54, 1
  v_add_u32 v19, 0, v27
  v_xor_b32 v19, v19, v18
  v_lshrrev_b32 v20, s75, v19
  v_mul_lo_u32 v20, v20, s76
  v_and_b32 v19, s54, v19
  v_lshl_add_u32 v2, v19, 4, v26
  v_add_u32 v2, v2, v20
  v_add_u32 v2, 4096, v2
  v_add_u32 v26, s62, v26
  v_add_u32 v19, 4, v27
  v_xor_b32 v19, v19, v18
  v_lshrrev_b32 v20, s75, v19
  v_mul_lo_u32 v20, v20, s76
  v_and_b32 v19, s54, v19
  v_lshl_add_u32 v3, v19, 4, v26
  v_add_u32 v3, v3, v20
  v_add_u32 v3, 3072, v3
  v_add_u32 v26, s62, v26
  v_add_u32 v19, 0, v27
  v_xor_b32 v19, v19, v18
  v_lshrrev_b32 v20, s75, v19
  v_mul_lo_u32 v20, v20, s76
  v_and_b32 v19, s54, v19
  v_lshl_add_u32 v4, v19, 4, v26
  v_add_u32 v4, v4, v20
  v_add_u32 v4, 2048, v4
  v_add_u32 v26, s62, v26
  v_add_u32 v19, 4, v27
  v_xor_b32 v19, v19, v18
  v_lshrrev_b32 v20, s75, v19
  v_mul_lo_u32 v20, v20, s76
  v_and_b32 v19, s54, v19
  v_lshl_add_u32 v5, v19, 4, v26
  v_add_u32 v5, v5, v20
  v_add_u32 v5, 1024, v5
  v_add_u32 v26, s62, v26
  v_add_u32 v19, 0, v27
  v_xor_b32 v19, v19, v18
  v_lshrrev_b32 v20, s75, v19
  v_mul_lo_u32 v20, v20, s76
  v_and_b32 v19, s54, v19
  v_lshl_add_u32 v6, v19, 4, v26
  v_add_u32 v6, v6, v20
  v_add_u32 v6, 4096, v6
  v_add_u32 v26, s62, v26
  v_add_u32 v19, 4, v27
  v_xor_b32 v19, v19, v18
  v_lshrrev_b32 v20, s75, v19
  v_mul_lo_u32 v20, v20, s76
  v_and_b32 v19, s54, v19
  v_lshl_add_u32 v7, v19, 4, v26
  v_add_u32 v7, v7, v20
  v_add_u32 v7, 3072, v7
  v_add_u32 v26, s62, v26
  v_add_u32 v19, 0, v27
  v_xor_b32 v19, v19, v18
  v_lshrrev_b32 v20, s75, v19
  v_mul_lo_u32 v20, v20, s76
  v_and_b32 v19, s54, v19
  v_lshl_add_u32 v8, v19, 4, v26
  v_add_u32 v8, v8, v20
  v_add_u32 v8, 2048, v8
  v_add_u32 v26, s62, v26
  v_add_u32 v19, 4, v27
  v_xor_b32 v19, v19, v18
  v_lshrrev_b32 v20, s75, v19
  v_mul_lo_u32 v20, v20, s76
  v_and_b32 v19, s54, v19
  v_lshl_add_u32 v9, v19, 4, v26
  v_add_u32 v9, v9, v20
  v_add_u32 v9, 1024, v9
  s_mul_i32 s54, s58, 8192
  v_lshrrev_b32 v27, 5, v1
  s_lshl_b32 s61, s58, 3
  v_add_u32 v26, s61, v27
  v_mul_lo_u32 v26, v26, s57
  v_and_b32 v18, 31, v1
  s_lshl_b32 s62, s57, 1
  v_add_u32 v19, 0, v27
  v_lshlrev_b32 v19, 2, v19
  v_xor_b32 v19, v19, v18
  v_lshl_add_u32 v10, v19, 4, v26
  v_add_u32 v26, s62, v26
  v_add_u32 v19, 2, v27
  v_lshlrev_b32 v19, 2, v19
  v_xor_b32 v19, v19, v18
  v_lshl_add_u32 v11, v19, 4, v26
  v_subrev_u32 v11, 1024, v11
  v_add_u32 v26, s62, v26
  v_add_u32 v19, 0, v27
  v_lshlrev_b32 v19, 2, v19
  v_xor_b32 v19, v19, v18
  v_lshl_add_u32 v12, v19, 4, v26
  v_subrev_u32 v12, 2048, v12
  v_add_u32 v26, s62, v26
  v_add_u32 v19, 2, v27
  v_lshlrev_b32 v19, 2, v19
  v_xor_b32 v19, v19, v18
  v_lshl_add_u32 v13, v19, 4, v26
  v_subrev_u32 v13, 3072, v13
  s_lshl_b32 s50, s57, 5
  s_mov_b32 s48, 0
  s_mov_b32 s53, s54
  s_mov_b32 s49, 0
  s_add_u32 m0, s53, 0
  s_nop 0
  buffer_load_dwordx4 v2, s[40:43], s48 offen offset:0 sc1 lds
  buffer_load_dwordx4 v3, s[40:43], s48 offen offset:1024 sc1 lds
  buffer_load_dwordx4 v4, s[40:43], s48 offen offset:2048 sc1 lds
  buffer_load_dwordx4 v5, s[40:43], s48 offen offset:3072 sc1 lds
  s_add_u32 m0, s55, 0
  s_nop 0
  buffer_load_dwordx4 v10, s[44:47], s49 offen offset:0 lds
  buffer_load_dwordx4 v11, s[44:47], s49 offen offset:1024 lds
  buffer_load_dwordx4 v12, s[44:47], s49 offen offset:2048 lds
  buffer_load_dwordx4 v13, s[44:47], s49 offen offset:3072 lds
  s_add_u32 s49, s49, s50
  s_add_u32 m0, s53, 4096
  s_nop 0
  buffer_load_dwordx4 v6, s[40:43], s48 offen offset:0 sc1 lds
  buffer_load_dwordx4 v7, s[40:43], s48 offen offset:1024 sc1 lds
  buffer_load_dwordx4 v8, s[40:43], s48 offen offset:2048 sc1 lds
  buffer_load_dwordx4 v9, s[40:43], s48 offen offset:3072 sc1 lds
  s_add_u32 s48, s48, s77
  s_add_u32 s53, s54, 32768
  s_add_u32 m0, s55, 16384
  s_nop 0
  buffer_load_dwordx4 v10, s[44:47], s49 offen offset:0 lds
  buffer_load_dwordx4 v11, s[44:47], s49 offen offset:1024 lds
  buffer_load_dwordx4 v12, s[44:47], s49 offen offset:2048 lds
  buffer_load_dwordx4 v13, s[44:47], s49 offen offset:3072 lds
  s_add_u32 s49, s49, s50
  s_add_u32 m0, s53, 0
  s_nop 0
  buffer_load_dwordx4 v2, s[40:43], s48 offen offset:0 sc1 lds
  buffer_load_dwordx4 v3, s[40:43], s48 offen offset:1024 sc1 lds
  buffer_load_dwordx4 v4, s[40:43], s48 offen offset:2048 sc1 lds
  buffer_load_dwordx4 v5, s[40:43], s48 offen offset:3072 sc1 lds
  s_add_u32 m0, s55, 32768
  s_nop 0
  buffer_load_dwordx4 v10, s[44:47], s49 offen offset:0 lds
  buffer_load_dwordx4 v11, s[44:47], s49 offen offset:1024 lds
  buffer_load_dwordx4 v12, s[44:47], s49 offen offset:2048 lds
  buffer_load_dwordx4 v13, s[44:47], s49 offen offset:3072 lds
  s_add_u32 s49, s49, s50
  s_add_u32 m0, s53, 4096
  s_nop 0
  buffer_load_dwordx4 v6, s[40:43], s48 offen offset:0 sc1 lds
  buffer_load_dwordx4 v7, s[40:43], s48 offen offset:1024 sc1 lds
  buffer_load_dwordx4 v8, s[40:43], s48 offen offset:2048 sc1 lds
  buffer_load_dwordx4 v9, s[40:43], s48 offen offset:3072 sc1 lds
  s_add_u32 s48, s48, s77
  s_add_u32 s53, s54, 65536
  s_add_u32 m0, s55, 49152
  s_nop 0
  buffer_load_dwordx4 v10, s[44:47], s49 offen offset:0 lds
  buffer_load_dwordx4 v11, s[44:47], s49 offen offset:1024 lds
  buffer_load_dwordx4 v12, s[44:47], s49 offen offset:2048 lds
  buffer_load_dwordx4 v13, s[44:47], s49 offen offset:3072 lds
  s_add_u32 s49, s49, s50
  s_add_u32 m0, s53, 0
  s_nop 0
  buffer_load_dwordx4 v2, s[40:43], s48 offen offset:0 sc1 lds
  buffer_load_dwordx4 v3, s[40:43], s48 offen offset:1024 sc1 lds
  buffer_load_dwordx4 v4, s[40:43], s48 offen offset:2048 sc1 lds
  buffer_load_dwordx4 v5, s[40:43], s48 offen offset:3072 sc1 lds
  s_nop 0
w_f_pre:
  s_mov_b32 s52, 0
  v_mov_b32 v18, v14
  v_mov_b32 v19, v15
  v_mov_b32 v20, v16
  v_mov_b32 v21, v17
  s_waitcnt vmcnt(24)
  s_barrier
  ds_read_b128 v[48:51], v18 offset:0
  ds_read_b64_tr_b16 v[32:33], v22 offset:0
  ds_read_b64_tr_b16 v[34:35], v22 offset:2048
  ds_read_b128 v[52:55], v18 offset:4096
  ds_read_b64_tr_b16 v[36:37], v23 offset:0
  ds_read_b64_tr_b16 v[38:39], v23 offset:2048
  ds_read_b128 v[56:59], v18 offset:8192
  ds_read_b64_tr_b16 v[40:41], v24 offset:0
  ds_read_b64_tr_b16 v[42:43], v24 offset:2048
  ds_read_b128 v[60:63], v18 offset:12288
  ds_read_b64_tr_b16 v[44:45], v25 offset:0
  ds_read_b64_tr_b16 v[46:47], v25 offset:2048
  s_waitcnt lgkmcnt(0)
  v_mfma_f32_32x32x16_bf16 a[0:15], v[32:35], v[48:51], 0
  ds_read_b128 v[80:83], v19 offset:0
  v_mfma_f32_32x32x16_bf16 a[16:31], v[32:35], v[52:55], 0
  ds_read_b64_tr_b16 v[64:65], v22 offset:8192
  v_mfma_f32_32x32x16_bf16 a[32:47], v[32:35], v[56:59], 0
  ds_read_b64_tr_b16 v[66:67], v22 offset:10240
  v_mfma_f32_32x32x16_bf16 a[48:63], v[32:35], v[60:63], 0
  ds_read_b128 v[84:87], v19 offset:4096
  v_mfma_f32_32x32x16_bf16 a[64:79], v[36:39], v[48:51], 0
  ds_read_b64_tr_b16 v[68:69], v23 offset:8192
  v_mfma_f32_32x32x16_bf16 a[80:95], v[36:39], v[52:55], 0
  ds_read_b64_tr_b16 v[70:71], v23 offset:10240
  v_mfma_f32_32x32x16_bf16 a[96:111], v[36:39], v[56:59], 0
  ds_read_b128 v[88:91], v19 offset:8192
  v_mfma_f32_32x32x16_bf16 a[112:127], v[36:39], v[60:63], 0
  ds_read_b64_tr_b16 v[72:73], v24 offset:8192
  v_mfma_f32_32x32x16_bf16 a[128:143], v[40:43], v[48:51], 0
  ds_read_b64_tr_b16 v[74:75], v24 offset:10240
  v_mfma_f32_32x32x16_bf16 a[144:159], v[40:43], v[52:55], 0
  ds_read_b128 v[92:95], v19 offset:12288
  v_mfma_f32_32x32x16_bf16 a[160:175], v[40:43], v[56:59], 0
  ds_read_b64_tr_b16 v[76:77], v25 offset:8192
  v_mfma_f32_32x32x16_bf16 a[176:191], v[40:43], v[60:63], 0
  ds_read_b64_tr_b16 v[78:79], v25 offset:10240
  v_mfma_f32_32x32x16_bf16 a[192:207], v[44:47], v[48:51], 0
  v_mfma_f32_32x32x16_bf16 a[208:223], v[44:47], v[52:55], 0
  v_mfma_f32_32x32x16_bf16 a[224:239], v[44:47], v[56:59], 0
  v_mfma_f32_32x32x16_bf16 a[240:255], v[44:47], v[60:63], 0
  s_branch gm_f
  s_nop 10
gl_f:
  s_waitcnt lgkmcnt(0)
  v_mfma_f32_32x32x16_bf16 a[0:15], v[32:35], v[48:51], a[0:15]
  ds_read_b128 v[80:83], v19 offset:0
  v_mfma_f32_32x32x16_bf16 a[16:31], v[32:35], v[52:55], a[16:31]
  ds_read_b64_tr_b16 v[64:65], v22 offset:8192
  v_mfma_f32_32x32x16_bf16 a[32:47], v[32:35], v[56:59], a[32:47]
  ds_read_b64_tr_b16 v[66:67], v22 offset:10240
  v_mfma_f32_32x32x16_bf16 a[48:63], v[32:35], v[60:63], a[48:63]
  ds_read_b128 v[84:87], v19 offset:4096
  v_mfma_f32_32x32x16_bf16 a[64:79], v[36:39], v[48:51], a[64:79]
  ds_read_b64_tr_b16 v[68:69], v23 offset:8192
  v_mfma_f32_32x32x16_bf16 a[80:95], v[36:39], v[52:55], a[80:95]
  ds_read_b64_tr_b16 v[70:71], v23 offset:10240
  v_mfma_f32_32x32x16_bf16 a[96:111], v[36:39], v[56:59], a[96:111]
  ds_read_b128 v[88:91], v19 offset:8192
  v_mfma_f32_32x32x16_bf16 a[112:127], v[36:39], v[60:63], a[112:127]
  ds_read_b64_tr_b16 v[72:73], v24 offset:8192
  v_mfma_f32_32x32x16_bf16 a[128:143], v[40:43], v[48:51], a[128:143]
  ds_read_b64_tr_b16 v[74:75], v24 offset:10240
  v_mfma_f32_32x32x16_bf16 a[144:159], v[40:43], v[52:55], a[144:159]
  ds_read_b128 v[92:95], v19 offset:12288
  v_mfma_f32_32x32x16_bf16 a[160:175], v[40:43], v[56:59], a[160:175]
  ds_read_b64_tr_b16 v[76:77], v25 offset:8192
  v_mfma_f32_32x32x16_bf16 a[176:191], v[40:43], v[60:63], a[176:191]
  ds_read_b64_tr_b16 v[78:79], v25 offset:10240
  v_mfma_f32_32x32x16_bf16 a[192:207], v[44:47], v[48:51], a[192:207]
  v_mfma_f32_32x32x16_bf16 a[208:223], v[44:47], v[52:55], a[208:223]
  v_mfma_f32_32x32x16_bf16 a[224:239], v[44:47], v[56:59], a[224:239]
  v_mfma_f32_32x32x16_bf16 a[240:255], v[44:47], v[60:63], a[240:255]
gm_f:
  s_waitcnt lgkmcnt(0)
  v_mfma_f32_32x32x16_bf16 a[0:15], v[64:67], v[80:83], a[0:15]
  v_mfma_f32_32x32x16_bf16 a[16:31], v[64:67], v[84:87], a[16:31]
  s_waitcnt vmcnt(16)
  s_barrier
  v_mfma_f32_32x32x16_bf16 a[32:47], v[64:67], v[88:91], a[32:47]
  ds_read_b128 v[48:51], v20 offset:0
  s_add_u32 m0, s55, 0
  v_mfma_f32_32x32x16_bf16 a[48:63], v[64:67], v[92:95], a[48:63]
  ds_read_b64_tr_b16 v[32:33], v22 offset:16384
  buffer_load_dwordx4 v10, s[44:47], s49 offen offset:0 lds
  v_mfma_f32_32x32x16_bf16 a[64:79], v[68:71], v[80:83], a[64:79]
  ds_read_b64_tr_b16 v[34:35], v22 offset:18432
  buffer_load_dwordx4 v11, s[44:47], s49 offen offset:1024 lds
  v_mfma_f32_32x32x16_bf16 a[80:95], v[68:71], v[84:87], a[80:95]
  ds_read_b128 v[52:55], v20 offset:4096
  buffer_load_dwordx4 v12, s[44:47], s49 offen offset:2048 lds
  v_mfma_f32_32x32x16_bf16 a[96:111], v[68:71], v[88:91], a[96:111]
  ds_read_b64_tr_b16 v[36:37], v23 offset:16384
  buffer_load_dwordx4 v13, s[44:47], s49 offen offset:3072 lds
  v_mfma_f32_32x32x16_bf16 a[112:127], v[68:71], v[92:95], a[112:127]
  ds_read_b64_tr_b16 v[38:39], v23 offset:18432
  s_add_u32 s49, s49, s50
  v_mfma_f32_32x32x16_bf16 a[128:143], v[72:75], v[80:83], a[128:143]
  ds_read_b128 v[56:59], v20 offset:8192
  s_add_u32 m0, s53, 4096
  v_mfma_f32_32x32x16_bf16 a[144:159], v[72:75], v[84:87], a[144:159]
  ds_read_b64_tr_b16 v[40:41], v24 offset:16384
  buffer_load_dwordx4 v6, s[40:43], s48 offen offset:0 sc1 lds
  v_mfma_f32_32x32x16_bf16 a[160:175], v[72:75], v[88:91], a[160:175]
  ds_read_b64_tr_b16 v[42:43], v24 offset:18432
  buffer_load_dwordx4 v7, s[40:43], s48 offen offset:1024 sc1 lds
  v_mfma_f32_32x32x16_bf16 a[176:191], v[72:75], v[92:95], a[176:191]
  ds_read_b128 v[60:63], v20 offset:12288
  buffer_load_dwordx4 v8, s[40:43], s48 offen offset:2048 sc1 lds
  v_mfma_f32_32x32x16_bf16 a[192:207], v[76:79], v[80:83], a[192:207]
  ds_read_b64_tr_b16 v[44:45], v25 offset:16384
  buffer_load_dwordx4 v9, s[40:43], s48 offen offset:3072 sc1 lds
  v_mfma_f32_32x32x16_bf16 a[208:223], v[76:79], v[84:87], a[208:223]
  ds_read_b64_tr_b16 v[46:47], v25 offset:18432
  s_add_u32 s48, s48, s77
  v_mfma_f32_32x32x16_bf16 a[224:239], v[76:79], v[88:91], a[224:239]
  v_mfma_f32_32x32x16_bf16 a[240:255], v[76:79], v[92:95], a[240:255]
  s_waitcnt lgkmcnt(0)
  v_mfma_f32_32x32x16_bf16 a[0:15], v[32:35], v[48:51], a[0:15]
  ds_read_b128 v[80:83], v21 offset:0
  v_mfma_f32_32x32x16_bf16 a[16:31], v[32:35], v[52:55], a[16:31]
  ds_read_b64_tr_b16 v[64:65], v22 offset:24576
  v_mfma_f32_32x32x16_bf16 a[32:47], v[32:35], v[56:59], a[32:47]
  ds_read_b64_tr_b16 v[66:67], v22 offset:26624
  v_mfma_f32_32x32x16_bf16 a[48:63], v[32:35], v[60:63], a[48:63]
  ds_read_b128 v[84:87], v21 offset:4096
  v_mfma_f32_32x32x16_bf16 a[64:79], v[36:39], v[48:51], a[64:79]
  ds_read_b64_tr_b16 v[68:69], v23 offset:24576
  v_mfma_f32_32x32x16_bf16 a[80:95], v[36:39], v[52:55], a[80:95]
  ds_read_b64_tr_b16 v[70:71], v23 offset:26624
  v_mfma_f32_32x32x16_bf16 a[96:111], v[36:39], v[56:59], a[96:111]
  ds_read_b128 v[88:91], v21 offset:8192
  v_mfma_f32_32x32x16_bf16 a[112:127], v[36:39], v[60:63], a[112:127]
  ds_read_b64_tr_b16 v[72:73], v24 offset:24576
  v_mfma_f32_32x32x16_bf16 a[128:143], v[40:43], v[48:51], a[128:143]
  ds_read_b64_tr_b16 v[74:75], v24 offset:26624
  v_mfma_f32_32x32x16_bf16 a[144:159], v[40:43], v[52:55], a[144:159]
  ds_read_b128 v[92:95], v21 offset:12288
  v_mfma_f32_32x32x16_bf16 a[160:175], v[40:43], v[56:59], a[160:175]
  ds_read_b64_tr_b16 v[76:77], v25 offset:24576
  v_mfma_f32_32x32x16_bf16 a[176:191], v[40:43], v[60:63], a[176:191]
  ds_read_b64_tr_b16 v[78:79], v25 offset:26624
  v_mfma_f32_32x32x16_bf16 a[192:207], v[44:47], v[48:51], a[192:207]
  v_mfma_f32_32x32x16_bf16 a[208:223], v[44:47], v[52:55], a[208:223]
  v_mfma_f32_32x32x16_bf16 a[224:239], v[44:47], v[56:59], a[224:239]
  v_mfma_f32_32x32x16_bf16 a[240:255], v[44:47], v[60:63], a[240:255]
  s_waitcnt lgkmcnt(0)
  v_mfma_f32_32x32x16_bf16 a[0:15], v[64:67], v[80:83], a[0:15]
  v_mfma_f32_32x32x16_bf16 a[16:31], v[64:67], v[84:87], a[16:31]
  s_add_u32 s53, s52, s54
  s_add_u32 s52, s52, 32768
  s_cmp_eq_u32 s52, 98304
  s_cselect_b32 s52, 0, s52
  v_add_u32 v18, s52, v14
  v_add_u32 v19, s52, v15
  v_add_u32 v20, s52, v16
  v_add_u32 v21, s52, v17
  s_waitcnt vmcnt(16)
  s_barrier
  v_mfma_f32_32x32x16_bf16 a[32:47], v[64:67], v[88:91], a[32:47]
  ds_read_b128 v[48:51], v18 offset:0
  s_add_u32 m0, s55, 16384
  v_mfma_f32_32x32x16_bf16 a[48:63], v[64:67], v[92:95], a[48:63]
  ds_read_b64_tr_b16 v[32:33], v22 offset:32768
  buffer_load_dwordx4 v10, s[44:47], s49 offen offset:0 lds
  v_mfma_f32_32x32x16_bf16 a[64:79], v[68:71], v[80:83], a[64:79]
  ds_read_b64_tr_b16 v[34:35], v22 offset:34816
  buffer_load_dwordx4 v11, s[44:47], s49 offen offset:1024 lds
  v_mfma_f32_32x32x16_bf16 a[80:95], v[68:71], v[84:87], a[80:95]
  ds_read_b128 v[52:55], v18 offset:4096
  buffer_load_dwordx4 v12, s[44:47], s49 offen offset:2048 lds
  v_mfma_f32_32x32x16_bf16 a[96:111], v[68:71], v[88:91], a[96:111]
  ds_read_b64_tr_b16 v[36:37], v23 offset:32768
  buffer_load_dwordx4 v13, s[44:47], s49 offen offset:3072 lds
  v_mfma_f32_32x32x16_bf16 a[112:127], v[68:71], v[92:95], a[112:127]
  ds_read_b64_tr_b16 v[38:39], v23 offset:34816
  s_add_u32 s49, s49, s50
  v_mfma_f32_32x32x16_bf16 a[128:143], v[72:75], v[80:83], a[128:143]
  ds_read_b128 v[56:59], v18 offset:8192
  s_add_u32 m0, s53, 0
  v_mfma_f32_32x32x16_bf16 a[144:159], v[72:75], v[84:87], a[144:159]
  ds_read_b64_tr_b16 v[40:41], v24 offset:32768
  buffer_load_dwordx4 v2, s[40:43], s48 offen offset:0 sc1 lds
  v_mfma_f32_32x32x16_bf16 a[160:175], v[72:75], v[88:91], a[160:175]
  ds_read_b64_tr_b16 v[42:43], v24 offset:34816
  buffer_load_dwordx4 v3, s[40:43], s48 offen offset:1024 sc1 lds
  v_mfma_f32_32x32x16_bf16 a[176:191], v[72:75], v[92:95], a[176:191]
  ds_read_b128 v[60:63], v18 offset:12288
  buffer_load_dwordx4 v4, s[40:43], s48 offen offset:2048 sc1 lds
  v_mfma_f32_32x32x16_bf16 a[192:207], v[76:79], v[80:83], a[192:207]
  ds_read_b64_tr_b16 v[44:45], v25 offset:32768
  buffer_load_dwordx4 v5, s[40:43], s48 offen offset:3072 sc1 lds
  v_mfma_f32_32x32x16_bf16 a[208:223], v[76:79], v[84:87], a[208:223]
  ds_read_b64_tr_b16 v[46:47], v25 offset:34816
  v_mfma_f32_32x32x16_bf16 a[224:239], v[76:79], v[88:91], a[224:239]
  v_mfma_f32_32x32x16_bf16 a[240:255], v[76:79], v[92:95], a[240:255]
  s_waitcnt lgkmcnt(0)
  v_mfma_f32_32x32x16_bf16 a[0:15], v[32:35], v[48:51], a[0:15]
  ds_read_b128 v[80:83], v19 offset:0
  v_mfma_f32_32x32x16_bf16 a[16:31], v[32:35], v[52:55], a[16:31]
  ds_read_b64_tr_b16 v[64:65], v22 offset:40960
  v_mfma_f32_32x32x16_bf16 a[32:47], v[32:35], v[56:59], a[32:47]
  ds_read_b64_tr_b16 v[66:67], v22 offset:43008
  v_mfma_f32_32x32x16_bf16 a[48:63], v[32:35], v[60:63], a[48:63]
  ds_read_b128 v[84:87], v19 offset:4096
  v_mfma_f32_32x32x16_bf16 a[64:79], v[36:39], v[48:51], a[64:79]
  ds_read_b64_tr_b16 v[68:69], v23 offset:40960
  v_mfma_f32_32x32x16_bf16 a[80:95], v[36:39], v[52:55], a[80:95]
  ds_read_b64_tr_b16 v[70:71], v23 offset:43008
  v_mfma_f32_32x32x16_bf16 a[96:111], v[36:39], v[56:59], a[96:111]
  ds_read_b128 v[88:91], v19 offset:8192
  v_mfma_f32_32x32x16_bf16 a[112:127], v[36:39], v[60:63], a[112:127]
  ds_read_b64_tr_b16 v[72:73], v24 offset:40960
  v_mfma_f32_32x32x16_bf16 a[128:143], v[40:43], v[48:51], a[128:143]
  ds_read_b64_tr_b16 v[74:75], v24 offset:43008
  v_mfma_f32_32x32x16_bf16 a[144:159], v[40:43], v[52:55], a[144:159]
  ds_read_b128 v[92:95], v19 offset:12288
  v_mfma_f32_32x32x16_bf16 a[160:175], v[40:43], v[56:59], a[160:175]
  ds_read_b64_tr_b16 v[76:77], v25 offset:40960
  v_mfma_f32_32x32x16_bf16 a[176:191], v[40:43], v[60:63], a[176:191]
  ds_read_b64_tr_b16 v[78:79], v25 offset:43008
  v_mfma_f32_32x32x16_bf16 a[192:207], v[44:47], v[48:51], a[192:207]
  v_mfma_f32_32x32x16_bf16 a[208:223], v[44:47], v[52:55], a[208:223]
  v_mfma_f32_32x32x16_bf16 a[224:239], v[44:47], v[56:59], a[224:239]
  v_mfma_f32_32x32x16_bf16 a[240:255], v[44:47], v[60:63], a[240:255]
  s_waitcnt lgkmcnt(0)
  v_mfma_f32_32x32x16_bf16 a[0:15], v[64:67], v[80:83], a[0:15]
  v_mfma_f32_32x32x16_bf16 a[16:31], v[64:67], v[84:87], a[16:31]
  s_waitcnt vmcnt(16)
  s_barrier
  v_mfma_f32_32x32x16_bf16 a[32:47], v[64:67], v[88:91], a[32:47]
  ds_read_b128 v[48:51], v20 offset:0
  s_add_u32 m0, s55, 32768
  v_mfma_f32_32x32x16_bf16 a[48:63], v[64:67], v[92:95], a[48:63]
  ds_read_b64_tr_b16 v[32:33], v22 offset:49152
  buffer_load_dwordx4 v10, s[44:47], s49 offen offset:0 lds
  v_mfma_f32_32x32x16_bf16 a[64:79], v[68:71], v[80:83], a[64:79]
  ds_read_b64_tr_b16 v[34:35], v22 offset:51200
  buffer_load_dwordx4 v11, s[44:47], s49 offen offset:1024 lds
  v_mfma_f32_32x32x16_bf16 a[80:95], v[68:71], v[84:87], a[80:95]
  ds_read_b128 v[52:55], v20 offset:4096
  buffer_load_dwordx4 v12, s[44:47], s49 offen offset:2048 lds
  v_mfma_f32_32x32x16_bf16 a[96:111], v[68:71], v[88:91], a[96:111]
  ds_read_b64_tr_b16 v[36:37], v23 offset:49152
  buffer_load_dwordx4 v13, s[44:47], s49 offen offset:3072 lds
  v_mfma_f32_32x32x16_bf16 a[112:127], v[68:71], v[92:95], a[112:127]
  ds_read_b64_tr_b16 v[38:39], v23 offset:51200
  s_add_u32 s49, s49, s50
  v_mfma_f32_32x32x16_bf16 a[128:143], v[72:75], v[80:83], a[128:143]
  ds_read_b128 v[56:59], v20 offset:8192
  s_add_u32 m0, s53, 4096
  v_mfma_f32_32x32x16_bf16 a[144:159], v[72:75], v[84:87], a[144:159]
  ds_read_b64_tr_b16 v[40:41], v24 offset:49152
  buffer_load_dwordx4 v6, s[40:43], s48 offen offset:0 sc1 lds
  v_mfma_f32_32x32x16_bf16 a[160:175], v[72:75], v[88:91], a[160:175]
  ds_read_b64_tr_b16 v[42:43], v24 offset:51200
  buffer_load_dwordx4 v7, s[40:43], s48 offen offset:1024 sc1 lds
  v_mfma_f32_32x32x16_bf16 a[176:191], v[72:75], v[92:95], a[176:191]
  ds_read_b128 v[60:63], v20 offset:12288
  buffer_load_dwordx4 v8, s[40:43], s48 offen offset:2048 sc1 lds
  v_mfma_f32_32x32x16_bf16 a[192:207], v[76:79], v[80:83], a[192:207]
  ds_read_b64_tr_b16 v[44:45], v25 offset:49152
  buffer_load_dwordx4 v9, s[40:43], s48 offen offset:3072 sc1 lds
  v_mfma_f32_32x32x16_bf16 a[208:223], v[76:79], v[84:87], a[208:223]
  ds_read_b64_tr_b16 v[46:47], v25 offset:51200
  s_add_u32 s48, s48, s77
  v_mfma_f32_32x32x16_bf16 a[224:239], v[76:79], v[88:91], a[224:239]
  v_mfma_f32_32x32x16_bf16 a[240:255], v[76:79], v[92:95], a[240:255]
  s_waitcnt lgkmcnt(0)
  v_mfma_f32_32x32x16_bf16 a[0:15], v[32:35], v[48:51], a[0:15]
  ds_read_b128 v[80:83], v21 offset:0
  v_mfma_f32_32x32x16_bf16 a[16:31], v[32:35], v[52:55], a[16:31]
  ds_read_b64_tr_b16 v[64:65], v22 offset:57344
  v_mfma_f32_32x32x16_bf16 a[32:47], v[32:35], v[56:59], a[32:47]
  ds_read_b64_tr_b16 v[66:67], v22 offset:59392
  v_mfma_f32_32x32x16_bf16 a[48:63], v[32:35], v[60:63], a[48:63]
  ds_read_b128 v[84:87], v21 offset:4096
  v_mfma_f32_32x32x16_bf16 a[64:79], v[36:39], v[48:51], a[64:79]
  ds_read_b64_tr_b16 v[68:69], v23 offset:57344
  v_mfma_f32_32x32x16_bf16 a[80:95], v[36:39], v[52:55], a[80:95]
  ds_read_b64_tr_b16 v[70:71], v23 offset:59392
  v_mfma_f32_32x32x16_bf16 a[96:111], v[36:39], v[56:59], a[96:111]
  ds_read_b128 v[88:91], v21 offset:8192
  v_mfma_f32_32x32x16_bf16 a[112:127], v[36:39], v[60:63], a[112:127]
  ds_read_b64_tr_b16 v[72:73], v24 offset:57344
  v_mfma_f32_32x32x16_bf16 a[128:143], v[40:43], v[48:51], a[128:143]
  ds_read_b64_tr_b16 v[74:75], v24 offset:59392
  v_mfma_f32_32x32x16_bf16 a[144:159], v[40:43], v[52:55], a[144:159]
  ds_read_b128 v[92:95], v21 offset:12288
  v_mfma_f32_32x32x16_bf16 a[160:175], v[40:43], v[56:59], a[160:175]
  ds_read_b64_tr_b16 v[76:77], v25 offset:57344
  v_mfma_f32_32x32x16_bf16 a[176:191], v[40:43], v[60:63], a[176:191]
  ds_read_b64_tr_b16 v[78:79], v25 offset:59392
  v_mfma_f32_32x32x16_bf16 a[192:207], v[44:47], v[48:51], a[192:207]
  v_mfma_f32_32x32x16_bf16 a[208:223], v[44:47], v[52:55], a[208:223]
  v_mfma_f32_32x32x16_bf16 a[224:239], v[44:47], v[56:59], a[224:239]
  v_mfma_f32_32x32x16_bf16 a[240:255], v[44:47], v[60:63], a[240:255]
  s_waitcnt lgkmcnt(0)
  v_mfma_f32_32x32x16_bf16 a[0:15], v[64:67], v[80:83], a[0:15]
  v_mfma_f32_32x32x16_bf16 a[16:31], v[64:67], v[84:87], a[16:31]
  s_add_u32 s53, s52, s54
  s_add_u32 s52, s52, 32768
  s_cmp_eq_u32 s52, 98304
  s_cselect_b32 s52, 0, s52
  v_add_u32 v18, s52, v14
  v_add_u32 v19, s52, v15
  v_add_u32 v20, s52, v16
  v_add_u32 v21, s52, v17
  s_waitcnt vmcnt(16)
  s_barrier
  v_mfma_f32_32x32x16_bf16 a[32:47], v[64:67], v[88:91], a[32:47]
  s_add_u32 m0, s55, 49152
  s_nop 0
  buffer_load_dwordx4 v10, s[44:47], s49 offen offset:0 lds
  buffer_load_dwordx4 v11, s[44:47], s49 offen offset:1024 lds
  buffer_load_dwordx4 v12, s[44:47], s49 offen offset:2048 lds
  buffer_load_dwordx4 v13, s[44:47], s49 offen offset:3072 lds
  s_add_u32 s49, s49, s50
  s_cmp_eq_u32 s51, 1
  s_cbranch_scc1 gs_f
  s_add_u32 m0, s53, 0
  s_nop 0
  buffer_load_dwordx4 v2, s[40:43], s48 offen offset:0 sc1 lds
  buffer_load_dwordx4 v3, s[40:43], s48 offen offset:1024 sc1 lds
  buffer_load_dwordx4 v4, s[40:43], s48 offen offset:2048 sc1 lds
  buffer_load_dwordx4 v5, s[40:43], s48 offen offset:3072 sc1 lds
gs_f:
  v_mfma_f32_32x32x16_bf16 a[48:63], v[64:67], v[92:95], a[48:63]
  ds_read_b128 v[48:51], v18 offset:0
  v_mfma_f32_32x32x16_bf16 a[64:79], v[68:71], v[80:83], a[64:79]
  ds_read_b64_tr_b16 v[32:33], v22 offset:0
  v_mfma_f32_32x32x16_bf16 a[80:95], v[68:71], v[84:87], a[80:95]
  ds_read_b64_tr_b16 v[34:35], v22 offset:2048
  v_mfma_f32_32x32x16_bf16 a[96:111], v[68:71], v[88:91], a[96:111]
  ds_read_b128 v[52:55], v18 offset:4096
  v_mfma_f32_32x32x16_bf16 a[112:127], v[68:71], v[92:95], a[112:127]
  ds_read_b64_tr_b16 v[36:37], v23 offset:0
  v_mfma_f32_32x32x16_bf16 a[128:143], v[72:75], v[80:83], a[128:143]
  ds_read_b64_tr_b16 v[38:39], v23 offset:2048
  v_mfma_f32_32x32x16_bf16 a[144:159], v[72:75], v[84:87], a[144:159]
  ds_read_b128 v[56:59], v18 offset:8192
  v_mfma_f32_32x32x16_bf16 a[160:175], v[72:75], v[88:91], a[160:175]
  ds_read_b64_tr_b16 v[40:41], v24 offset:0
  v_mfma_f32_32x32x16_bf16 a[176:191], v[72:75], v[92:95], a[176:191]
  ds_read_b64_tr_b16 v[42:43], v24 offset:2048
  v_mfma_f32_32x32x16_bf16 a[192:207], v[76:79], v[80:83], a[192:207]
  ds_read_b128 v[60:63], v18 offset:12288
  v_mfma_f32_32x32x16_bf16 a[208:223], v[76:79], v[84:87], a[208:223]
  ds_read_b64_tr_b16 v[44:45], v25 offset:0
  v_mfma_f32_32x32x16_bf16 a[224:239], v[76:79], v[88:91], a[224:239]
  ds_read_b64_tr_b16 v[46:47], v25 offset:2048
  v_mfma_f32_32x32x16_bf16 a[240:255], v[76:79], v[92:95], a[240:255]
  s_sub_u32 s51, s51, 1
  s_cmp_lg_u32 s51, 0
  s_cbranch_scc1 gl_f
  s_waitcnt lgkmcnt(0)
  v_mfma_f32_32x32x16_bf16 a[0:15], v[32:35], v[48:51], a[0:15]
  ds_read_b128 v[80:83], v19 offset:0
  v_mfma_f32_32x32x16_bf16 a[16:31], v[32:35], v[52:55], a[16:31]
  ds_read_b64_tr_b16 v[64:65], v22 offset:8192
  v_mfma_f32_32x32x16_bf16 a[32:47], v[32:35], v[56:59], a[32:47]
  ds_read_b64_tr_b16 v[66:67], v22 offset:10240
  v_mfma_f32_32x32x16_bf16 a[48:63], v[32:35], v[60:63], a[48:63]
  ds_read_b128 v[84:87], v19 offset:4096
  v_mfma_f32_32x32x16_bf16 a[64:79], v[36:39], v[48:51], a[64:79]
  ds_read_b64_tr_b16 v[68:69], v23 offset:8192
  v_mfma_f32_32x32x16_bf16 a[80:95], v[36:39], v[52:55], a[80:95]
  ds_read_b64_tr_b16 v[70:71], v23 offset:10240
  v_mfma_f32_32x32x16_bf16 a[96:111], v[36:39], v[56:59], a[96:111]
  ds_read_b128 v[88:91], v19 offset:8192
  v_mfma_f32_32x32x16_bf16 a[112:127], v[36:39], v[60:63], a[112:127]
  ds_read_b64_tr_b16 v[72:73], v24 offset:8192
  v_mfma_f32_32x32x16_bf16 a[128:143], v[40:43], v[48:51], a[128:143]
  ds_read_b64_tr_b16 v[74:75], v24 offset:10240
  v_mfma_f32_32x32x16_bf16 a[144:159], v[40:43], v[52:55], a[144:159]
  ds_read_b128 v[92:95], v19 offset:12288
  v_mfma_f32_32x32x16_bf16 a[160:175], v[40:43], v[56:59], a[160:175]
  ds_read_b64_tr_b16 v[76:77], v25 offset:8192
  v_mfma_f32_32x32x16_bf16 a[176:191], v[40:43], v[60:63], a[176:191]
  ds_read_b64_tr_b16 v[78:79], v25 offset:10240
  v_mfma_f32_32x32x16_bf16 a[192:207], v[44:47], v[48:51], a[192:207]
  v_mfma_f32_32x32x16_bf16 a[208:223], v[44:47], v[52:55], a[208:223]
  v_mfma_f32_32x32x16_bf16 a[224:239], v[44:47], v[56:59], a[224:239]
  v_mfma_f32_32x32x16_bf16 a[240:255], v[44:47], v[60:63], a[240:255]
  s_waitcnt lgkmcnt(0)
  v_mfma_f32_32x32x16_bf16 a[0:15], v[64:67], v[80:83], a[0:15]
  v_mfma_f32_32x32x16_bf16 a[16:31], v[64:67], v[84:87], a[16:31]
  s_waitcnt vmcnt(12)
  s_barrier
  v_mfma_f32_32x32x16_bf16 a[32:47], v[64:67], v[88:91], a[32:47]
  ds_read_b128 v[48:51], v20 offset:0
  v_mfma_f32_32x32x16_bf16 a[48:63], v[64:67], v[92:95], a[48:63]
  ds_read_b64_tr_b16 v[32:33], v22 offset:16384
  v_mfma_f32_32x32x16_bf16 a[64:79], v[68:71], v[80:83], a[64:79]
  ds_read_b64_tr_b16 v[34:35], v22 offset:18432
  v_mfma_f32_32x32x16_bf16 a[80:95], v[68:71], v[84:87], a[80:95]
  ds_read_b128 v[52:55], v20 offset:4096
  v_mfma_f32_32x32x16_bf16 a[96:111], v[68:71], v[88:91], a[96:111]
  ds_read_b64_tr_b16 v[36:37], v23 offset:16384
  v_mfma_f32_32x32x16_bf16 a[112:127], v[68:71], v[92:95], a[112:127]
  ds_read_b64_tr_b16 v[38:39], v23 offset:18432
  v_mfma_f32_32x32x16_bf16 a[128:143], v[72:75], v[80:83], a[128:143]
  ds_read_b128 v[56:59], v20 offset:8192
  v_mfma_f32_32x32x16_bf16 a[144:159], v[72:75], v[84:87], a[144:159]
  ds_read_b64_tr_b16 v[40:41], v24 offset:16384
  v_mfma_f32_32x32x16_bf16 a[160:175], v[72:75], v[88:91], a[160:175]
  ds_read_b64_tr_b16 v[42:43], v24 offset:18432
  v_mfma_f32_32x32x16_bf16 a[176:191], v[72:75], v[92:95], a[176:191]
  ds_read_b128 v[60:63], v20 offset:12288
  v_mfma_f32_32x32x16_bf16 a[192:207], v[76:79], v[80:83], a[192:207]
  ds_read_b64_tr_b16 v[44:45], v25 offset:16384
  v_mfma_f32_32x32x16_bf16 a[208:223], v[76:79], v[84:87], a[208:223]
  ds_read_b64_tr_b16 v[46:47], v25 offset:18432
  v_mfma_f32_32x32x16_bf16 a[224:239], v[76:79], v[88:91], a[224:239]
  v_mfma_f32_32x32x16_bf16 a[240:255], v[76:79], v[92:95], a[240:255]
  s_waitcnt lgkmcnt(0)
  v_mfma_f32_32x32x16_bf16 a[0:15], v[32:35], v[48:51], a[0:15]
  ds_read_b128 v[80:83], v21 offset:0
  v_mfma_f32_32x32x16_bf16 a[16:31], v[32:35], v[52:55], a[16:31]
  ds_read_b64_tr_b16 v[64:65], v22 offset:24576
  v_mfma_f32_32x32x16_bf16 a[32:47], v[32:35], v[56:59], a[32:47]
  ds_read_b64_tr_b16 v[66:67], v22 offset:26624
  v_mfma_f32_32x32x16_bf16 a[48:63], v[32:35], v[60:63], a[48:63]
  ds_read_b128 v[84:87], v21 offset:4096
  v_mfma_f32_32x32x16_bf16 a[64:79], v[36:39], v[48:51], a[64:79]
  ds_read_b64_tr_b16 v[68:69], v23 offset:24576
  v_mfma_f32_32x32x16_bf16 a[80:95], v[36:39], v[52:55], a[80:95]
  ds_read_b64_tr_b16 v[70:71], v23 offset:26624
  v_mfma_f32_32x32x16_bf16 a[96:111], v[36:39], v[56:59], a[96:111]
  ds_read_b128 v[88:91], v21 offset:8192
  v_mfma_f32_32x32x16_bf16 a[112:127], v[36:39], v[60:63], a[112:127]
  ds_read_b64_tr_b16 v[72:73], v24 offset:24576
  v_mfma_f32_32x32x16_bf16 a[128:143], v[40:43], v[48:51], a[128:143]
  ds_read_b64_tr_b16 v[74:75], v24 offset:26624
  v_mfma_f32_32x32x16_bf16 a[144:159], v[40:43], v[52:55], a[144:159]
  ds_read_b128 v[92:95], v21 offset:12288
  v_mfma_f32_32x32x16_bf16 a[160:175], v[40:43], v[56:59], a[160:175]
  ds_read_b64_tr_b16 v[76:77], v25 offset:24576
  v_mfma_f32_32x32x16_bf16 a[176:191], v[40:43], v[60:63], a[176:191]
  ds_read_b64_tr_b16 v[78:79], v25 offset:26624
  v_mfma_f32_32x32x16_bf16 a[192:207], v[44:47], v[48:51], a[192:207]
  v_mfma_f32_32x32x16_bf16 a[208:223], v[44:47], v[52:55], a[208:223]
  v_mfma_f32_32x32x16_bf16 a[224:239], v[44:47], v[56:59], a[224:239]
  v_mfma_f32_32x32x16_bf16 a[240:255], v[44:47], v[60:63], a[240:255]
  s_waitcnt lgkmcnt(0)
  v_mfma_f32_32x32x16_bf16 a[0:15], v[64:67], v[80:83], a[0:15]
  v_mfma_f32_32x32x16_bf16 a[16:31], v[64:67], v[84:87], a[16:31]
  s_add_u32 s53, s52, s54
  s_add_u32 s52, s52, 32768
  s_cmp_eq_u32 s52, 98304
  s_cselect_b32 s52, 0, s52
  v_add_u32 v18, s52, v14
  v_add_u32 v19, s52, v15
  v_add_u32 v20, s52, v16
  v_add_u32 v21, s52, v17
  s_waitcnt vmcnt(4)
  s_barrier
  v_mfma_f32_32x32x16_bf16 a[32:47], v[64:67], v[88:91], a[32:47]
  ds_read_b128 v[48:51], v18 offset:0
  v_mfma_f32_32x32x16_bf16 a[48:63], v[64:67], v[92:95], a[48:63]
  ds_read_b64_tr_b16 v[32:33], v22 offset:32768
  v_mfma_f32_32x32x16_bf16 a[64:79], v[68:71], v[80:83], a[64:79]
  ds_read_b64_tr_b16 v[34:35], v22 offset:34816
  v_mfma_f32_32x32x16_bf16 a[80:95], v[68:71], v[84:87], a[80:95]
  ds_read_b128 v[52:55], v18 offset:4096
  v_mfma_f32_32x32x16_bf16 a[96:111], v[68:71], v[88:91], a[96:111]
  ds_read_b64_tr_b16 v[36:37], v23 offset:32768
  v_mfma_f32_32x32x16_bf16 a[112:127], v[68:71], v[92:95], a[112:127]
  ds_read_b64_tr_b16 v[38:39], v23 offset:34816
  v_mfma_f32_32x32x16_bf16 a[128:143], v[72:75], v[80:83], a[128:143]
  ds_read_b128 v[56:59], v18 offset:8192
  v_mfma_f32_32x32x16_bf16 a[144:159], v[72:75], v[84:87], a[144:159]
  ds_read_b64_tr_b16 v[40:41], v24 offset:32768
  v_mfma_f32_32x32x16_bf16 a[160:175], v[72:75], v[88:91], a[160:175]
  ds_read_b64_tr_b16 v[42:43], v24 offset:34816
  v_mfma_f32_32x32x16_bf16 a[176:191], v[72:75], v[92:95], a[176:191]
  ds_read_b128 v[60:63], v18 offset:12288
  v_mfma_f32_32x32x16_bf16 a[192:207], v[76:79], v[80:83], a[192:207]
  ds_read_b64_tr_b16 v[44:45], v25 offset:32768
  v_mfma_f32_32x32x16_bf16 a[208:223], v[76:79], v[84:87], a[208:223]
  ds_read_b64_tr_b16 v[46:47], v25 offset:34816
  v_mfma_f32_32x32x16_bf16 a[224:239], v[76:79], v[88:91], a[224:239]
  v_mfma_f32_32x32x16_bf16 a[240:255], v[76:79], v[92:95], a[240:255]
  s_waitcnt lgkmcnt(0)
  v_mfma_f32_32x32x16_bf16 a[0:15], v[32:35], v[48:51], a[0:15]
  ds_read_b128 v[80:83], v19 offset:0
  v_mfma_f32_32x32x16_bf16 a[16:31], v[32:35], v[52:55], a[16:31]
  ds_read_b64_tr_b16 v[64:65], v22 offset:40960
  v_mfma_f32_32x32x16_bf16 a[32:47], v[32:35], v[56:59], a[32:47]
  ds_read_b64_tr_b16 v[66:67], v22 offset:43008
  v_mfma_f32_32x32x16_bf16 a[48:63], v[32:35], v[60:63], a[48:63]
  ds_read_b128 v[84:87], v19 offset:4096
  v_mfma_f32_32x32x16_bf16 a[64:79], v[36:39], v[48:51], a[64:79]
  ds_read_b64_tr_b16 v[68:69], v23 offset:40960
  v_mfma_f32_32x32x16_bf16 a[80:95], v[36:39], v[52:55], a[80:95]
  ds_read_b64_tr_b16 v[70:71], v23 offset:43008
  v_mfma_f32_32x32x16_bf16 a[96:111], v[36:39], v[56:59], a[96:111]
  ds_read_b128 v[88:91], v19 offset:8192
  v_mfma_f32_32x32x16_bf16 a[112:127], v[36:39], v[60:63], a[112:127]
  ds_read_b64_tr_b16 v[72:73], v24 offset:40960
  v_mfma_f32_32x32x16_bf16 a[128:143], v[40:43], v[48:51], a[128:143]
  ds_read_b64_tr_b16 v[74:75], v24 offset:43008
  v_mfma_f32_32x32x16_bf16 a[144:159], v[40:43], v[52:55], a[144:159]
  ds_read_b128 v[92:95], v19 offset:12288
  v_mfma_f32_32x32x16_bf16 a[160:175], v[40:43], v[56:59], a[160:175]
  ds_read_b64_tr_b16 v[76:77], v25 offset:40960
  v_mfma_f32_32x32x16_bf16 a[176:191], v[40:43], v[60:63], a[176:191]
  ds_read_b64_tr_b16 v[78:79], v25 offset:43008
  v_mfma_f32_32x32x16_bf16 a[192:207], v[44:47], v[48:51], a[192:207]
  v_mfma_f32_32x32x16_bf16 a[208:223], v[44:47], v[52:55], a[208:223]
  v_mfma_f32_32x32x16_bf16 a[224:239], v[44:47], v[56:59], a[224:239]
  v_mfma_f32_32x32x16_bf16 a[240:255], v[44:47], v[60:63], a[240:255]
  s_waitcnt lgkmcnt(0)
  v_mfma_f32_32x32x16_bf16 a[0:15], v[64:67], v[80:83], a[0:15]
  v_mfma_f32_32x32x16_bf16 a[16:31], v[64:67], v[84:87], a[16:31]
  s_waitcnt vmcnt(0)
  s_barrier
  v_mfma_f32_32x32x16_bf16 a[32:47], v[64:67], v[88:91], a[32:47]
  ds_read_b128 v[48:51], v20 offset:0
  v_mfma_f32_32x32x16_bf16 a[48:63], v[64:67], v[92:95], a[48:63]
  ds_read_b64_tr_b16 v[32:33], v22 offset:49152
  v_mfma_f32_32x32x16_bf16 a[64:79], v[68:71], v[80:83], a[64:79]
  ds_read_b64_tr_b16 v[34:35], v22 offset:51200
  v_mfma_f32_32x32x16_bf16 a[80:95], v[68:71], v[84:87], a[80:95]
  ds_read_b128 v[52:55], v20 offset:4096
  v_mfma_f32_32x32x16_bf16 a[96:111], v[68:71], v[88:91], a[96:111]
  ds_read_b64_tr_b16 v[36:37], v23 offset:49152
  v_mfma_f32_32x32x16_bf16 a[112:127], v[68:71], v[92:95], a[112:127]
  ds_read_b64_tr_b16 v[38:39], v23 offset:51200
  v_mfma_f32_32x32x16_bf16 a[128:143], v[72:75], v[80:83], a[128:143]
  ds_read_b128 v[56:59], v20 offset:8192
  v_mfma_f32_32x32x16_bf16 a[144:159], v[72:75], v[84:87], a[144:159]
  ds_read_b64_tr_b16 v[40:41], v24 offset:49152
  v_mfma_f32_32x32x16_bf16 a[160:175], v[72:75], v[88:91], a[160:175]
  ds_read_b64_tr_b16 v[42:43], v24 offset:51200
  v_mfma_f32_32x32x16_bf16 a[176:191], v[72:75], v[92:95], a[176:191]
  ds_read_b128 v[60:63], v20 offset:12288
  v_mfma_f32_32x32x16_bf16 a[192:207], v[76:79], v[80:83], a[192:207]
  ds_read_b64_tr_b16 v[44:45], v25 offset:49152
  v_mfma_f32_32x32x16_bf16 a[208:223], v[76:79], v[84:87], a[208:223]
  ds_read_b64_tr_b16 v[46:47], v25 offset:51200
  v_mfma_f32_32x32x16_bf16 a[224:239], v[76:79], v[88:91], a[224:239]
  v_mfma_f32_32x32x16_bf16 a[240:255], v[76:79], v[92:95], a[240:255]
  s_waitcnt lgkmcnt(0)
  v_mfma_f32_32x32x16_bf16 a[0:15], v[32:35], v[48:51], a[0:15]
  ds_read_b128 v[80:83], v21 offset:0
  v_mfma_f32_32x32x16_bf16 a[16:31], v[32:35], v[52:55], a[16:31]
  ds_read_b64_tr_b16 v[64:65], v22 offset:57344
  v_mfma_f32_32x32x16_bf16 a[32:47], v[32:35], v[56:59], a[32:47]
  ds_read_b64_tr_b16 v[66:67], v22 offset:59392
  v_mfma_f32_32x32x16_bf16 a[48:63], v[32:35], v[60:63], a[48:63]
  ds_read_b128 v[84:87], v21 offset:4096
  v_mfma_f32_32x32x16_bf16 a[64:79], v[36:39], v[48:51], a[64:79]
  ds_read_b64_tr_b16 v[68:69], v23 offset:57344
  v_mfma_f32_32x32x16_bf16 a[80:95], v[36:39], v[52:55], a[80:95]
  ds_read_b64_tr_b16 v[70:71], v23 offset:59392
  v_mfma_f32_32x32x16_bf16 a[96:111], v[36:39], v[56:59], a[96:111]
  ds_read_b128 v[88:91], v21 offset:8192
  v_mfma_f32_32x32x16_bf16 a[112:127], v[36:39], v[60:63], a[112:127]
  ds_read_b64_tr_b16 v[72:73], v24 offset:57344
  v_mfma_f32_32x32x16_bf16 a[128:143], v[40:43], v[48:51], a[128:143]
  ds_read_b64_tr_b16 v[74:75], v24 offset:59392
  v_mfma_f32_32x32x16_bf16 a[144:159], v[40:43], v[52:55], a[144:159]
  ds_read_b128 v[92:95], v21 offset:12288
  v_mfma_f32_32x32x16_bf16 a[160:175], v[40:43], v[56:59], a[160:175]
  ds_read_b64_tr_b16 v[76:77], v25 offset:57344
  v_mfma_f32_32x32x16_bf16 a[176:191], v[40:43], v[60:63], a[176:191]
  ds_read_b64_tr_b16 v[78:79], v25 offset:59392
  v_mfma_f32_32x32x16_bf16 a[192:207], v[44:47], v[48:51], a[192:207]
  v_mfma_f32_32x32x16_bf16 a[208:223], v[44:47], v[52:55], a[208:223]
  v_mfma_f32_32x32x16_bf16 a[224:239], v[44:47], v[56:59], a[224:239]
  v_mfma_f32_32x32x16_bf16 a[240:255], v[44:47], v[60:63], a[240:255]
  s_waitcnt lgkmcnt(0)
  v_mfma_f32_32x32x16_bf16 a[0:15], v[64:67], v[80:83], a[0:15]
  v_mfma_f32_32x32x16_bf16 a[16:31], v[64:67], v[84:87], a[16:31]
  v_mfma_f32_32x32x16_bf16 a[32:47], v[64:67], v[88:91], a[32:47]
  v_mfma_f32_32x32x16_bf16 a[48:63], v[64:67], v[92:95], a[48:63]
  v_mfma_f32_32x32x16_bf16 a[64:79], v[68:71], v[80:83], a[64:79]
  v_mfma_f32_32x32x16_bf16 a[80:95], v[68:71], v[84:87], a[80:95]
  v_mfma_f32_32x32x16_bf16 a[96:111], v[68:71], v[88:91], a[96:111]
  v_mfma_f32_32x32x16_bf16 a[112:127], v[68:71], v[92:95], a[112:127]
  v_mfma_f32_32x32x16_bf16 a[128:143], v[72:75], v[80:83], a[128:143]
  v_mfma_f32_32x32x16_bf16 a[144:159], v[72:75], v[84:87], a[144:159]
  v_mfma_f32_32x32x16_bf16 a[160:175], v[72:75], v[88:91], a[160:175]
  v_mfma_f32_32x32x16_bf16 a[176:191], v[72:75], v[92:95], a[176:191]
  v_mfma_f32_32x32x16_bf16 a[192:207], v[76:79], v[80:83], a[192:207]
  v_mfma_f32_32x32x16_bf16 a[208:223], v[76:79], v[84:87], a[208:223]
  v_mfma_f32_32x32x16_bf16 a[224:239], v[76:79], v[88:91], a[224:239]
  v_mfma_f32_32x32x16_bf16 a[240:255], v[76:79], v[92:95], a[240:255]
  s_nop 11
  s_cmp_eq_u32 s81, 5
  s_cbranch_scc1 w_g5e
  s_load_dword s63, s[26:27], 0
  s_mov_b32 s79, 0
  s_waitcnt lgkmcnt(0)
  s_and_b32 s89, s63, 15
  s_cmp_lg_u32 s89, 1
  s_cbranch_scc1 w_nopre
  s_bfe_u32 s86, s63, 0x30010
  s_cmp_eq_u32 s86, 1
  s_cselect_b32 s64, s8, s6
  s_cselect_b32 s65, s9, s7
  s_cmp_eq_u32 s86, 2
  s_cselect_b32 s64, s10, s64
  s_cselect_b32 s65, s11, s65
  s_bfe_u32 s89, s63, 0x6000a
  s_lshl_b32 s89, s89, 9
  s_add_u32 s44, s64, s89
  s_addc_u32 s45, s65, 0
  s_sub_u32 s46, 8388608, s89
  s_mov_b32 s47, 0x20000
  s_bfe_u32 s89, s63, 0x60004
  s_lshl_b32 s89, s89, 19
  s_add_u32 s89, s89, 0
  s_add_u32 s40, s14, s89
  s_addc_u32 s41, s15, 0
  s_sub_u32 s40, s40, 4096
  s_subb_u32 s41, s41, 0
  s_sub_u32 s42, 268439552, s89
  s_mov_b32 s43, 0x20000
  s_mov_b32 s56, 2048
  s_mov_b32 s75, 3
  s_mov_b32 s76, 0
  s_mov_b32 s77, 128
  s_barrier
  s_mov_b32 s48, 0
  s_mov_b32 s53, s54
  s_mov_b32 s49, 0
  s_add_u32 m0, s53, 0
  s_nop 0
  buffer_load_dwordx4 v2, s[40:43], s48 offen offset:0 sc1 lds
  buffer_load_dwordx4 v3, s[40:43], s48 offen offset:1024 sc1 lds
  buffer_load_dwordx4 v4, s[40:43], s48 offen offset:2048 sc1 lds
  buffer_load_dwordx4 v5, s[40:43], s48 offen offset:3072 sc1 lds
  s_add_u32 m0, s55, 0
  s_nop 0
  buffer_load_dwordx4 v10, s[44:47], s49 offen offset:0 lds
  buffer_load_dwordx4 v11, s[44:47], s49 offen offset:1024 lds
  buffer_load_dwordx4 v12, s[44:47], s49 offen offset:2048 lds
  buffer_load_dwordx4 v13, s[44:47], s49 offen offset:3072 lds
  s_add_u32 s49, s49, s50
  s_add_u32 m0, s53, 4096
  s_nop 0
  buffer_load_dwordx4 v6, s[40:43], s48 offen offset:0 sc1 lds
  buffer_load_dwordx4 v7, s[40:43], s48 offen offset:1024 sc1 lds
  buffer_load_dwordx4 v8, s[40:43], s48 offen offset:2048 sc1 lds
  buffer_load_dwordx4 v9, s[40:43], s48 offen offset:3072 sc1 lds
  s_add_u32 s48, s48, s77
  s_add_u32 s53, s54, 32768
  s_add_u32 m0, s55, 16384
  s_nop 0
  buffer_load_dwordx4 v10, s[44:47], s49 offen offset:0 lds
  buffer_load_dwordx4 v11, s[44:47], s49 offen offset:1024 lds
  buffer_load_dwordx4 v12, s[44:47], s49 offen offset:2048 lds
  buffer_load_dwordx4 v13, s[44:47], s49 offen offset:3072 lds
  s_add_u32 s49, s49, s50
  s_add_u32 m0, s53, 0
  s_nop 0
  buffer_load_dwordx4 v2, s[40:43], s48 offen offset:0 sc1 lds
  buffer_load_dwordx4 v3, s[40:43], s48 offen offset:1024 sc1 lds
  buffer_load_dwordx4 v4, s[40:43], s48 offen offset:2048 sc1 lds
  buffer_load_dwordx4 v5, s[40:43], s48 offen offset:3072 sc1 lds
  s_add_u32 m0, s55, 32768
  s_nop 0
  buffer_load_dwordx4 v10, s[44:47], s49 offen offset:0 lds
  buffer_load_dwordx4 v11, s[44:47], s49 offen offset:1024 lds
  buffer_load_dwordx4 v12, s[44:47], s49 offen offset:2048 lds
  buffer_load_dwordx4 v13, s[44:47], s49 offen offset:3072 lds
  s_add_u32 s49, s49, s50
  s_add_u32 m0, s53, 4096
  s_nop 0
  buffer_load_dwordx4 v6, s[40:43], s48 offen offset:0 sc1 lds
  buffer_load_dwordx4 v7, s[40:43], s48 offen offset:1024 sc1 lds
  buffer_load_dwordx4 v8, s[40:43], s48 offen offset:2048 sc1 lds
  buffer_load_dwordx4 v9, s[40:43], s48 offen offset:3072 sc1 lds
  s_add_u32 s48, s48, s77
  s_add_u32 s53, s54, 65536
  s_add_u32 m0, s55, 49152
  s_nop 0
  buffer_load_dwordx4 v10, s[44:47], s49 offen offset:0 lds
  buffer_load_dwordx4 v11, s[44:47], s49 offen offset:1024 lds
  buffer_load_dwordx4 v12, s[44:47], s49 offen offset:2048 lds
  buffer_load_dwordx4 v13, s[44:47], s49 offen offset:3072 lds
  s_add_u32 s49, s49, s50
  s_add_u32 m0, s53, 0
  s_nop 0
  buffer_load_dwordx4 v2, s[40:43], s48 offen offset:0 sc1 lds
  buffer_load_dwordx4 v3, s[40:43], s48 offen offset:1024 sc1 lds
  buffer_load_dwordx4 v4, s[40:43], s48 offen offset:2048 sc1 lds
  buffer_load_dwordx4 v5, s[40:43], s48 offen offset:3072 sc1 lds
  s_mov_b32 s79, 1
w_nopre:
  s_nop 0
  s_lshl_b32 s85, s84, 24
  s_add_u32 s85, s85, 8388608
  s_lshl_b32 s89, s83, 1
  s_add_u32 s89, s89, s59
  s_lshl_b32 s89, s89, 13
  s_add_u32 s85, s85, s89
  s_mul_i32 s89, s82, 8
  s_mul_i32 s86, s60, 4
  s_add_u32 s89, s89, s86
  s_lshl_b32 s89, s89, 18
  s_add_u32 s85, s85, s89
  v_bfe_u32 v26, v1, 4, 1
  v_lshlrev_b32 v26, 12, v26
  v_lshrrev_b32 v27, 5, v1
  v_lshl_add_u32 v26, v27, 8, v26
  v_and_b32 v27, 15, v1
  v_lshl_add_u32 v26, v27, 4, v26
  v_accvgpr_read_b32 v160, a0
  v_accvgpr_read_b32 v161, a1
  v_accvgpr_read_b32 v162, a2
  v_accvgpr_read_b32 v163, a3
  v_accvgpr_read_b32 v164, a4
  v_accvgpr_read_b32 v165, a5
  v_accvgpr_read_b32 v166, a6
  v_accvgpr_read_b32 v167, a7
  v_accvgpr_read_b32 v168, a8
  v_accvgpr_read_b32 v169, a9
  v_accvgpr_read_b32 v170, a10
  v_accvgpr_read_b32 v171, a11
  v_accvgpr_read_b32 v172, a12
  v_accvgpr_read_b32 v173, a13
  v_accvgpr_read_b32 v174, a14
  v_accvgpr_read_b32 v175, a15
  v_cvt_pk_bf16_f32 v96, v160, v161
  v_cvt_pk_bf16_f32 v97, v162, v163
  v_cvt_pk_bf16_f32 v98, v164, v165
  v_cvt_pk_bf16_f32 v99, v166, v167
  v_cvt_pk_bf16_f32 v100, v168, v169
  v_cvt_pk_bf16_f32 v101, v170, v171
  v_cvt_pk_bf16_f32 v102, v172, v173
  v_cvt_pk_bf16_f32 v103, v174, v175
  v_permlane32_swap_b32 v96, v98
  v_permlane32_swap_b32 v97, v99
  v_permlane32_swap_b32 v100, v102
  v_permlane32_swap_b32 v101, v103
  buffer_store_dwordx4 v[96:99], v26, s[28:31], s85 offen offset:0 sc1
  buffer_store_dwordx4 v[100:103], v26, s[28:31], s85 offen offset:512 sc1
  v_accvgpr_read_b32 v160, a64
  v_accvgpr_read_b32 v161, a65
  v_accvgpr_read_b32 v162, a66
  v_accvgpr_read_b32 v163, a67
  v_accvgpr_read_b32 v164, a68
  v_accvgpr_read_b32 v165, a69
  v_accvgpr_read_b32 v166, a70
  v_accvgpr_read_b32 v167, a71
  v_accvgpr_read_b32 v168, a72
  v_accvgpr_read_b32 v169, a73
  v_accvgpr_read_b32 v170, a74
  v_accvgpr_read_b32 v171, a75
  v_accvgpr_read_b32 v172, a76
  v_accvgpr_read_b32 v173, a77
  v_accvgpr_read_b32 v174, a78
  v_accvgpr_read_b32 v175, a79
  v_cvt_pk_bf16_f32 v104, v160, v161
  v_cvt_pk_bf16_f32 v105, v162, v163
  v_cvt_pk_bf16_f32 v106, v164, v165
  v_cvt_pk_bf16_f32 v107, v166, v167
  v_cvt_pk_bf16_f32 v108, v168, v169
  v_cvt_pk_bf16_f32 v109, v170, v171
  v_cvt_pk_bf16_f32 v110, v172, v173
  v_cvt_pk_bf16_f32 v111, v174, v175
  v_permlane32_swap_b32 v104, v106
  v_permlane32_swap_b32 v105, v107
  v_permlane32_swap_b32 v108, v110
  v_permlane32_swap_b32 v109, v111
  buffer_store_dwordx4 v[104:107], v26, s[28:31], s85 offen offset:1024 sc1
  buffer_store_dwordx4 v[108:111], v26, s[28:31], s85 offen offset:1536 sc1
  v_accvgpr_read_b32 v160, a128
  v_accvgpr_read_b32 v161, a129
  v_accvgpr_read_b32 v162, a130
  v_accvgpr_read_b32 v163, a131
  v_accvgpr_read_b32 v164, a132
  v_accvgpr_read_b32 v165, a133
  v_accvgpr_read_b32 v166, a134
  v_accvgpr_read_b32 v167, a135
  v_accvgpr_read_b32 v168, a136
  v_accvgpr_read_b32 v169, a137
  v_accvgpr_read_b32 v170, a138
  v_accvgpr_read_b32 v171, a139
  v_accvgpr_read_b32 v172, a140
  v_accvgpr_read_b32 v173, a141
  v_accvgpr_read_b32 v174, a142
  v_accvgpr_read_b32 v175, a143
  v_cvt_pk_bf16_f32 v112, v160, v161
  v_cvt_pk_bf16_f32 v113, v162, v163
  v_cvt_pk_bf16_f32 v114, v164, v165
  v_cvt_pk_bf16_f32 v115, v166, v167
  v_cvt_pk_bf16_f32 v116, v168, v169
  v_cvt_pk_bf16_f32 v117, v170, v171
  v_cvt_pk_bf16_f32 v118, v172, v173
  v_cvt_pk_bf16_f32 v119, v174, v175
  v_permlane32_swap_b32 v112, v114
  v_permlane32_swap_b32 v113, v115
  v_permlane32_swap_b32 v116, v118
  v_permlane32_swap_b32 v117, v119
  buffer_store_dwordx4 v[112:115], v26, s[28:31], s85 offen offset:2048 sc1
  buffer_store_dwordx4 v[116:119], v26, s[28:31], s85 offen offset:2560 sc1
  v_accvgpr_read_b32 v160, a192
  v_accvgpr_read_b32 v161, a193
  v_accvgpr_read_b32 v162, a194
  v_accvgpr_read_b32 v163, a195
  v_accvgpr_read_b32 v164, a196
  v_accvgpr_read_b32 v165, a197
  v_accvgpr_read_b32 v166, a198
  v_accvgpr_read_b32 v167, a199
  v_accvgpr_read_b32 v168, a200
  v_accvgpr_read_b32 v169, a201
  v_accvgpr_read_b32 v170, a202
  v_accvgpr_read_b32 v171, a203
  v_accvgpr_read_b32 v172, a204
  v_accvgpr_read_b32 v173, a205
  v_accvgpr_read_b32 v174, a206
  v_accvgpr_read_b32 v175, a207
  v_cvt_pk_bf16_f32 v120, v160, v161
  v_cvt_pk_bf16_f32 v121, v162, v163
  v_cvt_pk_bf16_f32 v122, v164, v165
  v_cvt_pk_bf16_f32 v123, v166, v167
  v_cvt_pk_bf16_f32 v124, v168, v169
  v_cvt_pk_bf16_f32 v125, v170, v171
  v_cvt_pk_bf16_f32 v126, v172, v173
  v_cvt_pk_bf16_f32 v127, v174, v175
  v_permlane32_swap_b32 v120, v122
  v_permlane32_swap_b32 v121, v123
  v_permlane32_swap_b32 v124, v126
  v_permlane32_swap_b32 v125, v127
  buffer_store_dwordx4 v[120:123], v26, s[28:31], s85 offen offset:3072 sc1
  buffer_store_dwordx4 v[124:127], v26, s[28:31], s85 offen offset:3584 sc1
  s_add_u32 s85, s85, 262144
  v_accvgpr_read_b32 v160, a16
  v_accvgpr_read_b32 v161, a17
  v_accvgpr_read_b32 v162, a18
  v_accvgpr_read_b32 v163, a19
  v_accvgpr_read_b32 v164, a20
  v_accvgpr_read_b32 v165, a21
  v_accvgpr_read_b32 v166, a22
  v_accvgpr_read_b32 v167, a23
  v_accvgpr_read_b32 v168, a24
  v_accvgpr_read_b32 v169, a25
  v_accvgpr_read_b32 v170, a26
  v_accvgpr_read_b32 v171, a27
  v_accvgpr_read_b32 v172, a28
  v_accvgpr_read_b32 v173, a29
  v_accvgpr_read_b32 v174, a30
  v_accvgpr_read_b32 v175, a31
  v_cvt_pk_bf16_f32 v96, v160, v161
  v_cvt_pk_bf16_f32 v97, v162, v163
  v_cvt_pk_bf16_f32 v98, v164, v165
  v_cvt_pk_bf16_f32 v99, v166, v167
  v_cvt_pk_bf16_f32 v100, v168, v169
  v_cvt_pk_bf16_f32 v101, v170, v171
  v_cvt_pk_bf16_f32 v102, v172, v173
  v_cvt_pk_bf16_f32 v103, v174, v175
  v_permlane32_swap_b32 v96, v98
  v_permlane32_swap_b32 v97, v99
  v_permlane32_swap_b32 v100, v102
  v_permlane32_swap_b32 v101, v103
  buffer_store_dwordx4 v[96:99], v26, s[28:31], s85 offen offset:0 sc1
  buffer_store_dwordx4 v[100:103], v26, s[28:31], s85 offen offset:512 sc1
  v_accvgpr_read_b32 v160, a80
  v_accvgpr_read_b32 v161, a81
  v_accvgpr_read_b32 v162, a82
  v_accvgpr_read_b32 v163, a83
  v_accvgpr_read_b32 v164, a84
  v_accvgpr_read_b32 v165, a85
  v_accvgpr_read_b32 v166, a86
  v_accvgpr_read_b32 v167, a87
  v_accvgpr_read_b32 v168, a88
  v_accvgpr_read_b32 v169, a89
  v_accvgpr_read_b32 v170, a90
  v_accvgpr_read_b32 v171, a91
  v_accvgpr_read_b32 v172, a92
  v_accvgpr_read_b32 v173, a93
  v_accvgpr_read_b32 v174, a94
  v_accvgpr_read_b32 v175, a95
  v_cvt_pk_bf16_f32 v104, v160, v161
  v_cvt_pk_bf16_f32 v105, v162, v163
  v_cvt_pk_bf16_f32 v106, v164, v165
  v_cvt_pk_bf16_f32 v107, v166, v167
  v_cvt_pk_bf16_f32 v108, v168, v169
  v_cvt_pk_bf16_f32 v109, v170, v171
  v_cvt_pk_bf16_f32 v110, v172, v173
  v_cvt_pk_bf16_f32 v111, v174, v175
  v_permlane32_swap_b32 v104, v106
  v_permlane32_swap_b32 v105, v107
  v_permlane32_swap_b32 v108, v110
  v_permlane32_swap_b32 v109, v111
  buffer_store_dwordx4 v[104:107], v26, s[28:31], s85 offen offset:1024 sc1
  buffer_store_dwordx4 v[108:111], v26, s[28:31], s85 offen offset:1536 sc1
  v_accvgpr_read_b32 v160, a144
  v_accvgpr_read_b32 v161, a145
  v_accvgpr_read_b32 v162, a146
  v_accvgpr_read_b32 v163, a147
  v_accvgpr_read_b32 v164, a148
  v_accvgpr_read_b32 v165, a149
  v_accvgpr_read_b32 v166, a150
  v_accvgpr_read_b32 v167, a151
  v_accvgpr_read_b32 v168, a152
  v_accvgpr_read_b32 v169, a153
  v_accvgpr_read_b32 v170, a154
  v_accvgpr_read_b32 v171, a155
  v_accvgpr_read_b32 v172, a156
  v_accvgpr_read_b32 v173, a157
  v_accvgpr_read_b32 v174, a158
  v_accvgpr_read_b32 v175, a159
  v_cvt_pk_bf16_f32 v112, v160, v161
  v_cvt_pk_bf16_f32 v113, v162, v163
  v_cvt_pk_bf16_f32 v114, v164, v165
  v_cvt_pk_bf16_f32 v115, v166, v167
  v_cvt_pk_bf16_f32 v116, v168, v169
  v_cvt_pk_bf16_f32 v117, v170, v171
  v_cvt_pk_bf16_f32 v118, v172, v173
  v_cvt_pk_bf16_f32 v119, v174, v175
  v_permlane32_swap_b32 v112, v114
  v_permlane32_swap_b32 v113, v115
  v_permlane32_swap_b32 v116, v118
  v_permlane32_swap_b32 v117, v119
  buffer_store_dwordx4 v[112:115], v26, s[28:31], s85 offen offset:2048 sc1
  buffer_store_dwordx4 v[116:119], v26, s[28:31], s85 offen offset:2560 sc1
  v_accvgpr_read_b32 v160, a208
  v_accvgpr_read_b32 v161, a209
  v_accvgpr_read_b32 v162, a210
  v_accvgpr_read_b32 v163, a211
  v_accvgpr_read_b32 v164, a212
  v_accvgpr_read_b32 v165, a213
  v_accvgpr_read_b32 v166, a214
  v_accvgpr_read_b32 v167, a215
  v_accvgpr_read_b32 v168, a216
  v_accvgpr_read_b32 v169, a217
  v_accvgpr_read_b32 v170, a218
  v_accvgpr_read_b32 v171, a219
  v_accvgpr_read_b32 v172, a220
  v_accvgpr_read_b32 v173, a221
  v_accvgpr_read_b32 v174, a222
  v_accvgpr_read_b32 v175, a223
  v_cvt_pk_bf16_f32 v120, v160, v161
  v_cvt_pk_bf16_f32 v121, v162, v163
  v_cvt_pk_bf16_f32 v122, v164, v165
  v_cvt_pk_bf16_f32 v123, v166, v167
  v_cvt_pk_bf16_f32 v124, v168, v169
  v_cvt_pk_bf16_f32 v125, v170, v171
  v_cvt_pk_bf16_f32 v126, v172, v173
  v_cvt_pk_bf16_f32 v127, v174, v175
  v_permlane32_swap_b32 v120, v122
  v_permlane32_swap_b32 v121, v123
  v_permlane32_swap_b32 v124, v126
  v_permlane32_swap_b32 v125, v127
  buffer_store_dwordx4 v[120:123], v26, s[28:31], s85 offen offset:3072 sc1
  buffer_store_dwordx4 v[124:127], v26, s[28:31], s85 offen offset:3584 sc1
  s_add_u32 s85, s85, 262144
  v_accvgpr_read_b32 v160, a32
  v_accvgpr_read_b32 v161, a33
  v_accvgpr_read_b32 v162, a34
  v_accvgpr_read_b32 v163, a35
  v_accvgpr_read_b32 v164, a36
  v_accvgpr_read_b32 v165, a37
  v_accvgpr_read_b32 v166, a38
  v_accvgpr_read_b32 v167, a39
  v_accvgpr_read_b32 v168, a40
  v_accvgpr_read_b32 v169, a41
  v_accvgpr_read_b32 v170, a42
  v_accvgpr_read_b32 v171, a43
  v_accvgpr_read_b32 v172, a44
  v_accvgpr_read_b32 v173, a45
  v_accvgpr_read_b32 v174, a46
  v_accvgpr_read_b32 v175, a47
  v_cvt_pk_bf16_f32 v96, v160, v161
  v_cvt_pk_bf16_f32 v97, v162, v163
  v_cvt_pk_bf16_f32 v98, v164, v165
  v_cvt_pk_bf16_f32 v99, v166, v167
  v_cvt_pk_bf16_f32 v100, v168, v169
  v_cvt_pk_bf16_f32 v101, v170, v171
  v_cvt_pk_bf16_f32 v102, v172, v173
  v_cvt_pk_bf16_f32 v103, v174, v175
  v_permlane32_swap_b32 v96, v98
  v_permlane32_swap_b32 v97, v99
  v_permlane32_swap_b32 v100, v102
  v_permlane32_swap_b32 v101, v103
  buffer_store_dwordx4 v[96:99], v26, s[28:31], s85 offen offset:0 sc1
  buffer_store_dwordx4 v[100:103], v26, s[28:31], s85 offen offset:512 sc1
  v_accvgpr_read_b32 v160, a96
  v_accvgpr_read_b32 v161, a97
  v_accvgpr_read_b32 v162, a98
  v_accvgpr_read_b32 v163, a99
  v_accvgpr_read_b32 v164, a100
  v_accvgpr_read_b32 v165, a101
  v_accvgpr_read_b32 v166, a102
  v_accvgpr_read_b32 v167, a103
  v_accvgpr_read_b32 v168, a104
  v_accvgpr_read_b32 v169, a105
  v_accvgpr_read_b32 v170, a106
  v_accvgpr_read_b32 v171, a107
  v_accvgpr_read_b32 v172, a108
  v_accvgpr_read_b32 v173, a109
  v_accvgpr_read_b32 v174, a110
  v_accvgpr_read_b32 v175, a111
  v_cvt_pk_bf16_f32 v104, v160, v161
  v_cvt_pk_bf16_f32 v105, v162, v163
  v_cvt_pk_bf16_f32 v106, v164, v165
  v_cvt_pk_bf16_f32 v107, v166, v167
  v_cvt_pk_bf16_f32 v108, v168, v169
  v_cvt_pk_bf16_f32 v109, v170, v171
  v_cvt_pk_bf16_f32 v110, v172, v173
  v_cvt_pk_bf16_f32 v111, v174, v175
  v_permlane32_swap_b32 v104, v106
  v_permlane32_swap_b32 v105, v107
  v_permlane32_swap_b32 v108, v110
  v_permlane32_swap_b32 v109, v111
  buffer_store_dwordx4 v[104:107], v26, s[28:31], s85 offen offset:1024 sc1
  buffer_store_dwordx4 v[108:111], v26, s[28:31], s85 offen offset:1536 sc1
  v_accvgpr_read_b32 v160, a160
  v_accvgpr_read_b32 v161, a161
  v_accvgpr_read_b32 v162, a162
  v_accvgpr_read_b32 v163, a163
  v_accvgpr_read_b32 v164, a164
  v_accvgpr_read_b32 v165, a165
  v_accvgpr_read_b32 v166, a166
  v_accvgpr_read_b32 v167, a167
  v_accvgpr_read_b32 v168, a168
  v_accvgpr_read_b32 v169, a169
  v_accvgpr_read_b32 v170, a170
  v_accvgpr_read_b32 v171, a171
  v_accvgpr_read_b32 v172, a172
  v_accvgpr_read_b32 v173, a173
  v_accvgpr_read_b32 v174, a174
  v_accvgpr_read_b32 v175, a175
  v_cvt_pk_bf16_f32 v112, v160, v161
  v_cvt_pk_bf16_f32 v113, v162, v163
  v_cvt_pk_bf16_f32 v114, v164, v165
  v_cvt_pk_bf16_f32 v115, v166, v167
  v_cvt_pk_bf16_f32 v116, v168, v169
  v_cvt_pk_bf16_f32 v117, v170, v171
  v_cvt_pk_bf16_f32 v118, v172, v173
  v_cvt_pk_bf16_f32 v119, v174, v175
  v_permlane32_swap_b32 v112, v114
  v_permlane32_swap_b32 v113, v115
  v_permlane32_swap_b32 v116, v118
  v_permlane32_swap_b32 v117, v119
  buffer_store_dwordx4 v[112:115], v26, s[28:31], s85 offen offset:2048 sc1
  buffer_store_dwordx4 v[116:119], v26, s[28:31], s85 offen offset:2560 sc1
  v_accvgpr_read_b32 v160, a224
  v_accvgpr_read_b32 v161, a225
  v_accvgpr_read_b32 v162, a226
  v_accvgpr_read_b32 v163, a227
  v_accvgpr_read_b32 v164, a228
  v_accvgpr_read_b32 v165, a229
  v_accvgpr_read_b32 v166, a230
  v_accvgpr_read_b32 v167, a231
  v_accvgpr_read_b32 v168, a232
  v_accvgpr_read_b32 v169, a233
  v_accvgpr_read_b32 v170, a234
  v_accvgpr_read_b32 v171, a235
  v_accvgpr_read_b32 v172, a236
  v_accvgpr_read_b32 v173, a237
  v_accvgpr_read_b32 v174, a238
  v_accvgpr_read_b32 v175, a239
  v_cvt_pk_bf16_f32 v120, v160, v161
  v_cvt_pk_bf16_f32 v121, v162, v163
  v_cvt_pk_bf16_f32 v122, v164, v165
  v_cvt_pk_bf16_f32 v123, v166, v167
  v_cvt_pk_bf16_f32 v124, v168, v169
  v_cvt_pk_bf16_f32 v125, v170, v171
  v_cvt_pk_bf16_f32 v126, v172, v173
  v_cvt_pk_bf16_f32 v127, v174, v175
  v_permlane32_swap_b32 v120, v122
  v_permlane32_swap_b32 v121, v123
  v_permlane32_swap_b32 v124, v126
  v_permlane32_swap_b32 v125, v127
  buffer_store_dwordx4 v[120:123], v26, s[28:31], s85 offen offset:3072 sc1
  buffer_store_dwordx4 v[124:127], v26, s[28:31], s85 offen offset:3584 sc1
  s_add_u32 s85, s85, 262144
  v_accvgpr_read_b32 v160, a48
  v_accvgpr_read_b32 v161, a49
  v_accvgpr_read_b32 v162, a50
  v_accvgpr_read_b32 v163, a51
  v_accvgpr_read_b32 v164, a52
  v_accvgpr_read_b32 v165, a53
  v_accvgpr_read_b32 v166, a54
  v_accvgpr_read_b32 v167, a55
  v_accvgpr_read_b32 v168, a56
  v_accvgpr_read_b32 v169, a57
  v_accvgpr_read_b32 v170, a58
  v_accvgpr_read_b32 v171, a59
  v_accvgpr_read_b32 v172, a60
  v_accvgpr_read_b32 v173, a61
  v_accvgpr_read_b32 v174, a62
  v_accvgpr_read_b32 v175, a63
  v_cvt_pk_bf16_f32 v96, v160, v161
  v_cvt_pk_bf16_f32 v97, v162, v163
  v_cvt_pk_bf16_f32 v98, v164, v165
  v_cvt_pk_bf16_f32 v99, v166, v167
  v_cvt_pk_bf16_f32 v100, v168, v169
  v_cvt_pk_bf16_f32 v101, v170, v171
  v_cvt_pk_bf16_f32 v102, v172, v173
  v_cvt_pk_bf16_f32 v103, v174, v175
  v_permlane32_swap_b32 v96, v98
  v_permlane32_swap_b32 v97, v99
  v_permlane32_swap_b32 v100, v102
  v_permlane32_swap_b32 v101, v103
  buffer_store_dwordx4 v[96:99], v26, s[28:31], s85 offen offset:0 sc1
  buffer_store_dwordx4 v[100:103], v26, s[28:31], s85 offen offset:512 sc1
  v_accvgpr_read_b32 v160, a112
  v_accvgpr_read_b32 v161, a113
  v_accvgpr_read_b32 v162, a114
  v_accvgpr_read_b32 v163, a115
  v_accvgpr_read_b32 v164, a116
  v_accvgpr_read_b32 v165, a117
  v_accvgpr_read_b32 v166, a118
  v_accvgpr_read_b32 v167, a119
  v_accvgpr_read_b32 v168, a120
  v_accvgpr_read_b32 v169, a121
  v_accvgpr_read_b32 v170, a122
  v_accvgpr_read_b32 v171, a123
  v_accvgpr_read_b32 v172, a124
  v_accvgpr_read_b32 v173, a125
  v_accvgpr_read_b32 v174, a126
  v_accvgpr_read_b32 v175, a127
  v_cvt_pk_bf16_f32 v104, v160, v161
  v_cvt_pk_bf16_f32 v105, v162, v163
  v_cvt_pk_bf16_f32 v106, v164, v165
  v_cvt_pk_bf16_f32 v107, v166, v167
  v_cvt_pk_bf16_f32 v108, v168, v169
  v_cvt_pk_bf16_f32 v109, v170, v171
  v_cvt_pk_bf16_f32 v110, v172, v173
  v_cvt_pk_bf16_f32 v111, v174, v175
  v_permlane32_swap_b32 v104, v106
  v_permlane32_swap_b32 v105, v107
  v_permlane32_swap_b32 v108, v110
  v_permlane32_swap_b32 v109, v111
  buffer_store_dwordx4 v[104:107], v26, s[28:31], s85 offen offset:1024 sc1
  buffer_store_dwordx4 v[108:111], v26, s[28:31], s85 offen offset:1536 sc1
  v_accvgpr_read_b32 v160, a176
  v_accvgpr_read_b32 v161, a177
  v_accvgpr_read_b32 v162, a178
  v_accvgpr_read_b32 v163, a179
  v_accvgpr_read_b32 v164, a180
  v_accvgpr_read_b32 v165, a181
  v_accvgpr_read_b32 v166, a182
  v_accvgpr_read_b32 v167, a183
  v_accvgpr_read_b32 v168, a184
  v_accvgpr_read_b32 v169, a185
  v_accvgpr_read_b32 v170, a186
  v_accvgpr_read_b32 v171, a187
  v_accvgpr_read_b32 v172, a188
  v_accvgpr_read_b32 v173, a189
  v_accvgpr_read_b32 v174, a190
  v_accvgpr_read_b32 v175, a191
  v_cvt_pk_bf16_f32 v112, v160, v161
  v_cvt_pk_bf16_f32 v113, v162, v163
  v_cvt_pk_bf16_f32 v114, v164, v165
  v_cvt_pk_bf16_f32 v115, v166, v167
  v_cvt_pk_bf16_f32 v116, v168, v169
  v_cvt_pk_bf16_f32 v117, v170, v171
  v_cvt_pk_bf16_f32 v118, v172, v173
  v_cvt_pk_bf16_f32 v119, v174, v175
  v_permlane32_swap_b32 v112, v114
  v_permlane32_swap_b32 v113, v115
  v_permlane32_swap_b32 v116, v118
  v_permlane32_swap_b32 v117, v119
  buffer_store_dwordx4 v[112:115], v26, s[28:31], s85 offen offset:2048 sc1
  buffer_store_dwordx4 v[116:119], v26, s[28:31], s85 offen offset:2560 sc1
  v_accvgpr_read_b32 v160, a240
  v_accvgpr_read_b32 v161, a241
  v_accvgpr_read_b32 v162, a242
  v_accvgpr_read_b32 v163, a243
  v_accvgpr_read_b32 v164, a244
  v_accvgpr_read_b32 v165, a245
  v_accvgpr_read_b32 v166, a246
  v_accvgpr_read_b32 v167, a247
  v_accvgpr_read_b32 v168, a248
  v_accvgpr_read_b32 v169, a249
  v_accvgpr_read_b32 v170, a250
  v_accvgpr_read_b32 v171, a251
  v_accvgpr_read_b32 v172, a252
  v_accvgpr_read_b32 v173, a253
  v_accvgpr_read_b32 v174, a254
  v_accvgpr_read_b32 v175, a255
  v_cvt_pk_bf16_f32 v120, v160, v161
  v_cvt_pk_bf16_f32 v121, v162, v163
  v_cvt_pk_bf16_f32 v122, v164, v165
  v_cvt_pk_bf16_f32 v123, v166, v167
  v_cvt_pk_bf16_f32 v124, v168, v169
  v_cvt_pk_bf16_f32 v125, v170, v171
  v_cvt_pk_bf16_f32 v126, v172, v173
  v_cvt_pk_bf16_f32 v127, v174, v175
  v_permlane32_swap_b32 v120, v122
  v_permlane32_swap_b32 v121, v123
  v_permlane32_swap_b32 v124, v126
  v_permlane32_swap_b32 v125, v127
  buffer_store_dwordx4 v[120:123], v26, s[28:31], s85 offen offset:3072 sc1
  buffer_store_dwordx4 v[124:127], v26, s[28:31], s85 offen offset:3584 sc1
  s_cmp_eq_u32 s84, 0
  s_cselect_b32 s86, 16, 0
  s_cselect_b32 s85, 1, 2
  s_lshl_b32 s89, s82, 1
  s_add_u32 s86, s86, s89
  s_add_u32 s87, s86, 1
  s_waitcnt vmcnt(0)
  s_barrier
  s_cmp_lg_u32 s58, 0
  s_cbranch_scc1 sg_58
  v_mov_b32 v26, s85
  s_mov_b64 exec, 1
  s_lshl_b32 s61, s86, 7
  s_add_u32 s61, s61, 99614720
  buffer_atomic_add v26, v255, s[28:31], s61 offen sc1
  s_lshl_b32 s61, s87, 7
  s_add_u32 s61, s61, 99614720
  buffer_atomic_add v26, v255, s[28:31], s61 offen sc1
  s_mov_b64 exec, -1
sg_58:
  s_nop 0
  s_branch w_next
w_g3e:
  s_lshl_b32 s89, s82, 1
  s_add_u32 s89, s89, s60
  s_lshl_b32 s85, s89, 12
  s_lshl_b32 s89, s83, 1
  s_add_u32 s89, s89, s59
  s_lshl_b32 s86, s89, 18
  s_add_u32 s85, s85, s86
  s_lshl_b32 s89, s89, 8
  s_add_u32 s85, s85, 58720256
  s_mov_b32 s32, s18
  s_mov_b32 s33, s19
  s_mov_b32 s34, 7168
  s_mov_b32 s35, 0x20000
  v_and_b32 v27, 31, v1
  v_lshlrev_b32 v26, 5, v27
  v_lshrrev_b32 v27, 5, v1
  v_lshl_add_u32 v26, v27, 4, v26
  v_lshrrev_b32 v27, 5, v1
  v_lshlrev_b32 v27, 3, v27
  buffer_load_dwordx2 v[112:113], v27, s[32:35], s89 offen offset:0
  buffer_load_dwordx2 v[114:115], v27, s[32:35], s89 offen offset:16
  buffer_load_dwordx2 v[116:117], v27, s[32:35], s89 offen offset:32
  buffer_load_dwordx2 v[118:119], v27, s[32:35], s89 offen offset:48
  buffer_load_dwordx2 v[120:121], v27, s[32:35], s89 offen offset:64
  buffer_load_dwordx2 v[122:123], v27, s[32:35], s89 offen offset:80
  buffer_load_dwordx2 v[124:125], v27, s[32:35], s89 offen offset:96
  buffer_load_dwordx2 v[126:127], v27, s[32:35], s89 offen offset:112
  buffer_load_dwordx2 v[128:129], v27, s[32:35], s89 offen offset:128
  buffer_load_dwordx2 v[130:131], v27, s[32:35], s89 offen offset:144
  buffer_load_dwordx2 v[132:133], v27, s[32:35], s89 offen offset:160
  buffer_load_dwordx2 v[134:135], v27, s[32:35], s89 offen offset:176
  buffer_load_dwordx2 v[136:137], v27, s[32:35], s89 offen offset:192
  buffer_load_dwordx2 v[138:139], v27, s[32:35], s89 offen offset:208
  buffer_load_dwordx2 v[140:141], v27, s[32:35], s89 offen offset:224
  buffer_load_dwordx2 v[142:143], v27, s[32:35], s89 offen offset:240
  s_mov_b32 s61, 0xc0135761
  s_mov_b32 s62, 0xbdd2d3e8
  v_mov_b32 v14, s61
  s_waitcnt vmcnt(0)
  v_lshlrev_b32 v144, 16, v112
  v_and_b32 v145, 0xffff0000, v112
  v_lshlrev_b32 v146, 16, v113
  v_and_b32 v147, 0xffff0000, v113
  v_lshlrev_b32 v148, 16, v114
  v_and_b32 v149, 0xffff0000, v114
  v_lshlrev_b32 v150, 16, v115
  v_and_b32 v151, 0xffff0000, v115
  v_lshlrev_b32 v152, 16, v116
  v_and_b32 v153, 0xffff0000, v116
  v_lshlrev_b32 v154, 16, v117
  v_and_b32 v155, 0xffff0000, v117
  v_lshlrev_b32 v156, 16, v118
  v_and_b32 v157, 0xffff0000, v118
  v_lshlrev_b32 v158, 16, v119
  v_and_b32 v159, 0xffff0000, v119
  s_mov_b32 s62, 0xbdd2d3e8
  s_mov_b32 s63, 0xbdd2d3e8
  v_mov_b32 v28, 1.0
  v_mov_b32 v29, 1.0
  v_accvgpr_read_b32 v160, a0
  v_accvgpr_read_b32 v161, a1
  v_accvgpr_read_b32 v162, a2
  v_accvgpr_read_b32 v163, a3
  v_accvgpr_read_b32 v164, a4
  v_accvgpr_read_b32 v165, a5
  v_accvgpr_read_b32 v166, a6
  v_accvgpr_read_b32 v167, a7
  v_accvgpr_read_b32 v168, a8
  v_accvgpr_read_b32 v169, a9
  v_accvgpr_read_b32 v170, a10
  v_accvgpr_read_b32 v171, a11
  v_accvgpr_read_b32 v172, a12
  v_accvgpr_read_b32 v173, a13
  v_accvgpr_read_b32 v174, a14
  v_accvgpr_read_b32 v175, a15
  v_pk_add_f32 v[160:161], v[160:161], v[144:145]
  v_pk_add_f32 v[162:163], v[162:163], v[146:147]
  v_pk_add_f32 v[164:165], v[164:165], v[148:149]
  v_pk_add_f32 v[166:167], v[166:167], v[150:151]
  v_pk_add_f32 v[168:169], v[168:169], v[152:153]
  v_pk_add_f32 v[170:171], v[170:171], v[154:155]
  v_pk_add_f32 v[172:173], v[172:173], v[156:157]
  v_pk_add_f32 v[174:175], v[174:175], v[158:159]
  v_pk_mul_f32 v[176:177], v[160:161], v[160:161]
  v_pk_mul_f32 v[178:179], v[162:163], v[162:163]
  v_pk_mul_f32 v[180:181], v[164:165], v[164:165]
  v_pk_mul_f32 v[182:183], v[166:167], v[166:167]
  v_pk_mul_f32 v[184:185], v[168:169], v[168:169]
  v_pk_mul_f32 v[186:187], v[170:171], v[170:171]
  v_pk_mul_f32 v[188:189], v[172:173], v[172:173]
  v_pk_mul_f32 v[190:191], v[174:175], v[174:175]
  v_pk_fma_f32 v[176:177], v[176:177], s[62:63], v[14:15] op_sel_hi:[1,1,0]
  v_pk_fma_f32 v[178:179], v[178:179], s[62:63], v[14:15] op_sel_hi:[1,1,0]
  v_pk_fma_f32 v[180:181], v[180:181], s[62:63], v[14:15] op_sel_hi:[1,1,0]
  v_pk_fma_f32 v[182:183], v[182:183], s[62:63], v[14:15] op_sel_hi:[1,1,0]
  v_pk_fma_f32 v[184:185], v[184:185], s[62:63], v[14:15] op_sel_hi:[1,1,0]
  v_pk_fma_f32 v[186:187], v[186:187], s[62:63], v[14:15] op_sel_hi:[1,1,0]
  v_pk_fma_f32 v[188:189], v[188:189], s[62:63], v[14:15] op_sel_hi:[1,1,0]
  v_pk_fma_f32 v[190:191], v[190:191], s[62:63], v[14:15] op_sel_hi:[1,1,0]
  v_pk_mul_f32 v[176:177], v[176:177], v[160:161]
  v_pk_mul_f32 v[178:179], v[178:179], v[162:163]
  v_pk_mul_f32 v[180:181], v[180:181], v[164:165]
  v_pk_mul_f32 v[182:183], v[182:183], v[166:167]
  v_pk_mul_f32 v[184:185], v[184:185], v[168:169]
  v_pk_mul_f32 v[186:187], v[186:187], v[170:171]
  v_pk_mul_f32 v[188:189], v[188:189], v[172:173]
  v_pk_mul_f32 v[190:191], v[190:191], v[174:175]
  v_exp_f32 v176, v176
  v_exp_f32 v177, v177
  v_exp_f32 v178, v178
  v_exp_f32 v179, v179
  v_exp_f32 v180, v180
  v_exp_f32 v181, v181
  v_exp_f32 v182, v182
  v_exp_f32 v183, v183
  v_exp_f32 v184, v184
  v_exp_f32 v185, v185
  v_exp_f32 v186, v186
  v_exp_f32 v187, v187
  v_exp_f32 v188, v188
  v_exp_f32 v189, v189
  v_exp_f32 v190, v190
  v_exp_f32 v191, v191
  v_pk_add_f32 v[176:177], v[176:177], v[28:29]
  v_pk_add_f32 v[178:179], v[178:179], v[28:29]
  v_pk_add_f32 v[180:181], v[180:181], v[28:29]
  v_pk_add_f32 v[182:183], v[182:183], v[28:29]
  v_pk_add_f32 v[184:185], v[184:185], v[28:29]
  v_pk_add_f32 v[186:187], v[186:187], v[28:29]
  v_pk_add_f32 v[188:189], v[188:189], v[28:29]
  v_pk_add_f32 v[190:191], v[190:191], v[28:29]
  v_rcp_f32 v176, v176
  v_rcp_f32 v177, v177
  v_rcp_f32 v178, v178
  v_rcp_f32 v179, v179
  v_rcp_f32 v180, v180
  v_rcp_f32 v181, v181
  v_rcp_f32 v182, v182
  v_rcp_f32 v183, v183
  v_rcp_f32 v184, v184
  v_rcp_f32 v185, v185
  v_rcp_f32 v186, v186
  v_rcp_f32 v187, v187
  v_rcp_f32 v188, v188
  v_rcp_f32 v189, v189
  v_rcp_f32 v190, v190
  v_rcp_f32 v191, v191
  v_pk_mul_f32 v[160:161], v[160:161], v[176:177]
  v_pk_mul_f32 v[162:163], v[162:163], v[178:179]
  v_pk_mul_f32 v[164:165], v[164:165], v[180:181]
  v_pk_mul_f32 v[166:167], v[166:167], v[182:183]
  v_pk_mul_f32 v[168:169], v[168:169], v[184:185]
  v_pk_mul_f32 v[170:171], v[170:171], v[186:187]
  v_pk_mul_f32 v[172:173], v[172:173], v[188:189]
  v_pk_mul_f32 v[174:175], v[174:175], v[190:191]
  v_cvt_pk_bf16_f32 v96, v160, v161
  v_cvt_pk_bf16_f32 v97, v162, v163
  v_cvt_pk_bf16_f32 v98, v164, v165
  v_cvt_pk_bf16_f32 v99, v166, v167
  v_cvt_pk_bf16_f32 v100, v168, v169
  v_cvt_pk_bf16_f32 v101, v170, v171
  v_cvt_pk_bf16_f32 v102, v172, v173
  v_cvt_pk_bf16_f32 v103, v174, v175
  v_permlane32_swap_b32 v96, v98
  v_permlane32_swap_b32 v97, v99
  v_permlane32_swap_b32 v100, v102
  v_permlane32_swap_b32 v101, v103
  s_add_u32 s49, s85, 0
  buffer_store_dwordx4 v[96:99], v26, s[28:31], s49 offen offset:0 sc1
  s_add_u32 s49, s85, 32768
  buffer_store_dwordx4 v[100:103], v26, s[28:31], s49 offen offset:0 sc1
  v_accvgpr_read_b32 v160, a16
  v_accvgpr_read_b32 v161, a17
  v_accvgpr_read_b32 v162, a18
  v_accvgpr_read_b32 v163, a19
  v_accvgpr_read_b32 v164, a20
  v_accvgpr_read_b32 v165, a21
  v_accvgpr_read_b32 v166, a22
  v_accvgpr_read_b32 v167, a23
  v_accvgpr_read_b32 v168, a24
  v_accvgpr_read_b32 v169, a25
  v_accvgpr_read_b32 v170, a26
  v_accvgpr_read_b32 v171, a27
  v_accvgpr_read_b32 v172, a28
  v_accvgpr_read_b32 v173, a29
  v_accvgpr_read_b32 v174, a30
  v_accvgpr_read_b32 v175, a31
  v_pk_add_f32 v[160:161], v[160:161], v[144:145]
  v_pk_add_f32 v[162:163], v[162:163], v[146:147]
  v_pk_add_f32 v[164:165], v[164:165], v[148:149]
  v_pk_add_f32 v[166:167], v[166:167], v[150:151]
  v_pk_add_f32 v[168:169], v[168:169], v[152:153]
  v_pk_add_f32 v[170:171], v[170:171], v[154:155]
  v_pk_add_f32 v[172:173], v[172:173], v[156:157]
  v_pk_add_f32 v[174:175], v[174:175], v[158:159]
  v_pk_mul_f32 v[176:177], v[160:161], v[160:161]
  v_pk_mul_f32 v[178:179], v[162:163], v[162:163]
  v_pk_mul_f32 v[180:181], v[164:165], v[164:165]
  v_pk_mul_f32 v[182:183], v[166:167], v[166:167]
  v_pk_mul_f32 v[184:185], v[168:169], v[168:169]
  v_pk_mul_f32 v[186:187], v[170:171], v[170:171]
  v_pk_mul_f32 v[188:189], v[172:173], v[172:173]
  v_pk_mul_f32 v[190:191], v[174:175], v[174:175]
  v_pk_fma_f32 v[176:177], v[176:177], s[62:63], v[14:15] op_sel_hi:[1,1,0]
  v_pk_fma_f32 v[178:179], v[178:179], s[62:63], v[14:15] op_sel_hi:[1,1,0]
  v_pk_fma_f32 v[180:181], v[180:181], s[62:63], v[14:15] op_sel_hi:[1,1,0]
  v_pk_fma_f32 v[182:183], v[182:183], s[62:63], v[14:15] op_sel_hi:[1,1,0]
  v_pk_fma_f32 v[184:185], v[184:185], s[62:63], v[14:15] op_sel_hi:[1,1,0]
  v_pk_fma_f32 v[186:187], v[186:187], s[62:63], v[14:15] op_sel_hi:[1,1,0]
  v_pk_fma_f32 v[188:189], v[188:189], s[62:63], v[14:15] op_sel_hi:[1,1,0]
  v_pk_fma_f32 v[190:191], v[190:191], s[62:63], v[14:15] op_sel_hi:[1,1,0]
  v_pk_mul_f32 v[176:177], v[176:177], v[160:161]
  v_pk_mul_f32 v[178:179], v[178:179], v[162:163]
  v_pk_mul_f32 v[180:181], v[180:181], v[164:165]
  v_pk_mul_f32 v[182:183], v[182:183], v[166:167]
  v_pk_mul_f32 v[184:185], v[184:185], v[168:169]
  v_pk_mul_f32 v[186:187], v[186:187], v[170:171]
  v_pk_mul_f32 v[188:189], v[188:189], v[172:173]
  v_pk_mul_f32 v[190:191], v[190:191], v[174:175]
  v_exp_f32 v176, v176
  v_exp_f32 v177, v177
  v_exp_f32 v178, v178
  v_exp_f32 v179, v179
  v_exp_f32 v180, v180
  v_exp_f32 v181, v181
  v_exp_f32 v182, v182
  v_exp_f32 v183, v183
  v_exp_f32 v184, v184
  v_exp_f32 v185, v185
  v_exp_f32 v186, v186
  v_exp_f32 v187, v187
  v_exp_f32 v188, v188
  v_exp_f32 v189, v189
  v_exp_f32 v190, v190
  v_exp_f32 v191, v191
  v_pk_add_f32 v[176:177], v[176:177], v[28:29]
  v_pk_add_f32 v[178:179], v[178:179], v[28:29]
  v_pk_add_f32 v[180:181], v[180:181], v[28:29]
  v_pk_add_f32 v[182:183], v[182:183], v[28:29]
  v_pk_add_f32 v[184:185], v[184:185], v[28:29]
  v_pk_add_f32 v[186:187], v[186:187], v[28:29]
  v_pk_add_f32 v[188:189], v[188:189], v[28:29]
  v_pk_add_f32 v[190:191], v[190:191], v[28:29]
  v_rcp_f32 v176, v176
  v_rcp_f32 v177, v177
  v_rcp_f32 v178, v178
  v_rcp_f32 v179, v179
  v_rcp_f32 v180, v180
  v_rcp_f32 v181, v181
  v_rcp_f32 v182, v182
  v_rcp_f32 v183, v183
  v_rcp_f32 v184, v184
  v_rcp_f32 v185, v185
  v_rcp_f32 v186, v186
  v_rcp_f32 v187, v187
  v_rcp_f32 v188, v188
  v_rcp_f32 v189, v189
  v_rcp_f32 v190, v190
  v_rcp_f32 v191, v191
  v_pk_mul_f32 v[160:161], v[160:161], v[176:177]
  v_pk_mul_f32 v[162:163], v[162:163], v[178:179]
  v_pk_mul_f32 v[164:165], v[164:165], v[180:181]
  v_pk_mul_f32 v[166:167], v[166:167], v[182:183]
  v_pk_mul_f32 v[168:169], v[168:169], v[184:185]
  v_pk_mul_f32 v[170:171], v[170:171], v[186:187]
  v_pk_mul_f32 v[172:173], v[172:173], v[188:189]
  v_pk_mul_f32 v[174:175], v[174:175], v[190:191]
  v_cvt_pk_bf16_f32 v104, v160, v161
  v_cvt_pk_bf16_f32 v105, v162, v163
  v_cvt_pk_bf16_f32 v106, v164, v165
  v_cvt_pk_bf16_f32 v107, v166, v167
  v_cvt_pk_bf16_f32 v108, v168, v169
  v_cvt_pk_bf16_f32 v109, v170, v171
  v_cvt_pk_bf16_f32 v110, v172, v173
  v_cvt_pk_bf16_f32 v111, v174, v175
  v_permlane32_swap_b32 v104, v106
  v_permlane32_swap_b32 v105, v107
  v_permlane32_swap_b32 v108, v110
  v_permlane32_swap_b32 v109, v111
  s_add_u32 s49, s85, 0
  buffer_store_dwordx4 v[104:107], v26, s[28:31], s49 offen offset:1024 sc1
  s_add_u32 s49, s85, 32768
  buffer_store_dwordx4 v[108:111], v26, s[28:31], s49 offen offset:1024 sc1
  v_accvgpr_read_b32 v160, a32
  v_accvgpr_read_b32 v161, a33
  v_accvgpr_read_b32 v162, a34
  v_accvgpr_read_b32 v163, a35
  v_accvgpr_read_b32 v164, a36
  v_accvgpr_read_b32 v165, a37
  v_accvgpr_read_b32 v166, a38
  v_accvgpr_read_b32 v167, a39
  v_accvgpr_read_b32 v168, a40
  v_accvgpr_read_b32 v169, a41
  v_accvgpr_read_b32 v170, a42
  v_accvgpr_read_b32 v171, a43
  v_accvgpr_read_b32 v172, a44
  v_accvgpr_read_b32 v173, a45
  v_accvgpr_read_b32 v174, a46
  v_accvgpr_read_b32 v175, a47
  v_pk_add_f32 v[160:161], v[160:161], v[144:145]
  v_pk_add_f32 v[162:163], v[162:163], v[146:147]
  v_pk_add_f32 v[164:165], v[164:165], v[148:149]
  v_pk_add_f32 v[166:167], v[166:167], v[150:151]
  v_pk_add_f32 v[168:169], v[168:169], v[152:153]
  v_pk_add_f32 v[170:171], v[170:171], v[154:155]
  v_pk_add_f32 v[172:173], v[172:173], v[156:157]
  v_pk_add_f32 v[174:175], v[174:175], v[158:159]
  v_pk_mul_f32 v[176:177], v[160:161], v[160:161]
  v_pk_mul_f32 v[178:179], v[162:163], v[162:163]
  v_pk_mul_f32 v[180:181], v[164:165], v[164:165]
  v_pk_mul_f32 v[182:183], v[166:167], v[166:167]
  v_pk_mul_f32 v[184:185], v[168:169], v[168:169]
  v_pk_mul_f32 v[186:187], v[170:171], v[170:171]
  v_pk_mul_f32 v[188:189], v[172:173], v[172:173]
  v_pk_mul_f32 v[190:191], v[174:175], v[174:175]
  v_pk_fma_f32 v[176:177], v[176:177], s[62:63], v[14:15] op_sel_hi:[1,1,0]
  v_pk_fma_f32 v[178:179], v[178:179], s[62:63], v[14:15] op_sel_hi:[1,1,0]
  v_pk_fma_f32 v[180:181], v[180:181], s[62:63], v[14:15] op_sel_hi:[1,1,0]
  v_pk_fma_f32 v[182:183], v[182:183], s[62:63], v[14:15] op_sel_hi:[1,1,0]
  v_pk_fma_f32 v[184:185], v[184:185], s[62:63], v[14:15] op_sel_hi:[1,1,0]
  v_pk_fma_f32 v[186:187], v[186:187], s[62:63], v[14:15] op_sel_hi:[1,1,0]
  v_pk_fma_f32 v[188:189], v[188:189], s[62:63], v[14:15] op_sel_hi:[1,1,0]
  v_pk_fma_f32 v[190:191], v[190:191], s[62:63], v[14:15] op_sel_hi:[1,1,0]
  v_pk_mul_f32 v[176:177], v[176:177], v[160:161]
  v_pk_mul_f32 v[178:179], v[178:179], v[162:163]
  v_pk_mul_f32 v[180:181], v[180:181], v[164:165]
  v_pk_mul_f32 v[182:183], v[182:183], v[166:167]
  v_pk_mul_f32 v[184:185], v[184:185], v[168:169]
  v_pk_mul_f32 v[186:187], v[186:187], v[170:171]
  v_pk_mul_f32 v[188:189], v[188:189], v[172:173]
  v_pk_mul_f32 v[190:191], v[190:191], v[174:175]
  v_exp_f32 v176, v176
  v_exp_f32 v177, v177
  v_exp_f32 v178, v178
  v_exp_f32 v179, v179
  v_exp_f32 v180, v180
  v_exp_f32 v181, v181
  v_exp_f32 v182, v182
  v_exp_f32 v183, v183
  v_exp_f32 v184, v184
  v_exp_f32 v185, v185
  v_exp_f32 v186, v186
  v_exp_f32 v187, v187
  v_exp_f32 v188, v188
  v_exp_f32 v189, v189
  v_exp_f32 v190, v190
  v_exp_f32 v191, v191
  v_pk_add_f32 v[176:177], v[176:177], v[28:29]
  v_pk_add_f32 v[178:179], v[178:179], v[28:29]
  v_pk_add_f32 v[180:181], v[180:181], v[28:29]
  v_pk_add_f32 v[182:183], v[182:183], v[28:29]
  v_pk_add_f32 v[184:185], v[184:185], v[28:29]
  v_pk_add_f32 v[186:187], v[186:187], v[28:29]
  v_pk_add_f32 v[188:189], v[188:189], v[28:29]
  v_pk_add_f32 v[190:191], v[190:191], v[28:29]
  v_rcp_f32 v176, v176
  v_rcp_f32 v177, v177
  v_rcp_f32 v178, v178
  v_rcp_f32 v179, v179
  v_rcp_f32 v180, v180
  v_rcp_f32 v181, v181
  v_rcp_f32 v182, v182
  v_rcp_f32 v183, v183
  v_rcp_f32 v184, v184
  v_rcp_f32 v185, v185
  v_rcp_f32 v186, v186
  v_rcp_f32 v187, v187
  v_rcp_f32 v188, v188
  v_rcp_f32 v189, v189
  v_rcp_f32 v190, v190
  v_rcp_f32 v191, v191
  v_pk_mul_f32 v[160:161], v[160:161], v[176:177]
  v_pk_mul_f32 v[162:163], v[162:163], v[178:179]
  v_pk_mul_f32 v[164:165], v[164:165], v[180:181]
  v_pk_mul_f32 v[166:167], v[166:167], v[182:183]
  v_pk_mul_f32 v[168:169], v[168:169], v[184:185]
  v_pk_mul_f32 v[170:171], v[170:171], v[186:187]
  v_pk_mul_f32 v[172:173], v[172:173], v[188:189]
  v_pk_mul_f32 v[174:175], v[174:175], v[190:191]
  v_cvt_pk_bf16_f32 v96, v160, v161
  v_cvt_pk_bf16_f32 v97, v162, v163
  v_cvt_pk_bf16_f32 v98, v164, v165
  v_cvt_pk_bf16_f32 v99, v166, v167
  v_cvt_pk_bf16_f32 v100, v168, v169
  v_cvt_pk_bf16_f32 v101, v170, v171
  v_cvt_pk_bf16_f32 v102, v172, v173
  v_cvt_pk_bf16_f32 v103, v174, v175
  v_permlane32_swap_b32 v96, v98
  v_permlane32_swap_b32 v97, v99
  v_permlane32_swap_b32 v100, v102
  v_permlane32_swap_b32 v101, v103
  s_add_u32 s49, s85, 0
  buffer_store_dwordx4 v[96:99], v26, s[28:31], s49 offen offset:2048 sc1
  s_add_u32 s49, s85, 32768
  buffer_store_dwordx4 v[100:103], v26, s[28:31], s49 offen offset:2048 sc1
  v_accvgpr_read_b32 v160, a48
  v_accvgpr_read_b32 v161, a49
  v_accvgpr_read_b32 v162, a50
  v_accvgpr_read_b32 v163, a51
  v_accvgpr_read_b32 v164, a52
  v_accvgpr_read_b32 v165, a53
  v_accvgpr_read_b32 v166, a54
  v_accvgpr_read_b32 v167, a55
  v_accvgpr_read_b32 v168, a56
  v_accvgpr_read_b32 v169, a57
  v_accvgpr_read_b32 v170, a58
  v_accvgpr_read_b32 v171, a59
  v_accvgpr_read_b32 v172, a60
  v_accvgpr_read_b32 v173, a61
  v_accvgpr_read_b32 v174, a62
  v_accvgpr_read_b32 v175, a63
  v_pk_add_f32 v[160:161], v[160:161], v[144:145]
  v_pk_add_f32 v[162:163], v[162:163], v[146:147]
  v_pk_add_f32 v[164:165], v[164:165], v[148:149]
  v_pk_add_f32 v[166:167], v[166:167], v[150:151]
  v_pk_add_f32 v[168:169], v[168:169], v[152:153]
  v_pk_add_f32 v[170:171], v[170:171], v[154:155]
  v_pk_add_f32 v[172:173], v[172:173], v[156:157]
  v_pk_add_f32 v[174:175], v[174:175], v[158:159]
  v_pk_mul_f32 v[176:177], v[160:161], v[160:161]
  v_pk_mul_f32 v[178:179], v[162:163], v[162:163]
  v_pk_mul_f32 v[180:181], v[164:165], v[164:165]
  v_pk_mul_f32 v[182:183], v[166:167], v[166:167]
  v_pk_mul_f32 v[184:185], v[168:169], v[168:169]
  v_pk_mul_f32 v[186:187], v[170:171], v[170:171]
  v_pk_mul_f32 v[188:189], v[172:173], v[172:173]
  v_pk_mul_f32 v[190:191], v[174:175], v[174:175]
  v_pk_fma_f32 v[176:177], v[176:177], s[62:63], v[14:15] op_sel_hi:[1,1,0]
  v_pk_fma_f32 v[178:179], v[178:179], s[62:63], v[14:15] op_sel_hi:[1,1,0]
  v_pk_fma_f32 v[180:181], v[180:181], s[62:63], v[14:15] op_sel_hi:[1,1,0]
  v_pk_fma_f32 v[182:183], v[182:183], s[62:63], v[14:15] op_sel_hi:[1,1,0]
  v_pk_fma_f32 v[184:185], v[184:185], s[62:63], v[14:15] op_sel_hi:[1,1,0]
  v_pk_fma_f32 v[186:187], v[186:187], s[62:63], v[14:15] op_sel_hi:[1,1,0]
  v_pk_fma_f32 v[188:189], v[188:189], s[62:63], v[14:15] op_sel_hi:[1,1,0]
  v_pk_fma_f32 v[190:191], v[190:191], s[62:63], v[14:15] op_sel_hi:[1,1,0]
  v_pk_mul_f32 v[176:177], v[176:177], v[160:161]
  v_pk_mul_f32 v[178:179], v[178:179], v[162:163]
  v_pk_mul_f32 v[180:181], v[180:181], v[164:165]
  v_pk_mul_f32 v[182:183], v[182:183], v[166:167]
  v_pk_mul_f32 v[184:185], v[184:185], v[168:169]
  v_pk_mul_f32 v[186:187], v[186:187], v[170:171]
  v_pk_mul_f32 v[188:189], v[188:189], v[172:173]
  v_pk_mul_f32 v[190:191], v[190:191], v[174:175]
  v_exp_f32 v176, v176
  v_exp_f32 v177, v177
  v_exp_f32 v178, v178
  v_exp_f32 v179, v179
  v_exp_f32 v180, v180
  v_exp_f32 v181, v181
  v_exp_f32 v182, v182
  v_exp_f32 v183, v183
  v_exp_f32 v184, v184
  v_exp_f32 v185, v185
  v_exp_f32 v186, v186
  v_exp_f32 v187, v187
  v_exp_f32 v188, v188
  v_exp_f32 v189, v189
  v_exp_f32 v190, v190
  v_exp_f32 v191, v191
  v_pk_add_f32 v[176:177], v[176:177], v[28:29]
  v_pk_add_f32 v[178:179], v[178:179], v[28:29]
  v_pk_add_f32 v[180:181], v[180:181], v[28:29]
  v_pk_add_f32 v[182:183], v[182:183], v[28:29]
  v_pk_add_f32 v[184:185], v[184:185], v[28:29]
  v_pk_add_f32 v[186:187], v[186:187], v[28:29]
  v_pk_add_f32 v[188:189], v[188:189], v[28:29]
  v_pk_add_f32 v[190:191], v[190:191], v[28:29]
  v_rcp_f32 v176, v176
  v_rcp_f32 v177, v177
  v_rcp_f32 v178, v178
  v_rcp_f32 v179, v179
  v_rcp_f32 v180, v180
  v_rcp_f32 v181, v181
  v_rcp_f32 v182, v182
  v_rcp_f32 v183, v183
  v_rcp_f32 v184, v184
  v_rcp_f32 v185, v185
  v_rcp_f32 v186, v186
  v_rcp_f32 v187, v187
  v_rcp_f32 v188, v188
  v_rcp_f32 v189, v189
  v_rcp_f32 v190, v190
  v_rcp_f32 v191, v191
  v_pk_mul_f32 v[160:161], v[160:161], v[176:177]
  v_pk_mul_f32 v[162:163], v[162:163], v[178:179]
  v_pk_mul_f32 v[164:165], v[164:165], v[180:181]
  v_pk_mul_f32 v[166:167], v[166:167], v[182:183]
  v_pk_mul_f32 v[168:169], v[168:169], v[184:185]
  v_pk_mul_f32 v[170:171], v[170:171], v[186:187]
  v_pk_mul_f32 v[172:173], v[172:173], v[188:189]
  v_pk_mul_f32 v[174:175], v[174:175], v[190:191]
  v_cvt_pk_bf16_f32 v104, v160, v161
  v_cvt_pk_bf16_f32 v105, v162, v163
  v_cvt_pk_bf16_f32 v106, v164, v165
  v_cvt_pk_bf16_f32 v107, v166, v167
  v_cvt_pk_bf16_f32 v108, v168, v169
  v_cvt_pk_bf16_f32 v109, v170, v171
  v_cvt_pk_bf16_f32 v110, v172, v173
  v_cvt_pk_bf16_f32 v111, v174, v175
  v_permlane32_swap_b32 v104, v106
  v_permlane32_swap_b32 v105, v107
  v_permlane32_swap_b32 v108, v110
  v_permlane32_swap_b32 v109, v111
  s_add_u32 s49, s85, 0
  buffer_store_dwordx4 v[104:107], v26, s[28:31], s49 offen offset:3072 sc1
  s_add_u32 s49, s85, 32768
  buffer_store_dwordx4 v[108:111], v26, s[28:31], s49 offen offset:3072 sc1
  v_lshlrev_b32 v144, 16, v120
  v_and_b32 v145, 0xffff0000, v120
  v_lshlrev_b32 v146, 16, v121
  v_and_b32 v147, 0xffff0000, v121
  v_lshlrev_b32 v148, 16, v122
  v_and_b32 v149, 0xffff0000, v122
  v_lshlrev_b32 v150, 16, v123
  v_and_b32 v151, 0xffff0000, v123
  v_lshlrev_b32 v152, 16, v124
  v_and_b32 v153, 0xffff0000, v124
  v_lshlrev_b32 v154, 16, v125
  v_and_b32 v155, 0xffff0000, v125
  v_lshlrev_b32 v156, 16, v126
  v_and_b32 v157, 0xffff0000, v126
  v_lshlrev_b32 v158, 16, v127
  v_and_b32 v159, 0xffff0000, v127
  v_accvgpr_read_b32 v160, a64
  v_accvgpr_read_b32 v161, a65
  v_accvgpr_read_b32 v162, a66
  v_accvgpr_read_b32 v163, a67
  v_accvgpr_read_b32 v164, a68
  v_accvgpr_read_b32 v165, a69
  v_accvgpr_read_b32 v166, a70
  v_accvgpr_read_b32 v167, a71
  v_accvgpr_read_b32 v168, a72
  v_accvgpr_read_b32 v169, a73
  v_accvgpr_read_b32 v170, a74
  v_accvgpr_read_b32 v171, a75
  v_accvgpr_read_b32 v172, a76
  v_accvgpr_read_b32 v173, a77
  v_accvgpr_read_b32 v174, a78
  v_accvgpr_read_b32 v175, a79
  v_pk_add_f32 v[160:161], v[160:161], v[144:145]
  v_pk_add_f32 v[162:163], v[162:163], v[146:147]
  v_pk_add_f32 v[164:165], v[164:165], v[148:149]
  v_pk_add_f32 v[166:167], v[166:167], v[150:151]
  v_pk_add_f32 v[168:169], v[168:169], v[152:153]
  v_pk_add_f32 v[170:171], v[170:171], v[154:155]
  v_pk_add_f32 v[172:173], v[172:173], v[156:157]
  v_pk_add_f32 v[174:175], v[174:175], v[158:159]
  v_pk_mul_f32 v[176:177], v[160:161], v[160:161]
  v_pk_mul_f32 v[178:179], v[162:163], v[162:163]
  v_pk_mul_f32 v[180:181], v[164:165], v[164:165]
  v_pk_mul_f32 v[182:183], v[166:167], v[166:167]
  v_pk_mul_f32 v[184:185], v[168:169], v[168:169]
  v_pk_mul_f32 v[186:187], v[170:171], v[170:171]
  v_pk_mul_f32 v[188:189], v[172:173], v[172:173]
  v_pk_mul_f32 v[190:191], v[174:175], v[174:175]
  v_pk_fma_f32 v[176:177], v[176:177], s[62:63], v[14:15] op_sel_hi:[1,1,0]
  v_pk_fma_f32 v[178:179], v[178:179], s[62:63], v[14:15] op_sel_hi:[1,1,0]
  v_pk_fma_f32 v[180:181], v[180:181], s[62:63], v[14:15] op_sel_hi:[1,1,0]
  v_pk_fma_f32 v[182:183], v[182:183], s[62:63], v[14:15] op_sel_hi:[1,1,0]
  v_pk_fma_f32 v[184:185], v[184:185], s[62:63], v[14:15] op_sel_hi:[1,1,0]
  v_pk_fma_f32 v[186:187], v[186:187], s[62:63], v[14:15] op_sel_hi:[1,1,0]
  v_pk_fma_f32 v[188:189], v[188:189], s[62:63], v[14:15] op_sel_hi:[1,1,0]
  v_pk_fma_f32 v[190:191], v[190:191], s[62:63], v[14:15] op_sel_hi:[1,1,0]
  v_pk_mul_f32 v[176:177], v[176:177], v[160:161]
  v_pk_mul_f32 v[178:179], v[178:179], v[162:163]
  v_pk_mul_f32 v[180:181], v[180:181], v[164:165]
  v_pk_mul_f32 v[182:183], v[182:183], v[166:167]
  v_pk_mul_f32 v[184:185], v[184:185], v[168:169]
  v_pk_mul_f32 v[186:187], v[186:187], v[170:171]
  v_pk_mul_f32 v[188:189], v[188:189], v[172:173]
  v_pk_mul_f32 v[190:191], v[190:191], v[174:175]
  v_exp_f32 v176, v176
  v_exp_f32 v177, v177
  v_exp_f32 v178, v178
  v_exp_f32 v179, v179
  v_exp_f32 v180, v180
  v_exp_f32 v181, v181
  v_exp_f32 v182, v182
  v_exp_f32 v183, v183
  v_exp_f32 v184, v184
  v_exp_f32 v185, v185
  v_exp_f32 v186, v186
  v_exp_f32 v187, v187
  v_exp_f32 v188, v188
  v_exp_f32 v189, v189
  v_exp_f32 v190, v190
  v_exp_f32 v191, v191
  v_pk_add_f32 v[176:177], v[176:177], v[28:29]
  v_pk_add_f32 v[178:179], v[178:179], v[28:29]
  v_pk_add_f32 v[180:181], v[180:181], v[28:29]
  v_pk_add_f32 v[182:183], v[182:183], v[28:29]
  v_pk_add_f32 v[184:185], v[184:185], v[28:29]
  v_pk_add_f32 v[186:187], v[186:187], v[28:29]
  v_pk_add_f32 v[188:189], v[188:189], v[28:29]
  v_pk_add_f32 v[190:191], v[190:191], v[28:29]
  v_rcp_f32 v176, v176
  v_rcp_f32 v177, v177
  v_rcp_f32 v178, v178
  v_rcp_f32 v179, v179
  v_rcp_f32 v180, v180
  v_rcp_f32 v181, v181
  v_rcp_f32 v182, v182
  v_rcp_f32 v183, v183
  v_rcp_f32 v184, v184
  v_rcp_f32 v185, v185
  v_rcp_f32 v186, v186
  v_rcp_f32 v187, v187
  v_rcp_f32 v188, v188
  v_rcp_f32 v189, v189
  v_rcp_f32 v190, v190
  v_rcp_f32 v191, v191
  v_pk_mul_f32 v[160:161], v[160:161], v[176:177]
  v_pk_mul_f32 v[162:163], v[162:163], v[178:179]
  v_pk_mul_f32 v[164:165], v[164:165], v[180:181]
  v_pk_mul_f32 v[166:167], v[166:167], v[182:183]
  v_pk_mul_f32 v[168:169], v[168:169], v[184:185]
  v_pk_mul_f32 v[170:171], v[170:171], v[186:187]
  v_pk_mul_f32 v[172:173], v[172:173], v[188:189]
  v_pk_mul_f32 v[174:175], v[174:175], v[190:191]
  v_cvt_pk_bf16_f32 v96, v160, v161
  v_cvt_pk_bf16_f32 v97, v162, v163
  v_cvt_pk_bf16_f32 v98, v164, v165
  v_cvt_pk_bf16_f32 v99, v166, v167
  v_cvt_pk_bf16_f32 v100, v168, v169
  v_cvt_pk_bf16_f32 v101, v170, v171
  v_cvt_pk_bf16_f32 v102, v172, v173
  v_cvt_pk_bf16_f32 v103, v174, v175
  v_permlane32_swap_b32 v96, v98
  v_permlane32_swap_b32 v97, v99
  v_permlane32_swap_b32 v100, v102
  v_permlane32_swap_b32 v101, v103
  s_add_u32 s49, s85, 65536
  buffer_store_dwordx4 v[96:99], v26, s[28:31], s49 offen offset:0 sc1
  s_add_u32 s49, s85, 98304
  buffer_store_dwordx4 v[100:103], v26, s[28:31], s49 offen offset:0 sc1
  v_accvgpr_read_b32 v160, a80
  v_accvgpr_read_b32 v161, a81
  v_accvgpr_read_b32 v162, a82
  v_accvgpr_read_b32 v163, a83
  v_accvgpr_read_b32 v164, a84
  v_accvgpr_read_b32 v165, a85
  v_accvgpr_read_b32 v166, a86
  v_accvgpr_read_b32 v167, a87
  v_accvgpr_read_b32 v168, a88
  v_accvgpr_read_b32 v169, a89
  v_accvgpr_read_b32 v170, a90
  v_accvgpr_read_b32 v171, a91
  v_accvgpr_read_b32 v172, a92
  v_accvgpr_read_b32 v173, a93
  v_accvgpr_read_b32 v174, a94
  v_accvgpr_read_b32 v175, a95
  v_pk_add_f32 v[160:161], v[160:161], v[144:145]
  v_pk_add_f32 v[162:163], v[162:163], v[146:147]
  v_pk_add_f32 v[164:165], v[164:165], v[148:149]
  v_pk_add_f32 v[166:167], v[166:167], v[150:151]
  v_pk_add_f32 v[168:169], v[168:169], v[152:153]
  v_pk_add_f32 v[170:171], v[170:171], v[154:155]
  v_pk_add_f32 v[172:173], v[172:173], v[156:157]
  v_pk_add_f32 v[174:175], v[174:175], v[158:159]
  v_pk_mul_f32 v[176:177], v[160:161], v[160:161]
  v_pk_mul_f32 v[178:179], v[162:163], v[162:163]
  v_pk_mul_f32 v[180:181], v[164:165], v[164:165]
  v_pk_mul_f32 v[182:183], v[166:167], v[166:167]
  v_pk_mul_f32 v[184:185], v[168:169], v[168:169]
  v_pk_mul_f32 v[186:187], v[170:171], v[170:171]
  v_pk_mul_f32 v[188:189], v[172:173], v[172:173]
  v_pk_mul_f32 v[190:191], v[174:175], v[174:175]
  v_pk_fma_f32 v[176:177], v[176:177], s[62:63], v[14:15] op_sel_hi:[1,1,0]
  v_pk_fma_f32 v[178:179], v[178:179], s[62:63], v[14:15] op_sel_hi:[1,1,0]
  v_pk_fma_f32 v[180:181], v[180:181], s[62:63], v[14:15] op_sel_hi:[1,1,0]
  v_pk_fma_f32 v[182:183], v[182:183], s[62:63], v[14:15] op_sel_hi:[1,1,0]
  v_pk_fma_f32 v[184:185], v[184:185], s[62:63], v[14:15] op_sel_hi:[1,1,0]
  v_pk_fma_f32 v[186:187], v[186:187], s[62:63], v[14:15] op_sel_hi:[1,1,0]
  v_pk_fma_f32 v[188:189], v[188:189], s[62:63], v[14:15] op_sel_hi:[1,1,0]
  v_pk_fma_f32 v[190:191], v[190:191], s[62:63], v[14:15] op_sel_hi:[1,1,0]
  v_pk_mul_f32 v[176:177], v[176:177], v[160:161]
  v_pk_mul_f32 v[178:179], v[178:179], v[162:163]
  v_pk_mul_f32 v[180:181], v[180:181], v[164:165]
  v_pk_mul_f32 v[182:183], v[182:183], v[166:167]
  v_pk_mul_f32 v[184:185], v[184:185], v[168:169]
  v_pk_mul_f32 v[186:187], v[186:187], v[170:171]
  v_pk_mul_f32 v[188:189], v[188:189], v[172:173]
  v_pk_mul_f32 v[190:191], v[190:191], v[174:175]
  v_exp_f32 v176, v176
  v_exp_f32 v177, v177
  v_exp_f32 v178, v178
  v_exp_f32 v179, v179
  v_exp_f32 v180, v180
  v_exp_f32 v181, v181
  v_exp_f32 v182, v182
  v_exp_f32 v183, v183
  v_exp_f32 v184, v184
  v_exp_f32 v185, v185
  v_exp_f32 v186, v186
  v_exp_f32 v187, v187
  v_exp_f32 v188, v188
  v_exp_f32 v189, v189
  v_exp_f32 v190, v190
  v_exp_f32 v191, v191
  v_pk_add_f32 v[176:177], v[176:177], v[28:29]
  v_pk_add_f32 v[178:179], v[178:179], v[28:29]
  v_pk_add_f32 v[180:181], v[180:181], v[28:29]
  v_pk_add_f32 v[182:183], v[182:183], v[28:29]
  v_pk_add_f32 v[184:185], v[184:185], v[28:29]
  v_pk_add_f32 v[186:187], v[186:187], v[28:29]
  v_pk_add_f32 v[188:189], v[188:189], v[28:29]
  v_pk_add_f32 v[190:191], v[190:191], v[28:29]
  v_rcp_f32 v176, v176
  v_rcp_f32 v177, v177
  v_rcp_f32 v178, v178
  v_rcp_f32 v179, v179
  v_rcp_f32 v180, v180
  v_rcp_f32 v181, v181
  v_rcp_f32 v182, v182
  v_rcp_f32 v183, v183
  v_rcp_f32 v184, v184
  v_rcp_f32 v185, v185
  v_rcp_f32 v186, v186
  v_rcp_f32 v187, v187
  v_rcp_f32 v188, v188
  v_rcp_f32 v189, v189
  v_rcp_f32 v190, v190
  v_rcp_f32 v191, v191
  v_pk_mul_f32 v[160:161], v[160:161], v[176:177]
  v_pk_mul_f32 v[162:163], v[162:163], v[178:179]
  v_pk_mul_f32 v[164:165], v[164:165], v[180:181]
  v_pk_mul_f32 v[166:167], v[166:167], v[182:183]
  v_pk_mul_f32 v[168:169], v[168:169], v[184:185]
  v_pk_mul_f32 v[170:171], v[170:171], v[186:187]
  v_pk_mul_f32 v[172:173], v[172:173], v[188:189]
  v_pk_mul_f32 v[174:175], v[174:175], v[190:191]
  v_cvt_pk_bf16_f32 v104, v160, v161
  v_cvt_pk_bf16_f32 v105, v162, v163
  v_cvt_pk_bf16_f32 v106, v164, v165
  v_cvt_pk_bf16_f32 v107, v166, v167
  v_cvt_pk_bf16_f32 v108, v168, v169
  v_cvt_pk_bf16_f32 v109, v170, v171
  v_cvt_pk_bf16_f32 v110, v172, v173
  v_cvt_pk_bf16_f32 v111, v174, v175
  v_permlane32_swap_b32 v104, v106
  v_permlane32_swap_b32 v105, v107
  v_permlane32_swap_b32 v108, v110
  v_permlane32_swap_b32 v109, v111
  s_add_u32 s49, s85, 65536
  buffer_store_dwordx4 v[104:107], v26, s[28:31], s49 offen offset:1024 sc1
  s_add_u32 s49, s85, 98304
  buffer_store_dwordx4 v[108:111], v26, s[28:31], s49 offen offset:1024 sc1
  v_accvgpr_read_b32 v160, a96
  v_accvgpr_read_b32 v161, a97
  v_accvgpr_read_b32 v162, a98
  v_accvgpr_read_b32 v163, a99
  v_accvgpr_read_b32 v164, a100
  v_accvgpr_read_b32 v165, a101
  v_accvgpr_read_b32 v166, a102
  v_accvgpr_read_b32 v167, a103
  v_accvgpr_read_b32 v168, a104
  v_accvgpr_read_b32 v169, a105
  v_accvgpr_read_b32 v170, a106
  v_accvgpr_read_b32 v171, a107
  v_accvgpr_read_b32 v172, a108
  v_accvgpr_read_b32 v173, a109
  v_accvgpr_read_b32 v174, a110
  v_accvgpr_read_b32 v175, a111
  v_pk_add_f32 v[160:161], v[160:161], v[144:145]
  v_pk_add_f32 v[162:163], v[162:163], v[146:147]
  v_pk_add_f32 v[164:165], v[164:165], v[148:149]
  v_pk_add_f32 v[166:167], v[166:167], v[150:151]
  v_pk_add_f32 v[168:169], v[168:169], v[152:153]
  v_pk_add_f32 v[170:171], v[170:171], v[154:155]
  v_pk_add_f32 v[172:173], v[172:173], v[156:157]
  v_pk_add_f32 v[174:175], v[174:175], v[158:159]
  v_pk_mul_f32 v[176:177], v[160:161], v[160:161]
  v_pk_mul_f32 v[178:179], v[162:163], v[162:163]
  v_pk_mul_f32 v[180:181], v[164:165], v[164:165]
  v_pk_mul_f32 v[182:183], v[166:167], v[166:167]
  v_pk_mul_f32 v[184:185], v[168:169], v[168:169]
  v_pk_mul_f32 v[186:187], v[170:171], v[170:171]
  v_pk_mul_f32 v[188:189], v[172:173], v[172:173]
  v_pk_mul_f32 v[190:191], v[174:175], v[174:175]
  v_pk_fma_f32 v[176:177], v[176:177], s[62:63], v[14:15] op_sel_hi:[1,1,0]
  v_pk_fma_f32 v[178:179], v[178:179], s[62:63], v[14:15] op_sel_hi:[1,1,0]
  v_pk_fma_f32 v[180:181], v[180:181], s[62:63], v[14:15] op_sel_hi:[1,1,0]
  v_pk_fma_f32 v[182:183], v[182:183], s[62:63], v[14:15] op_sel_hi:[1,1,0]
  v_pk_fma_f32 v[184:185], v[184:185], s[62:63], v[14:15] op_sel_hi:[1,1,0]
  v_pk_fma_f32 v[186:187], v[186:187], s[62:63], v[14:15] op_sel_hi:[1,1,0]
  v_pk_fma_f32 v[188:189], v[188:189], s[62:63], v[14:15] op_sel_hi:[1,1,0]
  v_pk_fma_f32 v[190:191], v[190:191], s[62:63], v[14:15] op_sel_hi:[1,1,0]
  v_pk_mul_f32 v[176:177], v[176:177], v[160:161]
  v_pk_mul_f32 v[178:179], v[178:179], v[162:163]
  v_pk_mul_f32 v[180:181], v[180:181], v[164:165]
  v_pk_mul_f32 v[182:183], v[182:183], v[166:167]
  v_pk_mul_f32 v[184:185], v[184:185], v[168:169]
  v_pk_mul_f32 v[186:187], v[186:187], v[170:171]
  v_pk_mul_f32 v[188:189], v[188:189], v[172:173]
  v_pk_mul_f32 v[190:191], v[190:191], v[174:175]
  v_exp_f32 v176, v176
  v_exp_f32 v177, v177
  v_exp_f32 v178, v178
  v_exp_f32 v179, v179
  v_exp_f32 v180, v180
  v_exp_f32 v181, v181
  v_exp_f32 v182, v182
  v_exp_f32 v183, v183
  v_exp_f32 v184, v184
  v_exp_f32 v185, v185
  v_exp_f32 v186, v186
  v_exp_f32 v187, v187
  v_exp_f32 v188, v188
  v_exp_f32 v189, v189
  v_exp_f32 v190, v190
  v_exp_f32 v191, v191
  v_pk_add_f32 v[176:177], v[176:177], v[28:29]
  v_pk_add_f32 v[178:179], v[178:179], v[28:29]
  v_pk_add_f32 v[180:181], v[180:181], v[28:29]
  v_pk_add_f32 v[182:183], v[182:183], v[28:29]
  v_pk_add_f32 v[184:185], v[184:185], v[28:29]
  v_pk_add_f32 v[186:187], v[186:187], v[28:29]
  v_pk_add_f32 v[188:189], v[188:189], v[28:29]
  v_pk_add_f32 v[190:191], v[190:191], v[28:29]
  v_rcp_f32 v176, v176
  v_rcp_f32 v177, v177
  v_rcp_f32 v178, v178
  v_rcp_f32 v179, v179
  v_rcp_f32 v180, v180
  v_rcp_f32 v181, v181
  v_rcp_f32 v182, v182
  v_rcp_f32 v183, v183
  v_rcp_f32 v184, v184
  v_rcp_f32 v185, v185
  v_rcp_f32 v186, v186
  v_rcp_f32 v187, v187
  v_rcp_f32 v188, v188
  v_rcp_f32 v189, v189
  v_rcp_f32 v190, v190
  v_rcp_f32 v191, v191
  v_pk_mul_f32 v[160:161], v[160:161], v[176:177]
  v_pk_mul_f32 v[162:163], v[162:163], v[178:179]
  v_pk_mul_f32 v[164:165], v[164:165], v[180:181]
  v_pk_mul_f32 v[166:167], v[166:167], v[182:183]
  v_pk_mul_f32 v[168:169], v[168:169], v[184:185]
  v_pk_mul_f32 v[170:171], v[170:171], v[186:187]
  v_pk_mul_f32 v[172:173], v[172:173], v[188:189]
  v_pk_mul_f32 v[174:175], v[174:175], v[190:191]
  v_cvt_pk_bf16_f32 v96, v160, v161
  v_cvt_pk_bf16_f32 v97, v162, v163
  v_cvt_pk_bf16_f32 v98, v164, v165
  v_cvt_pk_bf16_f32 v99, v166, v167
  v_cvt_pk_bf16_f32 v100, v168, v169
  v_cvt_pk_bf16_f32 v101, v170, v171
  v_cvt_pk_bf16_f32 v102, v172, v173
  v_cvt_pk_bf16_f32 v103, v174, v175
  v_permlane32_swap_b32 v96, v98
  v_permlane32_swap_b32 v97, v99
  v_permlane32_swap_b32 v100, v102
  v_permlane32_swap_b32 v101, v103
  s_add_u32 s49, s85, 65536
  buffer_store_dwordx4 v[96:99], v26, s[28:31], s49 offen offset:2048 sc1
  s_add_u32 s49, s85, 98304
  buffer_store_dwordx4 v[100:103], v26, s[28:31], s49 offen offset:2048 sc1
  v_accvgpr_read_b32 v160, a112
  v_accvgpr_read_b32 v161, a113
  v_accvgpr_read_b32 v162, a114
  v_accvgpr_read_b32 v163, a115
  v_accvgpr_read_b32 v164, a116
  v_accvgpr_read_b32 v165, a117
  v_accvgpr_read_b32 v166, a118
  v_accvgpr_read_b32 v167, a119
  v_accvgpr_read_b32 v168, a120
  v_accvgpr_read_b32 v169, a121
  v_accvgpr_read_b32 v170, a122
  v_accvgpr_read_b32 v171, a123
  v_accvgpr_read_b32 v172, a124
  v_accvgpr_read_b32 v173, a125
  v_accvgpr_read_b32 v174, a126
  v_accvgpr_read_b32 v175, a127
  v_pk_add_f32 v[160:161], v[160:161], v[144:145]
  v_pk_add_f32 v[162:163], v[162:163], v[146:147]
  v_pk_add_f32 v[164:165], v[164:165], v[148:149]
  v_pk_add_f32 v[166:167], v[166:167], v[150:151]
  v_pk_add_f32 v[168:169], v[168:169], v[152:153]
  v_pk_add_f32 v[170:171], v[170:171], v[154:155]
  v_pk_add_f32 v[172:173], v[172:173], v[156:157]
  v_pk_add_f32 v[174:175], v[174:175], v[158:159]
  v_pk_mul_f32 v[176:177], v[160:161], v[160:161]
  v_pk_mul_f32 v[178:179], v[162:163], v[162:163]
  v_pk_mul_f32 v[180:181], v[164:165], v[164:165]
  v_pk_mul_f32 v[182:183], v[166:167], v[166:167]
  v_pk_mul_f32 v[184:185], v[168:169], v[168:169]
  v_pk_mul_f32 v[186:187], v[170:171], v[170:171]
  v_pk_mul_f32 v[188:189], v[172:173], v[172:173]
  v_pk_mul_f32 v[190:191], v[174:175], v[174:175]
  v_pk_fma_f32 v[176:177], v[176:177], s[62:63], v[14:15] op_sel_hi:[1,1,0]
  v_pk_fma_f32 v[178:179], v[178:179], s[62:63], v[14:15] op_sel_hi:[1,1,0]
  v_pk_fma_f32 v[180:181], v[180:181], s[62:63], v[14:15] op_sel_hi:[1,1,0]
  v_pk_fma_f32 v[182:183], v[182:183], s[62:63], v[14:15] op_sel_hi:[1,1,0]
  v_pk_fma_f32 v[184:185], v[184:185], s[62:63], v[14:15] op_sel_hi:[1,1,0]
  v_pk_fma_f32 v[186:187], v[186:187], s[62:63], v[14:15] op_sel_hi:[1,1,0]
  v_pk_fma_f32 v[188:189], v[188:189], s[62:63], v[14:15] op_sel_hi:[1,1,0]
  v_pk_fma_f32 v[190:191], v[190:191], s[62:63], v[14:15] op_sel_hi:[1,1,0]
  v_pk_mul_f32 v[176:177], v[176:177], v[160:161]
  v_pk_mul_f32 v[178:179], v[178:179], v[162:163]
  v_pk_mul_f32 v[180:181], v[180:181], v[164:165]
  v_pk_mul_f32 v[182:183], v[182:183], v[166:167]
  v_pk_mul_f32 v[184:185], v[184:185], v[168:169]
  v_pk_mul_f32 v[186:187], v[186:187], v[170:171]
  v_pk_mul_f32 v[188:189], v[188:189], v[172:173]
  v_pk_mul_f32 v[190:191], v[190:191], v[174:175]
  v_exp_f32 v176, v176
  v_exp_f32 v177, v177
  v_exp_f32 v178, v178
  v_exp_f32 v179, v179
  v_exp_f32 v180, v180
  v_exp_f32 v181, v181
  v_exp_f32 v182, v182
  v_exp_f32 v183, v183
  v_exp_f32 v184, v184
  v_exp_f32 v185, v185
  v_exp_f32 v186, v186
  v_exp_f32 v187, v187
  v_exp_f32 v188, v188
  v_exp_f32 v189, v189
  v_exp_f32 v190, v190
  v_exp_f32 v191, v191
  v_pk_add_f32 v[176:177], v[176:177], v[28:29]
  v_pk_add_f32 v[178:179], v[178:179], v[28:29]
  v_pk_add_f32 v[180:181], v[180:181], v[28:29]
  v_pk_add_f32 v[182:183], v[182:183], v[28:29]
  v_pk_add_f32 v[184:185], v[184:185], v[28:29]
  v_pk_add_f32 v[186:187], v[186:187], v[28:29]
  v_pk_add_f32 v[188:189], v[188:189], v[28:29]
  v_pk_add_f32 v[190:191], v[190:191], v[28:29]
  v_rcp_f32 v176, v176
  v_rcp_f32 v177, v177
  v_rcp_f32 v178, v178
  v_rcp_f32 v179, v179
  v_rcp_f32 v180, v180
  v_rcp_f32 v181, v181
  v_rcp_f32 v182, v182
  v_rcp_f32 v183, v183
  v_rcp_f32 v184, v184
  v_rcp_f32 v185, v185
  v_rcp_f32 v186, v186
  v_rcp_f32 v187, v187
  v_rcp_f32 v188, v188
  v_rcp_f32 v189, v189
  v_rcp_f32 v190, v190
  v_rcp_f32 v191, v191
  v_pk_mul_f32 v[160:161], v[160:161], v[176:177]
  v_pk_mul_f32 v[162:163], v[162:163], v[178:179]
  v_pk_mul_f32 v[164:165], v[164:165], v[180:181]
  v_pk_mul_f32 v[166:167], v[166:167], v[182:183]
  v_pk_mul_f32 v[168:169], v[168:169], v[184:185]
  v_pk_mul_f32 v[170:171], v[170:171], v[186:187]
  v_pk_mul_f32 v[172:173], v[172:173], v[188:189]
  v_pk_mul_f32 v[174:175], v[174:175], v[190:191]
  v_cvt_pk_bf16_f32 v104, v160, v161
  v_cvt_pk_bf16_f32 v105, v162, v163
  v_cvt_pk_bf16_f32 v106, v164, v165
  v_cvt_pk_bf16_f32 v107, v166, v167
  v_cvt_pk_bf16_f32 v108, v168, v169
  v_cvt_pk_bf16_f32 v109, v170, v171
  v_cvt_pk_bf16_f32 v110, v172, v173
  v_cvt_pk_bf16_f32 v111, v174, v175
  v_permlane32_swap_b32 v104, v106
  v_permlane32_swap_b32 v105, v107
  v_permlane32_swap_b32 v108, v110
  v_permlane32_swap_b32 v109, v111
  s_add_u32 s49, s85, 65536
  buffer_store_dwordx4 v[104:107], v26, s[28:31], s49 offen offset:3072 sc1
  s_add_u32 s49, s85, 98304
  buffer_store_dwordx4 v[108:111], v26, s[28:31], s49 offen offset:3072 sc1
  v_lshlrev_b32 v144, 16, v128
  v_and_b32 v145, 0xffff0000, v128
  v_lshlrev_b32 v146, 16, v129
  v_and_b32 v147, 0xffff0000, v129
  v_lshlrev_b32 v148, 16, v130
  v_and_b32 v149, 0xffff0000, v130
  v_lshlrev_b32 v150, 16, v131
  v_and_b32 v151, 0xffff0000, v131
  v_lshlrev_b32 v152, 16, v132
  v_and_b32 v153, 0xffff0000, v132
  v_lshlrev_b32 v154, 16, v133
  v_and_b32 v155, 0xffff0000, v133
  v_lshlrev_b32 v156, 16, v134
  v_and_b32 v157, 0xffff0000, v134
  v_lshlrev_b32 v158, 16, v135
  v_and_b32 v159, 0xffff0000, v135
  v_accvgpr_read_b32 v160, a128
  v_accvgpr_read_b32 v161, a129
  v_accvgpr_read_b32 v162, a130
  v_accvgpr_read_b32 v163, a131
  v_accvgpr_read_b32 v164, a132
  v_accvgpr_read_b32 v165, a133
  v_accvgpr_read_b32 v166, a134
  v_accvgpr_read_b32 v167, a135
  v_accvgpr_read_b32 v168, a136
  v_accvgpr_read_b32 v169, a137
  v_accvgpr_read_b32 v170, a138
  v_accvgpr_read_b32 v171, a139
  v_accvgpr_read_b32 v172, a140
  v_accvgpr_read_b32 v173, a141
  v_accvgpr_read_b32 v174, a142
  v_accvgpr_read_b32 v175, a143
  v_pk_add_f32 v[160:161], v[160:161], v[144:145]
  v_pk_add_f32 v[162:163], v[162:163], v[146:147]
  v_pk_add_f32 v[164:165], v[164:165], v[148:149]
  v_pk_add_f32 v[166:167], v[166:167], v[150:151]
  v_pk_add_f32 v[168:169], v[168:169], v[152:153]
  v_pk_add_f32 v[170:171], v[170:171], v[154:155]
  v_pk_add_f32 v[172:173], v[172:173], v[156:157]
  v_pk_add_f32 v[174:175], v[174:175], v[158:159]
  v_pk_mul_f32 v[176:177], v[160:161], v[160:161]
  v_pk_mul_f32 v[178:179], v[162:163], v[162:163]
  v_pk_mul_f32 v[180:181], v[164:165], v[164:165]
  v_pk_mul_f32 v[182:183], v[166:167], v[166:167]
  v_pk_mul_f32 v[184:185], v[168:169], v[168:169]
  v_pk_mul_f32 v[186:187], v[170:171], v[170:171]
  v_pk_mul_f32 v[188:189], v[172:173], v[172:173]
  v_pk_mul_f32 v[190:191], v[174:175], v[174:175]
  v_pk_fma_f32 v[176:177], v[176:177], s[62:63], v[14:15] op_sel_hi:[1,1,0]
  v_pk_fma_f32 v[178:179], v[178:179], s[62:63], v[14:15] op_sel_hi:[1,1,0]
  v_pk_fma_f32 v[180:181], v[180:181], s[62:63], v[14:15] op_sel_hi:[1,1,0]
  v_pk_fma_f32 v[182:183], v[182:183], s[62:63], v[14:15] op_sel_hi:[1,1,0]
  v_pk_fma_f32 v[184:185], v[184:185], s[62:63], v[14:15] op_sel_hi:[1,1,0]
  v_pk_fma_f32 v[186:187], v[186:187], s[62:63], v[14:15] op_sel_hi:[1,1,0]
  v_pk_fma_f32 v[188:189], v[188:189], s[62:63], v[14:15] op_sel_hi:[1,1,0]
  v_pk_fma_f32 v[190:191], v[190:191], s[62:63], v[14:15] op_sel_hi:[1,1,0]
  v_pk_mul_f32 v[176:177], v[176:177], v[160:161]
  v_pk_mul_f32 v[178:179], v[178:179], v[162:163]
  v_pk_mul_f32 v[180:181], v[180:181], v[164:165]
  v_pk_mul_f32 v[182:183], v[182:183], v[166:167]
  v_pk_mul_f32 v[184:185], v[184:185], v[168:169]
  v_pk_mul_f32 v[186:187], v[186:187], v[170:171]
  v_pk_mul_f32 v[188:189], v[188:189], v[172:173]
  v_pk_mul_f32 v[190:191], v[190:191], v[174:175]
  v_exp_f32 v176, v176
  v_exp_f32 v177, v177
  v_exp_f32 v178, v178
  v_exp_f32 v179, v179
  v_exp_f32 v180, v180
  v_exp_f32 v181, v181
  v_exp_f32 v182, v182
  v_exp_f32 v183, v183
  v_exp_f32 v184, v184
  v_exp_f32 v185, v185
  v_exp_f32 v186, v186
  v_exp_f32 v187, v187
  v_exp_f32 v188, v188
  v_exp_f32 v189, v189
  v_exp_f32 v190, v190
  v_exp_f32 v191, v191
  v_pk_add_f32 v[176:177], v[176:177], v[28:29]
  v_pk_add_f32 v[178:179], v[178:179], v[28:29]
  v_pk_add_f32 v[180:181], v[180:181], v[28:29]
  v_pk_add_f32 v[182:183], v[182:183], v[28:29]
  v_pk_add_f32 v[184:185], v[184:185], v[28:29]
  v_pk_add_f32 v[186:187], v[186:187], v[28:29]
  v_pk_add_f32 v[188:189], v[188:189], v[28:29]
  v_pk_add_f32 v[190:191], v[190:191], v[28:29]
  v_rcp_f32 v176, v176
  v_rcp_f32 v177, v177
  v_rcp_f32 v178, v178
  v_rcp_f32 v179, v179
  v_rcp_f32 v180, v180
  v_rcp_f32 v181, v181
  v_rcp_f32 v182, v182
  v_rcp_f32 v183, v183
  v_rcp_f32 v184, v184
  v_rcp_f32 v185, v185
  v_rcp_f32 v186, v186
  v_rcp_f32 v187, v187
  v_rcp_f32 v188, v188
  v_rcp_f32 v189, v189
  v_rcp_f32 v190, v190
  v_rcp_f32 v191, v191
  v_pk_mul_f32 v[160:161], v[160:161], v[176:177]
  v_pk_mul_f32 v[162:163], v[162:163], v[178:179]
  v_pk_mul_f32 v[164:165], v[164:165], v[180:181]
  v_pk_mul_f32 v[166:167], v[166:167], v[182:183]
  v_pk_mul_f32 v[168:169], v[168:169], v[184:185]
  v_pk_mul_f32 v[170:171], v[170:171], v[186:187]
  v_pk_mul_f32 v[172:173], v[172:173], v[188:189]
  v_pk_mul_f32 v[174:175], v[174:175], v[190:191]
  v_cvt_pk_bf16_f32 v96, v160, v161
  v_cvt_pk_bf16_f32 v97, v162, v163
  v_cvt_pk_bf16_f32 v98, v164, v165
  v_cvt_pk_bf16_f32 v99, v166, v167
  v_cvt_pk_bf16_f32 v100, v168, v169
  v_cvt_pk_bf16_f32 v101, v170, v171
  v_cvt_pk_bf16_f32 v102, v172, v173
  v_cvt_pk_bf16_f32 v103, v174, v175
  v_permlane32_swap_b32 v96, v98
  v_permlane32_swap_b32 v97, v99
  v_permlane32_swap_b32 v100, v102
  v_permlane32_swap_b32 v101, v103
  s_add_u32 s49, s85, 131072
  buffer_store_dwordx4 v[96:99], v26, s[28:31], s49 offen offset:0 sc1
  s_add_u32 s49, s85, 163840
  buffer_store_dwordx4 v[100:103], v26, s[28:31], s49 offen offset:0 sc1
  v_accvgpr_read_b32 v160, a144
  v_accvgpr_read_b32 v161, a145
  v_accvgpr_read_b32 v162, a146
  v_accvgpr_read_b32 v163, a147
  v_accvgpr_read_b32 v164, a148
  v_accvgpr_read_b32 v165, a149
  v_accvgpr_read_b32 v166, a150
  v_accvgpr_read_b32 v167, a151
  v_accvgpr_read_b32 v168, a152
  v_accvgpr_read_b32 v169, a153
  v_accvgpr_read_b32 v170, a154
  v_accvgpr_read_b32 v171, a155
  v_accvgpr_read_b32 v172, a156
  v_accvgpr_read_b32 v173, a157
  v_accvgpr_read_b32 v174, a158
  v_accvgpr_read_b32 v175, a159
  v_pk_add_f32 v[160:161], v[160:161], v[144:145]
  v_pk_add_f32 v[162:163], v[162:163], v[146:147]
  v_pk_add_f32 v[164:165], v[164:165], v[148:149]
  v_pk_add_f32 v[166:167], v[166:167], v[150:151]
  v_pk_add_f32 v[168:169], v[168:169], v[152:153]
  v_pk_add_f32 v[170:171], v[170:171], v[154:155]
  v_pk_add_f32 v[172:173], v[172:173], v[156:157]
  v_pk_add_f32 v[174:175], v[174:175], v[158:159]
  v_pk_mul_f32 v[176:177], v[160:161], v[160:161]
  v_pk_mul_f32 v[178:179], v[162:163], v[162:163]
  v_pk_mul_f32 v[180:181], v[164:165], v[164:165]
  v_pk_mul_f32 v[182:183], v[166:167], v[166:167]
  v_pk_mul_f32 v[184:185], v[168:169], v[168:169]
  v_pk_mul_f32 v[186:187], v[170:171], v[170:171]
  v_pk_mul_f32 v[188:189], v[172:173], v[172:173]
  v_pk_mul_f32 v[190:191], v[174:175], v[174:175]
  v_pk_fma_f32 v[176:177], v[176:177], s[62:63], v[14:15] op_sel_hi:[1,1,0]
  v_pk_fma_f32 v[178:179], v[178:179], s[62:63], v[14:15] op_sel_hi:[1,1,0]
  v_pk_fma_f32 v[180:181], v[180:181], s[62:63], v[14:15] op_sel_hi:[1,1,0]
  v_pk_fma_f32 v[182:183], v[182:183], s[62:63], v[14:15] op_sel_hi:[1,1,0]
  v_pk_fma_f32 v[184:185], v[184:185], s[62:63], v[14:15] op_sel_hi:[1,1,0]
  v_pk_fma_f32 v[186:187], v[186:187], s[62:63], v[14:15] op_sel_hi:[1,1,0]
  v_pk_fma_f32 v[188:189], v[188:189], s[62:63], v[14:15] op_sel_hi:[1,1,0]
  v_pk_fma_f32 v[190:191], v[190:191], s[62:63], v[14:15] op_sel_hi:[1,1,0]
  v_pk_mul_f32 v[176:177], v[176:177], v[160:161]
  v_pk_mul_f32 v[178:179], v[178:179], v[162:163]
  v_pk_mul_f32 v[180:181], v[180:181], v[164:165]
  v_pk_mul_f32 v[182:183], v[182:183], v[166:167]
  v_pk_mul_f32 v[184:185], v[184:185], v[168:169]
  v_pk_mul_f32 v[186:187], v[186:187], v[170:171]
  v_pk_mul_f32 v[188:189], v[188:189], v[172:173]
  v_pk_mul_f32 v[190:191], v[190:191], v[174:175]
  v_exp_f32 v176, v176
  v_exp_f32 v177, v177
  v_exp_f32 v178, v178
  v_exp_f32 v179, v179
  v_exp_f32 v180, v180
  v_exp_f32 v181, v181
  v_exp_f32 v182, v182
  v_exp_f32 v183, v183
  v_exp_f32 v184, v184
  v_exp_f32 v185, v185
  v_exp_f32 v186, v186
  v_exp_f32 v187, v187
  v_exp_f32 v188, v188
  v_exp_f32 v189, v189
  v_exp_f32 v190, v190
  v_exp_f32 v191, v191
  v_pk_add_f32 v[176:177], v[176:177], v[28:29]
  v_pk_add_f32 v[178:179], v[178:179], v[28:29]
  v_pk_add_f32 v[180:181], v[180:181], v[28:29]
  v_pk_add_f32 v[182:183], v[182:183], v[28:29]
  v_pk_add_f32 v[184:185], v[184:185], v[28:29]
  v_pk_add_f32 v[186:187], v[186:187], v[28:29]
  v_pk_add_f32 v[188:189], v[188:189], v[28:29]
  v_pk_add_f32 v[190:191], v[190:191], v[28:29]
  v_rcp_f32 v176, v176
  v_rcp_f32 v177, v177
  v_rcp_f32 v178, v178
  v_rcp_f32 v179, v179
  v_rcp_f32 v180, v180
  v_rcp_f32 v181, v181
  v_rcp_f32 v182, v182
  v_rcp_f32 v183, v183
  v_rcp_f32 v184, v184
  v_rcp_f32 v185, v185
  v_rcp_f32 v186, v186
  v_rcp_f32 v187, v187
  v_rcp_f32 v188, v188
  v_rcp_f32 v189, v189
  v_rcp_f32 v190, v190
  v_rcp_f32 v191, v191
  v_pk_mul_f32 v[160:161], v[160:161], v[176:177]
  v_pk_mul_f32 v[162:163], v[162:163], v[178:179]
  v_pk_mul_f32 v[164:165], v[164:165], v[180:181]
  v_pk_mul_f32 v[166:167], v[166:167], v[182:183]
  v_pk_mul_f32 v[168:169], v[168:169], v[184:185]
  v_pk_mul_f32 v[170:171], v[170:171], v[186:187]
  v_pk_mul_f32 v[172:173], v[172:173], v[188:189]
  v_pk_mul_f32 v[174:175], v[174:175], v[190:191]
  v_cvt_pk_bf16_f32 v104, v160, v161
  v_cvt_pk_bf16_f32 v105, v162, v163
  v_cvt_pk_bf16_f32 v106, v164, v165
  v_cvt_pk_bf16_f32 v107, v166, v167
  v_cvt_pk_bf16_f32 v108, v168, v169
  v_cvt_pk_bf16_f32 v109, v170, v171
  v_cvt_pk_bf16_f32 v110, v172, v173
  v_cvt_pk_bf16_f32 v111, v174, v175
  v_permlane32_swap_b32 v104, v106
  v_permlane32_swap_b32 v105, v107
  v_permlane32_swap_b32 v108, v110
  v_permlane32_swap_b32 v109, v111
  s_add_u32 s49, s85, 131072
  buffer_store_dwordx4 v[104:107], v26, s[28:31], s49 offen offset:1024 sc1
  s_add_u32 s49, s85, 163840
  buffer_store_dwordx4 v[108:111], v26, s[28:31], s49 offen offset:1024 sc1
  v_accvgpr_read_b32 v160, a160
  v_accvgpr_read_b32 v161, a161
  v_accvgpr_read_b32 v162, a162
  v_accvgpr_read_b32 v163, a163
  v_accvgpr_read_b32 v164, a164
  v_accvgpr_read_b32 v165, a165
  v_accvgpr_read_b32 v166, a166
  v_accvgpr_read_b32 v167, a167
  v_accvgpr_read_b32 v168, a168
  v_accvgpr_read_b32 v169, a169
  v_accvgpr_read_b32 v170, a170
  v_accvgpr_read_b32 v171, a171
  v_accvgpr_read_b32 v172, a172
  v_accvgpr_read_b32 v173, a173
  v_accvgpr_read_b32 v174, a174
  v_accvgpr_read_b32 v175, a175
  v_pk_add_f32 v[160:161], v[160:161], v[144:145]
  v_pk_add_f32 v[162:163], v[162:163], v[146:147]
  v_pk_add_f32 v[164:165], v[164:165], v[148:149]
  v_pk_add_f32 v[166:167], v[166:167], v[150:151]
  v_pk_add_f32 v[168:169], v[168:169], v[152:153]
  v_pk_add_f32 v[170:171], v[170:171], v[154:155]
  v_pk_add_f32 v[172:173], v[172:173], v[156:157]
  v_pk_add_f32 v[174:175], v[174:175], v[158:159]
  v_pk_mul_f32 v[176:177], v[160:161], v[160:161]
  v_pk_mul_f32 v[178:179], v[162:163], v[162:163]
  v_pk_mul_f32 v[180:181], v[164:165], v[164:165]
  v_pk_mul_f32 v[182:183], v[166:167], v[166:167]
  v_pk_mul_f32 v[184:185], v[168:169], v[168:169]
  v_pk_mul_f32 v[186:187], v[170:171], v[170:171]
  v_pk_mul_f32 v[188:189], v[172:173], v[172:173]
  v_pk_mul_f32 v[190:191], v[174:175], v[174:175]
  v_pk_fma_f32 v[176:177], v[176:177], s[62:63], v[14:15] op_sel_hi:[1,1,0]
  v_pk_fma_f32 v[178:179], v[178:179], s[62:63], v[14:15] op_sel_hi:[1,1,0]
  v_pk_fma_f32 v[180:181], v[180:181], s[62:63], v[14:15] op_sel_hi:[1,1,0]
  v_pk_fma_f32 v[182:183], v[182:183], s[62:63], v[14:15] op_sel_hi:[1,1,0]
  v_pk_fma_f32 v[184:185], v[184:185], s[62:63], v[14:15] op_sel_hi:[1,1,0]
  v_pk_fma_f32 v[186:187], v[186:187], s[62:63], v[14:15] op_sel_hi:[1,1,0]
  v_pk_fma_f32 v[188:189], v[188:189], s[62:63], v[14:15] op_sel_hi:[1,1,0]
  v_pk_fma_f32 v[190:191], v[190:191], s[62:63], v[14:15] op_sel_hi:[1,1,0]
  v_pk_mul_f32 v[176:177], v[176:177], v[160:161]
  v_pk_mul_f32 v[178:179], v[178:179], v[162:163]
  v_pk_mul_f32 v[180:181], v[180:181], v[164:165]
  v_pk_mul_f32 v[182:183], v[182:183], v[166:167]
  v_pk_mul_f32 v[184:185], v[184:185], v[168:169]
  v_pk_mul_f32 v[186:187], v[186:187], v[170:171]
  v_pk_mul_f32 v[188:189], v[188:189], v[172:173]
  v_pk_mul_f32 v[190:191], v[190:191], v[174:175]
  v_exp_f32 v176, v176
  v_exp_f32 v177, v177
  v_exp_f32 v178, v178
  v_exp_f32 v179, v179
  v_exp_f32 v180, v180
  v_exp_f32 v181, v181
  v_exp_f32 v182, v182
  v_exp_f32 v183, v183
  v_exp_f32 v184, v184
  v_exp_f32 v185, v185
  v_exp_f32 v186, v186
  v_exp_f32 v187, v187
  v_exp_f32 v188, v188
  v_exp_f32 v189, v189
  v_exp_f32 v190, v190
  v_exp_f32 v191, v191
  v_pk_add_f32 v[176:177], v[176:177], v[28:29]
  v_pk_add_f32 v[178:179], v[178:179], v[28:29]
  v_pk_add_f32 v[180:181], v[180:181], v[28:29]
  v_pk_add_f32 v[182:183], v[182:183], v[28:29]
  v_pk_add_f32 v[184:185], v[184:185], v[28:29]
  v_pk_add_f32 v[186:187], v[186:187], v[28:29]
  v_pk_add_f32 v[188:189], v[188:189], v[28:29]
  v_pk_add_f32 v[190:191], v[190:191], v[28:29]
  v_rcp_f32 v176, v176
  v_rcp_f32 v177, v177
  v_rcp_f32 v178, v178
  v_rcp_f32 v179, v179
  v_rcp_f32 v180, v180
  v_rcp_f32 v181, v181
  v_rcp_f32 v182, v182
  v_rcp_f32 v183, v183
  v_rcp_f32 v184, v184
  v_rcp_f32 v185, v185
  v_rcp_f32 v186, v186
  v_rcp_f32 v187, v187
  v_rcp_f32 v188, v188
  v_rcp_f32 v189, v189
  v_rcp_f32 v190, v190
  v_rcp_f32 v191, v191
  v_pk_mul_f32 v[160:161], v[160:161], v[176:177]
  v_pk_mul_f32 v[162:163], v[162:163], v[178:179]
  v_pk_mul_f32 v[164:165], v[164:165], v[180:181]
  v_pk_mul_f32 v[166:167], v[166:167], v[182:183]
  v_pk_mul_f32 v[168:169], v[168:169], v[184:185]
  v_pk_mul_f32 v[170:171], v[170:171], v[186:187]
  v_pk_mul_f32 v[172:173], v[172:173], v[188:189]
  v_pk_mul_f32 v[174:175], v[174:175], v[190:191]
  v_cvt_pk_bf16_f32 v96, v160, v161
  v_cvt_pk_bf16_f32 v97, v162, v163
  v_cvt_pk_bf16_f32 v98, v164, v165
  v_cvt_pk_bf16_f32 v99, v166, v167
  v_cvt_pk_bf16_f32 v100, v168, v169
  v_cvt_pk_bf16_f32 v101, v170, v171
  v_cvt_pk_bf16_f32 v102, v172, v173
  v_cvt_pk_bf16_f32 v103, v174, v175
  v_permlane32_swap_b32 v96, v98
  v_permlane32_swap_b32 v97, v99
  v_permlane32_swap_b32 v100, v102
  v_permlane32_swap_b32 v101, v103
  s_add_u32 s49, s85, 131072
  buffer_store_dwordx4 v[96:99], v26, s[28:31], s49 offen offset:2048 sc1
  s_add_u32 s49, s85, 163840
  buffer_store_dwordx4 v[100:103], v26, s[28:31], s49 offen offset:2048 sc1
  v_accvgpr_read_b32 v160, a176
  v_accvgpr_read_b32 v161, a177
  v_accvgpr_read_b32 v162, a178
  v_accvgpr_read_b32 v163, a179
  v_accvgpr_read_b32 v164, a180
  v_accvgpr_read_b32 v165, a181
  v_accvgpr_read_b32 v166, a182
  v_accvgpr_read_b32 v167, a183
  v_accvgpr_read_b32 v168, a184
  v_accvgpr_read_b32 v169, a185
  v_accvgpr_read_b32 v170, a186
  v_accvgpr_read_b32 v171, a187
  v_accvgpr_read_b32 v172, a188
  v_accvgpr_read_b32 v173, a189
  v_accvgpr_read_b32 v174, a190
  v_accvgpr_read_b32 v175, a191
  v_pk_add_f32 v[160:161], v[160:161], v[144:145]
  v_pk_add_f32 v[162:163], v[162:163], v[146:147]
  v_pk_add_f32 v[164:165], v[164:165], v[148:149]
  v_pk_add_f32 v[166:167], v[166:167], v[150:151]
  v_pk_add_f32 v[168:169], v[168:169], v[152:153]
  v_pk_add_f32 v[170:171], v[170:171], v[154:155]
  v_pk_add_f32 v[172:173], v[172:173], v[156:157]
  v_pk_add_f32 v[174:175], v[174:175], v[158:159]
  v_pk_mul_f32 v[176:177], v[160:161], v[160:161]
  v_pk_mul_f32 v[178:179], v[162:163], v[162:163]
  v_pk_mul_f32 v[180:181], v[164:165], v[164:165]
  v_pk_mul_f32 v[182:183], v[166:167], v[166:167]
  v_pk_mul_f32 v[184:185], v[168:169], v[168:169]
  v_pk_mul_f32 v[186:187], v[170:171], v[170:171]
  v_pk_mul_f32 v[188:189], v[172:173], v[172:173]
  v_pk_mul_f32 v[190:191], v[174:175], v[174:175]
  v_pk_fma_f32 v[176:177], v[176:177], s[62:63], v[14:15] op_sel_hi:[1,1,0]
  v_pk_fma_f32 v[178:179], v[178:179], s[62:63], v[14:15] op_sel_hi:[1,1,0]
  v_pk_fma_f32 v[180:181], v[180:181], s[62:63], v[14:15] op_sel_hi:[1,1,0]
  v_pk_fma_f32 v[182:183], v[182:183], s[62:63], v[14:15] op_sel_hi:[1,1,0]
  v_pk_fma_f32 v[184:185], v[184:185], s[62:63], v[14:15] op_sel_hi:[1,1,0]
  v_pk_fma_f32 v[186:187], v[186:187], s[62:63], v[14:15] op_sel_hi:[1,1,0]
  v_pk_fma_f32 v[188:189], v[188:189], s[62:63], v[14:15] op_sel_hi:[1,1,0]
  v_pk_fma_f32 v[190:191], v[190:191], s[62:63], v[14:15] op_sel_hi:[1,1,0]
  v_pk_mul_f32 v[176:177], v[176:177], v[160:161]
  v_pk_mul_f32 v[178:179], v[178:179], v[162:163]
  v_pk_mul_f32 v[180:181], v[180:181], v[164:165]
  v_pk_mul_f32 v[182:183], v[182:183], v[166:167]
  v_pk_mul_f32 v[184:185], v[184:185], v[168:169]
  v_pk_mul_f32 v[186:187], v[186:187], v[170:171]
  v_pk_mul_f32 v[188:189], v[188:189], v[172:173]
  v_pk_mul_f32 v[190:191], v[190:191], v[174:175]
  v_exp_f32 v176, v176
  v_exp_f32 v177, v177
  v_exp_f32 v178, v178
  v_exp_f32 v179, v179
  v_exp_f32 v180, v180
  v_exp_f32 v181, v181
  v_exp_f32 v182, v182
  v_exp_f32 v183, v183
  v_exp_f32 v184, v184
  v_exp_f32 v185, v185
  v_exp_f32 v186, v186
  v_exp_f32 v187, v187
  v_exp_f32 v188, v188
  v_exp_f32 v189, v189
  v_exp_f32 v190, v190
  v_exp_f32 v191, v191
  v_pk_add_f32 v[176:177], v[176:177], v[28:29]
  v_pk_add_f32 v[178:179], v[178:179], v[28:29]
  v_pk_add_f32 v[180:181], v[180:181], v[28:29]
  v_pk_add_f32 v[182:183], v[182:183], v[28:29]
  v_pk_add_f32 v[184:185], v[184:185], v[28:29]
  v_pk_add_f32 v[186:187], v[186:187], v[28:29]
  v_pk_add_f32 v[188:189], v[188:189], v[28:29]
  v_pk_add_f32 v[190:191], v[190:191], v[28:29]
  v_rcp_f32 v176, v176
  v_rcp_f32 v177, v177
  v_rcp_f32 v178, v178
  v_rcp_f32 v179, v179
  v_rcp_f32 v180, v180
  v_rcp_f32 v181, v181
  v_rcp_f32 v182, v182
  v_rcp_f32 v183, v183
  v_rcp_f32 v184, v184
  v_rcp_f32 v185, v185
  v_rcp_f32 v186, v186
  v_rcp_f32 v187, v187
  v_rcp_f32 v188, v188
  v_rcp_f32 v189, v189
  v_rcp_f32 v190, v190
  v_rcp_f32 v191, v191
  v_pk_mul_f32 v[160:161], v[160:161], v[176:177]
  v_pk_mul_f32 v[162:163], v[162:163], v[178:179]
  v_pk_mul_f32 v[164:165], v[164:165], v[180:181]
  v_pk_mul_f32 v[166:167], v[166:167], v[182:183]
  v_pk_mul_f32 v[168:169], v[168:169], v[184:185]
  v_pk_mul_f32 v[170:171], v[170:171], v[186:187]
  v_pk_mul_f32 v[172:173], v[172:173], v[188:189]
  v_pk_mul_f32 v[174:175], v[174:175], v[190:191]
  v_cvt_pk_bf16_f32 v104, v160, v161
  v_cvt_pk_bf16_f32 v105, v162, v163
  v_cvt_pk_bf16_f32 v106, v164, v165
  v_cvt_pk_bf16_f32 v107, v166, v167
  v_cvt_pk_bf16_f32 v108, v168, v169
  v_cvt_pk_bf16_f32 v109, v170, v171
  v_cvt_pk_bf16_f32 v110, v172, v173
  v_cvt_pk_bf16_f32 v111, v174, v175
  v_permlane32_swap_b32 v104, v106
  v_permlane32_swap_b32 v105, v107
  v_permlane32_swap_b32 v108, v110
  v_permlane32_swap_b32 v109, v111
  s_add_u32 s49, s85, 131072
  buffer_store_dwordx4 v[104:107], v26, s[28:31], s49 offen offset:3072 sc1
  s_add_u32 s49, s85, 163840
  buffer_store_dwordx4 v[108:111], v26, s[28:31], s49 offen offset:3072 sc1
  v_lshlrev_b32 v144, 16, v136
  v_and_b32 v145, 0xffff0000, v136
  v_lshlrev_b32 v146, 16, v137
  v_and_b32 v147, 0xffff0000, v137
  v_lshlrev_b32 v148, 16, v138
  v_and_b32 v149, 0xffff0000, v138
  v_lshlrev_b32 v150, 16, v139
  v_and_b32 v151, 0xffff0000, v139
  v_lshlrev_b32 v152, 16, v140
  v_and_b32 v153, 0xffff0000, v140
  v_lshlrev_b32 v154, 16, v141
  v_and_b32 v155, 0xffff0000, v141
  v_lshlrev_b32 v156, 16, v142
  v_and_b32 v157, 0xffff0000, v142
  v_lshlrev_b32 v158, 16, v143
  v_and_b32 v159, 0xffff0000, v143
  v_accvgpr_read_b32 v160, a192
  v_accvgpr_read_b32 v161, a193
  v_accvgpr_read_b32 v162, a194
  v_accvgpr_read_b32 v163, a195
  v_accvgpr_read_b32 v164, a196
  v_accvgpr_read_b32 v165, a197
  v_accvgpr_read_b32 v166, a198
  v_accvgpr_read_b32 v167, a199
  v_accvgpr_read_b32 v168, a200
  v_accvgpr_read_b32 v169, a201
  v_accvgpr_read_b32 v170, a202
  v_accvgpr_read_b32 v171, a203
  v_accvgpr_read_b32 v172, a204
  v_accvgpr_read_b32 v173, a205
  v_accvgpr_read_b32 v174, a206
  v_accvgpr_read_b32 v175, a207
  v_pk_add_f32 v[160:161], v[160:161], v[144:145]
  v_pk_add_f32 v[162:163], v[162:163], v[146:147]
  v_pk_add_f32 v[164:165], v[164:165], v[148:149]
  v_pk_add_f32 v[166:167], v[166:167], v[150:151]
  v_pk_add_f32 v[168:169], v[168:169], v[152:153]
  v_pk_add_f32 v[170:171], v[170:171], v[154:155]
  v_pk_add_f32 v[172:173], v[172:173], v[156:157]
  v_pk_add_f32 v[174:175], v[174:175], v[158:159]
  v_pk_mul_f32 v[176:177], v[160:161], v[160:161]
  v_pk_mul_f32 v[178:179], v[162:163], v[162:163]
  v_pk_mul_f32 v[180:181], v[164:165], v[164:165]
  v_pk_mul_f32 v[182:183], v[166:167], v[166:167]
  v_pk_mul_f32 v[184:185], v[168:169], v[168:169]
  v_pk_mul_f32 v[186:187], v[170:171], v[170:171]
  v_pk_mul_f32 v[188:189], v[172:173], v[172:173]
  v_pk_mul_f32 v[190:191], v[174:175], v[174:175]
  v_pk_fma_f32 v[176:177], v[176:177], s[62:63], v[14:15] op_sel_hi:[1,1,0]
  v_pk_fma_f32 v[178:179], v[178:179], s[62:63], v[14:15] op_sel_hi:[1,1,0]
  v_pk_fma_f32 v[180:181], v[180:181], s[62:63], v[14:15] op_sel_hi:[1,1,0]
  v_pk_fma_f32 v[182:183], v[182:183], s[62:63], v[14:15] op_sel_hi:[1,1,0]
  v_pk_fma_f32 v[184:185], v[184:185], s[62:63], v[14:15] op_sel_hi:[1,1,0]
  v_pk_fma_f32 v[186:187], v[186:187], s[62:63], v[14:15] op_sel_hi:[1,1,0]
  v_pk_fma_f32 v[188:189], v[188:189], s[62:63], v[14:15] op_sel_hi:[1,1,0]
  v_pk_fma_f32 v[190:191], v[190:191], s[62:63], v[14:15] op_sel_hi:[1,1,0]
  v_pk_mul_f32 v[176:177], v[176:177], v[160:161]
  v_pk_mul_f32 v[178:179], v[178:179], v[162:163]
  v_pk_mul_f32 v[180:181], v[180:181], v[164:165]
  v_pk_mul_f32 v[182:183], v[182:183], v[166:167]
  v_pk_mul_f32 v[184:185], v[184:185], v[168:169]
  v_pk_mul_f32 v[186:187], v[186:187], v[170:171]
  v_pk_mul_f32 v[188:189], v[188:189], v[172:173]
  v_pk_mul_f32 v[190:191], v[190:191], v[174:175]
  v_exp_f32 v176, v176
  v_exp_f32 v177, v177
  v_exp_f32 v178, v178
  v_exp_f32 v179, v179
  v_exp_f32 v180, v180
  v_exp_f32 v181, v181
  v_exp_f32 v182, v182
  v_exp_f32 v183, v183
  v_exp_f32 v184, v184
  v_exp_f32 v185, v185
  v_exp_f32 v186, v186
  v_exp_f32 v187, v187
  v_exp_f32 v188, v188
  v_exp_f32 v189, v189
  v_exp_f32 v190, v190
  v_exp_f32 v191, v191
  v_pk_add_f32 v[176:177], v[176:177], v[28:29]
  v_pk_add_f32 v[178:179], v[178:179], v[28:29]
  v_pk_add_f32 v[180:181], v[180:181], v[28:29]
  v_pk_add_f32 v[182:183], v[182:183], v[28:29]
  v_pk_add_f32 v[184:185], v[184:185], v[28:29]
  v_pk_add_f32 v[186:187], v[186:187], v[28:29]
  v_pk_add_f32 v[188:189], v[188:189], v[28:29]
  v_pk_add_f32 v[190:191], v[190:191], v[28:29]
  v_rcp_f32 v176, v176
  v_rcp_f32 v177, v177
  v_rcp_f32 v178, v178
  v_rcp_f32 v179, v179
  v_rcp_f32 v180, v180
  v_rcp_f32 v181, v181
  v_rcp_f32 v182, v182
  v_rcp_f32 v183, v183
  v_rcp_f32 v184, v184
  v_rcp_f32 v185, v185
  v_rcp_f32 v186, v186
  v_rcp_f32 v187, v187
  v_rcp_f32 v188, v188
  v_rcp_f32 v189, v189
  v_rcp_f32 v190, v190
  v_rcp_f32 v191, v191
  v_pk_mul_f32 v[160:161], v[160:161], v[176:177]
  v_pk_mul_f32 v[162:163], v[162:163], v[178:179]
  v_pk_mul_f32 v[164:165], v[164:165], v[180:181]
  v_pk_mul_f32 v[166:167], v[166:167], v[182:183]
  v_pk_mul_f32 v[168:169], v[168:169], v[184:185]
  v_pk_mul_f32 v[170:171], v[170:171], v[186:187]
  v_pk_mul_f32 v[172:173], v[172:173], v[188:189]
  v_pk_mul_f32 v[174:175], v[174:175], v[190:191]
  v_cvt_pk_bf16_f32 v96, v160, v161
  v_cvt_pk_bf16_f32 v97, v162, v163
  v_cvt_pk_bf16_f32 v98, v164, v165
  v_cvt_pk_bf16_f32 v99, v166, v167
  v_cvt_pk_bf16_f32 v100, v168, v169
  v_cvt_pk_bf16_f32 v101, v170, v171
  v_cvt_pk_bf16_f32 v102, v172, v173
  v_cvt_pk_bf16_f32 v103, v174, v175
  v_permlane32_swap_b32 v96, v98
  v_permlane32_swap_b32 v97, v99
  v_permlane32_swap_b32 v100, v102
  v_permlane32_swap_b32 v101, v103
  s_add_u32 s49, s85, 196608
  buffer_store_dwordx4 v[96:99], v26, s[28:31], s49 offen offset:0 sc1
  s_add_u32 s49, s85, 229376
  buffer_store_dwordx4 v[100:103], v26, s[28:31], s49 offen offset:0 sc1
  v_accvgpr_read_b32 v160, a208
  v_accvgpr_read_b32 v161, a209
  v_accvgpr_read_b32 v162, a210
  v_accvgpr_read_b32 v163, a211
  v_accvgpr_read_b32 v164, a212
  v_accvgpr_read_b32 v165, a213
  v_accvgpr_read_b32 v166, a214
  v_accvgpr_read_b32 v167, a215
  v_accvgpr_read_b32 v168, a216
  v_accvgpr_read_b32 v169, a217
  v_accvgpr_read_b32 v170, a218
  v_accvgpr_read_b32 v171, a219
  v_accvgpr_read_b32 v172, a220
  v_accvgpr_read_b32 v173, a221
  v_accvgpr_read_b32 v174, a222
  v_accvgpr_read_b32 v175, a223
  v_pk_add_f32 v[160:161], v[160:161], v[144:145]
  v_pk_add_f32 v[162:163], v[162:163], v[146:147]
  v_pk_add_f32 v[164:165], v[164:165], v[148:149]
  v_pk_add_f32 v[166:167], v[166:167], v[150:151]
  v_pk_add_f32 v[168:169], v[168:169], v[152:153]
  v_pk_add_f32 v[170:171], v[170:171], v[154:155]
  v_pk_add_f32 v[172:173], v[172:173], v[156:157]
  v_pk_add_f32 v[174:175], v[174:175], v[158:159]
  v_pk_mul_f32 v[176:177], v[160:161], v[160:161]
  v_pk_mul_f32 v[178:179], v[162:163], v[162:163]
  v_pk_mul_f32 v[180:181], v[164:165], v[164:165]
  v_pk_mul_f32 v[182:183], v[166:167], v[166:167]
  v_pk_mul_f32 v[184:185], v[168:169], v[168:169]
  v_pk_mul_f32 v[186:187], v[170:171], v[170:171]
  v_pk_mul_f32 v[188:189], v[172:173], v[172:173]
  v_pk_mul_f32 v[190:191], v[174:175], v[174:175]
  v_pk_fma_f32 v[176:177], v[176:177], s[62:63], v[14:15] op_sel_hi:[1,1,0]
  v_pk_fma_f32 v[178:179], v[178:179], s[62:63], v[14:15] op_sel_hi:[1,1,0]
  v_pk_fma_f32 v[180:181], v[180:181], s[62:63], v[14:15] op_sel_hi:[1,1,0]
  v_pk_fma_f32 v[182:183], v[182:183], s[62:63], v[14:15] op_sel_hi:[1,1,0]
  v_pk_fma_f32 v[184:185], v[184:185], s[62:63], v[14:15] op_sel_hi:[1,1,0]
  v_pk_fma_f32 v[186:187], v[186:187], s[62:63], v[14:15] op_sel_hi:[1,1,0]
  v_pk_fma_f32 v[188:189], v[188:189], s[62:63], v[14:15] op_sel_hi:[1,1,0]
  v_pk_fma_f32 v[190:191], v[190:191], s[62:63], v[14:15] op_sel_hi:[1,1,0]
  v_pk_mul_f32 v[176:177], v[176:177], v[160:161]
  v_pk_mul_f32 v[178:179], v[178:179], v[162:163]
  v_pk_mul_f32 v[180:181], v[180:181], v[164:165]
  v_pk_mul_f32 v[182:183], v[182:183], v[166:167]
  v_pk_mul_f32 v[184:185], v[184:185], v[168:169]
  v_pk_mul_f32 v[186:187], v[186:187], v[170:171]
  v_pk_mul_f32 v[188:189], v[188:189], v[172:173]
  v_pk_mul_f32 v[190:191], v[190:191], v[174:175]
  v_exp_f32 v176, v176
  v_exp_f32 v177, v177
  v_exp_f32 v178, v178
  v_exp_f32 v179, v179
  v_exp_f32 v180, v180
  v_exp_f32 v181, v181
  v_exp_f32 v182, v182
  v_exp_f32 v183, v183
  v_exp_f32 v184, v184
  v_exp_f32 v185, v185
  v_exp_f32 v186, v186
  v_exp_f32 v187, v187
  v_exp_f32 v188, v188
  v_exp_f32 v189, v189
  v_exp_f32 v190, v190
  v_exp_f32 v191, v191
  v_pk_add_f32 v[176:177], v[176:177], v[28:29]
  v_pk_add_f32 v[178:179], v[178:179], v[28:29]
  v_pk_add_f32 v[180:181], v[180:181], v[28:29]
  v_pk_add_f32 v[182:183], v[182:183], v[28:29]
  v_pk_add_f32 v[184:185], v[184:185], v[28:29]
  v_pk_add_f32 v[186:187], v[186:187], v[28:29]
  v_pk_add_f32 v[188:189], v[188:189], v[28:29]
  v_pk_add_f32 v[190:191], v[190:191], v[28:29]
  v_rcp_f32 v176, v176
  v_rcp_f32 v177, v177
  v_rcp_f32 v178, v178
  v_rcp_f32 v179, v179
  v_rcp_f32 v180, v180
  v_rcp_f32 v181, v181
  v_rcp_f32 v182, v182
  v_rcp_f32 v183, v183
  v_rcp_f32 v184, v184
  v_rcp_f32 v185, v185
  v_rcp_f32 v186, v186
  v_rcp_f32 v187, v187
  v_rcp_f32 v188, v188
  v_rcp_f32 v189, v189
  v_rcp_f32 v190, v190
  v_rcp_f32 v191, v191
  v_pk_mul_f32 v[160:161], v[160:161], v[176:177]
  v_pk_mul_f32 v[162:163], v[162:163], v[178:179]
  v_pk_mul_f32 v[164:165], v[164:165], v[180:181]
  v_pk_mul_f32 v[166:167], v[166:167], v[182:183]
  v_pk_mul_f32 v[168:169], v[168:169], v[184:185]
  v_pk_mul_f32 v[170:171], v[170:171], v[186:187]
  v_pk_mul_f32 v[172:173], v[172:173], v[188:189]
  v_pk_mul_f32 v[174:175], v[174:175], v[190:191]
  v_cvt_pk_bf16_f32 v104, v160, v161
  v_cvt_pk_bf16_f32 v105, v162, v163
  v_cvt_pk_bf16_f32 v106, v164, v165
  v_cvt_pk_bf16_f32 v107, v166, v167
  v_cvt_pk_bf16_f32 v108, v168, v169
  v_cvt_pk_bf16_f32 v109, v170, v171
  v_cvt_pk_bf16_f32 v110, v172, v173
  v_cvt_pk_bf16_f32 v111, v174, v175
  v_permlane32_swap_b32 v104, v106
  v_permlane32_swap_b32 v105, v107
  v_permlane32_swap_b32 v108, v110
  v_permlane32_swap_b32 v109, v111
  s_add_u32 s49, s85, 196608
  buffer_store_dwordx4 v[104:107], v26, s[28:31], s49 offen offset:1024 sc1
  s_add_u32 s49, s85, 229376
  buffer_store_dwordx4 v[108:111], v26, s[28:31], s49 offen offset:1024 sc1
  v_accvgpr_read_b32 v160, a224
  v_accvgpr_read_b32 v161, a225
  v_accvgpr_read_b32 v162, a226
  v_accvgpr_read_b32 v163, a227
  v_accvgpr_read_b32 v164, a228
  v_accvgpr_read_b32 v165, a229
  v_accvgpr_read_b32 v166, a230
  v_accvgpr_read_b32 v167, a231
  v_accvgpr_read_b32 v168, a232
  v_accvgpr_read_b32 v169, a233
  v_accvgpr_read_b32 v170, a234
  v_accvgpr_read_b32 v171, a235
  v_accvgpr_read_b32 v172, a236
  v_accvgpr_read_b32 v173, a237
  v_accvgpr_read_b32 v174, a238
  v_accvgpr_read_b32 v175, a239
  v_pk_add_f32 v[160:161], v[160:161], v[144:145]
  v_pk_add_f32 v[162:163], v[162:163], v[146:147]
  v_pk_add_f32 v[164:165], v[164:165], v[148:149]
  v_pk_add_f32 v[166:167], v[166:167], v[150:151]
  v_pk_add_f32 v[168:169], v[168:169], v[152:153]
  v_pk_add_f32 v[170:171], v[170:171], v[154:155]
  v_pk_add_f32 v[172:173], v[172:173], v[156:157]
  v_pk_add_f32 v[174:175], v[174:175], v[158:159]
  v_pk_mul_f32 v[176:177], v[160:161], v[160:161]
  v_pk_mul_f32 v[178:179], v[162:163], v[162:163]
  v_pk_mul_f32 v[180:181], v[164:165], v[164:165]
  v_pk_mul_f32 v[182:183], v[166:167], v[166:167]
  v_pk_mul_f32 v[184:185], v[168:169], v[168:169]
  v_pk_mul_f32 v[186:187], v[170:171], v[170:171]
  v_pk_mul_f32 v[188:189], v[172:173], v[172:173]
  v_pk_mul_f32 v[190:191], v[174:175], v[174:175]
  v_pk_fma_f32 v[176:177], v[176:177], s[62:63], v[14:15] op_sel_hi:[1,1,0]
  v_pk_fma_f32 v[178:179], v[178:179], s[62:63], v[14:15] op_sel_hi:[1,1,0]
  v_pk_fma_f32 v[180:181], v[180:181], s[62:63], v[14:15] op_sel_hi:[1,1,0]
  v_pk_fma_f32 v[182:183], v[182:183], s[62:63], v[14:15] op_sel_hi:[1,1,0]
  v_pk_fma_f32 v[184:185], v[184:185], s[62:63], v[14:15] op_sel_hi:[1,1,0]
  v_pk_fma_f32 v[186:187], v[186:187], s[62:63], v[14:15] op_sel_hi:[1,1,0]
  v_pk_fma_f32 v[188:189], v[188:189], s[62:63], v[14:15] op_sel_hi:[1,1,0]
  v_pk_fma_f32 v[190:191], v[190:191], s[62:63], v[14:15] op_sel_hi:[1,1,0]
  v_pk_mul_f32 v[176:177], v[176:177], v[160:161]
  v_pk_mul_f32 v[178:179], v[178:179], v[162:163]
  v_pk_mul_f32 v[180:181], v[180:181], v[164:165]
  v_pk_mul_f32 v[182:183], v[182:183], v[166:167]
  v_pk_mul_f32 v[184:185], v[184:185], v[168:169]
  v_pk_mul_f32 v[186:187], v[186:187], v[170:171]
  v_pk_mul_f32 v[188:189], v[188:189], v[172:173]
  v_pk_mul_f32 v[190:191], v[190:191], v[174:175]
  v_exp_f32 v176, v176
  v_exp_f32 v177, v177
  v_exp_f32 v178, v178
  v_exp_f32 v179, v179
  v_exp_f32 v180, v180
  v_exp_f32 v181, v181
  v_exp_f32 v182, v182
  v_exp_f32 v183, v183
  v_exp_f32 v184, v184
  v_exp_f32 v185, v185
  v_exp_f32 v186, v186
  v_exp_f32 v187, v187
  v_exp_f32 v188, v188
  v_exp_f32 v189, v189
  v_exp_f32 v190, v190
  v_exp_f32 v191, v191
  v_pk_add_f32 v[176:177], v[176:177], v[28:29]
  v_pk_add_f32 v[178:179], v[178:179], v[28:29]
  v_pk_add_f32 v[180:181], v[180:181], v[28:29]
  v_pk_add_f32 v[182:183], v[182:183], v[28:29]
  v_pk_add_f32 v[184:185], v[184:185], v[28:29]
  v_pk_add_f32 v[186:187], v[186:187], v[28:29]
  v_pk_add_f32 v[188:189], v[188:189], v[28:29]
  v_pk_add_f32 v[190:191], v[190:191], v[28:29]
  v_rcp_f32 v176, v176
  v_rcp_f32 v177, v177
  v_rcp_f32 v178, v178
  v_rcp_f32 v179, v179
  v_rcp_f32 v180, v180
  v_rcp_f32 v181, v181
  v_rcp_f32 v182, v182
  v_rcp_f32 v183, v183
  v_rcp_f32 v184, v184
  v_rcp_f32 v185, v185
  v_rcp_f32 v186, v186
  v_rcp_f32 v187, v187
  v_rcp_f32 v188, v188
  v_rcp_f32 v189, v189
  v_rcp_f32 v190, v190
  v_rcp_f32 v191, v191
  v_pk_mul_f32 v[160:161], v[160:161], v[176:177]
  v_pk_mul_f32 v[162:163], v[162:163], v[178:179]
  v_pk_mul_f32 v[164:165], v[164:165], v[180:181]
  v_pk_mul_f32 v[166:167], v[166:167], v[182:183]
  v_pk_mul_f32 v[168:169], v[168:169], v[184:185]
  v_pk_mul_f32 v[170:171], v[170:171], v[186:187]
  v_pk_mul_f32 v[172:173], v[172:173], v[188:189]
  v_pk_mul_f32 v[174:175], v[174:175], v[190:191]
  v_cvt_pk_bf16_f32 v96, v160, v161
  v_cvt_pk_bf16_f32 v97, v162, v163
  v_cvt_pk_bf16_f32 v98, v164, v165
  v_cvt_pk_bf16_f32 v99, v166, v167
  v_cvt_pk_bf16_f32 v100, v168, v169
  v_cvt_pk_bf16_f32 v101, v170, v171
  v_cvt_pk_bf16_f32 v102, v172, v173
  v_cvt_pk_bf16_f32 v103, v174, v175
  v_permlane32_swap_b32 v96, v98
  v_permlane32_swap_b32 v97, v99
  v_permlane32_swap_b32 v100, v102
  v_permlane32_swap_b32 v101, v103
  s_add_u32 s49, s85, 196608
  buffer_store_dwordx4 v[96:99], v26, s[28:31], s49 offen offset:2048 sc1
  s_add_u32 s49, s85, 229376
  buffer_store_dwordx4 v[100:103], v26, s[28:31], s49 offen offset:2048 sc1
  v_accvgpr_read_b32 v160, a240
  v_accvgpr_read_b32 v161, a241
  v_accvgpr_read_b32 v162, a242
  v_accvgpr_read_b32 v163, a243
  v_accvgpr_read_b32 v164, a244
  v_accvgpr_read_b32 v165, a245
  v_accvgpr_read_b32 v166, a246
  v_accvgpr_read_b32 v167, a247
  v_accvgpr_read_b32 v168, a248
  v_accvgpr_read_b32 v169, a249
  v_accvgpr_read_b32 v170, a250
  v_accvgpr_read_b32 v171, a251
  v_accvgpr_read_b32 v172, a252
  v_accvgpr_read_b32 v173, a253
  v_accvgpr_read_b32 v174, a254
  v_accvgpr_read_b32 v175, a255
  v_pk_add_f32 v[160:161], v[160:161], v[144:145]
  v_pk_add_f32 v[162:163], v[162:163], v[146:147]
  v_pk_add_f32 v[164:165], v[164:165], v[148:149]
  v_pk_add_f32 v[166:167], v[166:167], v[150:151]
  v_pk_add_f32 v[168:169], v[168:169], v[152:153]
  v_pk_add_f32 v[170:171], v[170:171], v[154:155]
  v_pk_add_f32 v[172:173], v[172:173], v[156:157]
  v_pk_add_f32 v[174:175], v[174:175], v[158:159]
  v_pk_mul_f32 v[176:177], v[160:161], v[160:161]
  v_pk_mul_f32 v[178:179], v[162:163], v[162:163]
  v_pk_mul_f32 v[180:181], v[164:165], v[164:165]
  v_pk_mul_f32 v[182:183], v[166:167], v[166:167]
  v_pk_mul_f32 v[184:185], v[168:169], v[168:169]
  v_pk_mul_f32 v[186:187], v[170:171], v[170:171]
  v_pk_mul_f32 v[188:189], v[172:173], v[172:173]
  v_pk_mul_f32 v[190:191], v[174:175], v[174:175]
  v_pk_fma_f32 v[176:177], v[176:177], s[62:63], v[14:15] op_sel_hi:[1,1,0]
  v_pk_fma_f32 v[178:179], v[178:179], s[62:63], v[14:15] op_sel_hi:[1,1,0]
  v_pk_fma_f32 v[180:181], v[180:181], s[62:63], v[14:15] op_sel_hi:[1,1,0]
  v_pk_fma_f32 v[182:183], v[182:183], s[62:63], v[14:15] op_sel_hi:[1,1,0]
  v_pk_fma_f32 v[184:185], v[184:185], s[62:63], v[14:15] op_sel_hi:[1,1,0]
  v_pk_fma_f32 v[186:187], v[186:187], s[62:63], v[14:15] op_sel_hi:[1,1,0]
  v_pk_fma_f32 v[188:189], v[188:189], s[62:63], v[14:15] op_sel_hi:[1,1,0]
  v_pk_fma_f32 v[190:191], v[190:191], s[62:63], v[14:15] op_sel_hi:[1,1,0]
  v_pk_mul_f32 v[176:177], v[176:177], v[160:161]
  v_pk_mul_f32 v[178:179], v[178:179], v[162:163]
  v_pk_mul_f32 v[180:181], v[180:181], v[164:165]
  v_pk_mul_f32 v[182:183], v[182:183], v[166:167]
  v_pk_mul_f32 v[184:185], v[184:185], v[168:169]
  v_pk_mul_f32 v[186:187], v[186:187], v[170:171]
  v_pk_mul_f32 v[188:189], v[188:189], v[172:173]
  v_pk_mul_f32 v[190:191], v[190:191], v[174:175]
  v_exp_f32 v176, v176
  v_exp_f32 v177, v177
  v_exp_f32 v178, v178
  v_exp_f32 v179, v179
  v_exp_f32 v180, v180
  v_exp_f32 v181, v181
  v_exp_f32 v182, v182
  v_exp_f32 v183, v183
  v_exp_f32 v184, v184
  v_exp_f32 v185, v185
  v_exp_f32 v186, v186
  v_exp_f32 v187, v187
  v_exp_f32 v188, v188
  v_exp_f32 v189, v189
  v_exp_f32 v190, v190
  v_exp_f32 v191, v191
  v_pk_add_f32 v[176:177], v[176:177], v[28:29]
  v_pk_add_f32 v[178:179], v[178:179], v[28:29]
  v_pk_add_f32 v[180:181], v[180:181], v[28:29]
  v_pk_add_f32 v[182:183], v[182:183], v[28:29]
  v_pk_add_f32 v[184:185], v[184:185], v[28:29]
  v_pk_add_f32 v[186:187], v[186:187], v[28:29]
  v_pk_add_f32 v[188:189], v[188:189], v[28:29]
  v_pk_add_f32 v[190:191], v[190:191], v[28:29]
  v_rcp_f32 v176, v176
  v_rcp_f32 v177, v177
  v_rcp_f32 v178, v178
  v_rcp_f32 v179, v179
  v_rcp_f32 v180, v180
  v_rcp_f32 v181, v181
  v_rcp_f32 v182, v182
  v_rcp_f32 v183, v183
  v_rcp_f32 v184, v184
  v_rcp_f32 v185, v185
  v_rcp_f32 v186, v186
  v_rcp_f32 v187, v187
  v_rcp_f32 v188, v188
  v_rcp_f32 v189, v189
  v_rcp_f32 v190, v190
  v_rcp_f32 v191, v191
  v_pk_mul_f32 v[160:161], v[160:161], v[176:177]
  v_pk_mul_f32 v[162:163], v[162:163], v[178:179]
  v_pk_mul_f32 v[164:165], v[164:165], v[180:181]
  v_pk_mul_f32 v[166:167], v[166:167], v[182:183]
  v_pk_mul_f32 v[168:169], v[168:169], v[184:185]
  v_pk_mul_f32 v[170:171], v[170:171], v[186:187]
  v_pk_mul_f32 v[172:173], v[172:173], v[188:189]
  v_pk_mul_f32 v[174:175], v[174:175], v[190:191]
  v_cvt_pk_bf16_f32 v104, v160, v161
  v_cvt_pk_bf16_f32 v105, v162, v163
  v_cvt_pk_bf16_f32 v106, v164, v165
  v_cvt_pk_bf16_f32 v107, v166, v167
  v_cvt_pk_bf16_f32 v108, v168, v169
  v_cvt_pk_bf16_f32 v109, v170, v171
  v_cvt_pk_bf16_f32 v110, v172, v173
  v_cvt_pk_bf16_f32 v111, v174, v175
  v_permlane32_swap_b32 v104, v106
  v_permlane32_swap_b32 v105, v107
  v_permlane32_swap_b32 v108, v110
  v_permlane32_swap_b32 v109, v111
  s_add_u32 s49, s85, 196608
  buffer_store_dwordx4 v[104:107], v26, s[28:31], s49 offen offset:3072 sc1
  s_add_u32 s49, s85, 229376
  buffer_store_dwordx4 v[108:111], v26, s[28:31], s49 offen offset:3072 sc1
  s_add_u32 s86, s82, 32
  s_waitcnt vmcnt(0)
  s_barrier
  s_cmp_lg_u32 s58, 0
  s_cbranch_scc1 sg_59
  v_mov_b32 v26, 1
  s_mov_b64 exec, 1
  s_lshl_b32 s61, s86, 7
  s_add_u32 s61, s61, 99614720
  buffer_atomic_add v26, v255, s[28:31], s61 offen sc1
  s_mov_b64 exec, -1
sg_59:
  s_nop 0
  s_branch w_next
w_g5e:
  s_add_u32 s86, s82, 40
  s_lshl_b32 s61, s86, 7
  s_add_u32 s61, s61, 99614720
  s_cmp_lg_u32 s58, 0
  s_cbranch_scc1 wf_60_ok
wf_60:
  buffer_load_dword v26, v255, s[28:31], s61 offen sc1
  s_waitcnt vmcnt(0)
  v_readfirstlane_b32 s62, v26
  s_nop 3
  s_cmp_ge_u32 s62, 4
  s_cbranch_scc1 wf_60_ok
  s_sub_u32 s88, s88, 1
  s_cselect_b32 s88, 0, s88
  s_cbranch_scc1 wf_60_ok
  s_sleep 3
  s_branch wf_60
wf_60_ok:
  s_barrier
  s_nop 0
  s_lshl_b32 s89, s82, 1
  s_add_u32 s89, s89, s60
  s_lshl_b32 s87, s89, 12
  s_lshl_b32 s89, s89, 18
  s_lshl_b32 s85, s83, 1
  s_add_u32 s85, s85, s59
  s_lshl_b32 s86, s85, 19
  s_lshl_b32 s85, s85, 8
  s_add_u32 s89, s89, s85
  s_add_u32 s85, s86, s87
  s_add_u32 s85, s85, 67108864
  s_mov_b32 s32, s4
  s_mov_b32 s33, s5
  s_mov_b32 s34, 4194304
  s_mov_b32 s35, 0x20000
  s_mov_b32 s36, s24
  s_mov_b32 s37, s25
  s_mov_b32 s38, 4194304
  s_mov_b32 s39, 0x20000
  v_and_b32 v27, 31, v1
  v_mul_u32_u24 v26, 2048, v27
  v_lshrrev_b32 v27, 5, v1
  v_lshl_add_u32 v26, v27, 4, v26
  v_add_u32 v14, 0, v26
  v_add_u32 v15, 65536, v26
  v_add_u32 v16, 131072, v26
  v_add_u32 v17, 196608, v26
  v_and_b32 v27, 31, v1
  v_lshlrev_b32 v18, 5, v27
  v_lshrrev_b32 v27, 5, v1
  v_lshl_add_u32 v18, v27, 4, v18
  buffer_load_dwordx4 v[112:115], v14, s[32:35], s89 offen offset:0
  s_add_u32 s49, s85, 0
  buffer_load_dwordx4 v[120:123], v18, s[28:31], s49 offen offset:0 sc1
  buffer_load_dwordx4 v[116:119], v14, s[32:35], s89 offen offset:32
  s_add_u32 s49, s85, 65536
  buffer_load_dwordx4 v[124:127], v18, s[28:31], s49 offen offset:0 sc1
  buffer_load_dwordx4 v[128:131], v14, s[32:35], s89 offen offset:64
  s_add_u32 s49, s85, 131072
  buffer_load_dwordx4 v[136:139], v18, s[28:31], s49 offen offset:0 sc1
  buffer_load_dwordx4 v[132:135], v14, s[32:35], s89 offen offset:96
  s_add_u32 s49, s85, 196608
  buffer_load_dwordx4 v[140:143], v18, s[28:31], s49 offen offset:0 sc1
  buffer_load_dwordx4 v[144:147], v14, s[32:35], s89 offen offset:128
  s_add_u32 s49, s85, 262144
  buffer_load_dwordx4 v[152:155], v18, s[28:31], s49 offen offset:0 sc1
  buffer_load_dwordx4 v[148:151], v14, s[32:35], s89 offen offset:160
  s_add_u32 s49, s85, 327680
  buffer_load_dwordx4 v[156:159], v18, s[28:31], s49 offen offset:0 sc1
  buffer_load_dwordx4 v[160:163], v14, s[32:35], s89 offen offset:192
  s_add_u32 s49, s85, 393216
  buffer_load_dwordx4 v[168:171], v18, s[28:31], s49 offen offset:0 sc1
  buffer_load_dwordx4 v[164:167], v14, s[32:35], s89 offen offset:224
  s_add_u32 s49, s85, 458752
  buffer_load_dwordx4 v[172:175], v18, s[28:31], s49 offen offset:0 sc1
  v_accvgpr_read_b32 v176, a0
  v_accvgpr_read_b32 v177, a1
  v_accvgpr_read_b32 v178, a2
  v_accvgpr_read_b32 v179, a3
  v_accvgpr_read_b32 v180, a4
  v_accvgpr_read_b32 v181, a5
  v_accvgpr_read_b32 v182, a6
  v_accvgpr_read_b32 v183, a7
  v_accvgpr_read_b32 v184, a8
  v_accvgpr_read_b32 v185, a9
  v_accvgpr_read_b32 v186, a10
  v_accvgpr_read_b32 v187, a11
  v_accvgpr_read_b32 v188, a12
  v_accvgpr_read_b32 v189, a13
  v_accvgpr_read_b32 v190, a14
  v_accvgpr_read_b32 v191, a15
  v_cvt_pk_bf16_f32 v96, v176, v177
  v_cvt_pk_bf16_f32 v97, v178, v179
  v_cvt_pk_bf16_f32 v98, v180, v181
  v_cvt_pk_bf16_f32 v99, v182, v183
  v_cvt_pk_bf16_f32 v100, v184, v185
  v_cvt_pk_bf16_f32 v101, v186, v187
  v_cvt_pk_bf16_f32 v102, v188, v189
  v_cvt_pk_bf16_f32 v103, v190, v191
  v_permlane32_swap_b32 v96, v98
  v_permlane32_swap_b32 v97, v99
  v_permlane32_swap_b32 v100, v102
  v_permlane32_swap_b32 v101, v103
  s_waitcnt vmcnt(12)
  v_lshlrev_b32 v26, 16, v96
  v_and_b32 v27, 0xffff0000, v96
  v_lshlrev_b32 v28, 16, v120
  v_and_b32 v29, 0xffff0000, v120
  v_pk_mul_f32 v[26:27], v[26:27], v[28:29]
  v_cvt_pk_bf16_f32 v28, v26, v27
  v_lshlrev_b32 v26, 16, v28
  v_and_b32 v27, 0xffff0000, v28
  v_lshlrev_b32 v30, 16, v112
  v_and_b32 v31, 0xffff0000, v112
  v_pk_add_f32 v[26:27], v[26:27], v[30:31]
  v_cvt_pk_bf16_f32 v96, v26, v27
  v_lshlrev_b32 v26, 16, v97
  v_and_b32 v27, 0xffff0000, v97
  v_lshlrev_b32 v28, 16, v121
  v_and_b32 v29, 0xffff0000, v121
  v_pk_mul_f32 v[26:27], v[26:27], v[28:29]
  v_cvt_pk_bf16_f32 v28, v26, v27
  v_lshlrev_b32 v26, 16, v28
  v_and_b32 v27, 0xffff0000, v28
  v_lshlrev_b32 v30, 16, v113
  v_and_b32 v31, 0xffff0000, v113
  v_pk_add_f32 v[26:27], v[26:27], v[30:31]
  v_cvt_pk_bf16_f32 v97, v26, v27
  v_lshlrev_b32 v26, 16, v98
  v_and_b32 v27, 0xffff0000, v98
  v_lshlrev_b32 v28, 16, v122
  v_and_b32 v29, 0xffff0000, v122
  v_pk_mul_f32 v[26:27], v[26:27], v[28:29]
  v_cvt_pk_bf16_f32 v28, v26, v27
  v_lshlrev_b32 v26, 16, v28
  v_and_b32 v27, 0xffff0000, v28
  v_lshlrev_b32 v30, 16, v114
  v_and_b32 v31, 0xffff0000, v114
  v_pk_add_f32 v[26:27], v[26:27], v[30:31]
  v_cvt_pk_bf16_f32 v98, v26, v27
  v_lshlrev_b32 v26, 16, v99
  v_and_b32 v27, 0xffff0000, v99
  v_lshlrev_b32 v28, 16, v123
  v_and_b32 v29, 0xffff0000, v123
  v_pk_mul_f32 v[26:27], v[26:27], v[28:29]
  v_cvt_pk_bf16_f32 v28, v26, v27
  v_lshlrev_b32 v26, 16, v28
  v_and_b32 v27, 0xffff0000, v28
  v_lshlrev_b32 v30, 16, v115
  v_and_b32 v31, 0xffff0000, v115
  v_pk_add_f32 v[26:27], v[26:27], v[30:31]
  v_cvt_pk_bf16_f32 v99, v26, v27
  v_lshlrev_b32 v26, 16, v100
  v_and_b32 v27, 0xffff0000, v100
  v_lshlrev_b32 v28, 16, v124
  v_and_b32 v29, 0xffff0000, v124
  v_pk_mul_f32 v[26:27], v[26:27], v[28:29]
  v_cvt_pk_bf16_f32 v28, v26, v27
  v_lshlrev_b32 v26, 16, v28
  v_and_b32 v27, 0xffff0000, v28
  v_lshlrev_b32 v30, 16, v116
  v_and_b32 v31, 0xffff0000, v116
  v_pk_add_f32 v[26:27], v[26:27], v[30:31]
  v_cvt_pk_bf16_f32 v100, v26, v27
  v_lshlrev_b32 v26, 16, v101
  v_and_b32 v27, 0xffff0000, v101
  v_lshlrev_b32 v28, 16, v125
  v_and_b32 v29, 0xffff0000, v125
  v_pk_mul_f32 v[26:27], v[26:27], v[28:29]
  v_cvt_pk_bf16_f32 v28, v26, v27
  v_lshlrev_b32 v26, 16, v28
  v_and_b32 v27, 0xffff0000, v28
  v_lshlrev_b32 v30, 16, v117
  v_and_b32 v31, 0xffff0000, v117
  v_pk_add_f32 v[26:27], v[26:27], v[30:31]
  v_cvt_pk_bf16_f32 v101, v26, v27
  v_lshlrev_b32 v26, 16, v102
  v_and_b32 v27, 0xffff0000, v102
  v_lshlrev_b32 v28, 16, v126
  v_and_b32 v29, 0xffff0000, v126
  v_pk_mul_f32 v[26:27], v[26:27], v[28:29]
  v_cvt_pk_bf16_f32 v28, v26, v27
  v_lshlrev_b32 v26, 16, v28
  v_and_b32 v27, 0xffff0000, v28
  v_lshlrev_b32 v30, 16, v118
  v_and_b32 v31, 0xffff0000, v118
  v_pk_add_f32 v[26:27], v[26:27], v[30:31]
  v_cvt_pk_bf16_f32 v102, v26, v27
  v_lshlrev_b32 v26, 16, v103
  v_and_b32 v27, 0xffff0000, v103
  v_lshlrev_b32 v28, 16, v127
  v_and_b32 v29, 0xffff0000, v127
  v_pk_mul_f32 v[26:27], v[26:27], v[28:29]
  v_cvt_pk_bf16_f32 v28, v26, v27
  v_lshlrev_b32 v26, 16, v28
  v_and_b32 v27, 0xffff0000, v28
  v_lshlrev_b32 v30, 16, v119
  v_and_b32 v31, 0xffff0000, v119
  v_pk_add_f32 v[26:27], v[26:27], v[30:31]
  v_cvt_pk_bf16_f32 v103, v26, v27
  buffer_store_dwordx4 v[96:99], v14, s[36:39], s89 offen offset:0
  buffer_store_dwordx4 v[100:103], v14, s[36:39], s89 offen offset:32
  buffer_load_dwordx4 v[112:115], v15, s[32:35], s89 offen offset:0
  s_add_u32 s49, s85, 0
  buffer_load_dwordx4 v[120:123], v18, s[28:31], s49 offen offset:1024 sc1
  buffer_load_dwordx4 v[116:119], v15, s[32:35], s89 offen offset:32
  s_add_u32 s49, s85, 65536
  buffer_load_dwordx4 v[124:127], v18, s[28:31], s49 offen offset:1024 sc1
  v_accvgpr_read_b32 v176, a64
  v_accvgpr_read_b32 v177, a65
  v_accvgpr_read_b32 v178, a66
  v_accvgpr_read_b32 v179, a67
  v_accvgpr_read_b32 v180, a68
  v_accvgpr_read_b32 v181, a69
  v_accvgpr_read_b32 v182, a70
  v_accvgpr_read_b32 v183, a71
  v_accvgpr_read_b32 v184, a72
  v_accvgpr_read_b32 v185, a73
  v_accvgpr_read_b32 v186, a74
  v_accvgpr_read_b32 v187, a75
  v_accvgpr_read_b32 v188, a76
  v_accvgpr_read_b32 v189, a77
  v_accvgpr_read_b32 v190, a78
  v_accvgpr_read_b32 v191, a79
  v_cvt_pk_bf16_f32 v104, v176, v177
  v_cvt_pk_bf16_f32 v105, v178, v179
  v_cvt_pk_bf16_f32 v106, v180, v181
  v_cvt_pk_bf16_f32 v107, v182, v183
  v_cvt_pk_bf16_f32 v108, v184, v185
  v_cvt_pk_bf16_f32 v109, v186, v187
  v_cvt_pk_bf16_f32 v110, v188, v189
  v_cvt_pk_bf16_f32 v111, v190, v191
  v_permlane32_swap_b32 v104, v106
  v_permlane32_swap_b32 v105, v107
  v_permlane32_swap_b32 v108, v110
  v_permlane32_swap_b32 v109, v111
  s_waitcnt vmcnt(14)
  v_lshlrev_b32 v26, 16, v104
  v_and_b32 v27, 0xffff0000, v104
  v_lshlrev_b32 v28, 16, v136
  v_and_b32 v29, 0xffff0000, v136
  v_pk_mul_f32 v[26:27], v[26:27], v[28:29]
  v_cvt_pk_bf16_f32 v28, v26, v27
  v_lshlrev_b32 v26, 16, v28
  v_and_b32 v27, 0xffff0000, v28
  v_lshlrev_b32 v30, 16, v128
  v_and_b32 v31, 0xffff0000, v128
  v_pk_add_f32 v[26:27], v[26:27], v[30:31]
  v_cvt_pk_bf16_f32 v104, v26, v27
  v_lshlrev_b32 v26, 16, v105
  v_and_b32 v27, 0xffff0000, v105
  v_lshlrev_b32 v28, 16, v137
  v_and_b32 v29, 0xffff0000, v137
  v_pk_mul_f32 v[26:27], v[26:27], v[28:29]
  v_cvt_pk_bf16_f32 v28, v26, v27
  v_lshlrev_b32 v26, 16, v28
  v_and_b32 v27, 0xffff0000, v28
  v_lshlrev_b32 v30, 16, v129
  v_and_b32 v31, 0xffff0000, v129
  v_pk_add_f32 v[26:27], v[26:27], v[30:31]
  v_cvt_pk_bf16_f32 v105, v26, v27
  v_lshlrev_b32 v26, 16, v106
  v_and_b32 v27, 0xffff0000, v106
  v_lshlrev_b32 v28, 16, v138
  v_and_b32 v29, 0xffff0000, v138
  v_pk_mul_f32 v[26:27], v[26:27], v[28:29]
  v_cvt_pk_bf16_f32 v28, v26, v27
  v_lshlrev_b32 v26, 16, v28
  v_and_b32 v27, 0xffff0000, v28
  v_lshlrev_b32 v30, 16, v130
  v_and_b32 v31, 0xffff0000, v130
  v_pk_add_f32 v[26:27], v[26:27], v[30:31]
  v_cvt_pk_bf16_f32 v106, v26, v27
  v_lshlrev_b32 v26, 16, v107
  v_and_b32 v27, 0xffff0000, v107
  v_lshlrev_b32 v28, 16, v139
  v_and_b32 v29, 0xffff0000, v139
  v_pk_mul_f32 v[26:27], v[26:27], v[28:29]
  v_cvt_pk_bf16_f32 v28, v26, v27
  v_lshlrev_b32 v26, 16, v28
  v_and_b32 v27, 0xffff0000, v28
  v_lshlrev_b32 v30, 16, v131
  v_and_b32 v31, 0xffff0000, v131
  v_pk_add_f32 v[26:27], v[26:27], v[30:31]
  v_cvt_pk_bf16_f32 v107, v26, v27
  v_lshlrev_b32 v26, 16, v108
  v_and_b32 v27, 0xffff0000, v108
  v_lshlrev_b32 v28, 16, v140
  v_and_b32 v29, 0xffff0000, v140
  v_pk_mul_f32 v[26:27], v[26:27], v[28:29]
  v_cvt_pk_bf16_f32 v28, v26, v27
  v_lshlrev_b32 v26, 16, v28
  v_and_b32 v27, 0xffff0000, v28
  v_lshlrev_b32 v30, 16, v132
  v_and_b32 v31, 0xffff0000, v132
  v_pk_add_f32 v[26:27], v[26:27], v[30:31]
  v_cvt_pk_bf16_f32 v108, v26, v27
  v_lshlrev_b32 v26, 16, v109
  v_and_b32 v27, 0xffff0000, v109
  v_lshlrev_b32 v28, 16, v141
  v_and_b32 v29, 0xffff0000, v141
  v_pk_mul_f32 v[26:27], v[26:27], v[28:29]
  v_cvt_pk_bf16_f32 v28, v26, v27
  v_lshlrev_b32 v26, 16, v28
  v_and_b32 v27, 0xffff0000, v28
  v_lshlrev_b32 v30, 16, v133
  v_and_b32 v31, 0xffff0000, v133
  v_pk_add_f32 v[26:27], v[26:27], v[30:31]
  v_cvt_pk_bf16_f32 v109, v26, v27
  v_lshlrev_b32 v26, 16, v110
  v_and_b32 v27, 0xffff0000, v110
  v_lshlrev_b32 v28, 16, v142
  v_and_b32 v29, 0xffff0000, v142
  v_pk_mul_f32 v[26:27], v[26:27], v[28:29]
  v_cvt_pk_bf16_f32 v28, v26, v27
  v_lshlrev_b32 v26, 16, v28
  v_and_b32 v27, 0xffff0000, v28
  v_lshlrev_b32 v30, 16, v134
  v_and_b32 v31, 0xffff0000, v134
  v_pk_add_f32 v[26:27], v[26:27], v[30:31]
  v_cvt_pk_bf16_f32 v110, v26, v27
  v_lshlrev_b32 v26, 16, v111
  v_and_b32 v27, 0xffff0000, v111
  v_lshlrev_b32 v28, 16, v143
  v_and_b32 v29, 0xffff0000, v143
  v_pk_mul_f32 v[26:27], v[26:27], v[28:29]
  v_cvt_pk_bf16_f32 v28, v26, v27
  v_lshlrev_b32 v26, 16, v28
  v_and_b32 v27, 0xffff0000, v28
  v_lshlrev_b32 v30, 16, v135
  v_and_b32 v31, 0xffff0000, v135
  v_pk_add_f32 v[26:27], v[26:27], v[30:31]
  v_cvt_pk_bf16_f32 v111, v26, v27
  buffer_store_dwordx4 v[104:107], v14, s[36:39], s89 offen offset:64
  buffer_store_dwordx4 v[108:111], v14, s[36:39], s89 offen offset:96
  buffer_load_dwordx4 v[128:131], v15, s[32:35], s89 offen offset:64
  s_add_u32 s49, s85, 131072
  buffer_load_dwordx4 v[136:139], v18, s[28:31], s49 offen offset:1024 sc1
  buffer_load_dwordx4 v[132:135], v15, s[32:35], s89 offen offset:96
  s_add_u32 s49, s85, 196608
  buffer_load_dwordx4 v[140:143], v18, s[28:31], s49 offen offset:1024 sc1
  v_accvgpr_read_b32 v176, a128
  v_accvgpr_read_b32 v177, a129
  v_accvgpr_read_b32 v178, a130
  v_accvgpr_read_b32 v179, a131
  v_accvgpr_read_b32 v180, a132
  v_accvgpr_read_b32 v181, a133
  v_accvgpr_read_b32 v182, a134
  v_accvgpr_read_b32 v183, a135
  v_accvgpr_read_b32 v184, a136
  v_accvgpr_read_b32 v185, a137
  v_accvgpr_read_b32 v186, a138
  v_accvgpr_read_b32 v187, a139
  v_accvgpr_read_b32 v188, a140
  v_accvgpr_read_b32 v189, a141
  v_accvgpr_read_b32 v190, a142
  v_accvgpr_read_b32 v191, a143
  v_cvt_pk_bf16_f32 v96, v176, v177
  v_cvt_pk_bf16_f32 v97, v178, v179
  v_cvt_pk_bf16_f32 v98, v180, v181
  v_cvt_pk_bf16_f32 v99, v182, v183
  v_cvt_pk_bf16_f32 v100, v184, v185
  v_cvt_pk_bf16_f32 v101, v186, v187
  v_cvt_pk_bf16_f32 v102, v188, v189
  v_cvt_pk_bf16_f32 v103, v190, v191
  v_permlane32_swap_b32 v96, v98
  v_permlane32_swap_b32 v97, v99
  v_permlane32_swap_b32 v100, v102
  v_permlane32_swap_b32 v101, v103
  s_waitcnt vmcnt(16)
  v_lshlrev_b32 v26, 16, v96
  v_and_b32 v27, 0xffff0000, v96
  v_lshlrev_b32 v28, 16, v152
  v_and_b32 v29, 0xffff0000, v152
  v_pk_mul_f32 v[26:27], v[26:27], v[28:29]
  v_cvt_pk_bf16_f32 v28, v26, v27
  v_lshlrev_b32 v26, 16, v28
  v_and_b32 v27, 0xffff0000, v28
  v_lshlrev_b32 v30, 16, v144
  v_and_b32 v31, 0xffff0000, v144
  v_pk_add_f32 v[26:27], v[26:27], v[30:31]
  v_cvt_pk_bf16_f32 v96, v26, v27
  v_lshlrev_b32 v26, 16, v97
  v_and_b32 v27, 0xffff0000, v97
  v_lshlrev_b32 v28, 16, v153
  v_and_b32 v29, 0xffff0000, v153
  v_pk_mul_f32 v[26:27], v[26:27], v[28:29]
  v_cvt_pk_bf16_f32 v28, v26, v27
  v_lshlrev_b32 v26, 16, v28
  v_and_b32 v27, 0xffff0000, v28
  v_lshlrev_b32 v30, 16, v145
  v_and_b32 v31, 0xffff0000, v145
  v_pk_add_f32 v[26:27], v[26:27], v[30:31]
  v_cvt_pk_bf16_f32 v97, v26, v27
  v_lshlrev_b32 v26, 16, v98
  v_and_b32 v27, 0xffff0000, v98
  v_lshlrev_b32 v28, 16, v154
  v_and_b32 v29, 0xffff0000, v154
  v_pk_mul_f32 v[26:27], v[26:27], v[28:29]
  v_cvt_pk_bf16_f32 v28, v26, v27
  v_lshlrev_b32 v26, 16, v28
  v_and_b32 v27, 0xffff0000, v28
  v_lshlrev_b32 v30, 16, v146
  v_and_b32 v31, 0xffff0000, v146
  v_pk_add_f32 v[26:27], v[26:27], v[30:31]
  v_cvt_pk_bf16_f32 v98, v26, v27
  v_lshlrev_b32 v26, 16, v99
  v_and_b32 v27, 0xffff0000, v99
  v_lshlrev_b32 v28, 16, v155
  v_and_b32 v29, 0xffff0000, v155
  v_pk_mul_f32 v[26:27], v[26:27], v[28:29]
  v_cvt_pk_bf16_f32 v28, v26, v27
  v_lshlrev_b32 v26, 16, v28
  v_and_b32 v27, 0xffff0000, v28
  v_lshlrev_b32 v30, 16, v147
  v_and_b32 v31, 0xffff0000, v147
  v_pk_add_f32 v[26:27], v[26:27], v[30:31]
  v_cvt_pk_bf16_f32 v99, v26, v27
  v_lshlrev_b32 v26, 16, v100
  v_and_b32 v27, 0xffff0000, v100
  v_lshlrev_b32 v28, 16, v156
  v_and_b32 v29, 0xffff0000, v156
  v_pk_mul_f32 v[26:27], v[26:27], v[28:29]
  v_cvt_pk_bf16_f32 v28, v26, v27
  v_lshlrev_b32 v26, 16, v28
  v_and_b32 v27, 0xffff0000, v28
  v_lshlrev_b32 v30, 16, v148
  v_and_b32 v31, 0xffff0000, v148
  v_pk_add_f32 v[26:27], v[26:27], v[30:31]
  v_cvt_pk_bf16_f32 v100, v26, v27
  v_lshlrev_b32 v26, 16, v101
  v_and_b32 v27, 0xffff0000, v101
  v_lshlrev_b32 v28, 16, v157
  v_and_b32 v29, 0xffff0000, v157
  v_pk_mul_f32 v[26:27], v[26:27], v[28:29]
  v_cvt_pk_bf16_f32 v28, v26, v27
  v_lshlrev_b32 v26, 16, v28
  v_and_b32 v27, 0xffff0000, v28
  v_lshlrev_b32 v30, 16, v149
  v_and_b32 v31, 0xffff0000, v149
  v_pk_add_f32 v[26:27], v[26:27], v[30:31]
  v_cvt_pk_bf16_f32 v101, v26, v27
  v_lshlrev_b32 v26, 16, v102
  v_and_b32 v27, 0xffff0000, v102
  v_lshlrev_b32 v28, 16, v158
  v_and_b32 v29, 0xffff0000, v158
  v_pk_mul_f32 v[26:27], v[26:27], v[28:29]
  v_cvt_pk_bf16_f32 v28, v26, v27
  v_lshlrev_b32 v26, 16, v28
  v_and_b32 v27, 0xffff0000, v28
  v_lshlrev_b32 v30, 16, v150
  v_and_b32 v31, 0xffff0000, v150
  v_pk_add_f32 v[26:27], v[26:27], v[30:31]
  v_cvt_pk_bf16_f32 v102, v26, v27
  v_lshlrev_b32 v26, 16, v103
  v_and_b32 v27, 0xffff0000, v103
  v_lshlrev_b32 v28, 16, v159
  v_and_b32 v29, 0xffff0000, v159
  v_pk_mul_f32 v[26:27], v[26:27], v[28:29]
  v_cvt_pk_bf16_f32 v28, v26, v27
  v_lshlrev_b32 v26, 16, v28
  v_and_b32 v27, 0xffff0000, v28
  v_lshlrev_b32 v30, 16, v151
  v_and_b32 v31, 0xffff0000, v151
  v_pk_add_f32 v[26:27], v[26:27], v[30:31]
  v_cvt_pk_bf16_f32 v103, v26, v27
  buffer_store_dwordx4 v[96:99], v14, s[36:39], s89 offen offset:128
  buffer_store_dwordx4 v[100:103], v14, s[36:39], s89 offen offset:160
  buffer_load_dwordx4 v[144:147], v15, s[32:35], s89 offen offset:128
  s_add_u32 s49, s85, 262144
  buffer_load_dwordx4 v[152:155], v18, s[28:31], s49 offen offset:1024 sc1
  buffer_load_dwordx4 v[148:151], v15, s[32:35], s89 offen offset:160
  s_add_u32 s49, s85, 327680
  buffer_load_dwordx4 v[156:159], v18, s[28:31], s49 offen offset:1024 sc1
  v_accvgpr_read_b32 v176, a192
  v_accvgpr_read_b32 v177, a193
  v_accvgpr_read_b32 v178, a194
  v_accvgpr_read_b32 v179, a195
  v_accvgpr_read_b32 v180, a196
  v_accvgpr_read_b32 v181, a197
  v_accvgpr_read_b32 v182, a198
  v_accvgpr_read_b32 v183, a199
  v_accvgpr_read_b32 v184, a200
  v_accvgpr_read_b32 v185, a201
  v_accvgpr_read_b32 v186, a202
  v_accvgpr_read_b32 v187, a203
  v_accvgpr_read_b32 v188, a204
  v_accvgpr_read_b32 v189, a205
  v_accvgpr_read_b32 v190, a206
  v_accvgpr_read_b32 v191, a207
  v_cvt_pk_bf16_f32 v104, v176, v177
  v_cvt_pk_bf16_f32 v105, v178, v179
  v_cvt_pk_bf16_f32 v106, v180, v181
  v_cvt_pk_bf16_f32 v107, v182, v183
  v_cvt_pk_bf16_f32 v108, v184, v185
  v_cvt_pk_bf16_f32 v109, v186, v187
  v_cvt_pk_bf16_f32 v110, v188, v189
  v_cvt_pk_bf16_f32 v111, v190, v191
  v_permlane32_swap_b32 v104, v106
  v_permlane32_swap_b32 v105, v107
  v_permlane32_swap_b32 v108, v110
  v_permlane32_swap_b32 v109, v111
  s_waitcnt vmcnt(18)
  v_lshlrev_b32 v26, 16, v104
  v_and_b32 v27, 0xffff0000, v104
  v_lshlrev_b32 v28, 16, v168
  v_and_b32 v29, 0xffff0000, v168
  v_pk_mul_f32 v[26:27], v[26:27], v[28:29]
  v_cvt_pk_bf16_f32 v28, v26, v27
  v_lshlrev_b32 v26, 16, v28
  v_and_b32 v27, 0xffff0000, v28
  v_lshlrev_b32 v30, 16, v160
  v_and_b32 v31, 0xffff0000, v160
  v_pk_add_f32 v[26:27], v[26:27], v[30:31]
  v_cvt_pk_bf16_f32 v104, v26, v27
  v_lshlrev_b32 v26, 16, v105
  v_and_b32 v27, 0xffff0000, v105
  v_lshlrev_b32 v28, 16, v169
  v_and_b32 v29, 0xffff0000, v169
  v_pk_mul_f32 v[26:27], v[26:27], v[28:29]
  v_cvt_pk_bf16_f32 v28, v26, v27
  v_lshlrev_b32 v26, 16, v28
  v_and_b32 v27, 0xffff0000, v28
  v_lshlrev_b32 v30, 16, v161
  v_and_b32 v31, 0xffff0000, v161
  v_pk_add_f32 v[26:27], v[26:27], v[30:31]
  v_cvt_pk_bf16_f32 v105, v26, v27
  v_lshlrev_b32 v26, 16, v106
  v_and_b32 v27, 0xffff0000, v106
  v_lshlrev_b32 v28, 16, v170
  v_and_b32 v29, 0xffff0000, v170
  v_pk_mul_f32 v[26:27], v[26:27], v[28:29]
  v_cvt_pk_bf16_f32 v28, v26, v27
  v_lshlrev_b32 v26, 16, v28
  v_and_b32 v27, 0xffff0000, v28
  v_lshlrev_b32 v30, 16, v162
  v_and_b32 v31, 0xffff0000, v162
  v_pk_add_f32 v[26:27], v[26:27], v[30:31]
  v_cvt_pk_bf16_f32 v106, v26, v27
  v_lshlrev_b32 v26, 16, v107
  v_and_b32 v27, 0xffff0000, v107
  v_lshlrev_b32 v28, 16, v171
  v_and_b32 v29, 0xffff0000, v171
  v_pk_mul_f32 v[26:27], v[26:27], v[28:29]
  v_cvt_pk_bf16_f32 v28, v26, v27
  v_lshlrev_b32 v26, 16, v28
  v_and_b32 v27, 0xffff0000, v28
  v_lshlrev_b32 v30, 16, v163
  v_and_b32 v31, 0xffff0000, v163
  v_pk_add_f32 v[26:27], v[26:27], v[30:31]
  v_cvt_pk_bf16_f32 v107, v26, v27
  v_lshlrev_b32 v26, 16, v108
  v_and_b32 v27, 0xffff0000, v108
  v_lshlrev_b32 v28, 16, v172
  v_and_b32 v29, 0xffff0000, v172
  v_pk_mul_f32 v[26:27], v[26:27], v[28:29]
  v_cvt_pk_bf16_f32 v28, v26, v27
  v_lshlrev_b32 v26, 16, v28
  v_and_b32 v27, 0xffff0000, v28
  v_lshlrev_b32 v30, 16, v164
  v_and_b32 v31, 0xffff0000, v164
  v_pk_add_f32 v[26:27], v[26:27], v[30:31]
  v_cvt_pk_bf16_f32 v108, v26, v27
  v_lshlrev_b32 v26, 16, v109
  v_and_b32 v27, 0xffff0000, v109
  v_lshlrev_b32 v28, 16, v173
  v_and_b32 v29, 0xffff0000, v173
  v_pk_mul_f32 v[26:27], v[26:27], v[28:29]
  v_cvt_pk_bf16_f32 v28, v26, v27
  v_lshlrev_b32 v26, 16, v28
  v_and_b32 v27, 0xffff0000, v28
  v_lshlrev_b32 v30, 16, v165
  v_and_b32 v31, 0xffff0000, v165
  v_pk_add_f32 v[26:27], v[26:27], v[30:31]
  v_cvt_pk_bf16_f32 v109, v26, v27
  v_lshlrev_b32 v26, 16, v110
  v_and_b32 v27, 0xffff0000, v110
  v_lshlrev_b32 v28, 16, v174
  v_and_b32 v29, 0xffff0000, v174
  v_pk_mul_f32 v[26:27], v[26:27], v[28:29]
  v_cvt_pk_bf16_f32 v28, v26, v27
  v_lshlrev_b32 v26, 16, v28
  v_and_b32 v27, 0xffff0000, v28
  v_lshlrev_b32 v30, 16, v166
  v_and_b32 v31, 0xffff0000, v166
  v_pk_add_f32 v[26:27], v[26:27], v[30:31]
  v_cvt_pk_bf16_f32 v110, v26, v27
  v_lshlrev_b32 v26, 16, v111
  v_and_b32 v27, 0xffff0000, v111
  v_lshlrev_b32 v28, 16, v175
  v_and_b32 v29, 0xffff0000, v175
  v_pk_mul_f32 v[26:27], v[26:27], v[28:29]
  v_cvt_pk_bf16_f32 v28, v26, v27
  v_lshlrev_b32 v26, 16, v28
  v_and_b32 v27, 0xffff0000, v28
  v_lshlrev_b32 v30, 16, v167
  v_and_b32 v31, 0xffff0000, v167
  v_pk_add_f32 v[26:27], v[26:27], v[30:31]
  v_cvt_pk_bf16_f32 v111, v26, v27
  buffer_store_dwordx4 v[104:107], v14, s[36:39], s89 offen offset:192
  buffer_store_dwordx4 v[108:111], v14, s[36:39], s89 offen offset:224
  buffer_load_dwordx4 v[160:163], v15, s[32:35], s89 offen offset:192
  s_add_u32 s49, s85, 393216
  buffer_load_dwordx4 v[168:171], v18, s[28:31], s49 offen offset:1024 sc1
  buffer_load_dwordx4 v[164:167], v15, s[32:35], s89 offen offset:224
  s_add_u32 s49, s85, 458752
  buffer_load_dwordx4 v[172:175], v18, s[28:31], s49 offen offset:1024 sc1
  v_accvgpr_read_b32 v176, a16
  v_accvgpr_read_b32 v177, a17
  v_accvgpr_read_b32 v178, a18
  v_accvgpr_read_b32 v179, a19
  v_accvgpr_read_b32 v180, a20
  v_accvgpr_read_b32 v181, a21
  v_accvgpr_read_b32 v182, a22
  v_accvgpr_read_b32 v183, a23
  v_accvgpr_read_b32 v184, a24
  v_accvgpr_read_b32 v185, a25
  v_accvgpr_read_b32 v186, a26
  v_accvgpr_read_b32 v187, a27
  v_accvgpr_read_b32 v188, a28
  v_accvgpr_read_b32 v189, a29
  v_accvgpr_read_b32 v190, a30
  v_accvgpr_read_b32 v191, a31
  v_cvt_pk_bf16_f32 v96, v176, v177
  v_cvt_pk_bf16_f32 v97, v178, v179
  v_cvt_pk_bf16_f32 v98, v180, v181
  v_cvt_pk_bf16_f32 v99, v182, v183
  v_cvt_pk_bf16_f32 v100, v184, v185
  v_cvt_pk_bf16_f32 v101, v186, v187
  v_cvt_pk_bf16_f32 v102, v188, v189
  v_cvt_pk_bf16_f32 v103, v190, v191
  v_permlane32_swap_b32 v96, v98
  v_permlane32_swap_b32 v97, v99
  v_permlane32_swap_b32 v100, v102
  v_permlane32_swap_b32 v101, v103
  s_waitcnt vmcnt(18)
  v_lshlrev_b32 v26, 16, v96
  v_and_b32 v27, 0xffff0000, v96
  v_lshlrev_b32 v28, 16, v120
  v_and_b32 v29, 0xffff0000, v120
  v_pk_mul_f32 v[26:27], v[26:27], v[28:29]
  v_cvt_pk_bf16_f32 v28, v26, v27
  v_lshlrev_b32 v26, 16, v28
  v_and_b32 v27, 0xffff0000, v28
  v_lshlrev_b32 v30, 16, v112
  v_and_b32 v31, 0xffff0000, v112
  v_pk_add_f32 v[26:27], v[26:27], v[30:31]
  v_cvt_pk_bf16_f32 v96, v26, v27
  v_lshlrev_b32 v26, 16, v97
  v_and_b32 v27, 0xffff0000, v97
  v_lshlrev_b32 v28, 16, v121
  v_and_b32 v29, 0xffff0000, v121
  v_pk_mul_f32 v[26:27], v[26:27], v[28:29]
  v_cvt_pk_bf16_f32 v28, v26, v27
  v_lshlrev_b32 v26, 16, v28
  v_and_b32 v27, 0xffff0000, v28
  v_lshlrev_b32 v30, 16, v113
  v_and_b32 v31, 0xffff0000, v113
  v_pk_add_f32 v[26:27], v[26:27], v[30:31]
  v_cvt_pk_bf16_f32 v97, v26, v27
  v_lshlrev_b32 v26, 16, v98
  v_and_b32 v27, 0xffff0000, v98
  v_lshlrev_b32 v28, 16, v122
  v_and_b32 v29, 0xffff0000, v122
  v_pk_mul_f32 v[26:27], v[26:27], v[28:29]
  v_cvt_pk_bf16_f32 v28, v26, v27
  v_lshlrev_b32 v26, 16, v28
  v_and_b32 v27, 0xffff0000, v28
  v_lshlrev_b32 v30, 16, v114
  v_and_b32 v31, 0xffff0000, v114
  v_pk_add_f32 v[26:27], v[26:27], v[30:31]
  v_cvt_pk_bf16_f32 v98, v26, v27
  v_lshlrev_b32 v26, 16, v99
  v_and_b32 v27, 0xffff0000, v99
  v_lshlrev_b32 v28, 16, v123
  v_and_b32 v29, 0xffff0000, v123
  v_pk_mul_f32 v[26:27], v[26:27], v[28:29]
  v_cvt_pk_bf16_f32 v28, v26, v27
  v_lshlrev_b32 v26, 16, v28
  v_and_b32 v27, 0xffff0000, v28
  v_lshlrev_b32 v30, 16, v115
  v_and_b32 v31, 0xffff0000, v115
  v_pk_add_f32 v[26:27], v[26:27], v[30:31]
  v_cvt_pk_bf16_f32 v99, v26, v27
  v_lshlrev_b32 v26, 16, v100
  v_and_b32 v27, 0xffff0000, v100
  v_lshlrev_b32 v28, 16, v124
  v_and_b32 v29, 0xffff0000, v124
  v_pk_mul_f32 v[26:27], v[26:27], v[28:29]
  v_cvt_pk_bf16_f32 v28, v26, v27
  v_lshlrev_b32 v26, 16, v28
  v_and_b32 v27, 0xffff0000, v28
  v_lshlrev_b32 v30, 16, v116
  v_and_b32 v31, 0xffff0000, v116
  v_pk_add_f32 v[26:27], v[26:27], v[30:31]
  v_cvt_pk_bf16_f32 v100, v26, v27
  v_lshlrev_b32 v26, 16, v101
  v_and_b32 v27, 0xffff0000, v101
  v_lshlrev_b32 v28, 16, v125
  v_and_b32 v29, 0xffff0000, v125
  v_pk_mul_f32 v[26:27], v[26:27], v[28:29]
  v_cvt_pk_bf16_f32 v28, v26, v27
  v_lshlrev_b32 v26, 16, v28
  v_and_b32 v27, 0xffff0000, v28
  v_lshlrev_b32 v30, 16, v117
  v_and_b32 v31, 0xffff0000, v117
  v_pk_add_f32 v[26:27], v[26:27], v[30:31]
  v_cvt_pk_bf16_f32 v101, v26, v27
  v_lshlrev_b32 v26, 16, v102
  v_and_b32 v27, 0xffff0000, v102
  v_lshlrev_b32 v28, 16, v126
  v_and_b32 v29, 0xffff0000, v126
  v_pk_mul_f32 v[26:27], v[26:27], v[28:29]
  v_cvt_pk_bf16_f32 v28, v26, v27
  v_lshlrev_b32 v26, 16, v28
  v_and_b32 v27, 0xffff0000, v28
  v_lshlrev_b32 v30, 16, v118
  v_and_b32 v31, 0xffff0000, v118
  v_pk_add_f32 v[26:27], v[26:27], v[30:31]
  v_cvt_pk_bf16_f32 v102, v26, v27
  v_lshlrev_b32 v26, 16, v103
  v_and_b32 v27, 0xffff0000, v103
  v_lshlrev_b32 v28, 16, v127
  v_and_b32 v29, 0xffff0000, v127
  v_pk_mul_f32 v[26:27], v[26:27], v[28:29]
  v_cvt_pk_bf16_f32 v28, v26, v27
  v_lshlrev_b32 v26, 16, v28
  v_and_b32 v27, 0xffff0000, v28
  v_lshlrev_b32 v30, 16, v119
  v_and_b32 v31, 0xffff0000, v119
  v_pk_add_f32 v[26:27], v[26:27], v[30:31]
  v_cvt_pk_bf16_f32 v103, v26, v27
  buffer_store_dwordx4 v[96:99], v15, s[36:39], s89 offen offset:0
  buffer_store_dwordx4 v[100:103], v15, s[36:39], s89 offen offset:32
  buffer_load_dwordx4 v[112:115], v16, s[32:35], s89 offen offset:0
  s_add_u32 s49, s85, 0
  buffer_load_dwordx4 v[120:123], v18, s[28:31], s49 offen offset:2048 sc1
  buffer_load_dwordx4 v[116:119], v16, s[32:35], s89 offen offset:32
  s_add_u32 s49, s85, 65536
  buffer_load_dwordx4 v[124:127], v18, s[28:31], s49 offen offset:2048 sc1
  v_accvgpr_read_b32 v176, a80
  v_accvgpr_read_b32 v177, a81
  v_accvgpr_read_b32 v178, a82
  v_accvgpr_read_b32 v179, a83
  v_accvgpr_read_b32 v180, a84
  v_accvgpr_read_b32 v181, a85
  v_accvgpr_read_b32 v182, a86
  v_accvgpr_read_b32 v183, a87
  v_accvgpr_read_b32 v184, a88
  v_accvgpr_read_b32 v185, a89
  v_accvgpr_read_b32 v186, a90
  v_accvgpr_read_b32 v187, a91
  v_accvgpr_read_b32 v188, a92
  v_accvgpr_read_b32 v189, a93
  v_accvgpr_read_b32 v190, a94
  v_accvgpr_read_b32 v191, a95
  v_cvt_pk_bf16_f32 v104, v176, v177
  v_cvt_pk_bf16_f32 v105, v178, v179
  v_cvt_pk_bf16_f32 v106, v180, v181
  v_cvt_pk_bf16_f32 v107, v182, v183
  v_cvt_pk_bf16_f32 v108, v184, v185
  v_cvt_pk_bf16_f32 v109, v186, v187
  v_cvt_pk_bf16_f32 v110, v188, v189
  v_cvt_pk_bf16_f32 v111, v190, v191
  v_permlane32_swap_b32 v104, v106
  v_permlane32_swap_b32 v105, v107
  v_permlane32_swap_b32 v108, v110
  v_permlane32_swap_b32 v109, v111
  s_waitcnt vmcnt(18)
  v_lshlrev_b32 v26, 16, v104
  v_and_b32 v27, 0xffff0000, v104
  v_lshlrev_b32 v28, 16, v136
  v_and_b32 v29, 0xffff0000, v136
  v_pk_mul_f32 v[26:27], v[26:27], v[28:29]
  v_cvt_pk_bf16_f32 v28, v26, v27
  v_lshlrev_b32 v26, 16, v28
  v_and_b32 v27, 0xffff0000, v28
  v_lshlrev_b32 v30, 16, v128
  v_and_b32 v31, 0xffff0000, v128
  v_pk_add_f32 v[26:27], v[26:27], v[30:31]
  v_cvt_pk_bf16_f32 v104, v26, v27
  v_lshlrev_b32 v26, 16, v105
  v_and_b32 v27, 0xffff0000, v105
  v_lshlrev_b32 v28, 16, v137
  v_and_b32 v29, 0xffff0000, v137
  v_pk_mul_f32 v[26:27], v[26:27], v[28:29]
  v_cvt_pk_bf16_f32 v28, v26, v27
  v_lshlrev_b32 v26, 16, v28
  v_and_b32 v27, 0xffff0000, v28
  v_lshlrev_b32 v30, 16, v129
  v_and_b32 v31, 0xffff0000, v129
  v_pk_add_f32 v[26:27], v[26:27], v[30:31]
  v_cvt_pk_bf16_f32 v105, v26, v27
  v_lshlrev_b32 v26, 16, v106
  v_and_b32 v27, 0xffff0000, v106
  v_lshlrev_b32 v28, 16, v138
  v_and_b32 v29, 0xffff0000, v138
  v_pk_mul_f32 v[26:27], v[26:27], v[28:29]
  v_cvt_pk_bf16_f32 v28, v26, v27
  v_lshlrev_b32 v26, 16, v28
  v_and_b32 v27, 0xffff0000, v28
  v_lshlrev_b32 v30, 16, v130
  v_and_b32 v31, 0xffff0000, v130
  v_pk_add_f32 v[26:27], v[26:27], v[30:31]
  v_cvt_pk_bf16_f32 v106, v26, v27
  v_lshlrev_b32 v26, 16, v107
  v_and_b32 v27, 0xffff0000, v107
  v_lshlrev_b32 v28, 16, v139
  v_and_b32 v29, 0xffff0000, v139
  v_pk_mul_f32 v[26:27], v[26:27], v[28:29]
  v_cvt_pk_bf16_f32 v28, v26, v27
  v_lshlrev_b32 v26, 16, v28
  v_and_b32 v27, 0xffff0000, v28
  v_lshlrev_b32 v30, 16, v131
  v_and_b32 v31, 0xffff0000, v131
  v_pk_add_f32 v[26:27], v[26:27], v[30:31]
  v_cvt_pk_bf16_f32 v107, v26, v27
  v_lshlrev_b32 v26, 16, v108
  v_and_b32 v27, 0xffff0000, v108
  v_lshlrev_b32 v28, 16, v140
  v_and_b32 v29, 0xffff0000, v140
  v_pk_mul_f32 v[26:27], v[26:27], v[28:29]
  v_cvt_pk_bf16_f32 v28, v26, v27
  v_lshlrev_b32 v26, 16, v28
  v_and_b32 v27, 0xffff0000, v28
  v_lshlrev_b32 v30, 16, v132
  v_and_b32 v31, 0xffff0000, v132
  v_pk_add_f32 v[26:27], v[26:27], v[30:31]
  v_cvt_pk_bf16_f32 v108, v26, v27
  v_lshlrev_b32 v26, 16, v109
  v_and_b32 v27, 0xffff0000, v109
  v_lshlrev_b32 v28, 16, v141
  v_and_b32 v29, 0xffff0000, v141
  v_pk_mul_f32 v[26:27], v[26:27], v[28:29]
  v_cvt_pk_bf16_f32 v28, v26, v27
  v_lshlrev_b32 v26, 16, v28
  v_and_b32 v27, 0xffff0000, v28
  v_lshlrev_b32 v30, 16, v133
  v_and_b32 v31, 0xffff0000, v133
  v_pk_add_f32 v[26:27], v[26:27], v[30:31]
  v_cvt_pk_bf16_f32 v109, v26, v27
  v_lshlrev_b32 v26, 16, v110
  v_and_b32 v27, 0xffff0000, v110
  v_lshlrev_b32 v28, 16, v142
  v_and_b32 v29, 0xffff0000, v142
  v_pk_mul_f32 v[26:27], v[26:27], v[28:29]
  v_cvt_pk_bf16_f32 v28, v26, v27
  v_lshlrev_b32 v26, 16, v28
  v_and_b32 v27, 0xffff0000, v28
  v_lshlrev_b32 v30, 16, v134
  v_and_b32 v31, 0xffff0000, v134
  v_pk_add_f32 v[26:27], v[26:27], v[30:31]
  v_cvt_pk_bf16_f32 v110, v26, v27
  v_lshlrev_b32 v26, 16, v111
  v_and_b32 v27, 0xffff0000, v111
  v_lshlrev_b32 v28, 16, v143
  v_and_b32 v29, 0xffff0000, v143
  v_pk_mul_f32 v[26:27], v[26:27], v[28:29]
  v_cvt_pk_bf16_f32 v28, v26, v27
  v_lshlrev_b32 v26, 16, v28
  v_and_b32 v27, 0xffff0000, v28
  v_lshlrev_b32 v30, 16, v135
  v_and_b32 v31, 0xffff0000, v135
  v_pk_add_f32 v[26:27], v[26:27], v[30:31]
  v_cvt_pk_bf16_f32 v111, v26, v27
  buffer_store_dwordx4 v[104:107], v15, s[36:39], s89 offen offset:64
  buffer_store_dwordx4 v[108:111], v15, s[36:39], s89 offen offset:96
  buffer_load_dwordx4 v[128:131], v16, s[32:35], s89 offen offset:64
  s_add_u32 s49, s85, 131072
  buffer_load_dwordx4 v[136:139], v18, s[28:31], s49 offen offset:2048 sc1
  buffer_load_dwordx4 v[132:135], v16, s[32:35], s89 offen offset:96
  s_add_u32 s49, s85, 196608
  buffer_load_dwordx4 v[140:143], v18, s[28:31], s49 offen offset:2048 sc1
  v_accvgpr_read_b32 v176, a144
  v_accvgpr_read_b32 v177, a145
  v_accvgpr_read_b32 v178, a146
  v_accvgpr_read_b32 v179, a147
  v_accvgpr_read_b32 v180, a148
  v_accvgpr_read_b32 v181, a149
  v_accvgpr_read_b32 v182, a150
  v_accvgpr_read_b32 v183, a151
  v_accvgpr_read_b32 v184, a152
  v_accvgpr_read_b32 v185, a153
  v_accvgpr_read_b32 v186, a154
  v_accvgpr_read_b32 v187, a155
  v_accvgpr_read_b32 v188, a156
  v_accvgpr_read_b32 v189, a157
  v_accvgpr_read_b32 v190, a158
  v_accvgpr_read_b32 v191, a159
  v_cvt_pk_bf16_f32 v96, v176, v177
  v_cvt_pk_bf16_f32 v97, v178, v179
  v_cvt_pk_bf16_f32 v98, v180, v181
  v_cvt_pk_bf16_f32 v99, v182, v183
  v_cvt_pk_bf16_f32 v100, v184, v185
  v_cvt_pk_bf16_f32 v101, v186, v187
  v_cvt_pk_bf16_f32 v102, v188, v189
  v_cvt_pk_bf16_f32 v103, v190, v191
  v_permlane32_swap_b32 v96, v98
  v_permlane32_swap_b32 v97, v99
  v_permlane32_swap_b32 v100, v102
  v_permlane32_swap_b32 v101, v103
  s_waitcnt vmcnt(18)
  v_lshlrev_b32 v26, 16, v96
  v_and_b32 v27, 0xffff0000, v96
  v_lshlrev_b32 v28, 16, v152
  v_and_b32 v29, 0xffff0000, v152
  v_pk_mul_f32 v[26:27], v[26:27], v[28:29]
  v_cvt_pk_bf16_f32 v28, v26, v27
  v_lshlrev_b32 v26, 16, v28
  v_and_b32 v27, 0xffff0000, v28
  v_lshlrev_b32 v30, 16, v144
  v_and_b32 v31, 0xffff0000, v144
  v_pk_add_f32 v[26:27], v[26:27], v[30:31]
  v_cvt_pk_bf16_f32 v96, v26, v27
  v_lshlrev_b32 v26, 16, v97
  v_and_b32 v27, 0xffff0000, v97
  v_lshlrev_b32 v28, 16, v153
  v_and_b32 v29, 0xffff0000, v153
  v_pk_mul_f32 v[26:27], v[26:27], v[28:29]
  v_cvt_pk_bf16_f32 v28, v26, v27
  v_lshlrev_b32 v26, 16, v28
  v_and_b32 v27, 0xffff0000, v28
  v_lshlrev_b32 v30, 16, v145
  v_and_b32 v31, 0xffff0000, v145
  v_pk_add_f32 v[26:27], v[26:27], v[30:31]
  v_cvt_pk_bf16_f32 v97, v26, v27
  v_lshlrev_b32 v26, 16, v98
  v_and_b32 v27, 0xffff0000, v98
  v_lshlrev_b32 v28, 16, v154
  v_and_b32 v29, 0xffff0000, v154
  v_pk_mul_f32 v[26:27], v[26:27], v[28:29]
  v_cvt_pk_bf16_f32 v28, v26, v27
  v_lshlrev_b32 v26, 16, v28
  v_and_b32 v27, 0xffff0000, v28
  v_lshlrev_b32 v30, 16, v146
  v_and_b32 v31, 0xffff0000, v146
  v_pk_add_f32 v[26:27], v[26:27], v[30:31]
  v_cvt_pk_bf16_f32 v98, v26, v27
  v_lshlrev_b32 v26, 16, v99
  v_and_b32 v27, 0xffff0000, v99
  v_lshlrev_b32 v28, 16, v155
  v_and_b32 v29, 0xffff0000, v155
  v_pk_mul_f32 v[26:27], v[26:27], v[28:29]
  v_cvt_pk_bf16_f32 v28, v26, v27
  v_lshlrev_b32 v26, 16, v28
  v_and_b32 v27, 0xffff0000, v28
  v_lshlrev_b32 v30, 16, v147
  v_and_b32 v31, 0xffff0000, v147
  v_pk_add_f32 v[26:27], v[26:27], v[30:31]
  v_cvt_pk_bf16_f32 v99, v26, v27
  v_lshlrev_b32 v26, 16, v100
  v_and_b32 v27, 0xffff0000, v100
  v_lshlrev_b32 v28, 16, v156
  v_and_b32 v29, 0xffff0000, v156
  v_pk_mul_f32 v[26:27], v[26:27], v[28:29]
  v_cvt_pk_bf16_f32 v28, v26, v27
  v_lshlrev_b32 v26, 16, v28
  v_and_b32 v27, 0xffff0000, v28
  v_lshlrev_b32 v30, 16, v148
  v_and_b32 v31, 0xffff0000, v148
  v_pk_add_f32 v[26:27], v[26:27], v[30:31]
  v_cvt_pk_bf16_f32 v100, v26, v27
  v_lshlrev_b32 v26, 16, v101
  v_and_b32 v27, 0xffff0000, v101
  v_lshlrev_b32 v28, 16, v157
  v_and_b32 v29, 0xffff0000, v157
  v_pk_mul_f32 v[26:27], v[26:27], v[28:29]
  v_cvt_pk_bf16_f32 v28, v26, v27
  v_lshlrev_b32 v26, 16, v28
  v_and_b32 v27, 0xffff0000, v28
  v_lshlrev_b32 v30, 16, v149
  v_and_b32 v31, 0xffff0000, v149
  v_pk_add_f32 v[26:27], v[26:27], v[30:31]
  v_cvt_pk_bf16_f32 v101, v26, v27
  v_lshlrev_b32 v26, 16, v102
  v_and_b32 v27, 0xffff0000, v102
  v_lshlrev_b32 v28, 16, v158
  v_and_b32 v29, 0xffff0000, v158
  v_pk_mul_f32 v[26:27], v[26:27], v[28:29]
  v_cvt_pk_bf16_f32 v28, v26, v27
  v_lshlrev_b32 v26, 16, v28
  v_and_b32 v27, 0xffff0000, v28
  v_lshlrev_b32 v30, 16, v150
  v_and_b32 v31, 0xffff0000, v150
  v_pk_add_f32 v[26:27], v[26:27], v[30:31]
  v_cvt_pk_bf16_f32 v102, v26, v27
  v_lshlrev_b32 v26, 16, v103
  v_and_b32 v27, 0xffff0000, v103
  v_lshlrev_b32 v28, 16, v159
  v_and_b32 v29, 0xffff0000, v159
  v_pk_mul_f32 v[26:27], v[26:27], v[28:29]
  v_cvt_pk_bf16_f32 v28, v26, v27
  v_lshlrev_b32 v26, 16, v28
  v_and_b32 v27, 0xffff0000, v28
  v_lshlrev_b32 v30, 16, v151
  v_and_b32 v31, 0xffff0000, v151
  v_pk_add_f32 v[26:27], v[26:27], v[30:31]
  v_cvt_pk_bf16_f32 v103, v26, v27
  buffer_store_dwordx4 v[96:99], v15, s[36:39], s89 offen offset:128
  buffer_store_dwordx4 v[100:103], v15, s[36:39], s89 offen offset:160
  buffer_load_dwordx4 v[144:147], v16, s[32:35], s89 offen offset:128
  s_add_u32 s49, s85, 262144
  buffer_load_dwordx4 v[152:155], v18, s[28:31], s49 offen offset:2048 sc1
  buffer_load_dwordx4 v[148:151], v16, s[32:35], s89 offen offset:160
  s_add_u32 s49, s85, 327680
  buffer_load_dwordx4 v[156:159], v18, s[28:31], s49 offen offset:2048 sc1
  v_accvgpr_read_b32 v176, a208
  v_accvgpr_read_b32 v177, a209
  v_accvgpr_read_b32 v178, a210
  v_accvgpr_read_b32 v179, a211
  v_accvgpr_read_b32 v180, a212
  v_accvgpr_read_b32 v181, a213
  v_accvgpr_read_b32 v182, a214
  v_accvgpr_read_b32 v183, a215
  v_accvgpr_read_b32 v184, a216
  v_accvgpr_read_b32 v185, a217
  v_accvgpr_read_b32 v186, a218
  v_accvgpr_read_b32 v187, a219
  v_accvgpr_read_b32 v188, a220
  v_accvgpr_read_b32 v189, a221
  v_accvgpr_read_b32 v190, a222
  v_accvgpr_read_b32 v191, a223
  v_cvt_pk_bf16_f32 v104, v176, v177
  v_cvt_pk_bf16_f32 v105, v178, v179
  v_cvt_pk_bf16_f32 v106, v180, v181
  v_cvt_pk_bf16_f32 v107, v182, v183
  v_cvt_pk_bf16_f32 v108, v184, v185
  v_cvt_pk_bf16_f32 v109, v186, v187
  v_cvt_pk_bf16_f32 v110, v188, v189
  v_cvt_pk_bf16_f32 v111, v190, v191
  v_permlane32_swap_b32 v104, v106
  v_permlane32_swap_b32 v105, v107
  v_permlane32_swap_b32 v108, v110
  v_permlane32_swap_b32 v109, v111
  s_waitcnt vmcnt(18)
  v_lshlrev_b32 v26, 16, v104
  v_and_b32 v27, 0xffff0000, v104
  v_lshlrev_b32 v28, 16, v168
  v_and_b32 v29, 0xffff0000, v168
  v_pk_mul_f32 v[26:27], v[26:27], v[28:29]
  v_cvt_pk_bf16_f32 v28, v26, v27
  v_lshlrev_b32 v26, 16, v28
  v_and_b32 v27, 0xffff0000, v28
  v_lshlrev_b32 v30, 16, v160
  v_and_b32 v31, 0xffff0000, v160
  v_pk_add_f32 v[26:27], v[26:27], v[30:31]
  v_cvt_pk_bf16_f32 v104, v26, v27
  v_lshlrev_b32 v26, 16, v105
  v_and_b32 v27, 0xffff0000, v105
  v_lshlrev_b32 v28, 16, v169
  v_and_b32 v29, 0xffff0000, v169
  v_pk_mul_f32 v[26:27], v[26:27], v[28:29]
  v_cvt_pk_bf16_f32 v28, v26, v27
  v_lshlrev_b32 v26, 16, v28
  v_and_b32 v27, 0xffff0000, v28
  v_lshlrev_b32 v30, 16, v161
  v_and_b32 v31, 0xffff0000, v161
  v_pk_add_f32 v[26:27], v[26:27], v[30:31]
  v_cvt_pk_bf16_f32 v105, v26, v27
  v_lshlrev_b32 v26, 16, v106
  v_and_b32 v27, 0xffff0000, v106
  v_lshlrev_b32 v28, 16, v170
  v_and_b32 v29, 0xffff0000, v170
  v_pk_mul_f32 v[26:27], v[26:27], v[28:29]
  v_cvt_pk_bf16_f32 v28, v26, v27
  v_lshlrev_b32 v26, 16, v28
  v_and_b32 v27, 0xffff0000, v28
  v_lshlrev_b32 v30, 16, v162
  v_and_b32 v31, 0xffff0000, v162
  v_pk_add_f32 v[26:27], v[26:27], v[30:31]
  v_cvt_pk_bf16_f32 v106, v26, v27
  v_lshlrev_b32 v26, 16, v107
  v_and_b32 v27, 0xffff0000, v107
  v_lshlrev_b32 v28, 16, v171
  v_and_b32 v29, 0xffff0000, v171
  v_pk_mul_f32 v[26:27], v[26:27], v[28:29]
  v_cvt_pk_bf16_f32 v28, v26, v27
  v_lshlrev_b32 v26, 16, v28
  v_and_b32 v27, 0xffff0000, v28
  v_lshlrev_b32 v30, 16, v163
  v_and_b32 v31, 0xffff0000, v163
  v_pk_add_f32 v[26:27], v[26:27], v[30:31]
  v_cvt_pk_bf16_f32 v107, v26, v27
  v_lshlrev_b32 v26, 16, v108
  v_and_b32 v27, 0xffff0000, v108
  v_lshlrev_b32 v28, 16, v172
  v_and_b32 v29, 0xffff0000, v172
  v_pk_mul_f32 v[26:27], v[26:27], v[28:29]
  v_cvt_pk_bf16_f32 v28, v26, v27
  v_lshlrev_b32 v26, 16, v28
  v_and_b32 v27, 0xffff0000, v28
  v_lshlrev_b32 v30, 16, v164
  v_and_b32 v31, 0xffff0000, v164
  v_pk_add_f32 v[26:27], v[26:27], v[30:31]
  v_cvt_pk_bf16_f32 v108, v26, v27
  v_lshlrev_b32 v26, 16, v109
  v_and_b32 v27, 0xffff0000, v109
  v_lshlrev_b32 v28, 16, v173
  v_and_b32 v29, 0xffff0000, v173
  v_pk_mul_f32 v[26:27], v[26:27], v[28:29]
  v_cvt_pk_bf16_f32 v28, v26, v27
  v_lshlrev_b32 v26, 16, v28
  v_and_b32 v27, 0xffff0000, v28
  v_lshlrev_b32 v30, 16, v165
  v_and_b32 v31, 0xffff0000, v165
  v_pk_add_f32 v[26:27], v[26:27], v[30:31]
  v_cvt_pk_bf16_f32 v109, v26, v27
  v_lshlrev_b32 v26, 16, v110
  v_and_b32 v27, 0xffff0000, v110
  v_lshlrev_b32 v28, 16, v174
  v_and_b32 v29, 0xffff0000, v174
  v_pk_mul_f32 v[26:27], v[26:27], v[28:29]
  v_cvt_pk_bf16_f32 v28, v26, v27
  v_lshlrev_b32 v26, 16, v28
  v_and_b32 v27, 0xffff0000, v28
  v_lshlrev_b32 v30, 16, v166
  v_and_b32 v31, 0xffff0000, v166
  v_pk_add_f32 v[26:27], v[26:27], v[30:31]
  v_cvt_pk_bf16_f32 v110, v26, v27
  v_lshlrev_b32 v26, 16, v111
  v_and_b32 v27, 0xffff0000, v111
  v_lshlrev_b32 v28, 16, v175
  v_and_b32 v29, 0xffff0000, v175
  v_pk_mul_f32 v[26:27], v[26:27], v[28:29]
  v_cvt_pk_bf16_f32 v28, v26, v27
  v_lshlrev_b32 v26, 16, v28
  v_and_b32 v27, 0xffff0000, v28
  v_lshlrev_b32 v30, 16, v167
  v_and_b32 v31, 0xffff0000, v167
  v_pk_add_f32 v[26:27], v[26:27], v[30:31]
  v_cvt_pk_bf16_f32 v111, v26, v27
  buffer_store_dwordx4 v[104:107], v15, s[36:39], s89 offen offset:192
  buffer_store_dwordx4 v[108:111], v15, s[36:39], s89 offen offset:224
  buffer_load_dwordx4 v[160:163], v16, s[32:35], s89 offen offset:192
  s_add_u32 s49, s85, 393216
  buffer_load_dwordx4 v[168:171], v18, s[28:31], s49 offen offset:2048 sc1
  buffer_load_dwordx4 v[164:167], v16, s[32:35], s89 offen offset:224
  s_add_u32 s49, s85, 458752
  buffer_load_dwordx4 v[172:175], v18, s[28:31], s49 offen offset:2048 sc1
  v_accvgpr_read_b32 v176, a32
  v_accvgpr_read_b32 v177, a33
  v_accvgpr_read_b32 v178, a34
  v_accvgpr_read_b32 v179, a35
  v_accvgpr_read_b32 v180, a36
  v_accvgpr_read_b32 v181, a37
  v_accvgpr_read_b32 v182, a38
  v_accvgpr_read_b32 v183, a39
  v_accvgpr_read_b32 v184, a40
  v_accvgpr_read_b32 v185, a41
  v_accvgpr_read_b32 v186, a42
  v_accvgpr_read_b32 v187, a43
  v_accvgpr_read_b32 v188, a44
  v_accvgpr_read_b32 v189, a45
  v_accvgpr_read_b32 v190, a46
  v_accvgpr_read_b32 v191, a47
  v_cvt_pk_bf16_f32 v96, v176, v177
  v_cvt_pk_bf16_f32 v97, v178, v179
  v_cvt_pk_bf16_f32 v98, v180, v181
  v_cvt_pk_bf16_f32 v99, v182, v183
  v_cvt_pk_bf16_f32 v100, v184, v185
  v_cvt_pk_bf16_f32 v101, v186, v187
  v_cvt_pk_bf16_f32 v102, v188, v189
  v_cvt_pk_bf16_f32 v103, v190, v191
  v_permlane32_swap_b32 v96, v98
  v_permlane32_swap_b32 v97, v99
  v_permlane32_swap_b32 v100, v102
  v_permlane32_swap_b32 v101, v103
  s_waitcnt vmcnt(18)
  v_lshlrev_b32 v26, 16, v96
  v_and_b32 v27, 0xffff0000, v96
  v_lshlrev_b32 v28, 16, v120
  v_and_b32 v29, 0xffff0000, v120
  v_pk_mul_f32 v[26:27], v[26:27], v[28:29]
  v_cvt_pk_bf16_f32 v28, v26, v27
  v_lshlrev_b32 v26, 16, v28
  v_and_b32 v27, 0xffff0000, v28
  v_lshlrev_b32 v30, 16, v112
  v_and_b32 v31, 0xffff0000, v112
  v_pk_add_f32 v[26:27], v[26:27], v[30:31]
  v_cvt_pk_bf16_f32 v96, v26, v27
  v_lshlrev_b32 v26, 16, v97
  v_and_b32 v27, 0xffff0000, v97
  v_lshlrev_b32 v28, 16, v121
  v_and_b32 v29, 0xffff0000, v121
  v_pk_mul_f32 v[26:27], v[26:27], v[28:29]
  v_cvt_pk_bf16_f32 v28, v26, v27
  v_lshlrev_b32 v26, 16, v28
  v_and_b32 v27, 0xffff0000, v28
  v_lshlrev_b32 v30, 16, v113
  v_and_b32 v31, 0xffff0000, v113
  v_pk_add_f32 v[26:27], v[26:27], v[30:31]
  v_cvt_pk_bf16_f32 v97, v26, v27
  v_lshlrev_b32 v26, 16, v98
  v_and_b32 v27, 0xffff0000, v98
  v_lshlrev_b32 v28, 16, v122
  v_and_b32 v29, 0xffff0000, v122
  v_pk_mul_f32 v[26:27], v[26:27], v[28:29]
  v_cvt_pk_bf16_f32 v28, v26, v27
  v_lshlrev_b32 v26, 16, v28
  v_and_b32 v27, 0xffff0000, v28
  v_lshlrev_b32 v30, 16, v114
  v_and_b32 v31, 0xffff0000, v114
  v_pk_add_f32 v[26:27], v[26:27], v[30:31]
  v_cvt_pk_bf16_f32 v98, v26, v27
  v_lshlrev_b32 v26, 16, v99
  v_and_b32 v27, 0xffff0000, v99
  v_lshlrev_b32 v28, 16, v123
  v_and_b32 v29, 0xffff0000, v123
  v_pk_mul_f32 v[26:27], v[26:27], v[28:29]
  v_cvt_pk_bf16_f32 v28, v26, v27
  v_lshlrev_b32 v26, 16, v28
  v_and_b32 v27, 0xffff0000, v28
  v_lshlrev_b32 v30, 16, v115
  v_and_b32 v31, 0xffff0000, v115
  v_pk_add_f32 v[26:27], v[26:27], v[30:31]
  v_cvt_pk_bf16_f32 v99, v26, v27
  v_lshlrev_b32 v26, 16, v100
  v_and_b32 v27, 0xffff0000, v100
  v_lshlrev_b32 v28, 16, v124
  v_and_b32 v29, 0xffff0000, v124
  v_pk_mul_f32 v[26:27], v[26:27], v[28:29]
  v_cvt_pk_bf16_f32 v28, v26, v27
  v_lshlrev_b32 v26, 16, v28
  v_and_b32 v27, 0xffff0000, v28
  v_lshlrev_b32 v30, 16, v116
  v_and_b32 v31, 0xffff0000, v116
  v_pk_add_f32 v[26:27], v[26:27], v[30:31]
  v_cvt_pk_bf16_f32 v100, v26, v27
  v_lshlrev_b32 v26, 16, v101
  v_and_b32 v27, 0xffff0000, v101
  v_lshlrev_b32 v28, 16, v125
  v_and_b32 v29, 0xffff0000, v125
  v_pk_mul_f32 v[26:27], v[26:27], v[28:29]
  v_cvt_pk_bf16_f32 v28, v26, v27
  v_lshlrev_b32 v26, 16, v28
  v_and_b32 v27, 0xffff0000, v28
  v_lshlrev_b32 v30, 16, v117
  v_and_b32 v31, 0xffff0000, v117
  v_pk_add_f32 v[26:27], v[26:27], v[30:31]
  v_cvt_pk_bf16_f32 v101, v26, v27
  v_lshlrev_b32 v26, 16, v102
  v_and_b32 v27, 0xffff0000, v102
  v_lshlrev_b32 v28, 16, v126
  v_and_b32 v29, 0xffff0000, v126
  v_pk_mul_f32 v[26:27], v[26:27], v[28:29]
  v_cvt_pk_bf16_f32 v28, v26, v27
  v_lshlrev_b32 v26, 16, v28
  v_and_b32 v27, 0xffff0000, v28
  v_lshlrev_b32 v30, 16, v118
  v_and_b32 v31, 0xffff0000, v118
  v_pk_add_f32 v[26:27], v[26:27], v[30:31]
  v_cvt_pk_bf16_f32 v102, v26, v27
  v_lshlrev_b32 v26, 16, v103
  v_and_b32 v27, 0xffff0000, v103
  v_lshlrev_b32 v28, 16, v127
  v_and_b32 v29, 0xffff0000, v127
  v_pk_mul_f32 v[26:27], v[26:27], v[28:29]
  v_cvt_pk_bf16_f32 v28, v26, v27
  v_lshlrev_b32 v26, 16, v28
  v_and_b32 v27, 0xffff0000, v28
  v_lshlrev_b32 v30, 16, v119
  v_and_b32 v31, 0xffff0000, v119
  v_pk_add_f32 v[26:27], v[26:27], v[30:31]
  v_cvt_pk_bf16_f32 v103, v26, v27
  buffer_store_dwordx4 v[96:99], v16, s[36:39], s89 offen offset:0
  buffer_store_dwordx4 v[100:103], v16, s[36:39], s89 offen offset:32
  buffer_load_dwordx4 v[112:115], v17, s[32:35], s89 offen offset:0
  s_add_u32 s49, s85, 0
  buffer_load_dwordx4 v[120:123], v18, s[28:31], s49 offen offset:3072 sc1
  buffer_load_dwordx4 v[116:119], v17, s[32:35], s89 offen offset:32
  s_add_u32 s49, s85, 65536
  buffer_load_dwordx4 v[124:127], v18, s[28:31], s49 offen offset:3072 sc1
  v_accvgpr_read_b32 v176, a96
  v_accvgpr_read_b32 v177, a97
  v_accvgpr_read_b32 v178, a98
  v_accvgpr_read_b32 v179, a99
  v_accvgpr_read_b32 v180, a100
  v_accvgpr_read_b32 v181, a101
  v_accvgpr_read_b32 v182, a102
  v_accvgpr_read_b32 v183, a103
  v_accvgpr_read_b32 v184, a104
  v_accvgpr_read_b32 v185, a105
  v_accvgpr_read_b32 v186, a106
  v_accvgpr_read_b32 v187, a107
  v_accvgpr_read_b32 v188, a108
  v_accvgpr_read_b32 v189, a109
  v_accvgpr_read_b32 v190, a110
  v_accvgpr_read_b32 v191, a111
  v_cvt_pk_bf16_f32 v104, v176, v177
  v_cvt_pk_bf16_f32 v105, v178, v179
  v_cvt_pk_bf16_f32 v106, v180, v181
  v_cvt_pk_bf16_f32 v107, v182, v183
  v_cvt_pk_bf16_f32 v108, v184, v185
  v_cvt_pk_bf16_f32 v109, v186, v187
  v_cvt_pk_bf16_f32 v110, v188, v189
  v_cvt_pk_bf16_f32 v111, v190, v191
  v_permlane32_swap_b32 v104, v106
  v_permlane32_swap_b32 v105, v107
  v_permlane32_swap_b32 v108, v110
  v_permlane32_swap_b32 v109, v111
  s_waitcnt vmcnt(18)
  v_lshlrev_b32 v26, 16, v104
  v_and_b32 v27, 0xffff0000, v104
  v_lshlrev_b32 v28, 16, v136
  v_and_b32 v29, 0xffff0000, v136
  v_pk_mul_f32 v[26:27], v[26:27], v[28:29]
  v_cvt_pk_bf16_f32 v28, v26, v27
  v_lshlrev_b32 v26, 16, v28
  v_and_b32 v27, 0xffff0000, v28
  v_lshlrev_b32 v30, 16, v128
  v_and_b32 v31, 0xffff0000, v128
  v_pk_add_f32 v[26:27], v[26:27], v[30:31]
  v_cvt_pk_bf16_f32 v104, v26, v27
  v_lshlrev_b32 v26, 16, v105
  v_and_b32 v27, 0xffff0000, v105
  v_lshlrev_b32 v28, 16, v137
  v_and_b32 v29, 0xffff0000, v137
  v_pk_mul_f32 v[26:27], v[26:27], v[28:29]
  v_cvt_pk_bf16_f32 v28, v26, v27
  v_lshlrev_b32 v26, 16, v28
  v_and_b32 v27, 0xffff0000, v28
  v_lshlrev_b32 v30, 16, v129
  v_and_b32 v31, 0xffff0000, v129
  v_pk_add_f32 v[26:27], v[26:27], v[30:31]
  v_cvt_pk_bf16_f32 v105, v26, v27
  v_lshlrev_b32 v26, 16, v106
  v_and_b32 v27, 0xffff0000, v106
  v_lshlrev_b32 v28, 16, v138
  v_and_b32 v29, 0xffff0000, v138
  v_pk_mul_f32 v[26:27], v[26:27], v[28:29]
  v_cvt_pk_bf16_f32 v28, v26, v27
  v_lshlrev_b32 v26, 16, v28
  v_and_b32 v27, 0xffff0000, v28
  v_lshlrev_b32 v30, 16, v130
  v_and_b32 v31, 0xffff0000, v130
  v_pk_add_f32 v[26:27], v[26:27], v[30:31]
  v_cvt_pk_bf16_f32 v106, v26, v27
  v_lshlrev_b32 v26, 16, v107
  v_and_b32 v27, 0xffff0000, v107
  v_lshlrev_b32 v28, 16, v139
  v_and_b32 v29, 0xffff0000, v139
  v_pk_mul_f32 v[26:27], v[26:27], v[28:29]
  v_cvt_pk_bf16_f32 v28, v26, v27
  v_lshlrev_b32 v26, 16, v28
  v_and_b32 v27, 0xffff0000, v28
  v_lshlrev_b32 v30, 16, v131
  v_and_b32 v31, 0xffff0000, v131
  v_pk_add_f32 v[26:27], v[26:27], v[30:31]
  v_cvt_pk_bf16_f32 v107, v26, v27
  v_lshlrev_b32 v26, 16, v108
  v_and_b32 v27, 0xffff0000, v108
  v_lshlrev_b32 v28, 16, v140
  v_and_b32 v29, 0xffff0000, v140
  v_pk_mul_f32 v[26:27], v[26:27], v[28:29]
  v_cvt_pk_bf16_f32 v28, v26, v27
  v_lshlrev_b32 v26, 16, v28
  v_and_b32 v27, 0xffff0000, v28
  v_lshlrev_b32 v30, 16, v132
  v_and_b32 v31, 0xffff0000, v132
  v_pk_add_f32 v[26:27], v[26:27], v[30:31]
  v_cvt_pk_bf16_f32 v108, v26, v27
  v_lshlrev_b32 v26, 16, v109
  v_and_b32 v27, 0xffff0000, v109
  v_lshlrev_b32 v28, 16, v141
  v_and_b32 v29, 0xffff0000, v141
  v_pk_mul_f32 v[26:27], v[26:27], v[28:29]
  v_cvt_pk_bf16_f32 v28, v26, v27
  v_lshlrev_b32 v26, 16, v28
  v_and_b32 v27, 0xffff0000, v28
  v_lshlrev_b32 v30, 16, v133
  v_and_b32 v31, 0xffff0000, v133
  v_pk_add_f32 v[26:27], v[26:27], v[30:31]
  v_cvt_pk_bf16_f32 v109, v26, v27
  v_lshlrev_b32 v26, 16, v110
  v_and_b32 v27, 0xffff0000, v110
  v_lshlrev_b32 v28, 16, v142
  v_and_b32 v29, 0xffff0000, v142
  v_pk_mul_f32 v[26:27], v[26:27], v[28:29]
  v_cvt_pk_bf16_f32 v28, v26, v27
  v_lshlrev_b32 v26, 16, v28
  v_and_b32 v27, 0xffff0000, v28
  v_lshlrev_b32 v30, 16, v134
  v_and_b32 v31, 0xffff0000, v134
  v_pk_add_f32 v[26:27], v[26:27], v[30:31]
  v_cvt_pk_bf16_f32 v110, v26, v27
  v_lshlrev_b32 v26, 16, v111
  v_and_b32 v27, 0xffff0000, v111
  v_lshlrev_b32 v28, 16, v143
  v_and_b32 v29, 0xffff0000, v143
  v_pk_mul_f32 v[26:27], v[26:27], v[28:29]
  v_cvt_pk_bf16_f32 v28, v26, v27
  v_lshlrev_b32 v26, 16, v28
  v_and_b32 v27, 0xffff0000, v28
  v_lshlrev_b32 v30, 16, v135
  v_and_b32 v31, 0xffff0000, v135
  v_pk_add_f32 v[26:27], v[26:27], v[30:31]
  v_cvt_pk_bf16_f32 v111, v26, v27
  buffer_store_dwordx4 v[104:107], v16, s[36:39], s89 offen offset:64
  buffer_store_dwordx4 v[108:111], v16, s[36:39], s89 offen offset:96
  buffer_load_dwordx4 v[128:131], v17, s[32:35], s89 offen offset:64
  s_add_u32 s49, s85, 131072
  buffer_load_dwordx4 v[136:139], v18, s[28:31], s49 offen offset:3072 sc1
  buffer_load_dwordx4 v[132:135], v17, s[32:35], s89 offen offset:96
  s_add_u32 s49, s85, 196608
  buffer_load_dwordx4 v[140:143], v18, s[28:31], s49 offen offset:3072 sc1
  v_accvgpr_read_b32 v176, a160
  v_accvgpr_read_b32 v177, a161
  v_accvgpr_read_b32 v178, a162
  v_accvgpr_read_b32 v179, a163
  v_accvgpr_read_b32 v180, a164
  v_accvgpr_read_b32 v181, a165
  v_accvgpr_read_b32 v182, a166
  v_accvgpr_read_b32 v183, a167
  v_accvgpr_read_b32 v184, a168
  v_accvgpr_read_b32 v185, a169
  v_accvgpr_read_b32 v186, a170
  v_accvgpr_read_b32 v187, a171
  v_accvgpr_read_b32 v188, a172
  v_accvgpr_read_b32 v189, a173
  v_accvgpr_read_b32 v190, a174
  v_accvgpr_read_b32 v191, a175
  v_cvt_pk_bf16_f32 v96, v176, v177
  v_cvt_pk_bf16_f32 v97, v178, v179
  v_cvt_pk_bf16_f32 v98, v180, v181
  v_cvt_pk_bf16_f32 v99, v182, v183
  v_cvt_pk_bf16_f32 v100, v184, v185
  v_cvt_pk_bf16_f32 v101, v186, v187
  v_cvt_pk_bf16_f32 v102, v188, v189
  v_cvt_pk_bf16_f32 v103, v190, v191
  v_permlane32_swap_b32 v96, v98
  v_permlane32_swap_b32 v97, v99
  v_permlane32_swap_b32 v100, v102
  v_permlane32_swap_b32 v101, v103
  s_waitcnt vmcnt(18)
  v_lshlrev_b32 v26, 16, v96
  v_and_b32 v27, 0xffff0000, v96
  v_lshlrev_b32 v28, 16, v152
  v_and_b32 v29, 0xffff0000, v152
  v_pk_mul_f32 v[26:27], v[26:27], v[28:29]
  v_cvt_pk_bf16_f32 v28, v26, v27
  v_lshlrev_b32 v26, 16, v28
  v_and_b32 v27, 0xffff0000, v28
  v_lshlrev_b32 v30, 16, v144
  v_and_b32 v31, 0xffff0000, v144
  v_pk_add_f32 v[26:27], v[26:27], v[30:31]
  v_cvt_pk_bf16_f32 v96, v26, v27
  v_lshlrev_b32 v26, 16, v97
  v_and_b32 v27, 0xffff0000, v97
  v_lshlrev_b32 v28, 16, v153
  v_and_b32 v29, 0xffff0000, v153
  v_pk_mul_f32 v[26:27], v[26:27], v[28:29]
  v_cvt_pk_bf16_f32 v28, v26, v27
  v_lshlrev_b32 v26, 16, v28
  v_and_b32 v27, 0xffff0000, v28
  v_lshlrev_b32 v30, 16, v145
  v_and_b32 v31, 0xffff0000, v145
  v_pk_add_f32 v[26:27], v[26:27], v[30:31]
  v_cvt_pk_bf16_f32 v97, v26, v27
  v_lshlrev_b32 v26, 16, v98
  v_and_b32 v27, 0xffff0000, v98
  v_lshlrev_b32 v28, 16, v154
  v_and_b32 v29, 0xffff0000, v154
  v_pk_mul_f32 v[26:27], v[26:27], v[28:29]
  v_cvt_pk_bf16_f32 v28, v26, v27
  v_lshlrev_b32 v26, 16, v28
  v_and_b32 v27, 0xffff0000, v28
  v_lshlrev_b32 v30, 16, v146
  v_and_b32 v31, 0xffff0000, v146
  v_pk_add_f32 v[26:27], v[26:27], v[30:31]
  v_cvt_pk_bf16_f32 v98, v26, v27
  v_lshlrev_b32 v26, 16, v99
  v_and_b32 v27, 0xffff0000, v99
  v_lshlrev_b32 v28, 16, v155
  v_and_b32 v29, 0xffff0000, v155
  v_pk_mul_f32 v[26:27], v[26:27], v[28:29]
  v_cvt_pk_bf16_f32 v28, v26, v27
  v_lshlrev_b32 v26, 16, v28
  v_and_b32 v27, 0xffff0000, v28
  v_lshlrev_b32 v30, 16, v147
  v_and_b32 v31, 0xffff0000, v147
  v_pk_add_f32 v[26:27], v[26:27], v[30:31]
  v_cvt_pk_bf16_f32 v99, v26, v27
  v_lshlrev_b32 v26, 16, v100
  v_and_b32 v27, 0xffff0000, v100
  v_lshlrev_b32 v28, 16, v156
  v_and_b32 v29, 0xffff0000, v156
  v_pk_mul_f32 v[26:27], v[26:27], v[28:29]
  v_cvt_pk_bf16_f32 v28, v26, v27
  v_lshlrev_b32 v26, 16, v28
  v_and_b32 v27, 0xffff0000, v28
  v_lshlrev_b32 v30, 16, v148
  v_and_b32 v31, 0xffff0000, v148
  v_pk_add_f32 v[26:27], v[26:27], v[30:31]
  v_cvt_pk_bf16_f32 v100, v26, v27
  v_lshlrev_b32 v26, 16, v101
  v_and_b32 v27, 0xffff0000, v101
  v_lshlrev_b32 v28, 16, v157
  v_and_b32 v29, 0xffff0000, v157
  v_pk_mul_f32 v[26:27], v[26:27], v[28:29]
  v_cvt_pk_bf16_f32 v28, v26, v27
  v_lshlrev_b32 v26, 16, v28
  v_and_b32 v27, 0xffff0000, v28
  v_lshlrev_b32 v30, 16, v149
  v_and_b32 v31, 0xffff0000, v149
  v_pk_add_f32 v[26:27], v[26:27], v[30:31]
  v_cvt_pk_bf16_f32 v101, v26, v27
  v_lshlrev_b32 v26, 16, v102
  v_and_b32 v27, 0xffff0000, v102
  v_lshlrev_b32 v28, 16, v158
  v_and_b32 v29, 0xffff0000, v158
  v_pk_mul_f32 v[26:27], v[26:27], v[28:29]
  v_cvt_pk_bf16_f32 v28, v26, v27
  v_lshlrev_b32 v26, 16, v28
  v_and_b32 v27, 0xffff0000, v28
  v_lshlrev_b32 v30, 16, v150
  v_and_b32 v31, 0xffff0000, v150
  v_pk_add_f32 v[26:27], v[26:27], v[30:31]
  v_cvt_pk_bf16_f32 v102, v26, v27
  v_lshlrev_b32 v26, 16, v103
  v_and_b32 v27, 0xffff0000, v103
  v_lshlrev_b32 v28, 16, v159
  v_and_b32 v29, 0xffff0000, v159
  v_pk_mul_f32 v[26:27], v[26:27], v[28:29]
  v_cvt_pk_bf16_f32 v28, v26, v27
  v_lshlrev_b32 v26, 16, v28
  v_and_b32 v27, 0xffff0000, v28
  v_lshlrev_b32 v30, 16, v151
  v_and_b32 v31, 0xffff0000, v151
  v_pk_add_f32 v[26:27], v[26:27], v[30:31]
  v_cvt_pk_bf16_f32 v103, v26, v27
  buffer_store_dwordx4 v[96:99], v16, s[36:39], s89 offen offset:128
  buffer_store_dwordx4 v[100:103], v16, s[36:39], s89 offen offset:160
  buffer_load_dwordx4 v[144:147], v17, s[32:35], s89 offen offset:128
  s_add_u32 s49, s85, 262144
  buffer_load_dwordx4 v[152:155], v18, s[28:31], s49 offen offset:3072 sc1
  buffer_load_dwordx4 v[148:151], v17, s[32:35], s89 offen offset:160
  s_add_u32 s49, s85, 327680
  buffer_load_dwordx4 v[156:159], v18, s[28:31], s49 offen offset:3072 sc1
  v_accvgpr_read_b32 v176, a224
  v_accvgpr_read_b32 v177, a225
  v_accvgpr_read_b32 v178, a226
  v_accvgpr_read_b32 v179, a227
  v_accvgpr_read_b32 v180, a228
  v_accvgpr_read_b32 v181, a229
  v_accvgpr_read_b32 v182, a230
  v_accvgpr_read_b32 v183, a231
  v_accvgpr_read_b32 v184, a232
  v_accvgpr_read_b32 v185, a233
  v_accvgpr_read_b32 v186, a234
  v_accvgpr_read_b32 v187, a235
  v_accvgpr_read_b32 v188, a236
  v_accvgpr_read_b32 v189, a237
  v_accvgpr_read_b32 v190, a238
  v_accvgpr_read_b32 v191, a239
  v_cvt_pk_bf16_f32 v104, v176, v177
  v_cvt_pk_bf16_f32 v105, v178, v179
  v_cvt_pk_bf16_f32 v106, v180, v181
  v_cvt_pk_bf16_f32 v107, v182, v183
  v_cvt_pk_bf16_f32 v108, v184, v185
  v_cvt_pk_bf16_f32 v109, v186, v187
  v_cvt_pk_bf16_f32 v110, v188, v189
  v_cvt_pk_bf16_f32 v111, v190, v191
  v_permlane32_swap_b32 v104, v106
  v_permlane32_swap_b32 v105, v107
  v_permlane32_swap_b32 v108, v110
  v_permlane32_swap_b32 v109, v111
  s_waitcnt vmcnt(18)
  v_lshlrev_b32 v26, 16, v104
  v_and_b32 v27, 0xffff0000, v104
  v_lshlrev_b32 v28, 16, v168
  v_and_b32 v29, 0xffff0000, v168
  v_pk_mul_f32 v[26:27], v[26:27], v[28:29]
  v_cvt_pk_bf16_f32 v28, v26, v27
  v_lshlrev_b32 v26, 16, v28
  v_and_b32 v27, 0xffff0000, v28
  v_lshlrev_b32 v30, 16, v160
  v_and_b32 v31, 0xffff0000, v160
  v_pk_add_f32 v[26:27], v[26:27], v[30:31]
  v_cvt_pk_bf16_f32 v104, v26, v27
  v_lshlrev_b32 v26, 16, v105
  v_and_b32 v27, 0xffff0000, v105
  v_lshlrev_b32 v28, 16, v169
  v_and_b32 v29, 0xffff0000, v169
  v_pk_mul_f32 v[26:27], v[26:27], v[28:29]
  v_cvt_pk_bf16_f32 v28, v26, v27
  v_lshlrev_b32 v26, 16, v28
  v_and_b32 v27, 0xffff0000, v28
  v_lshlrev_b32 v30, 16, v161
  v_and_b32 v31, 0xffff0000, v161
  v_pk_add_f32 v[26:27], v[26:27], v[30:31]
  v_cvt_pk_bf16_f32 v105, v26, v27
  v_lshlrev_b32 v26, 16, v106
  v_and_b32 v27, 0xffff0000, v106
  v_lshlrev_b32 v28, 16, v170
  v_and_b32 v29, 0xffff0000, v170
  v_pk_mul_f32 v[26:27], v[26:27], v[28:29]
  v_cvt_pk_bf16_f32 v28, v26, v27
  v_lshlrev_b32 v26, 16, v28
  v_and_b32 v27, 0xffff0000, v28
  v_lshlrev_b32 v30, 16, v162
  v_and_b32 v31, 0xffff0000, v162
  v_pk_add_f32 v[26:27], v[26:27], v[30:31]
  v_cvt_pk_bf16_f32 v106, v26, v27
  v_lshlrev_b32 v26, 16, v107
  v_and_b32 v27, 0xffff0000, v107
  v_lshlrev_b32 v28, 16, v171
  v_and_b32 v29, 0xffff0000, v171
  v_pk_mul_f32 v[26:27], v[26:27], v[28:29]
  v_cvt_pk_bf16_f32 v28, v26, v27
  v_lshlrev_b32 v26, 16, v28
  v_and_b32 v27, 0xffff0000, v28
  v_lshlrev_b32 v30, 16, v163
  v_and_b32 v31, 0xffff0000, v163
  v_pk_add_f32 v[26:27], v[26:27], v[30:31]
  v_cvt_pk_bf16_f32 v107, v26, v27
  v_lshlrev_b32 v26, 16, v108
  v_and_b32 v27, 0xffff0000, v108
  v_lshlrev_b32 v28, 16, v172
  v_and_b32 v29, 0xffff0000, v172
  v_pk_mul_f32 v[26:27], v[26:27], v[28:29]
  v_cvt_pk_bf16_f32 v28, v26, v27
  v_lshlrev_b32 v26, 16, v28
  v_and_b32 v27, 0xffff0000, v28
  v_lshlrev_b32 v30, 16, v164
  v_and_b32 v31, 0xffff0000, v164
  v_pk_add_f32 v[26:27], v[26:27], v[30:31]
  v_cvt_pk_bf16_f32 v108, v26, v27
  v_lshlrev_b32 v26, 16, v109
  v_and_b32 v27, 0xffff0000, v109
  v_lshlrev_b32 v28, 16, v173
  v_and_b32 v29, 0xffff0000, v173
  v_pk_mul_f32 v[26:27], v[26:27], v[28:29]
  v_cvt_pk_bf16_f32 v28, v26, v27
  v_lshlrev_b32 v26, 16, v28
  v_and_b32 v27, 0xffff0000, v28
  v_lshlrev_b32 v30, 16, v165
  v_and_b32 v31, 0xffff0000, v165
  v_pk_add_f32 v[26:27], v[26:27], v[30:31]
  v_cvt_pk_bf16_f32 v109, v26, v27
  v_lshlrev_b32 v26, 16, v110
  v_and_b32 v27, 0xffff0000, v110
  v_lshlrev_b32 v28, 16, v174
  v_and_b32 v29, 0xffff0000, v174
  v_pk_mul_f32 v[26:27], v[26:27], v[28:29]
  v_cvt_pk_bf16_f32 v28, v26, v27
  v_lshlrev_b32 v26, 16, v28
  v_and_b32 v27, 0xffff0000, v28
  v_lshlrev_b32 v30, 16, v166
  v_and_b32 v31, 0xffff0000, v166
  v_pk_add_f32 v[26:27], v[26:27], v[30:31]
  v_cvt_pk_bf16_f32 v110, v26, v27
  v_lshlrev_b32 v26, 16, v111
  v_and_b32 v27, 0xffff0000, v111
  v_lshlrev_b32 v28, 16, v175
  v_and_b32 v29, 0xffff0000, v175
  v_pk_mul_f32 v[26:27], v[26:27], v[28:29]
  v_cvt_pk_bf16_f32 v28, v26, v27
  v_lshlrev_b32 v26, 16, v28
  v_and_b32 v27, 0xffff0000, v28
  v_lshlrev_b32 v30, 16, v167
  v_and_b32 v31, 0xffff0000, v167
  v_pk_add_f32 v[26:27], v[26:27], v[30:31]
  v_cvt_pk_bf16_f32 v111, v26, v27
  buffer_store_dwordx4 v[104:107], v16, s[36:39], s89 offen offset:192
  buffer_store_dwordx4 v[108:111], v16, s[36:39], s89 offen offset:224
  buffer_load_dwordx4 v[160:163], v17, s[32:35], s89 offen offset:192
  s_add_u32 s49, s85, 393216
  buffer_load_dwordx4 v[168:171], v18, s[28:31], s49 offen offset:3072 sc1
  buffer_load_dwordx4 v[164:167], v17, s[32:35], s89 offen offset:224
  s_add_u32 s49, s85, 458752
  buffer_load_dwordx4 v[172:175], v18, s[28:31], s49 offen offset:3072 sc1
  v_accvgpr_read_b32 v176, a48
  v_accvgpr_read_b32 v177, a49
  v_accvgpr_read_b32 v178, a50
  v_accvgpr_read_b32 v179, a51
  v_accvgpr_read_b32 v180, a52
  v_accvgpr_read_b32 v181, a53
  v_accvgpr_read_b32 v182, a54
  v_accvgpr_read_b32 v183, a55
  v_accvgpr_read_b32 v184, a56
  v_accvgpr_read_b32 v185, a57
  v_accvgpr_read_b32 v186, a58
  v_accvgpr_read_b32 v187, a59
  v_accvgpr_read_b32 v188, a60
  v_accvgpr_read_b32 v189, a61
  v_accvgpr_read_b32 v190, a62
  v_accvgpr_read_b32 v191, a63
  v_cvt_pk_bf16_f32 v96, v176, v177
  v_cvt_pk_bf16_f32 v97, v178, v179
  v_cvt_pk_bf16_f32 v98, v180, v181
  v_cvt_pk_bf16_f32 v99, v182, v183
  v_cvt_pk_bf16_f32 v100, v184, v185
  v_cvt_pk_bf16_f32 v101, v186, v187
  v_cvt_pk_bf16_f32 v102, v188, v189
  v_cvt_pk_bf16_f32 v103, v190, v191
  v_permlane32_swap_b32 v96, v98
  v_permlane32_swap_b32 v97, v99
  v_permlane32_swap_b32 v100, v102
  v_permlane32_swap_b32 v101, v103
  s_waitcnt vmcnt(18)
  v_lshlrev_b32 v26, 16, v96
  v_and_b32 v27, 0xffff0000, v96
  v_lshlrev_b32 v28, 16, v120
  v_and_b32 v29, 0xffff0000, v120
  v_pk_mul_f32 v[26:27], v[26:27], v[28:29]
  v_cvt_pk_bf16_f32 v28, v26, v27
  v_lshlrev_b32 v26, 16, v28
  v_and_b32 v27, 0xffff0000, v28
  v_lshlrev_b32 v30, 16, v112
  v_and_b32 v31, 0xffff0000, v112
  v_pk_add_f32 v[26:27], v[26:27], v[30:31]
  v_cvt_pk_bf16_f32 v96, v26, v27
  v_lshlrev_b32 v26, 16, v97
  v_and_b32 v27, 0xffff0000, v97
  v_lshlrev_b32 v28, 16, v121
  v_and_b32 v29, 0xffff0000, v121
  v_pk_mul_f32 v[26:27], v[26:27], v[28:29]
  v_cvt_pk_bf16_f32 v28, v26, v27
  v_lshlrev_b32 v26, 16, v28
  v_and_b32 v27, 0xffff0000, v28
  v_lshlrev_b32 v30, 16, v113
  v_and_b32 v31, 0xffff0000, v113
  v_pk_add_f32 v[26:27], v[26:27], v[30:31]
  v_cvt_pk_bf16_f32 v97, v26, v27
  v_lshlrev_b32 v26, 16, v98
  v_and_b32 v27, 0xffff0000, v98
  v_lshlrev_b32 v28, 16, v122
  v_and_b32 v29, 0xffff0000, v122
  v_pk_mul_f32 v[26:27], v[26:27], v[28:29]
  v_cvt_pk_bf16_f32 v28, v26, v27
  v_lshlrev_b32 v26, 16, v28
  v_and_b32 v27, 0xffff0000, v28
  v_lshlrev_b32 v30, 16, v114
  v_and_b32 v31, 0xffff0000, v114
  v_pk_add_f32 v[26:27], v[26:27], v[30:31]
  v_cvt_pk_bf16_f32 v98, v26, v27
  v_lshlrev_b32 v26, 16, v99
  v_and_b32 v27, 0xffff0000, v99
  v_lshlrev_b32 v28, 16, v123
  v_and_b32 v29, 0xffff0000, v123
  v_pk_mul_f32 v[26:27], v[26:27], v[28:29]
  v_cvt_pk_bf16_f32 v28, v26, v27
  v_lshlrev_b32 v26, 16, v28
  v_and_b32 v27, 0xffff0000, v28
  v_lshlrev_b32 v30, 16, v115
  v_and_b32 v31, 0xffff0000, v115
  v_pk_add_f32 v[26:27], v[26:27], v[30:31]
  v_cvt_pk_bf16_f32 v99, v26, v27
  v_lshlrev_b32 v26, 16, v100
  v_and_b32 v27, 0xffff0000, v100
  v_lshlrev_b32 v28, 16, v124
  v_and_b32 v29, 0xffff0000, v124
  v_pk_mul_f32 v[26:27], v[26:27], v[28:29]
  v_cvt_pk_bf16_f32 v28, v26, v27
  v_lshlrev_b32 v26, 16, v28
  v_and_b32 v27, 0xffff0000, v28
  v_lshlrev_b32 v30, 16, v116
  v_and_b32 v31, 0xffff0000, v116
  v_pk_add_f32 v[26:27], v[26:27], v[30:31]
  v_cvt_pk_bf16_f32 v100, v26, v27
  v_lshlrev_b32 v26, 16, v101
  v_and_b32 v27, 0xffff0000, v101
  v_lshlrev_b32 v28, 16, v125
  v_and_b32 v29, 0xffff0000, v125
  v_pk_mul_f32 v[26:27], v[26:27], v[28:29]
  v_cvt_pk_bf16_f32 v28, v26, v27
  v_lshlrev_b32 v26, 16, v28
  v_and_b32 v27, 0xffff0000, v28
  v_lshlrev_b32 v30, 16, v117
  v_and_b32 v31, 0xffff0000, v117
  v_pk_add_f32 v[26:27], v[26:27], v[30:31]
  v_cvt_pk_bf16_f32 v101, v26, v27
  v_lshlrev_b32 v26, 16, v102
  v_and_b32 v27, 0xffff0000, v102
  v_lshlrev_b32 v28, 16, v126
  v_and_b32 v29, 0xffff0000, v126
  v_pk_mul_f32 v[26:27], v[26:27], v[28:29]
  v_cvt_pk_bf16_f32 v28, v26, v27
  v_lshlrev_b32 v26, 16, v28
  v_and_b32 v27, 0xffff0000, v28
  v_lshlrev_b32 v30, 16, v118
  v_and_b32 v31, 0xffff0000, v118
  v_pk_add_f32 v[26:27], v[26:27], v[30:31]
  v_cvt_pk_bf16_f32 v102, v26, v27
  v_lshlrev_b32 v26, 16, v103
  v_and_b32 v27, 0xffff0000, v103
  v_lshlrev_b32 v28, 16, v127
  v_and_b32 v29, 0xffff0000, v127
  v_pk_mul_f32 v[26:27], v[26:27], v[28:29]
  v_cvt_pk_bf16_f32 v28, v26, v27
  v_lshlrev_b32 v26, 16, v28
  v_and_b32 v27, 0xffff0000, v28
  v_lshlrev_b32 v30, 16, v119
  v_and_b32 v31, 0xffff0000, v119
  v_pk_add_f32 v[26:27], v[26:27], v[30:31]
  v_cvt_pk_bf16_f32 v103, v26, v27
  buffer_store_dwordx4 v[96:99], v17, s[36:39], s89 offen offset:0
  buffer_store_dwordx4 v[100:103], v17, s[36:39], s89 offen offset:32
  v_accvgpr_read_b32 v176, a112
  v_accvgpr_read_b32 v177, a113
  v_accvgpr_read_b32 v178, a114
  v_accvgpr_read_b32 v179, a115
  v_accvgpr_read_b32 v180, a116
  v_accvgpr_read_b32 v181, a117
  v_accvgpr_read_b32 v182, a118
  v_accvgpr_read_b32 v183, a119
  v_accvgpr_read_b32 v184, a120
  v_accvgpr_read_b32 v185, a121
  v_accvgpr_read_b32 v186, a122
  v_accvgpr_read_b32 v187, a123
  v_accvgpr_read_b32 v188, a124
  v_accvgpr_read_b32 v189, a125
  v_accvgpr_read_b32 v190, a126
  v_accvgpr_read_b32 v191, a127
  v_cvt_pk_bf16_f32 v104, v176, v177
  v_cvt_pk_bf16_f32 v105, v178, v179
  v_cvt_pk_bf16_f32 v106, v180, v181
  v_cvt_pk_bf16_f32 v107, v182, v183
  v_cvt_pk_bf16_f32 v108, v184, v185
  v_cvt_pk_bf16_f32 v109, v186, v187
  v_cvt_pk_bf16_f32 v110, v188, v189
  v_cvt_pk_bf16_f32 v111, v190, v191
  v_permlane32_swap_b32 v104, v106
  v_permlane32_swap_b32 v105, v107
  v_permlane32_swap_b32 v108, v110
  v_permlane32_swap_b32 v109, v111
  s_waitcnt vmcnt(14)
  v_lshlrev_b32 v26, 16, v104
  v_and_b32 v27, 0xffff0000, v104
  v_lshlrev_b32 v28, 16, v136
  v_and_b32 v29, 0xffff0000, v136
  v_pk_mul_f32 v[26:27], v[26:27], v[28:29]
  v_cvt_pk_bf16_f32 v28, v26, v27
  v_lshlrev_b32 v26, 16, v28
  v_and_b32 v27, 0xffff0000, v28
  v_lshlrev_b32 v30, 16, v128
  v_and_b32 v31, 0xffff0000, v128
  v_pk_add_f32 v[26:27], v[26:27], v[30:31]
  v_cvt_pk_bf16_f32 v104, v26, v27
  v_lshlrev_b32 v26, 16, v105
  v_and_b32 v27, 0xffff0000, v105
  v_lshlrev_b32 v28, 16, v137
  v_and_b32 v29, 0xffff0000, v137
  v_pk_mul_f32 v[26:27], v[26:27], v[28:29]
  v_cvt_pk_bf16_f32 v28, v26, v27
  v_lshlrev_b32 v26, 16, v28
  v_and_b32 v27, 0xffff0000, v28
  v_lshlrev_b32 v30, 16, v129
  v_and_b32 v31, 0xffff0000, v129
  v_pk_add_f32 v[26:27], v[26:27], v[30:31]
  v_cvt_pk_bf16_f32 v105, v26, v27
  v_lshlrev_b32 v26, 16, v106
  v_and_b32 v27, 0xffff0000, v106
  v_lshlrev_b32 v28, 16, v138
  v_and_b32 v29, 0xffff0000, v138
  v_pk_mul_f32 v[26:27], v[26:27], v[28:29]
  v_cvt_pk_bf16_f32 v28, v26, v27
  v_lshlrev_b32 v26, 16, v28
  v_and_b32 v27, 0xffff0000, v28
  v_lshlrev_b32 v30, 16, v130
  v_and_b32 v31, 0xffff0000, v130
  v_pk_add_f32 v[26:27], v[26:27], v[30:31]
  v_cvt_pk_bf16_f32 v106, v26, v27
  v_lshlrev_b32 v26, 16, v107
  v_and_b32 v27, 0xffff0000, v107
  v_lshlrev_b32 v28, 16, v139
  v_and_b32 v29, 0xffff0000, v139
  v_pk_mul_f32 v[26:27], v[26:27], v[28:29]
  v_cvt_pk_bf16_f32 v28, v26, v27
  v_lshlrev_b32 v26, 16, v28
  v_and_b32 v27, 0xffff0000, v28
  v_lshlrev_b32 v30, 16, v131
  v_and_b32 v31, 0xffff0000, v131
  v_pk_add_f32 v[26:27], v[26:27], v[30:31]
  v_cvt_pk_bf16_f32 v107, v26, v27
  v_lshlrev_b32 v26, 16, v108
  v_and_b32 v27, 0xffff0000, v108
  v_lshlrev_b32 v28, 16, v140
  v_and_b32 v29, 0xffff0000, v140
  v_pk_mul_f32 v[26:27], v[26:27], v[28:29]
  v_cvt_pk_bf16_f32 v28, v26, v27
  v_lshlrev_b32 v26, 16, v28
  v_and_b32 v27, 0xffff0000, v28
  v_lshlrev_b32 v30, 16, v132
  v_and_b32 v31, 0xffff0000, v132
  v_pk_add_f32 v[26:27], v[26:27], v[30:31]
  v_cvt_pk_bf16_f32 v108, v26, v27
  v_lshlrev_b32 v26, 16, v109
  v_and_b32 v27, 0xffff0000, v109
  v_lshlrev_b32 v28, 16, v141
  v_and_b32 v29, 0xffff0000, v141
  v_pk_mul_f32 v[26:27], v[26:27], v[28:29]
  v_cvt_pk_bf16_f32 v28, v26, v27
  v_lshlrev_b32 v26, 16, v28
  v_and_b32 v27, 0xffff0000, v28
  v_lshlrev_b32 v30, 16, v133
  v_and_b32 v31, 0xffff0000, v133
  v_pk_add_f32 v[26:27], v[26:27], v[30:31]
  v_cvt_pk_bf16_f32 v109, v26, v27
  v_lshlrev_b32 v26, 16, v110
  v_and_b32 v27, 0xffff0000, v110
  v_lshlrev_b32 v28, 16, v142
  v_and_b32 v29, 0xffff0000, v142
  v_pk_mul_f32 v[26:27], v[26:27], v[28:29]
  v_cvt_pk_bf16_f32 v28, v26, v27
  v_lshlrev_b32 v26, 16, v28
  v_and_b32 v27, 0xffff0000, v28
  v_lshlrev_b32 v30, 16, v134
  v_and_b32 v31, 0xffff0000, v134
  v_pk_add_f32 v[26:27], v[26:27], v[30:31]
  v_cvt_pk_bf16_f32 v110, v26, v27
  v_lshlrev_b32 v26, 16, v111
  v_and_b32 v27, 0xffff0000, v111
  v_lshlrev_b32 v28, 16, v143
  v_and_b32 v29, 0xffff0000, v143
  v_pk_mul_f32 v[26:27], v[26:27], v[28:29]
  v_cvt_pk_bf16_f32 v28, v26, v27
  v_lshlrev_b32 v26, 16, v28
  v_and_b32 v27, 0xffff0000, v28
  v_lshlrev_b32 v30, 16, v135
  v_and_b32 v31, 0xffff0000, v135
  v_pk_add_f32 v[26:27], v[26:27], v[30:31]
  v_cvt_pk_bf16_f32 v111, v26, v27
  buffer_store_dwordx4 v[104:107], v17, s[36:39], s89 offen offset:64
  buffer_store_dwordx4 v[108:111], v17, s[36:39], s89 offen offset:96
  v_accvgpr_read_b32 v176, a176
  v_accvgpr_read_b32 v177, a177
  v_accvgpr_read_b32 v178, a178
  v_accvgpr_read_b32 v179, a179
  v_accvgpr_read_b32 v180, a180
  v_accvgpr_read_b32 v181, a181
  v_accvgpr_read_b32 v182, a182
  v_accvgpr_read_b32 v183, a183
  v_accvgpr_read_b32 v184, a184
  v_accvgpr_read_b32 v185, a185
  v_accvgpr_read_b32 v186, a186
  v_accvgpr_read_b32 v187, a187
  v_accvgpr_read_b32 v188, a188
  v_accvgpr_read_b32 v189, a189
  v_accvgpr_read_b32 v190, a190
  v_accvgpr_read_b32 v191, a191
  v_cvt_pk_bf16_f32 v96, v176, v177
  v_cvt_pk_bf16_f32 v97, v178, v179
  v_cvt_pk_bf16_f32 v98, v180, v181
  v_cvt_pk_bf16_f32 v99, v182, v183
  v_cvt_pk_bf16_f32 v100, v184, v185
  v_cvt_pk_bf16_f32 v101, v186, v187
  v_cvt_pk_bf16_f32 v102, v188, v189
  v_cvt_pk_bf16_f32 v103, v190, v191
  v_permlane32_swap_b32 v96, v98
  v_permlane32_swap_b32 v97, v99
  v_permlane32_swap_b32 v100, v102
  v_permlane32_swap_b32 v101, v103
  s_waitcnt vmcnt(10)
  v_lshlrev_b32 v26, 16, v96
  v_and_b32 v27, 0xffff0000, v96
  v_lshlrev_b32 v28, 16, v152
  v_and_b32 v29, 0xffff0000, v152
  v_pk_mul_f32 v[26:27], v[26:27], v[28:29]
  v_cvt_pk_bf16_f32 v28, v26, v27
  v_lshlrev_b32 v26, 16, v28
  v_and_b32 v27, 0xffff0000, v28
  v_lshlrev_b32 v30, 16, v144
  v_and_b32 v31, 0xffff0000, v144
  v_pk_add_f32 v[26:27], v[26:27], v[30:31]
  v_cvt_pk_bf16_f32 v96, v26, v27
  v_lshlrev_b32 v26, 16, v97
  v_and_b32 v27, 0xffff0000, v97
  v_lshlrev_b32 v28, 16, v153
  v_and_b32 v29, 0xffff0000, v153
  v_pk_mul_f32 v[26:27], v[26:27], v[28:29]
  v_cvt_pk_bf16_f32 v28, v26, v27
  v_lshlrev_b32 v26, 16, v28
  v_and_b32 v27, 0xffff0000, v28
  v_lshlrev_b32 v30, 16, v145
  v_and_b32 v31, 0xffff0000, v145
  v_pk_add_f32 v[26:27], v[26:27], v[30:31]
  v_cvt_pk_bf16_f32 v97, v26, v27
  v_lshlrev_b32 v26, 16, v98
  v_and_b32 v27, 0xffff0000, v98
  v_lshlrev_b32 v28, 16, v154
  v_and_b32 v29, 0xffff0000, v154
  v_pk_mul_f32 v[26:27], v[26:27], v[28:29]
  v_cvt_pk_bf16_f32 v28, v26, v27
  v_lshlrev_b32 v26, 16, v28
  v_and_b32 v27, 0xffff0000, v28
  v_lshlrev_b32 v30, 16, v146
  v_and_b32 v31, 0xffff0000, v146
  v_pk_add_f32 v[26:27], v[26:27], v[30:31]
  v_cvt_pk_bf16_f32 v98, v26, v27
  v_lshlrev_b32 v26, 16, v99
  v_and_b32 v27, 0xffff0000, v99
  v_lshlrev_b32 v28, 16, v155
  v_and_b32 v29, 0xffff0000, v155
  v_pk_mul_f32 v[26:27], v[26:27], v[28:29]
  v_cvt_pk_bf16_f32 v28, v26, v27
  v_lshlrev_b32 v26, 16, v28
  v_and_b32 v27, 0xffff0000, v28
  v_lshlrev_b32 v30, 16, v147
  v_and_b32 v31, 0xffff0000, v147
  v_pk_add_f32 v[26:27], v[26:27], v[30:31]
  v_cvt_pk_bf16_f32 v99, v26, v27
  v_lshlrev_b32 v26, 16, v100
  v_and_b32 v27, 0xffff0000, v100
  v_lshlrev_b32 v28, 16, v156
  v_and_b32 v29, 0xffff0000, v156
  v_pk_mul_f32 v[26:27], v[26:27], v[28:29]
  v_cvt_pk_bf16_f32 v28, v26, v27
  v_lshlrev_b32 v26, 16, v28
  v_and_b32 v27, 0xffff0000, v28
  v_lshlrev_b32 v30, 16, v148
  v_and_b32 v31, 0xffff0000, v148
  v_pk_add_f32 v[26:27], v[26:27], v[30:31]
  v_cvt_pk_bf16_f32 v100, v26, v27
  v_lshlrev_b32 v26, 16, v101
  v_and_b32 v27, 0xffff0000, v101
  v_lshlrev_b32 v28, 16, v157
  v_and_b32 v29, 0xffff0000, v157
  v_pk_mul_f32 v[26:27], v[26:27], v[28:29]
  v_cvt_pk_bf16_f32 v28, v26, v27
  v_lshlrev_b32 v26, 16, v28
  v_and_b32 v27, 0xffff0000, v28
  v_lshlrev_b32 v30, 16, v149
  v_and_b32 v31, 0xffff0000, v149
  v_pk_add_f32 v[26:27], v[26:27], v[30:31]
  v_cvt_pk_bf16_f32 v101, v26, v27
  v_lshlrev_b32 v26, 16, v102
  v_and_b32 v27, 0xffff0000, v102
  v_lshlrev_b32 v28, 16, v158
  v_and_b32 v29, 0xffff0000, v158
  v_pk_mul_f32 v[26:27], v[26:27], v[28:29]
  v_cvt_pk_bf16_f32 v28, v26, v27
  v_lshlrev_b32 v26, 16, v28
  v_and_b32 v27, 0xffff0000, v28
  v_lshlrev_b32 v30, 16, v150
  v_and_b32 v31, 0xffff0000, v150
  v_pk_add_f32 v[26:27], v[26:27], v[30:31]
  v_cvt_pk_bf16_f32 v102, v26, v27
  v_lshlrev_b32 v26, 16, v103
  v_and_b32 v27, 0xffff0000, v103
  v_lshlrev_b32 v28, 16, v159
  v_and_b32 v29, 0xffff0000, v159
  v_pk_mul_f32 v[26:27], v[26:27], v[28:29]
  v_cvt_pk_bf16_f32 v28, v26, v27
  v_lshlrev_b32 v26, 16, v28
  v_and_b32 v27, 0xffff0000, v28
  v_lshlrev_b32 v30, 16, v151
  v_and_b32 v31, 0xffff0000, v151
  v_pk_add_f32 v[26:27], v[26:27], v[30:31]
  v_cvt_pk_bf16_f32 v103, v26, v27
  buffer_store_dwordx4 v[96:99], v17, s[36:39], s89 offen offset:128
  buffer_store_dwordx4 v[100:103], v17, s[36:39], s89 offen offset:160
  v_accvgpr_read_b32 v176, a240
  v_accvgpr_read_b32 v177, a241
  v_accvgpr_read_b32 v178, a242
  v_accvgpr_read_b32 v179, a243
  v_accvgpr_read_b32 v180, a244
  v_accvgpr_read_b32 v181, a245
  v_accvgpr_read_b32 v182, a246
  v_accvgpr_read_b32 v183, a247
  v_accvgpr_read_b32 v184, a248
  v_accvgpr_read_b32 v185, a249
  v_accvgpr_read_b32 v186, a250
  v_accvgpr_read_b32 v187, a251
  v_accvgpr_read_b32 v188, a252
  v_accvgpr_read_b32 v189, a253
  v_accvgpr_read_b32 v190, a254
  v_accvgpr_read_b32 v191, a255
  v_cvt_pk_bf16_f32 v104, v176, v177
  v_cvt_pk_bf16_f32 v105, v178, v179
  v_cvt_pk_bf16_f32 v106, v180, v181
  v_cvt_pk_bf16_f32 v107, v182, v183
  v_cvt_pk_bf16_f32 v108, v184, v185
  v_cvt_pk_bf16_f32 v109, v186, v187
  v_cvt_pk_bf16_f32 v110, v188, v189
  v_cvt_pk_bf16_f32 v111, v190, v191
  v_permlane32_swap_b32 v104, v106
  v_permlane32_swap_b32 v105, v107
  v_permlane32_swap_b32 v108, v110
  v_permlane32_swap_b32 v109, v111
  s_waitcnt vmcnt(6)
  v_lshlrev_b32 v26, 16, v104
  v_and_b32 v27, 0xffff0000, v104
  v_lshlrev_b32 v28, 16, v168
  v_and_b32 v29, 0xffff0000, v168
  v_pk_mul_f32 v[26:27], v[26:27], v[28:29]
  v_cvt_pk_bf16_f32 v28, v26, v27
  v_lshlrev_b32 v26, 16, v28
  v_and_b32 v27, 0xffff0000, v28
  v_lshlrev_b32 v30, 16, v160
  v_and_b32 v31, 0xffff0000, v160
  v_pk_add_f32 v[26:27], v[26:27], v[30:31]
  v_cvt_pk_bf16_f32 v104, v26, v27
  v_lshlrev_b32 v26, 16, v105
  v_and_b32 v27, 0xffff0000, v105
  v_lshlrev_b32 v28, 16, v169
  v_and_b32 v29, 0xffff0000, v169
  v_pk_mul_f32 v[26:27], v[26:27], v[28:29]
  v_cvt_pk_bf16_f32 v28, v26, v27
  v_lshlrev_b32 v26, 16, v28
  v_and_b32 v27, 0xffff0000, v28
  v_lshlrev_b32 v30, 16, v161
  v_and_b32 v31, 0xffff0000, v161
  v_pk_add_f32 v[26:27], v[26:27], v[30:31]
  v_cvt_pk_bf16_f32 v105, v26, v27
  v_lshlrev_b32 v26, 16, v106
  v_and_b32 v27, 0xffff0000, v106
  v_lshlrev_b32 v28, 16, v170
  v_and_b32 v29, 0xffff0000, v170
  v_pk_mul_f32 v[26:27], v[26:27], v[28:29]
  v_cvt_pk_bf16_f32 v28, v26, v27
  v_lshlrev_b32 v26, 16, v28
  v_and_b32 v27, 0xffff0000, v28
  v_lshlrev_b32 v30, 16, v162
  v_and_b32 v31, 0xffff0000, v162
  v_pk_add_f32 v[26:27], v[26:27], v[30:31]
  v_cvt_pk_bf16_f32 v106, v26, v27
  v_lshlrev_b32 v26, 16, v107
  v_and_b32 v27, 0xffff0000, v107
  v_lshlrev_b32 v28, 16, v171
  v_and_b32 v29, 0xffff0000, v171
  v_pk_mul_f32 v[26:27], v[26:27], v[28:29]
  v_cvt_pk_bf16_f32 v28, v26, v27
  v_lshlrev_b32 v26, 16, v28
  v_and_b32 v27, 0xffff0000, v28
  v_lshlrev_b32 v30, 16, v163
  v_and_b32 v31, 0xffff0000, v163
  v_pk_add_f32 v[26:27], v[26:27], v[30:31]
  v_cvt_pk_bf16_f32 v107, v26, v27
  v_lshlrev_b32 v26, 16, v108
  v_and_b32 v27, 0xffff0000, v108
  v_lshlrev_b32 v28, 16, v172
  v_and_b32 v29, 0xffff0000, v172
  v_pk_mul_f32 v[26:27], v[26:27], v[28:29]
  v_cvt_pk_bf16_f32 v28, v26, v27
  v_lshlrev_b32 v26, 16, v28
  v_and_b32 v27, 0xffff0000, v28
  v_lshlrev_b32 v30, 16, v164
  v_and_b32 v31, 0xffff0000, v164
  v_pk_add_f32 v[26:27], v[26:27], v[30:31]
  v_cvt_pk_bf16_f32 v108, v26, v27
  v_lshlrev_b32 v26, 16, v109
  v_and_b32 v27, 0xffff0000, v109
  v_lshlrev_b32 v28, 16, v173
  v_and_b32 v29, 0xffff0000, v173
  v_pk_mul_f32 v[26:27], v[26:27], v[28:29]
  v_cvt_pk_bf16_f32 v28, v26, v27
  v_lshlrev_b32 v26, 16, v28
  v_and_b32 v27, 0xffff0000, v28
  v_lshlrev_b32 v30, 16, v165
  v_and_b32 v31, 0xffff0000, v165
  v_pk_add_f32 v[26:27], v[26:27], v[30:31]
  v_cvt_pk_bf16_f32 v109, v26, v27
  v_lshlrev_b32 v26, 16, v110
  v_and_b32 v27, 0xffff0000, v110
  v_lshlrev_b32 v28, 16, v174
  v_and_b32 v29, 0xffff0000, v174
  v_pk_mul_f32 v[26:27], v[26:27], v[28:29]
  v_cvt_pk_bf16_f32 v28, v26, v27
  v_lshlrev_b32 v26, 16, v28
  v_and_b32 v27, 0xffff0000, v28
  v_lshlrev_b32 v30, 16, v166
  v_and_b32 v31, 0xffff0000, v166
  v_pk_add_f32 v[26:27], v[26:27], v[30:31]
  v_cvt_pk_bf16_f32 v110, v26, v27
  v_lshlrev_b32 v26, 16, v111
  v_and_b32 v27, 0xffff0000, v111
  v_lshlrev_b32 v28, 16, v175
  v_and_b32 v29, 0xffff0000, v175
  v_pk_mul_f32 v[26:27], v[26:27], v[28:29]
  v_cvt_pk_bf16_f32 v28, v26, v27
  v_lshlrev_b32 v26, 16, v28
  v_and_b32 v27, 0xffff0000, v28
  v_lshlrev_b32 v30, 16, v167
  v_and_b32 v31, 0xffff0000, v167
  v_pk_add_f32 v[26:27], v[26:27], v[30:31]
  v_cvt_pk_bf16_f32 v111, v26, v27
  buffer_store_dwordx4 v[104:107], v17, s[36:39], s89 offen offset:192
  buffer_store_dwordx4 v[108:111], v17, s[36:39], s89 offen offset:224
  s_waitcnt vmcnt(0)
  s_barrier
  s_branch w_next
w_g5h:
  s_add_u32 s86, s82, 48
  s_lshl_b32 s61, s86, 7
  s_add_u32 s61, s61, 99614720
  s_cmp_lg_u32 s58, 0
  s_cbranch_scc1 wf_61_ok
wf_61:
  buffer_load_dword v26, v255, s[28:31], s61 offen sc1
  s_waitcnt vmcnt(0)
  v_readfirstlane_b32 s62, v26
  s_nop 3
  s_cmp_ge_u32 s62, 32
  s_cbranch_scc1 wf_61_ok
  s_sub_u32 s88, s88, 1
  s_cselect_b32 s88, 0, s88
  s_cbranch_scc1 wf_61_ok
  s_sleep 3
  s_branch wf_61
wf_61_ok:
  s_barrier
  s_nop 0
  s_lshl_b32 s89, s83, 9
  s_add_u32 s44, s12, s89
  s_addc_u32 s45, s13, 0
  s_sub_u32 s46, 8388608, s89
  s_mov_b32 s47, 0x20000
  s_lshl_b32 s89, s82, 13
  s_add_u32 s89, s89, 71303168
  s_add_u32 s40, s14, s89
  s_addc_u32 s41, s15, 0
  s_sub_u32 s40, s40, 4096
  s_subb_u32 s41, s41, 0
  s_sub_u32 s42, 268439552, s89
  s_mov_b32 s43, 0x20000
  s_mov_b32 s56, 64
  s_mov_b32 s75, 2
  s_mov_b32 s76, 131072
  s_mov_b32 s77, 262144
  s_mov_b32 s56, 64
  s_mov_b32 s57, 2048
  s_mov_b32 s51, 31
  s_branch w_h0
w_g5s:
  s_lshl_b32 s89, s83, 9
  s_lshl_b32 s86, s84, 20
  s_add_u32 s89, s89, s86
  s_add_u32 s44, s12, s89
  s_addc_u32 s45, s13, 0
  s_sub_u32 s46, 8388608, s89
  s_mov_b32 s47, 0x20000
  s_lshl_b32 s89, s82, 13
  s_lshl_b32 s86, s84, 21
  s_add_u32 s89, s89, s86
  s_add_u32 s89, s89, 71303168
  s_add_u32 s40, s14, s89
  s_addc_u32 s41, s15, 0
  s_sub_u32 s40, s40, 4096
  s_subb_u32 s41, s41, 0
  s_sub_u32 s42, 268439552, s89
  s_mov_b32 s43, 0x20000
  s_mov_b32 s56, 64
  s_mov_b32 s75, 2
  s_mov_b32 s76, 131072
  s_mov_b32 s77, 262144
  s_mov_b32 s56, 64
  s_mov_b32 s57, 2048
  s_mov_b32 s51, 3
  v_and_b32 v26, 31, v1
  s_mul_i32 s61, s60, 64
  v_add_u32 v27, s61, v26
  v_lshlrev_b32 v27, 7, v27
  v_bfe_u32 v26, v1, 1, 3
  v_lshrrev_b32 v18, 5, v1
  v_add_u32 v19, 0, v18
  v_xor_b32 v19, v19, v26
  v_lshl_add_u32 v14, v19, 4, v27
  v_add_u32 v19, 2, v18
  v_xor_b32 v19, v19, v26
  v_lshl_add_u32 v15, v19, 4, v27
  v_add_u32 v19, 4, v18
  v_xor_b32 v19, v19, v26
  v_lshl_add_u32 v16, v19, 4, v27
  v_add_u32 v19, 6, v18
  v_xor_b32 v19, v19, v26
  v_lshl_add_u32 v17, v19, 4, v27
  v_lshrrev_b32 v26, 3, v1
  s_mul_i32 s61, s58, 32
  v_add_u32 v26, s61, v26
  v_mul_lo_u32 v26, v26, s56
  v_lshrrev_b32 v27, 4, v1
  v_and_b32 v18, 7, v1
  s_lshl_b32 s62, s56, 3
  s_lshl_b32 s54, 1, s75
  s_sub_u32 s54, s54, 1
  v_add_u32 v19, 0, v27
  v_xor_b32 v19, v19, v18
  v_lshrrev_b32 v20, s75, v19
  v_mul_lo_u32 v20, v20, s76
  v_and_b32 v19, s54, v19
  v_lshl_add_u32 v2, v19, 4, v26
  v_add_u32 v2, v2, v20
  v_add_u32 v2, 4096, v2
  v_add_u32 v26, s62, v26
  v_add_u32 v19, 4, v27
  v_xor_b32 v19, v19, v18
  v_lshrrev_b32 v20, s75, v19
  v_mul_lo_u32 v20, v20, s76
  v_and_b32 v19, s54, v19
  v_lshl_add_u32 v3, v19, 4, v26
  v_add_u32 v3, v3, v20
  v_add_u32 v3, 3072, v3
  v_add_u32 v26, s62, v26
  v_add_u32 v19, 0, v27
  v_xor_b32 v19, v19, v18
  v_lshrrev_b32 v20, s75, v19
  v_mul_lo_u32 v20, v20, s76
  v_and_b32 v19, s54, v19
  v_lshl_add_u32 v4, v19, 4, v26
  v_add_u32 v4, v4, v20
  v_add_u32 v4, 4096, v4
  v_add_u32 v26, s62, v26
  v_add_u32 v19, 4, v27
  v_xor_b32 v19, v19, v18
  v_lshrrev_b32 v20, s75, v19
  v_mul_lo_u32 v20, v20, s76
  v_and_b32 v19, s54, v19
  v_lshl_add_u32 v5, v19, 4, v26
  v_add_u32 v5, v5, v20
  v_add_u32 v5, 3072, v5
  s_mul_i32 s54, s58, 4096
  v_lshrrev_b32 v27, 5, v1
  s_lshl_b32 s61, s58, 3
  v_add_u32 v26, s61, v27
  v_mul_lo_u32 v26, v26, s57
  v_and_b32 v18, 31, v1
  s_lshl_b32 s62, s57, 1
  v_add_u32 v19, 0, v27
  v_lshlrev_b32 v19, 2, v19
  v_xor_b32 v19, v19, v18
  v_lshl_add_u32 v10, v19, 4, v26
  v_add_u32 v26, s62, v26
  v_add_u32 v19, 2, v27
  v_lshlrev_b32 v19, 2, v19
  v_xor_b32 v19, v19, v18
  v_lshl_add_u32 v11, v19, 4, v26
  v_subrev_u32 v11, 1024, v11
  v_add_u32 v26, s62, v26
  v_add_u32 v19, 0, v27
  v_lshlrev_b32 v19, 2, v19
  v_xor_b32 v19, v19, v18
  v_lshl_add_u32 v12, v19, 4, v26
  v_subrev_u32 v12, 2048, v12
  v_add_u32 v26, s62, v26
  v_add_u32 v19, 2, v27
  v_lshlrev_b32 v19, 2, v19
  v_xor_b32 v19, v19, v18
  v_lshl_add_u32 v13, v19, 4, v26
  v_subrev_u32 v13, 3072, v13
  s_lshl_b32 s50, s57, 5
  s_mov_b32 s49, 0
  s_add_u32 m0, s55, 0
  s_nop 0
  buffer_load_dwordx4 v10, s[44:47], s49 offen offset:0 lds
  buffer_load_dwordx4 v11, s[44:47], s49 offen offset:1024 lds
  buffer_load_dwordx4 v12, s[44:47], s49 offen offset:2048 lds
  buffer_load_dwordx4 v13, s[44:47], s49 offen offset:3072 lds
  s_add_u32 s49, s49, s50
  s_add_u32 m0, s55, 16384
  s_nop 0
  buffer_load_dwordx4 v10, s[44:47], s49 offen offset:0 lds
  buffer_load_dwordx4 v11, s[44:47], s49 offen offset:1024 lds
  buffer_load_dwordx4 v12, s[44:47], s49 offen offset:2048 lds
  buffer_load_dwordx4 v13, s[44:47], s49 offen offset:3072 lds
  s_add_u32 s49, s49, s50
  s_add_u32 m0, s55, 32768
  s_nop 0
  buffer_load_dwordx4 v10, s[44:47], s49 offen offset:0 lds
  buffer_load_dwordx4 v11, s[44:47], s49 offen offset:1024 lds
  buffer_load_dwordx4 v12, s[44:47], s49 offen offset:2048 lds
  buffer_load_dwordx4 v13, s[44:47], s49 offen offset:3072 lds
  s_add_u32 s49, s49, s50
  s_add_u32 m0, s55, 49152
  s_nop 0
  buffer_load_dwordx4 v10, s[44:47], s49 offen offset:0 lds
  buffer_load_dwordx4 v11, s[44:47], s49 offen offset:1024 lds
  buffer_load_dwordx4 v12, s[44:47], s49 offen offset:2048 lds
  buffer_load_dwordx4 v13, s[44:47], s49 offen offset:3072 lds
  s_add_u32 s49, s49, s50
  s_lshl_b32 s86, s82, 3
  s_add_u32 s86, s86, s84
  s_add_u32 s86, s86, 320
  s_lshl_b32 s61, s86, 7
  s_add_u32 s61, s61, 99614720
  s_cmp_lg_u32 s58, 0
  s_cbranch_scc1 wf_62_ok
wf_62:
  buffer_load_dword v26, v255, s[28:31], s61 offen sc1
  s_waitcnt vmcnt(0)
  v_readfirstlane_b32 s62, v26
  s_nop 3
  s_cmp_ge_u32 s62, 4
  s_cbranch_scc1 wf_62_ok
  s_sub_u32 s88, s88, 1
  s_cselect_b32 s88, 0, s88
  s_cbranch_scc1 wf_62_ok
  s_sleep 3
  s_branch wf_62
wf_62_ok:
  s_barrier
  s_nop 0
  s_mov_b32 s48, 0
  s_mov_b32 s53, s54
  s_add_u32 m0, s53, 0
  s_nop 0
  buffer_load_dwordx4 v2, s[40:43], s48 offen offset:0 sc1 lds
  buffer_load_dwordx4 v3, s[40:43], s48 offen offset:1024 sc1 lds
  s_add_u32 m0, s53, 2048
  s_nop 0
  buffer_load_dwordx4 v4, s[40:43], s48 offen offset:0 sc1 lds
  buffer_load_dwordx4 v5, s[40:43], s48 offen offset:1024 sc1 lds
  s_add_u32 s48, s48, s77
  s_add_u32 s53, s54, 16384
  s_add_u32 m0, s53, 0
  s_nop 0
  buffer_load_dwordx4 v2, s[40:43], s48 offen offset:0 sc1 lds
  buffer_load_dwordx4 v3, s[40:43], s48 offen offset:1024 sc1 lds
  s_add_u32 m0, s53, 2048
  s_nop 0
  buffer_load_dwordx4 v4, s[40:43], s48 offen offset:0 sc1 lds
  buffer_load_dwordx4 v5, s[40:43], s48 offen offset:1024 sc1 lds
  s_add_u32 s48, s48, s77
  s_add_u32 s53, s54, 32768
  s_add_u32 m0, s53, 0
  s_nop 0
  buffer_load_dwordx4 v2, s[40:43], s48 offen offset:0 sc1 lds
  buffer_load_dwordx4 v3, s[40:43], s48 offen offset:1024 sc1 lds
  s_waitcnt vmcnt(0)
  s_branch w_h_pre
w_h0:
  v_and_b32 v26, 31, v1
  s_mul_i32 s61, s60, 64
  v_add_u32 v27, s61, v26
  v_lshlrev_b32 v27, 7, v27
  v_bfe_u32 v26, v1, 1, 3
  v_lshrrev_b32 v18, 5, v1
  v_add_u32 v19, 0, v18
  v_xor_b32 v19, v19, v26
  v_lshl_add_u32 v14, v19, 4, v27
  v_add_u32 v19, 2, v18
  v_xor_b32 v19, v19, v26
  v_lshl_add_u32 v15, v19, 4, v27
  v_add_u32 v19, 4, v18
  v_xor_b32 v19, v19, v26
  v_lshl_add_u32 v16, v19, 4, v27
  v_add_u32 v19, 6, v18
  v_xor_b32 v19, v19, v26
  v_lshl_add_u32 v17, v19, 4, v27
  v_lshrrev_b32 v26, 3, v1
  s_mul_i32 s61, s58, 32
  v_add_u32 v26, s61, v26
  v_mul_lo_u32 v26, v26, s56
  v_lshrrev_b32 v27, 4, v1
  v_and_b32 v18, 7, v1
  s_lshl_b32 s62, s56, 3
  s_lshl_b32 s54, 1, s75
  s_sub_u32 s54, s54, 1
  v_add_u32 v19, 0, v27
  v_xor_b32 v19, v19, v18
  v_lshrrev_b32 v20, s75, v19
  v_mul_lo_u32 v20, v20, s76
  v_and_b32 v19, s54, v19
  v_lshl_add_u32 v2, v19, 4, v26
  v_add_u32 v2, v2, v20
  v_add_u32 v2, 4096, v2
  v_add_u32 v26, s62, v26
  v_add_u32 v19, 4, v27
  v_xor_b32 v19, v19, v18
  v_lshrrev_b32 v20, s75, v19
  v_mul_lo_u32 v20, v20, s76
  v_and_b32 v19, s54, v19
  v_lshl_add_u32 v3, v19, 4, v26
  v_add_u32 v3, v3, v20
  v_add_u32 v3, 3072, v3
  v_add_u32 v26, s62, v26
  v_add_u32 v19, 0, v27
  v_xor_b32 v19, v19, v18
  v_lshrrev_b32 v20, s75, v19
  v_mul_lo_u32 v20, v20, s76
  v_and_b32 v19, s54, v19
  v_lshl_add_u32 v4, v19, 4, v26
  v_add_u32 v4, v4, v20
  v_add_u32 v4, 4096, v4
  v_add_u32 v26, s62, v26
  v_add_u32 v19, 4, v27
  v_xor_b32 v19, v19, v18
  v_lshrrev_b32 v20, s75, v19
  v_mul_lo_u32 v20, v20, s76
  v_and_b32 v19, s54, v19
  v_lshl_add_u32 v5, v19, 4, v26
  v_add_u32 v5, v5, v20
  v_add_u32 v5, 3072, v5
  s_mul_i32 s54, s58, 4096
  v_lshrrev_b32 v27, 5, v1
  s_lshl_b32 s61, s58, 3
  v_add_u32 v26, s61, v27
  v_mul_lo_u32 v26, v26, s57
  v_and_b32 v18, 31, v1
  s_lshl_b32 s62, s57, 1
  v_add_u32 v19, 0, v27
  v_lshlrev_b32 v19, 2, v19
  v_xor_b32 v19, v19, v18
  v_lshl_add_u32 v10, v19, 4, v26
  v_add_u32 v26, s62, v26
  v_add_u32 v19, 2, v27
  v_lshlrev_b32 v19, 2, v19
  v_xor_b32 v19, v19, v18
  v_lshl_add_u32 v11, v19, 4, v26
  v_subrev_u32 v11, 1024, v11
  v_add_u32 v26, s62, v26
  v_add_u32 v19, 0, v27
  v_lshlrev_b32 v19, 2, v19
  v_xor_b32 v19, v19, v18
  v_lshl_add_u32 v12, v19, 4, v26
  v_subrev_u32 v12, 2048, v12
  v_add_u32 v26, s62, v26
  v_add_u32 v19, 2, v27
  v_lshlrev_b32 v19, 2, v19
  v_xor_b32 v19, v19, v18
  v_lshl_add_u32 v13, v19, 4, v26
  v_subrev_u32 v13, 3072, v13
  s_lshl_b32 s50, s57, 5
  s_mov_b32 s48, 0
  s_mov_b32 s53, s54
  s_mov_b32 s49, 0
  s_add_u32 m0, s53, 0
  s_nop 0
  buffer_load_dwordx4 v2, s[40:43], s48 offen offset:0 sc1 lds
  buffer_load_dwordx4 v3, s[40:43], s48 offen offset:1024 sc1 lds
  s_add_u32 m0, s55, 0
  s_nop 0
  buffer_load_dwordx4 v10, s[44:47], s49 offen offset:0 lds
  buffer_load_dwordx4 v11, s[44:47], s49 offen offset:1024 lds
  buffer_load_dwordx4 v12, s[44:47], s49 offen offset:2048 lds
  buffer_load_dwordx4 v13, s[44:47], s49 offen offset:3072 lds
  s_add_u32 s49, s49, s50
  s_add_u32 m0, s53, 2048
  s_nop 0
  buffer_load_dwordx4 v4, s[40:43], s48 offen offset:0 sc1 lds
  buffer_load_dwordx4 v5, s[40:43], s48 offen offset:1024 sc1 lds
  s_add_u32 s48, s48, s77
  s_add_u32 s53, s54, 16384
  s_add_u32 m0, s55, 16384
  s_nop 0
  buffer_load_dwordx4 v10, s[44:47], s49 offen offset:0 lds
  buffer_load_dwordx4 v11, s[44:47], s49 offen offset:1024 lds
  buffer_load_dwordx4 v12, s[44:47], s49 offen offset:2048 lds
  buffer_load_dwordx4 v13, s[44:47], s49 offen offset:3072 lds
  s_add_u32 s49, s49, s50
  s_add_u32 m0, s53, 0
  s_nop 0
  buffer_load_dwordx4 v2, s[40:43], s48 offen offset:0 sc1 lds
  buffer_load_dwordx4 v3, s[40:43], s48 offen offset:1024 sc1 lds
  s_add_u32 m0, s55, 32768
  s_nop 0
  buffer_load_dwordx4 v10, s[44:47], s49 offen offset:0 lds
  buffer_load_dwordx4 v11, s[44:47], s49 offen offset:1024 lds
  buffer_load_dwordx4 v12, s[44:47], s49 offen offset:2048 lds
  buffer_load_dwordx4 v13, s[44:47], s49 offen offset:3072 lds
  s_add_u32 s49, s49, s50
  s_add_u32 m0, s53, 2048
  s_nop 0
  buffer_load_dwordx4 v4, s[40:43], s48 offen offset:0 sc1 lds
  buffer_load_dwordx4 v5, s[40:43], s48 offen offset:1024 sc1 lds
  s_add_u32 s48, s48, s77
  s_add_u32 s53, s54, 32768
  s_add_u32 m0, s55, 49152
  s_nop 0
  buffer_load_dwordx4 v10, s[44:47], s49 offen offset:0 lds
  buffer_load_dwordx4 v11, s[44:47], s49 offen offset:1024 lds
  buffer_load_dwordx4 v12, s[44:47], s49 offen offset:2048 lds
  buffer_load_dwordx4 v13, s[44:47], s49 offen offset:3072 lds
  s_add_u32 s49, s49, s50
  s_add_u32 m0, s53, 0
  s_nop 0
  buffer_load_dwordx4 v2, s[40:43], s48 offen offset:0 sc1 lds
  buffer_load_dwordx4 v3, s[40:43], s48 offen offset:1024 sc1 lds
  s_nop 0
w_h_pre:
  s_mov_b32 s52, 0
  v_mov_b32 v18, v14
  v_mov_b32 v19, v15
  v_mov_b32 v20, v16
  v_mov_b32 v21, v17
  s_waitcnt vmcnt(18)
  s_barrier
  ds_read_b128 v[48:51], v18 offset:0
  ds_read_b64_tr_b16 v[32:33], v22 offset:0
  ds_read_b64_tr_b16 v[34:35], v22 offset:2048
  ds_read_b128 v[52:55], v18 offset:4096
  ds_read_b64_tr_b16 v[36:37], v23 offset:0
  ds_read_b64_tr_b16 v[38:39], v23 offset:2048
  ds_read_b64_tr_b16 v[40:41], v24 offset:0
  ds_read_b64_tr_b16 v[42:43], v24 offset:2048
  ds_read_b64_tr_b16 v[44:45], v25 offset:0
  ds_read_b64_tr_b16 v[46:47], v25 offset:2048
  s_waitcnt lgkmcnt(0)
  v_mfma_f32_32x32x16_bf16 a[0:15], v[32:35], v[48:51], 0
  ds_read_b128 v[80:83], v19 offset:0
  ds_read_b64_tr_b16 v[64:65], v22 offset:8192
  v_mfma_f32_32x32x16_bf16 a[16:31], v[32:35], v[52:55], 0
  ds_read_b64_tr_b16 v[66:67], v22 offset:10240
  ds_read_b128 v[84:87], v19 offset:4096
  v_mfma_f32_32x32x16_bf16 a[32:47], v[36:39], v[48:51], 0
  ds_read_b64_tr_b16 v[68:69], v23 offset:8192
  ds_read_b64_tr_b16 v[70:71], v23 offset:10240
  v_mfma_f32_32x32x16_bf16 a[48:63], v[36:39], v[52:55], 0
  ds_read_b64_tr_b16 v[72:73], v24 offset:8192
  ds_read_b64_tr_b16 v[74:75], v24 offset:10240
  v_mfma_f32_32x32x16_bf16 a[64:79], v[40:43], v[48:51], 0
  ds_read_b64_tr_b16 v[76:77], v25 offset:8192
  ds_read_b64_tr_b16 v[78:79], v25 offset:10240
  v_mfma_f32_32x32x16_bf16 a[80:95], v[40:43], v[52:55], 0
  v_mfma_f32_32x32x16_bf16 a[96:111], v[44:47], v[48:51], 0
  v_mfma_f32_32x32x16_bf16 a[112:127], v[44:47], v[52:55], 0
  s_branch gm_h
  s_nop 10
gl_h:
  s_waitcnt lgkmcnt(0)
  v_mfma_f32_32x32x16_bf16 a[0:15], v[32:35], v[48:51], a[0:15]
  ds_read_b128 v[80:83], v19 offset:0
  ds_read_b64_tr_b16 v[64:65], v22 offset:8192
  v_mfma_f32_32x32x16_bf16 a[16:31], v[32:35], v[52:55], a[16:31]
  ds_read_b64_tr_b16 v[66:67], v22 offset:10240
  ds_read_b128 v[84:87], v19 offset:4096
  v_mfma_f32_32x32x16_bf16 a[32:47], v[36:39], v[48:51], a[32:47]
  ds_read_b64_tr_b16 v[68:69], v23 offset:8192
  ds_read_b64_tr_b16 v[70:71], v23 offset:10240
  v_mfma_f32_32x32x16_bf16 a[48:63], v[36:39], v[52:55], a[48:63]
  ds_read_b64_tr_b16 v[72:73], v24 offset:8192
  ds_read_b64_tr_b16 v[74:75], v24 offset:10240
  v_mfma_f32_32x32x16_bf16 a[64:79], v[40:43], v[48:51], a[64:79]
  ds_read_b64_tr_b16 v[76:77], v25 offset:8192
  ds_read_b64_tr_b16 v[78:79], v25 offset:10240
  v_mfma_f32_32x32x16_bf16 a[80:95], v[40:43], v[52:55], a[80:95]
  v_mfma_f32_32x32x16_bf16 a[96:111], v[44:47], v[48:51], a[96:111]
  v_mfma_f32_32x32x16_bf16 a[112:127], v[44:47], v[52:55], a[112:127]
gm_h:
  s_waitcnt lgkmcnt(0)
  v_mfma_f32_32x32x16_bf16 a[0:15], v[64:67], v[80:83], a[0:15]
  v_mfma_f32_32x32x16_bf16 a[16:31], v[64:67], v[84:87], a[16:31]
  s_waitcnt vmcnt(12)
  s_barrier
  v_mfma_f32_32x32x16_bf16 a[32:47], v[68:71], v[80:83], a[32:47]
  ds_read_b128 v[48:51], v20 offset:0
  s_add_u32 m0, s55, 0
  ds_read_b64_tr_b16 v[32:33], v22 offset:16384
  buffer_load_dwordx4 v10, s[44:47], s49 offen offset:0 lds
  v_mfma_f32_32x32x16_bf16 a[48:63], v[68:71], v[84:87], a[48:63]
  ds_read_b64_tr_b16 v[34:35], v22 offset:18432
  buffer_load_dwordx4 v11, s[44:47], s49 offen offset:1024 lds
  ds_read_b128 v[52:55], v20 offset:4096
  buffer_load_dwordx4 v12, s[44:47], s49 offen offset:2048 lds
  v_mfma_f32_32x32x16_bf16 a[64:79], v[72:75], v[80:83], a[64:79]
  ds_read_b64_tr_b16 v[36:37], v23 offset:16384
  buffer_load_dwordx4 v13, s[44:47], s49 offen offset:3072 lds
  ds_read_b64_tr_b16 v[38:39], v23 offset:18432
  s_add_u32 s49, s49, s50
  v_mfma_f32_32x32x16_bf16 a[80:95], v[72:75], v[84:87], a[80:95]
  ds_read_b64_tr_b16 v[40:41], v24 offset:16384
  s_add_u32 m0, s53, 2048
  ds_read_b64_tr_b16 v[42:43], v24 offset:18432
  buffer_load_dwordx4 v4, s[40:43], s48 offen offset:0 sc1 lds
  v_mfma_f32_32x32x16_bf16 a[96:111], v[76:79], v[80:83], a[96:111]
  ds_read_b64_tr_b16 v[44:45], v25 offset:16384
  buffer_load_dwordx4 v5, s[40:43], s48 offen offset:1024 sc1 lds
  ds_read_b64_tr_b16 v[46:47], v25 offset:18432
  s_add_u32 s48, s48, s77
  v_mfma_f32_32x32x16_bf16 a[112:127], v[76:79], v[84:87], a[112:127]
  s_waitcnt lgkmcnt(0)
  v_mfma_f32_32x32x16_bf16 a[0:15], v[32:35], v[48:51], a[0:15]
  ds_read_b128 v[80:83], v21 offset:0
  ds_read_b64_tr_b16 v[64:65], v22 offset:24576
  v_mfma_f32_32x32x16_bf16 a[16:31], v[32:35], v[52:55], a[16:31]
  ds_read_b64_tr_b16 v[66:67], v22 offset:26624
  ds_read_b128 v[84:87], v21 offset:4096
  v_mfma_f32_32x32x16_bf16 a[32:47], v[36:39], v[48:51], a[32:47]
  ds_read_b64_tr_b16 v[68:69], v23 offset:24576
  ds_read_b64_tr_b16 v[70:71], v23 offset:26624
  v_mfma_f32_32x32x16_bf16 a[48:63], v[36:39], v[52:55], a[48:63]
  ds_read_b64_tr_b16 v[72:73], v24 offset:24576
  ds_read_b64_tr_b16 v[74:75], v24 offset:26624
  v_mfma_f32_32x32x16_bf16 a[64:79], v[40:43], v[48:51], a[64:79]
  ds_read_b64_tr_b16 v[76:77], v25 offset:24576
  ds_read_b64_tr_b16 v[78:79], v25 offset:26624
  v_mfma_f32_32x32x16_bf16 a[80:95], v[40:43], v[52:55], a[80:95]
  v_mfma_f32_32x32x16_bf16 a[96:111], v[44:47], v[48:51], a[96:111]
  v_mfma_f32_32x32x16_bf16 a[112:127], v[44:47], v[52:55], a[112:127]
  s_waitcnt lgkmcnt(0)
  v_mfma_f32_32x32x16_bf16 a[0:15], v[64:67], v[80:83], a[0:15]
  v_mfma_f32_32x32x16_bf16 a[16:31], v[64:67], v[84:87], a[16:31]
  s_add_u32 s53, s52, s54
  s_add_u32 s52, s52, 16384
  s_cmp_eq_u32 s52, 49152
  s_cselect_b32 s52, 0, s52
  v_add_u32 v18, s52, v14
  v_add_u32 v19, s52, v15
  v_add_u32 v20, s52, v16
  v_add_u32 v21, s52, v17
  s_waitcnt vmcnt(12)
  s_barrier
  v_mfma_f32_32x32x16_bf16 a[32:47], v[68:71], v[80:83], a[32:47]
  ds_read_b128 v[48:51], v18 offset:0
  s_add_u32 m0, s55, 16384
  ds_read_b64_tr_b16 v[32:33], v22 offset:32768
  buffer_load_dwordx4 v10, s[44:47], s49 offen offset:0 lds
  v_mfma_f32_32x32x16_bf16 a[48:63], v[68:71], v[84:87], a[48:63]
  ds_read_b64_tr_b16 v[34:35], v22 offset:34816
  buffer_load_dwordx4 v11, s[44:47], s49 offen offset:1024 lds
  ds_read_b128 v[52:55], v18 offset:4096
  buffer_load_dwordx4 v12, s[44:47], s49 offen offset:2048 lds
  v_mfma_f32_32x32x16_bf16 a[64:79], v[72:75], v[80:83], a[64:79]
  ds_read_b64_tr_b16 v[36:37], v23 offset:32768
  buffer_load_dwordx4 v13, s[44:47], s49 offen offset:3072 lds
  ds_read_b64_tr_b16 v[38:39], v23 offset:34816
  s_add_u32 s49, s49, s50
  v_mfma_f32_32x32x16_bf16 a[80:95], v[72:75], v[84:87], a[80:95]
  ds_read_b64_tr_b16 v[40:41], v24 offset:32768
  s_add_u32 m0, s53, 0
  ds_read_b64_tr_b16 v[42:43], v24 offset:34816
  buffer_load_dwordx4 v2, s[40:43], s48 offen offset:0 sc1 lds
  v_mfma_f32_32x32x16_bf16 a[96:111], v[76:79], v[80:83], a[96:111]
  ds_read_b64_tr_b16 v[44:45], v25 offset:32768
  buffer_load_dwordx4 v3, s[40:43], s48 offen offset:1024 sc1 lds
  ds_read_b64_tr_b16 v[46:47], v25 offset:34816
  v_mfma_f32_32x32x16_bf16 a[112:127], v[76:79], v[84:87], a[112:127]
  s_waitcnt lgkmcnt(0)
  v_mfma_f32_32x32x16_bf16 a[0:15], v[32:35], v[48:51], a[0:15]
  ds_read_b128 v[80:83], v19 offset:0
  ds_read_b64_tr_b16 v[64:65], v22 offset:40960
  v_mfma_f32_32x32x16_bf16 a[16:31], v[32:35], v[52:55], a[16:31]
  ds_read_b64_tr_b16 v[66:67], v22 offset:43008
  ds_read_b128 v[84:87], v19 offset:4096
  v_mfma_f32_32x32x16_bf16 a[32:47], v[36:39], v[48:51], a[32:47]
  ds_read_b64_tr_b16 v[68:69], v23 offset:40960
  ds_read_b64_tr_b16 v[70:71], v23 offset:43008
  v_mfma_f32_32x32x16_bf16 a[48:63], v[36:39], v[52:55], a[48:63]
  ds_read_b64_tr_b16 v[72:73], v24 offset:40960
  ds_read_b64_tr_b16 v[74:75], v24 offset:43008
  v_mfma_f32_32x32x16_bf16 a[64:79], v[40:43], v[48:51], a[64:79]
  ds_read_b64_tr_b16 v[76:77], v25 offset:40960
  ds_read_b64_tr_b16 v[78:79], v25 offset:43008
  v_mfma_f32_32x32x16_bf16 a[80:95], v[40:43], v[52:55], a[80:95]
  v_mfma_f32_32x32x16_bf16 a[96:111], v[44:47], v[48:51], a[96:111]
  v_mfma_f32_32x32x16_bf16 a[112:127], v[44:47], v[52:55], a[112:127]
  s_waitcnt lgkmcnt(0)
  v_mfma_f32_32x32x16_bf16 a[0:15], v[64:67], v[80:83], a[0:15]
  v_mfma_f32_32x32x16_bf16 a[16:31], v[64:67], v[84:87], a[16:31]
  s_waitcnt vmcnt(12)
  s_barrier
  v_mfma_f32_32x32x16_bf16 a[32:47], v[68:71], v[80:83], a[32:47]
  ds_read_b128 v[48:51], v20 offset:0
  s_add_u32 m0, s55, 32768
  ds_read_b64_tr_b16 v[32:33], v22 offset:49152
  buffer_load_dwordx4 v10, s[44:47], s49 offen offset:0 lds
  v_mfma_f32_32x32x16_bf16 a[48:63], v[68:71], v[84:87], a[48:63]
  ds_read_b64_tr_b16 v[34:35], v22 offset:51200
  buffer_load_dwordx4 v11, s[44:47], s49 offen offset:1024 lds
  ds_read_b128 v[52:55], v20 offset:4096
  buffer_load_dwordx4 v12, s[44:47], s49 offen offset:2048 lds
  v_mfma_f32_32x32x16_bf16 a[64:79], v[72:75], v[80:83], a[64:79]
  ds_read_b64_tr_b16 v[36:37], v23 offset:49152
  buffer_load_dwordx4 v13, s[44:47], s49 offen offset:3072 lds
  ds_read_b64_tr_b16 v[38:39], v23 offset:51200
  s_add_u32 s49, s49, s50
  v_mfma_f32_32x32x16_bf16 a[80:95], v[72:75], v[84:87], a[80:95]
  ds_read_b64_tr_b16 v[40:41], v24 offset:49152
  s_add_u32 m0, s53, 2048
  ds_read_b64_tr_b16 v[42:43], v24 offset:51200
  buffer_load_dwordx4 v4, s[40:43], s48 offen offset:0 sc1 lds
  v_mfma_f32_32x32x16_bf16 a[96:111], v[76:79], v[80:83], a[96:111]
  ds_read_b64_tr_b16 v[44:45], v25 offset:49152
  buffer_load_dwordx4 v5, s[40:43], s48 offen offset:1024 sc1 lds
  ds_read_b64_tr_b16 v[46:47], v25 offset:51200
  s_add_u32 s48, s48, s77
  v_mfma_f32_32x32x16_bf16 a[112:127], v[76:79], v[84:87], a[112:127]
  s_waitcnt lgkmcnt(0)
  v_mfma_f32_32x32x16_bf16 a[0:15], v[32:35], v[48:51], a[0:15]
  ds_read_b128 v[80:83], v21 offset:0
  ds_read_b64_tr_b16 v[64:65], v22 offset:57344
  v_mfma_f32_32x32x16_bf16 a[16:31], v[32:35], v[52:55], a[16:31]
  ds_read_b64_tr_b16 v[66:67], v22 offset:59392
  ds_read_b128 v[84:87], v21 offset:4096
  v_mfma_f32_32x32x16_bf16 a[32:47], v[36:39], v[48:51], a[32:47]
  ds_read_b64_tr_b16 v[68:69], v23 offset:57344
  ds_read_b64_tr_b16 v[70:71], v23 offset:59392
  v_mfma_f32_32x32x16_bf16 a[48:63], v[36:39], v[52:55], a[48:63]
  ds_read_b64_tr_b16 v[72:73], v24 offset:57344
  ds_read_b64_tr_b16 v[74:75], v24 offset:59392
  v_mfma_f32_32x32x16_bf16 a[64:79], v[40:43], v[48:51], a[64:79]
  ds_read_b64_tr_b16 v[76:77], v25 offset:57344
  ds_read_b64_tr_b16 v[78:79], v25 offset:59392
  v_mfma_f32_32x32x16_bf16 a[80:95], v[40:43], v[52:55], a[80:95]
  v_mfma_f32_32x32x16_bf16 a[96:111], v[44:47], v[48:51], a[96:111]
  v_mfma_f32_32x32x16_bf16 a[112:127], v[44:47], v[52:55], a[112:127]
  s_waitcnt lgkmcnt(0)
  v_mfma_f32_32x32x16_bf16 a[0:15], v[64:67], v[80:83], a[0:15]
  v_mfma_f32_32x32x16_bf16 a[16:31], v[64:67], v[84:87], a[16:31]
  s_add_u32 s53, s52, s54
  s_add_u32 s52, s52, 16384
  s_cmp_eq_u32 s52, 49152
  s_cselect_b32 s52, 0, s52
  v_add_u32 v18, s52, v14
  v_add_u32 v19, s52, v15
  v_add_u32 v20, s52, v16
  v_add_u32 v21, s52, v17
  s_waitcnt vmcnt(12)
  s_barrier
  v_mfma_f32_32x32x16_bf16 a[32:47], v[68:71], v[80:83], a[32:47]
  s_add_u32 m0, s55, 49152
  s_nop 0
  buffer_load_dwordx4 v10, s[44:47], s49 offen offset:0 lds
  buffer_load_dwordx4 v11, s[44:47], s49 offen offset:1024 lds
  buffer_load_dwordx4 v12, s[44:47], s49 offen offset:2048 lds
  buffer_load_dwordx4 v13, s[44:47], s49 offen offset:3072 lds
  s_add_u32 s49, s49, s50
  s_cmp_eq_u32 s51, 1
  s_cbranch_scc1 gs_h
  s_add_u32 m0, s53, 0
  s_nop 0
  buffer_load_dwordx4 v2, s[40:43], s48 offen offset:0 sc1 lds
  buffer_load_dwordx4 v3, s[40:43], s48 offen offset:1024 sc1 lds
gs_h:
  v_mfma_f32_32x32x16_bf16 a[48:63], v[68:71], v[84:87], a[48:63]
  ds_read_b128 v[48:51], v18 offset:0
  ds_read_b64_tr_b16 v[32:33], v22 offset:0
  ds_read_b64_tr_b16 v[34:35], v22 offset:2048
  v_mfma_f32_32x32x16_bf16 a[64:79], v[72:75], v[80:83], a[64:79]
  ds_read_b128 v[52:55], v18 offset:4096
  ds_read_b64_tr_b16 v[36:37], v23 offset:0
  ds_read_b64_tr_b16 v[38:39], v23 offset:2048
  v_mfma_f32_32x32x16_bf16 a[80:95], v[72:75], v[84:87], a[80:95]
  ds_read_b64_tr_b16 v[40:41], v24 offset:0
  ds_read_b64_tr_b16 v[42:43], v24 offset:2048
  ds_read_b64_tr_b16 v[44:45], v25 offset:0
  v_mfma_f32_32x32x16_bf16 a[96:111], v[76:79], v[80:83], a[96:111]
  ds_read_b64_tr_b16 v[46:47], v25 offset:2048
  v_mfma_f32_32x32x16_bf16 a[112:127], v[76:79], v[84:87], a[112:127]
  s_sub_u32 s51, s51, 1
  s_cmp_lg_u32 s51, 0
  s_cbranch_scc1 gl_h
  s_waitcnt lgkmcnt(0)
  v_mfma_f32_32x32x16_bf16 a[0:15], v[32:35], v[48:51], a[0:15]
  ds_read_b128 v[80:83], v19 offset:0
  ds_read_b64_tr_b16 v[64:65], v22 offset:8192
  v_mfma_f32_32x32x16_bf16 a[16:31], v[32:35], v[52:55], a[16:31]
  ds_read_b64_tr_b16 v[66:67], v22 offset:10240
  ds_read_b128 v[84:87], v19 offset:4096
  v_mfma_f32_32x32x16_bf16 a[32:47], v[36:39], v[48:51], a[32:47]
  ds_read_b64_tr_b16 v[68:69], v23 offset:8192
  ds_read_b64_tr_b16 v[70:71], v23 offset:10240
  v_mfma_f32_32x32x16_bf16 a[48:63], v[36:39], v[52:55], a[48:63]
  ds_read_b64_tr_b16 v[72:73], v24 offset:8192
  ds_read_b64_tr_b16 v[74:75], v24 offset:10240
  v_mfma_f32_32x32x16_bf16 a[64:79], v[40:43], v[48:51], a[64:79]
  ds_read_b64_tr_b16 v[76:77], v25 offset:8192
  ds_read_b64_tr_b16 v[78:79], v25 offset:10240
  v_mfma_f32_32x32x16_bf16 a[80:95], v[40:43], v[52:55], a[80:95]
  v_mfma_f32_32x32x16_bf16 a[96:111], v[44:47], v[48:51], a[96:111]
  v_mfma_f32_32x32x16_bf16 a[112:127], v[44:47], v[52:55], a[112:127]
  s_waitcnt lgkmcnt(0)
  v_mfma_f32_32x32x16_bf16 a[0:15], v[64:67], v[80:83], a[0:15]
  v_mfma_f32_32x32x16_bf16 a[16:31], v[64:67], v[84:87], a[16:31]
  s_waitcnt vmcnt(10)
  s_barrier
  v_mfma_f32_32x32x16_bf16 a[32:47], v[68:71], v[80:83], a[32:47]
  ds_read_b128 v[48:51], v20 offset:0
  ds_read_b64_tr_b16 v[32:33], v22 offset:16384
  v_mfma_f32_32x32x16_bf16 a[48:63], v[68:71], v[84:87], a[48:63]
  ds_read_b64_tr_b16 v[34:35], v22 offset:18432
  ds_read_b128 v[52:55], v20 offset:4096
  v_mfma_f32_32x32x16_bf16 a[64:79], v[72:75], v[80:83], a[64:79]
  ds_read_b64_tr_b16 v[36:37], v23 offset:16384
  ds_read_b64_tr_b16 v[38:39], v23 offset:18432
  v_mfma_f32_32x32x16_bf16 a[80:95], v[72:75], v[84:87], a[80:95]
  ds_read_b64_tr_b16 v[40:41], v24 offset:16384
  ds_read_b64_tr_b16 v[42:43], v24 offset:18432
  v_mfma_f32_32x32x16_bf16 a[96:111], v[76:79], v[80:83], a[96:111]
  ds_read_b64_tr_b16 v[44:45], v25 offset:16384
  ds_read_b64_tr_b16 v[46:47], v25 offset:18432
  v_mfma_f32_32x32x16_bf16 a[112:127], v[76:79], v[84:87], a[112:127]
  s_waitcnt lgkmcnt(0)
  v_mfma_f32_32x32x16_bf16 a[0:15], v[32:35], v[48:51], a[0:15]
  ds_read_b128 v[80:83], v21 offset:0
  ds_read_b64_tr_b16 v[64:65], v22 offset:24576
  v_mfma_f32_32x32x16_bf16 a[16:31], v[32:35], v[52:55], a[16:31]
  ds_read_b64_tr_b16 v[66:67], v22 offset:26624
  ds_read_b128 v[84:87], v21 offset:4096
  v_mfma_f32_32x32x16_bf16 a[32:47], v[36:39], v[48:51], a[32:47]
  ds_read_b64_tr_b16 v[68:69], v23 offset:24576
  ds_read_b64_tr_b16 v[70:71], v23 offset:26624
  v_mfma_f32_32x32x16_bf16 a[48:63], v[36:39], v[52:55], a[48:63]
  ds_read_b64_tr_b16 v[72:73], v24 offset:24576
  ds_read_b64_tr_b16 v[74:75], v24 offset:26624
  v_mfma_f32_32x32x16_bf16 a[64:79], v[40:43], v[48:51], a[64:79]
  ds_read_b64_tr_b16 v[76:77], v25 offset:24576
  ds_read_b64_tr_b16 v[78:79], v25 offset:26624
  v_mfma_f32_32x32x16_bf16 a[80:95], v[40:43], v[52:55], a[80:95]
  v_mfma_f32_32x32x16_bf16 a[96:111], v[44:47], v[48:51], a[96:111]
  v_mfma_f32_32x32x16_bf16 a[112:127], v[44:47], v[52:55], a[112:127]
  s_waitcnt lgkmcnt(0)
  v_mfma_f32_32x32x16_bf16 a[0:15], v[64:67], v[80:83], a[0:15]
  v_mfma_f32_32x32x16_bf16 a[16:31], v[64:67], v[84:87], a[16:31]
  s_add_u32 s53, s52, s54
  s_add_u32 s52, s52, 16384
  s_cmp_eq_u32 s52, 49152
  s_cselect_b32 s52, 0, s52
  v_add_u32 v18, s52, v14
  v_add_u32 v19, s52, v15
  v_add_u32 v20, s52, v16
  v_add_u32 v21, s52, v17
  s_waitcnt vmcnt(4)
  s_barrier
  v_mfma_f32_32x32x16_bf16 a[32:47], v[68:71], v[80:83], a[32:47]
  ds_read_b128 v[48:51], v18 offset:0
  ds_read_b64_tr_b16 v[32:33], v22 offset:32768
  v_mfma_f32_32x32x16_bf16 a[48:63], v[68:71], v[84:87], a[48:63]
  ds_read_b64_tr_b16 v[34:35], v22 offset:34816
  ds_read_b128 v[52:55], v18 offset:4096
  v_mfma_f32_32x32x16_bf16 a[64:79], v[72:75], v[80:83], a[64:79]
  ds_read_b64_tr_b16 v[36:37], v23 offset:32768
  ds_read_b64_tr_b16 v[38:39], v23 offset:34816
  v_mfma_f32_32x32x16_bf16 a[80:95], v[72:75], v[84:87], a[80:95]
  ds_read_b64_tr_b16 v[40:41], v24 offset:32768
  ds_read_b64_tr_b16 v[42:43], v24 offset:34816
  v_mfma_f32_32x32x16_bf16 a[96:111], v[76:79], v[80:83], a[96:111]
  ds_read_b64_tr_b16 v[44:45], v25 offset:32768
  ds_read_b64_tr_b16 v[46:47], v25 offset:34816
  v_mfma_f32_32x32x16_bf16 a[112:127], v[76:79], v[84:87], a[112:127]
  s_waitcnt lgkmcnt(0)
  v_mfma_f32_32x32x16_bf16 a[0:15], v[32:35], v[48:51], a[0:15]
  ds_read_b128 v[80:83], v19 offset:0
  ds_read_b64_tr_b16 v[64:65], v22 offset:40960
  v_mfma_f32_32x32x16_bf16 a[16:31], v[32:35], v[52:55], a[16:31]
  ds_read_b64_tr_b16 v[66:67], v22 offset:43008
  ds_read_b128 v[84:87], v19 offset:4096
  v_mfma_f32_32x32x16_bf16 a[32:47], v[36:39], v[48:51], a[32:47]
  ds_read_b64_tr_b16 v[68:69], v23 offset:40960
  ds_read_b64_tr_b16 v[70:71], v23 offset:43008
  v_mfma_f32_32x32x16_bf16 a[48:63], v[36:39], v[52:55], a[48:63]
  ds_read_b64_tr_b16 v[72:73], v24 offset:40960
  ds_read_b64_tr_b16 v[74:75], v24 offset:43008
  v_mfma_f32_32x32x16_bf16 a[64:79], v[40:43], v[48:51], a[64:79]
  ds_read_b64_tr_b16 v[76:77], v25 offset:40960
  ds_read_b64_tr_b16 v[78:79], v25 offset:43008
  v_mfma_f32_32x32x16_bf16 a[80:95], v[40:43], v[52:55], a[80:95]
  v_mfma_f32_32x32x16_bf16 a[96:111], v[44:47], v[48:51], a[96:111]
  v_mfma_f32_32x32x16_bf16 a[112:127], v[44:47], v[52:55], a[112:127]
  s_waitcnt lgkmcnt(0)
  v_mfma_f32_32x32x16_bf16 a[0:15], v[64:67], v[80:83], a[0:15]
  v_mfma_f32_32x32x16_bf16 a[16:31], v[64:67], v[84:87], a[16:31]
  s_waitcnt vmcnt(0)
  s_barrier
  v_mfma_f32_32x32x16_bf16 a[32:47], v[68:71], v[80:83], a[32:47]
  ds_read_b128 v[48:51], v20 offset:0
  ds_read_b64_tr_b16 v[32:33], v22 offset:49152
  v_mfma_f32_32x32x16_bf16 a[48:63], v[68:71], v[84:87], a[48:63]
  ds_read_b64_tr_b16 v[34:35], v22 offset:51200
  ds_read_b128 v[52:55], v20 offset:4096
  v_mfma_f32_32x32x16_bf16 a[64:79], v[72:75], v[80:83], a[64:79]
  ds_read_b64_tr_b16 v[36:37], v23 offset:49152
  ds_read_b64_tr_b16 v[38:39], v23 offset:51200
  v_mfma_f32_32x32x16_bf16 a[80:95], v[72:75], v[84:87], a[80:95]
  ds_read_b64_tr_b16 v[40:41], v24 offset:49152
  ds_read_b64_tr_b16 v[42:43], v24 offset:51200
  v_mfma_f32_32x32x16_bf16 a[96:111], v[76:79], v[80:83], a[96:111]
  ds_read_b64_tr_b16 v[44:45], v25 offset:49152
  ds_read_b64_tr_b16 v[46:47], v25 offset:51200
  v_mfma_f32_32x32x16_bf16 a[112:127], v[76:79], v[84:87], a[112:127]
  s_waitcnt lgkmcnt(0)
  v_mfma_f32_32x32x16_bf16 a[0:15], v[32:35], v[48:51], a[0:15]
  ds_read_b128 v[80:83], v21 offset:0
  ds_read_b64_tr_b16 v[64:65], v22 offset:57344
  v_mfma_f32_32x32x16_bf16 a[16:31], v[32:35], v[52:55], a[16:31]
  ds_read_b64_tr_b16 v[66:67], v22 offset:59392
  ds_read_b128 v[84:87], v21 offset:4096
  v_mfma_f32_32x32x16_bf16 a[32:47], v[36:39], v[48:51], a[32:47]
  ds_read_b64_tr_b16 v[68:69], v23 offset:57344
  ds_read_b64_tr_b16 v[70:71], v23 offset:59392
  v_mfma_f32_32x32x16_bf16 a[48:63], v[36:39], v[52:55], a[48:63]
  ds_read_b64_tr_b16 v[72:73], v24 offset:57344
  ds_read_b64_tr_b16 v[74:75], v24 offset:59392
  v_mfma_f32_32x32x16_bf16 a[64:79], v[40:43], v[48:51], a[64:79]
  ds_read_b64_tr_b16 v[76:77], v25 offset:57344
  ds_read_b64_tr_b16 v[78:79], v25 offset:59392
  v_mfma_f32_32x32x16_bf16 a[80:95], v[40:43], v[52:55], a[80:95]
  v_mfma_f32_32x32x16_bf16 a[96:111], v[44:47], v[48:51], a[96:111]
  v_mfma_f32_32x32x16_bf16 a[112:127], v[44:47], v[52:55], a[112:127]
  s_waitcnt lgkmcnt(0)
  v_mfma_f32_32x32x16_bf16 a[0:15], v[64:67], v[80:83], a[0:15]
  v_mfma_f32_32x32x16_bf16 a[16:31], v[64:67], v[84:87], a[16:31]
  v_mfma_f32_32x32x16_bf16 a[32:47], v[68:71], v[80:83], a[32:47]
  v_mfma_f32_32x32x16_bf16 a[48:63], v[68:71], v[84:87], a[48:63]
  v_mfma_f32_32x32x16_bf16 a[64:79], v[72:75], v[80:83], a[64:79]
  v_mfma_f32_32x32x16_bf16 a[80:95], v[72:75], v[84:87], a[80:95]
  v_mfma_f32_32x32x16_bf16 a[96:111], v[76:79], v[80:83], a[96:111]
  v_mfma_f32_32x32x16_bf16 a[112:127], v[76:79], v[84:87], a[112:127]
  s_nop 11
  s_cmp_eq_u32 s81, 7
  s_cbranch_scc1 w_g5se
  s_cmp_eq_u32 s81, 8
  s_cbranch_scc1 w_g5he
  s_lshl_b32 s85, s84, 24
  s_add_u32 s85, s85, 8388608
  s_lshl_b32 s89, s83, 1
  s_add_u32 s89, s89, s59
  s_lshl_b32 s89, s89, 13
  s_add_u32 s85, s85, s89
  s_mul_i32 s89, s82, 4
  s_mul_i32 s86, s60, 2
  s_add_u32 s89, s89, s86
  s_lshl_b32 s89, s89, 18
  s_add_u32 s85, s85, s89
  v_bfe_u32 v26, v1, 4, 1
  v_lshlrev_b32 v26, 12, v26
  v_lshrrev_b32 v27, 5, v1
  v_lshl_add_u32 v26, v27, 8, v26
  v_and_b32 v27, 15, v1
  v_lshl_add_u32 v26, v27, 4, v26
  v_accvgpr_read_b32 v160, a0
  v_accvgpr_read_b32 v161, a1
  v_accvgpr_read_b32 v162, a2
  v_accvgpr_read_b32 v163, a3
  v_accvgpr_read_b32 v164, a4
  v_accvgpr_read_b32 v165, a5
  v_accvgpr_read_b32 v166, a6
  v_accvgpr_read_b32 v167, a7
  v_accvgpr_read_b32 v168, a8
  v_accvgpr_read_b32 v169, a9
  v_accvgpr_read_b32 v170, a10
  v_accvgpr_read_b32 v171, a11
  v_accvgpr_read_b32 v172, a12
  v_accvgpr_read_b32 v173, a13
  v_accvgpr_read_b32 v174, a14
  v_accvgpr_read_b32 v175, a15
  v_cvt_pk_bf16_f32 v96, v160, v161
  v_cvt_pk_bf16_f32 v97, v162, v163
  v_cvt_pk_bf16_f32 v98, v164, v165
  v_cvt_pk_bf16_f32 v99, v166, v167
  v_cvt_pk_bf16_f32 v100, v168, v169
  v_cvt_pk_bf16_f32 v101, v170, v171
  v_cvt_pk_bf16_f32 v102, v172, v173
  v_cvt_pk_bf16_f32 v103, v174, v175
  v_permlane32_swap_b32 v96, v98
  v_permlane32_swap_b32 v97, v99
  v_permlane32_swap_b32 v100, v102
  v_permlane32_swap_b32 v101, v103
  buffer_store_dwordx4 v[96:99], v26, s[28:31], s85 offen offset:0 sc1
  buffer_store_dwordx4 v[100:103], v26, s[28:31], s85 offen offset:512 sc1
  v_accvgpr_read_b32 v160, a32
  v_accvgpr_read_b32 v161, a33
  v_accvgpr_read_b32 v162, a34
  v_accvgpr_read_b32 v163, a35
  v_accvgpr_read_b32 v164, a36
  v_accvgpr_read_b32 v165, a37
  v_accvgpr_read_b32 v166, a38
  v_accvgpr_read_b32 v167, a39
  v_accvgpr_read_b32 v168, a40
  v_accvgpr_read_b32 v169, a41
  v_accvgpr_read_b32 v170, a42
  v_accvgpr_read_b32 v171, a43
  v_accvgpr_read_b32 v172, a44
  v_accvgpr_read_b32 v173, a45
  v_accvgpr_read_b32 v174, a46
  v_accvgpr_read_b32 v175, a47
  v_cvt_pk_bf16_f32 v104, v160, v161
  v_cvt_pk_bf16_f32 v105, v162, v163
  v_cvt_pk_bf16_f32 v106, v164, v165
  v_cvt_pk_bf16_f32 v107, v166, v167
  v_cvt_pk_bf16_f32 v108, v168, v169
  v_cvt_pk_bf16_f32 v109, v170, v171
  v_cvt_pk_bf16_f32 v110, v172, v173
  v_cvt_pk_bf16_f32 v111, v174, v175
  v_permlane32_swap_b32 v104, v106
  v_permlane32_swap_b32 v105, v107
  v_permlane32_swap_b32 v108, v110
  v_permlane32_swap_b32 v109, v111
  buffer_store_dwordx4 v[104:107], v26, s[28:31], s85 offen offset:1024 sc1
  buffer_store_dwordx4 v[108:111], v26, s[28:31], s85 offen offset:1536 sc1
  v_accvgpr_read_b32 v160, a64
  v_accvgpr_read_b32 v161, a65
  v_accvgpr_read_b32 v162, a66
  v_accvgpr_read_b32 v163, a67
  v_accvgpr_read_b32 v164, a68
  v_accvgpr_read_b32 v165, a69
  v_accvgpr_read_b32 v166, a70
  v_accvgpr_read_b32 v167, a71
  v_accvgpr_read_b32 v168, a72
  v_accvgpr_read_b32 v169, a73
  v_accvgpr_read_b32 v170, a74
  v_accvgpr_read_b32 v171, a75
  v_accvgpr_read_b32 v172, a76
  v_accvgpr_read_b32 v173, a77
  v_accvgpr_read_b32 v174, a78
  v_accvgpr_read_b32 v175, a79
  v_cvt_pk_bf16_f32 v112, v160, v161
  v_cvt_pk_bf16_f32 v113, v162, v163
  v_cvt_pk_bf16_f32 v114, v164, v165
  v_cvt_pk_bf16_f32 v115, v166, v167
  v_cvt_pk_bf16_f32 v116, v168, v169
  v_cvt_pk_bf16_f32 v117, v170, v171
  v_cvt_pk_bf16_f32 v118, v172, v173
  v_cvt_pk_bf16_f32 v119, v174, v175
  v_permlane32_swap_b32 v112, v114
  v_permlane32_swap_b32 v113, v115
  v_permlane32_swap_b32 v116, v118
  v_permlane32_swap_b32 v117, v119
  buffer_store_dwordx4 v[112:115], v26, s[28:31], s85 offen offset:2048 sc1
  buffer_store_dwordx4 v[116:119], v26, s[28:31], s85 offen offset:2560 sc1
  v_accvgpr_read_b32 v160, a96
  v_accvgpr_read_b32 v161, a97
  v_accvgpr_read_b32 v162, a98
  v_accvgpr_read_b32 v163, a99
  v_accvgpr_read_b32 v164, a100
  v_accvgpr_read_b32 v165, a101
  v_accvgpr_read_b32 v166, a102
  v_accvgpr_read_b32 v167, a103
  v_accvgpr_read_b32 v168, a104
  v_accvgpr_read_b32 v169, a105
  v_accvgpr_read_b32 v170, a106
  v_accvgpr_read_b32 v171, a107
  v_accvgpr_read_b32 v172, a108
  v_accvgpr_read_b32 v173, a109
  v_accvgpr_read_b32 v174, a110
  v_accvgpr_read_b32 v175, a111
  v_cvt_pk_bf16_f32 v120, v160, v161
  v_cvt_pk_bf16_f32 v121, v162, v163
  v_cvt_pk_bf16_f32 v122, v164, v165
  v_cvt_pk_bf16_f32 v123, v166, v167
  v_cvt_pk_bf16_f32 v124, v168, v169
  v_cvt_pk_bf16_f32 v125, v170, v171
  v_cvt_pk_bf16_f32 v126, v172, v173
  v_cvt_pk_bf16_f32 v127, v174, v175
  v_permlane32_swap_b32 v120, v122
  v_permlane32_swap_b32 v121, v123
  v_permlane32_swap_b32 v124, v126
  v_permlane32_swap_b32 v125, v127
  buffer_store_dwordx4 v[120:123], v26, s[28:31], s85 offen offset:3072 sc1
  buffer_store_dwordx4 v[124:127], v26, s[28:31], s85 offen offset:3584 sc1
  s_add_u32 s85, s85, 262144
  v_accvgpr_read_b32 v160, a16
  v_accvgpr_read_b32 v161, a17
  v_accvgpr_read_b32 v162, a18
  v_accvgpr_read_b32 v163, a19
  v_accvgpr_read_b32 v164, a20
  v_accvgpr_read_b32 v165, a21
  v_accvgpr_read_b32 v166, a22
  v_accvgpr_read_b32 v167, a23
  v_accvgpr_read_b32 v168, a24
  v_accvgpr_read_b32 v169, a25
  v_accvgpr_read_b32 v170, a26
  v_accvgpr_read_b32 v171, a27
  v_accvgpr_read_b32 v172, a28
  v_accvgpr_read_b32 v173, a29
  v_accvgpr_read_b32 v174, a30
  v_accvgpr_read_b32 v175, a31
  v_cvt_pk_bf16_f32 v96, v160, v161
  v_cvt_pk_bf16_f32 v97, v162, v163
  v_cvt_pk_bf16_f32 v98, v164, v165
  v_cvt_pk_bf16_f32 v99, v166, v167
  v_cvt_pk_bf16_f32 v100, v168, v169
  v_cvt_pk_bf16_f32 v101, v170, v171
  v_cvt_pk_bf16_f32 v102, v172, v173
  v_cvt_pk_bf16_f32 v103, v174, v175
  v_permlane32_swap_b32 v96, v98
  v_permlane32_swap_b32 v97, v99
  v_permlane32_swap_b32 v100, v102
  v_permlane32_swap_b32 v101, v103
  buffer_store_dwordx4 v[96:99], v26, s[28:31], s85 offen offset:0 sc1
  buffer_store_dwordx4 v[100:103], v26, s[28:31], s85 offen offset:512 sc1
  v_accvgpr_read_b32 v160, a48
  v_accvgpr_read_b32 v161, a49
  v_accvgpr_read_b32 v162, a50
  v_accvgpr_read_b32 v163, a51
  v_accvgpr_read_b32 v164, a52
  v_accvgpr_read_b32 v165, a53
  v_accvgpr_read_b32 v166, a54
  v_accvgpr_read_b32 v167, a55
  v_accvgpr_read_b32 v168, a56
  v_accvgpr_read_b32 v169, a57
  v_accvgpr_read_b32 v170, a58
  v_accvgpr_read_b32 v171, a59
  v_accvgpr_read_b32 v172, a60
  v_accvgpr_read_b32 v173, a61
  v_accvgpr_read_b32 v174, a62
  v_accvgpr_read_b32 v175, a63
  v_cvt_pk_bf16_f32 v104, v160, v161
  v_cvt_pk_bf16_f32 v105, v162, v163
  v_cvt_pk_bf16_f32 v106, v164, v165
  v_cvt_pk_bf16_f32 v107, v166, v167
  v_cvt_pk_bf16_f32 v108, v168, v169
  v_cvt_pk_bf16_f32 v109, v170, v171
  v_cvt_pk_bf16_f32 v110, v172, v173
  v_cvt_pk_bf16_f32 v111, v174, v175
  v_permlane32_swap_b32 v104, v106
  v_permlane32_swap_b32 v105, v107
  v_permlane32_swap_b32 v108, v110
  v_permlane32_swap_b32 v109, v111
  buffer_store_dwordx4 v[104:107], v26, s[28:31], s85 offen offset:1024 sc1
  buffer_store_dwordx4 v[108:111], v26, s[28:31], s85 offen offset:1536 sc1
  v_accvgpr_read_b32 v160, a80
  v_accvgpr_read_b32 v161, a81
  v_accvgpr_read_b32 v162, a82
  v_accvgpr_read_b32 v163, a83
  v_accvgpr_read_b32 v164, a84
  v_accvgpr_read_b32 v165, a85
  v_accvgpr_read_b32 v166, a86
  v_accvgpr_read_b32 v167, a87
  v_accvgpr_read_b32 v168, a88
  v_accvgpr_read_b32 v169, a89
  v_accvgpr_read_b32 v170, a90
  v_accvgpr_read_b32 v171, a91
  v_accvgpr_read_b32 v172, a92
  v_accvgpr_read_b32 v173, a93
  v_accvgpr_read_b32 v174, a94
  v_accvgpr_read_b32 v175, a95
  v_cvt_pk_bf16_f32 v112, v160, v161
  v_cvt_pk_bf16_f32 v113, v162, v163
  v_cvt_pk_bf16_f32 v114, v164, v165
  v_cvt_pk_bf16_f32 v115, v166, v167
  v_cvt_pk_bf16_f32 v116, v168, v169
  v_cvt_pk_bf16_f32 v117, v170, v171
  v_cvt_pk_bf16_f32 v118, v172, v173
  v_cvt_pk_bf16_f32 v119, v174, v175
  v_permlane32_swap_b32 v112, v114
  v_permlane32_swap_b32 v113, v115
  v_permlane32_swap_b32 v116, v118
  v_permlane32_swap_b32 v117, v119
  buffer_store_dwordx4 v[112:115], v26, s[28:31], s85 offen offset:2048 sc1
  buffer_store_dwordx4 v[116:119], v26, s[28:31], s85 offen offset:2560 sc1
  v_accvgpr_read_b32 v160, a112
  v_accvgpr_read_b32 v161, a113
  v_accvgpr_read_b32 v162, a114
  v_accvgpr_read_b32 v163, a115
  v_accvgpr_read_b32 v164, a116
  v_accvgpr_read_b32 v165, a117
  v_accvgpr_read_b32 v166, a118
  v_accvgpr_read_b32 v167, a119
  v_accvgpr_read_b32 v168, a120
  v_accvgpr_read_b32 v169, a121
  v_accvgpr_read_b32 v170, a122
  v_accvgpr_read_b32 v171, a123
  v_accvgpr_read_b32 v172, a124
  v_accvgpr_read_b32 v173, a125
  v_accvgpr_read_b32 v174, a126
  v_accvgpr_read_b32 v175, a127
  v_cvt_pk_bf16_f32 v120, v160, v161
  v_cvt_pk_bf16_f32 v121, v162, v163
  v_cvt_pk_bf16_f32 v122, v164, v165
  v_cvt_pk_bf16_f32 v123, v166, v167
  v_cvt_pk_bf16_f32 v124, v168, v169
  v_cvt_pk_bf16_f32 v125, v170, v171
  v_cvt_pk_bf16_f32 v126, v172, v173
  v_cvt_pk_bf16_f32 v127, v174, v175
  v_permlane32_swap_b32 v120, v122
  v_permlane32_swap_b32 v121, v123
  v_permlane32_swap_b32 v124, v126
  v_permlane32_swap_b32 v125, v127
  buffer_store_dwordx4 v[120:123], v26, s[28:31], s85 offen offset:3072 sc1
  buffer_store_dwordx4 v[124:127], v26, s[28:31], s85 offen offset:3584 sc1
  s_cmp_eq_u32 s84, 0
  s_cselect_b32 s86, 16, 0
  s_cselect_b32 s85, 1, 2
  s_add_u32 s86, s86, s82
  s_waitcnt vmcnt(0)
  s_barrier
  s_cmp_lg_u32 s58, 0
  s_cbranch_scc1 sg_63
  v_mov_b32 v26, s85
  s_mov_b64 exec, 1
  s_lshl_b32 s61, s86, 7
  s_add_u32 s61, s61, 99614720
  buffer_atomic_add v26, v255, s[28:31], s61 offen sc1
  s_mov_b64 exec, -1
sg_63:
  s_nop 0
  s_branch w_next
w_g5he:
  s_lshr_b32 s86, s82, 1
  s_add_u32 s86, s86, 40
  s_lshl_b32 s61, s86, 7
  s_add_u32 s61, s61, 99614720
  s_cmp_lg_u32 s58, 0
  s_cbranch_scc1 wf_64_ok
wf_64:
  buffer_load_dword v26, v255, s[28:31], s61 offen sc1
  s_waitcnt vmcnt(0)
  v_readfirstlane_b32 s62, v26
  s_nop 3
  s_cmp_ge_u32 s62, 4
  s_cbranch_scc1 wf_64_ok
  s_sub_u32 s88, s88, 1
  s_cselect_b32 s88, 0, s88
  s_cbranch_scc1 wf_64_ok
  s_sleep 3
  s_branch wf_64
wf_64_ok:
  s_barrier
  s_nop 0
  s_lshl_b32 s89, s82, 1
  s_add_u32 s89, s89, s60
  s_lshl_b32 s87, s89, 11
  s_lshl_b32 s89, s89, 17
  s_lshl_b32 s85, s83, 1
  s_add_u32 s85, s85, s59
  s_lshl_b32 s86, s85, 19
  s_lshl_b32 s85, s85, 8
  s_add_u32 s89, s89, s85
  s_add_u32 s85, s86, s87
  s_add_u32 s85, s85, 67108864
  s_mov_b32 s32, s4
  s_mov_b32 s33, s5
  s_mov_b32 s34, 4194304
  s_mov_b32 s35, 0x20000
  s_mov_b32 s36, s24
  s_mov_b32 s37, s25
  s_mov_b32 s38, 4194304
  s_mov_b32 s39, 0x20000
  v_and_b32 v27, 31, v1
  v_mul_u32_u24 v26, 2048, v27
  v_lshrrev_b32 v27, 5, v1
  v_lshl_add_u32 v26, v27, 4, v26
  v_add_u32 v14, 0, v26
  v_add_u32 v15, 65536, v26
  v_and_b32 v27, 31, v1
  v_lshlrev_b32 v18, 5, v27
  v_lshrrev_b32 v27, 5, v1
  v_lshl_add_u32 v18, v27, 4, v18
  buffer_load_dwordx4 v[112:115], v14, s[32:35], s89 offen offset:0
  s_add_u32 s49, s85, 0
  buffer_load_dwordx4 v[120:123], v18, s[28:31], s49 offen offset:0 sc1
  buffer_load_dwordx4 v[116:119], v14, s[32:35], s89 offen offset:32
  s_add_u32 s49, s85, 65536
  buffer_load_dwordx4 v[124:127], v18, s[28:31], s49 offen offset:0 sc1
  buffer_load_dwordx4 v[128:131], v14, s[32:35], s89 offen offset:64
  s_add_u32 s49, s85, 131072
  buffer_load_dwordx4 v[136:139], v18, s[28:31], s49 offen offset:0 sc1
  buffer_load_dwordx4 v[132:135], v14, s[32:35], s89 offen offset:96
  s_add_u32 s49, s85, 196608
  buffer_load_dwordx4 v[140:143], v18, s[28:31], s49 offen offset:0 sc1
  buffer_load_dwordx4 v[144:147], v14, s[32:35], s89 offen offset:128
  s_add_u32 s49, s85, 262144
  buffer_load_dwordx4 v[152:155], v18, s[28:31], s49 offen offset:0 sc1
  buffer_load_dwordx4 v[148:151], v14, s[32:35], s89 offen offset:160
  s_add_u32 s49, s85, 327680
  buffer_load_dwordx4 v[156:159], v18, s[28:31], s49 offen offset:0 sc1
  buffer_load_dwordx4 v[160:163], v14, s[32:35], s89 offen offset:192
  s_add_u32 s49, s85, 393216
  buffer_load_dwordx4 v[168:171], v18, s[28:31], s49 offen offset:0 sc1
  buffer_load_dwordx4 v[164:167], v14, s[32:35], s89 offen offset:224
  s_add_u32 s49, s85, 458752
  buffer_load_dwordx4 v[172:175], v18, s[28:31], s49 offen offset:0 sc1
  v_accvgpr_read_b32 v176, a0
  v_accvgpr_read_b32 v177, a1
  v_accvgpr_read_b32 v178, a2
  v_accvgpr_read_b32 v179, a3
  v_accvgpr_read_b32 v180, a4
  v_accvgpr_read_b32 v181, a5
  v_accvgpr_read_b32 v182, a6
  v_accvgpr_read_b32 v183, a7
  v_accvgpr_read_b32 v184, a8
  v_accvgpr_read_b32 v185, a9
  v_accvgpr_read_b32 v186, a10
  v_accvgpr_read_b32 v187, a11
  v_accvgpr_read_b32 v188, a12
  v_accvgpr_read_b32 v189, a13
  v_accvgpr_read_b32 v190, a14
  v_accvgpr_read_b32 v191, a15
  v_cvt_pk_bf16_f32 v96, v176, v177
  v_cvt_pk_bf16_f32 v97, v178, v179
  v_cvt_pk_bf16_f32 v98, v180, v181
  v_cvt_pk_bf16_f32 v99, v182, v183
  v_cvt_pk_bf16_f32 v100, v184, v185
  v_cvt_pk_bf16_f32 v101, v186, v187
  v_cvt_pk_bf16_f32 v102, v188, v189
  v_cvt_pk_bf16_f32 v103, v190, v191
  v_permlane32_swap_b32 v96, v98
  v_permlane32_swap_b32 v97, v99
  v_permlane32_swap_b32 v100, v102
  v_permlane32_swap_b32 v101, v103
  s_waitcnt vmcnt(12)
  v_lshlrev_b32 v26, 16, v96
  v_and_b32 v27, 0xffff0000, v96
  v_lshlrev_b32 v28, 16, v120
  v_and_b32 v29, 0xffff0000, v120
  v_pk_mul_f32 v[26:27], v[26:27], v[28:29]
  v_cvt_pk_bf16_f32 v28, v26, v27
  v_lshlrev_b32 v26, 16, v28
  v_and_b32 v27, 0xffff0000, v28
  v_lshlrev_b32 v30, 16, v112
  v_and_b32 v31, 0xffff0000, v112
  v_pk_add_f32 v[26:27], v[26:27], v[30:31]
  v_cvt_pk_bf16_f32 v96, v26, v27
  v_lshlrev_b32 v26, 16, v97
  v_and_b32 v27, 0xffff0000, v97
  v_lshlrev_b32 v28, 16, v121
  v_and_b32 v29, 0xffff0000, v121
  v_pk_mul_f32 v[26:27], v[26:27], v[28:29]
  v_cvt_pk_bf16_f32 v28, v26, v27
  v_lshlrev_b32 v26, 16, v28
  v_and_b32 v27, 0xffff0000, v28
  v_lshlrev_b32 v30, 16, v113
  v_and_b32 v31, 0xffff0000, v113
  v_pk_add_f32 v[26:27], v[26:27], v[30:31]
  v_cvt_pk_bf16_f32 v97, v26, v27
  v_lshlrev_b32 v26, 16, v98
  v_and_b32 v27, 0xffff0000, v98
  v_lshlrev_b32 v28, 16, v122
  v_and_b32 v29, 0xffff0000, v122
  v_pk_mul_f32 v[26:27], v[26:27], v[28:29]
  v_cvt_pk_bf16_f32 v28, v26, v27
  v_lshlrev_b32 v26, 16, v28
  v_and_b32 v27, 0xffff0000, v28
  v_lshlrev_b32 v30, 16, v114
  v_and_b32 v31, 0xffff0000, v114
  v_pk_add_f32 v[26:27], v[26:27], v[30:31]
  v_cvt_pk_bf16_f32 v98, v26, v27
  v_lshlrev_b32 v26, 16, v99
  v_and_b32 v27, 0xffff0000, v99
  v_lshlrev_b32 v28, 16, v123
  v_and_b32 v29, 0xffff0000, v123
  v_pk_mul_f32 v[26:27], v[26:27], v[28:29]
  v_cvt_pk_bf16_f32 v28, v26, v27
  v_lshlrev_b32 v26, 16, v28
  v_and_b32 v27, 0xffff0000, v28
  v_lshlrev_b32 v30, 16, v115
  v_and_b32 v31, 0xffff0000, v115
  v_pk_add_f32 v[26:27], v[26:27], v[30:31]
  v_cvt_pk_bf16_f32 v99, v26, v27
  v_lshlrev_b32 v26, 16, v100
  v_and_b32 v27, 0xffff0000, v100
  v_lshlrev_b32 v28, 16, v124
  v_and_b32 v29, 0xffff0000, v124
  v_pk_mul_f32 v[26:27], v[26:27], v[28:29]
  v_cvt_pk_bf16_f32 v28, v26, v27
  v_lshlrev_b32 v26, 16, v28
  v_and_b32 v27, 0xffff0000, v28
  v_lshlrev_b32 v30, 16, v116
  v_and_b32 v31, 0xffff0000, v116
  v_pk_add_f32 v[26:27], v[26:27], v[30:31]
  v_cvt_pk_bf16_f32 v100, v26, v27
  v_lshlrev_b32 v26, 16, v101
  v_and_b32 v27, 0xffff0000, v101
  v_lshlrev_b32 v28, 16, v125
  v_and_b32 v29, 0xffff0000, v125
  v_pk_mul_f32 v[26:27], v[26:27], v[28:29]
  v_cvt_pk_bf16_f32 v28, v26, v27
  v_lshlrev_b32 v26, 16, v28
  v_and_b32 v27, 0xffff0000, v28
  v_lshlrev_b32 v30, 16, v117
  v_and_b32 v31, 0xffff0000, v117
  v_pk_add_f32 v[26:27], v[26:27], v[30:31]
  v_cvt_pk_bf16_f32 v101, v26, v27
  v_lshlrev_b32 v26, 16, v102
  v_and_b32 v27, 0xffff0000, v102
  v_lshlrev_b32 v28, 16, v126
  v_and_b32 v29, 0xffff0000, v126
  v_pk_mul_f32 v[26:27], v[26:27], v[28:29]
  v_cvt_pk_bf16_f32 v28, v26, v27
  v_lshlrev_b32 v26, 16, v28
  v_and_b32 v27, 0xffff0000, v28
  v_lshlrev_b32 v30, 16, v118
  v_and_b32 v31, 0xffff0000, v118
  v_pk_add_f32 v[26:27], v[26:27], v[30:31]
  v_cvt_pk_bf16_f32 v102, v26, v27
  v_lshlrev_b32 v26, 16, v103
  v_and_b32 v27, 0xffff0000, v103
  v_lshlrev_b32 v28, 16, v127
  v_and_b32 v29, 0xffff0000, v127
  v_pk_mul_f32 v[26:27], v[26:27], v[28:29]
  v_cvt_pk_bf16_f32 v28, v26, v27
  v_lshlrev_b32 v26, 16, v28
  v_and_b32 v27, 0xffff0000, v28
  v_lshlrev_b32 v30, 16, v119
  v_and_b32 v31, 0xffff0000, v119
  v_pk_add_f32 v[26:27], v[26:27], v[30:31]
  v_cvt_pk_bf16_f32 v103, v26, v27
  buffer_store_dwordx4 v[96:99], v14, s[36:39], s89 offen offset:0
  buffer_store_dwordx4 v[100:103], v14, s[36:39], s89 offen offset:32
  buffer_load_dwordx4 v[112:115], v15, s[32:35], s89 offen offset:0
  s_add_u32 s49, s85, 0
  buffer_load_dwordx4 v[120:123], v18, s[28:31], s49 offen offset:1024 sc1
  buffer_load_dwordx4 v[116:119], v15, s[32:35], s89 offen offset:32
  s_add_u32 s49, s85, 65536
  buffer_load_dwordx4 v[124:127], v18, s[28:31], s49 offen offset:1024 sc1
  v_accvgpr_read_b32 v176, a32
  v_accvgpr_read_b32 v177, a33
  v_accvgpr_read_b32 v178, a34
  v_accvgpr_read_b32 v179, a35
  v_accvgpr_read_b32 v180, a36
  v_accvgpr_read_b32 v181, a37
  v_accvgpr_read_b32 v182, a38
  v_accvgpr_read_b32 v183, a39
  v_accvgpr_read_b32 v184, a40
  v_accvgpr_read_b32 v185, a41
  v_accvgpr_read_b32 v186, a42
  v_accvgpr_read_b32 v187, a43
  v_accvgpr_read_b32 v188, a44
  v_accvgpr_read_b32 v189, a45
  v_accvgpr_read_b32 v190, a46
  v_accvgpr_read_b32 v191, a47
  v_cvt_pk_bf16_f32 v104, v176, v177
  v_cvt_pk_bf16_f32 v105, v178, v179
  v_cvt_pk_bf16_f32 v106, v180, v181
  v_cvt_pk_bf16_f32 v107, v182, v183
  v_cvt_pk_bf16_f32 v108, v184, v185
  v_cvt_pk_bf16_f32 v109, v186, v187
  v_cvt_pk_bf16_f32 v110, v188, v189
  v_cvt_pk_bf16_f32 v111, v190, v191
  v_permlane32_swap_b32 v104, v106
  v_permlane32_swap_b32 v105, v107
  v_permlane32_swap_b32 v108, v110
  v_permlane32_swap_b32 v109, v111
  s_waitcnt vmcnt(14)
  v_lshlrev_b32 v26, 16, v104
  v_and_b32 v27, 0xffff0000, v104
  v_lshlrev_b32 v28, 16, v136
  v_and_b32 v29, 0xffff0000, v136
  v_pk_mul_f32 v[26:27], v[26:27], v[28:29]
  v_cvt_pk_bf16_f32 v28, v26, v27
  v_lshlrev_b32 v26, 16, v28
  v_and_b32 v27, 0xffff0000, v28
  v_lshlrev_b32 v30, 16, v128
  v_and_b32 v31, 0xffff0000, v128
  v_pk_add_f32 v[26:27], v[26:27], v[30:31]
  v_cvt_pk_bf16_f32 v104, v26, v27
  v_lshlrev_b32 v26, 16, v105
  v_and_b32 v27, 0xffff0000, v105
  v_lshlrev_b32 v28, 16, v137
  v_and_b32 v29, 0xffff0000, v137
  v_pk_mul_f32 v[26:27], v[26:27], v[28:29]
  v_cvt_pk_bf16_f32 v28, v26, v27
  v_lshlrev_b32 v26, 16, v28
  v_and_b32 v27, 0xffff0000, v28
  v_lshlrev_b32 v30, 16, v129
  v_and_b32 v31, 0xffff0000, v129
  v_pk_add_f32 v[26:27], v[26:27], v[30:31]
  v_cvt_pk_bf16_f32 v105, v26, v27
  v_lshlrev_b32 v26, 16, v106
  v_and_b32 v27, 0xffff0000, v106
  v_lshlrev_b32 v28, 16, v138
  v_and_b32 v29, 0xffff0000, v138
  v_pk_mul_f32 v[26:27], v[26:27], v[28:29]
  v_cvt_pk_bf16_f32 v28, v26, v27
  v_lshlrev_b32 v26, 16, v28
  v_and_b32 v27, 0xffff0000, v28
  v_lshlrev_b32 v30, 16, v130
  v_and_b32 v31, 0xffff0000, v130
  v_pk_add_f32 v[26:27], v[26:27], v[30:31]
  v_cvt_pk_bf16_f32 v106, v26, v27
  v_lshlrev_b32 v26, 16, v107
  v_and_b32 v27, 0xffff0000, v107
  v_lshlrev_b32 v28, 16, v139
  v_and_b32 v29, 0xffff0000, v139
  v_pk_mul_f32 v[26:27], v[26:27], v[28:29]
  v_cvt_pk_bf16_f32 v28, v26, v27
  v_lshlrev_b32 v26, 16, v28
  v_and_b32 v27, 0xffff0000, v28
  v_lshlrev_b32 v30, 16, v131
  v_and_b32 v31, 0xffff0000, v131
  v_pk_add_f32 v[26:27], v[26:27], v[30:31]
  v_cvt_pk_bf16_f32 v107, v26, v27
  v_lshlrev_b32 v26, 16, v108
  v_and_b32 v27, 0xffff0000, v108
  v_lshlrev_b32 v28, 16, v140
  v_and_b32 v29, 0xffff0000, v140
  v_pk_mul_f32 v[26:27], v[26:27], v[28:29]
  v_cvt_pk_bf16_f32 v28, v26, v27
  v_lshlrev_b32 v26, 16, v28
  v_and_b32 v27, 0xffff0000, v28
  v_lshlrev_b32 v30, 16, v132
  v_and_b32 v31, 0xffff0000, v132
  v_pk_add_f32 v[26:27], v[26:27], v[30:31]
  v_cvt_pk_bf16_f32 v108, v26, v27
  v_lshlrev_b32 v26, 16, v109
  v_and_b32 v27, 0xffff0000, v109
  v_lshlrev_b32 v28, 16, v141
  v_and_b32 v29, 0xffff0000, v141
  v_pk_mul_f32 v[26:27], v[26:27], v[28:29]
  v_cvt_pk_bf16_f32 v28, v26, v27
  v_lshlrev_b32 v26, 16, v28
  v_and_b32 v27, 0xffff0000, v28
  v_lshlrev_b32 v30, 16, v133
  v_and_b32 v31, 0xffff0000, v133
  v_pk_add_f32 v[26:27], v[26:27], v[30:31]
  v_cvt_pk_bf16_f32 v109, v26, v27
  v_lshlrev_b32 v26, 16, v110
  v_and_b32 v27, 0xffff0000, v110
  v_lshlrev_b32 v28, 16, v142
  v_and_b32 v29, 0xffff0000, v142
  v_pk_mul_f32 v[26:27], v[26:27], v[28:29]
  v_cvt_pk_bf16_f32 v28, v26, v27
  v_lshlrev_b32 v26, 16, v28
  v_and_b32 v27, 0xffff0000, v28
  v_lshlrev_b32 v30, 16, v134
  v_and_b32 v31, 0xffff0000, v134
  v_pk_add_f32 v[26:27], v[26:27], v[30:31]
  v_cvt_pk_bf16_f32 v110, v26, v27
  v_lshlrev_b32 v26, 16, v111
  v_and_b32 v27, 0xffff0000, v111
  v_lshlrev_b32 v28, 16, v143
  v_and_b32 v29, 0xffff0000, v143
  v_pk_mul_f32 v[26:27], v[26:27], v[28:29]
  v_cvt_pk_bf16_f32 v28, v26, v27
  v_lshlrev_b32 v26, 16, v28
  v_and_b32 v27, 0xffff0000, v28
  v_lshlrev_b32 v30, 16, v135
  v_and_b32 v31, 0xffff0000, v135
  v_pk_add_f32 v[26:27], v[26:27], v[30:31]
  v_cvt_pk_bf16_f32 v111, v26, v27
  buffer_store_dwordx4 v[104:107], v14, s[36:39], s89 offen offset:64
  buffer_store_dwordx4 v[108:111], v14, s[36:39], s89 offen offset:96
  buffer_load_dwordx4 v[128:131], v15, s[32:35], s89 offen offset:64
  s_add_u32 s49, s85, 131072
  buffer_load_dwordx4 v[136:139], v18, s[28:31], s49 offen offset:1024 sc1
  buffer_load_dwordx4 v[132:135], v15, s[32:35], s89 offen offset:96
  s_add_u32 s49, s85, 196608
  buffer_load_dwordx4 v[140:143], v18, s[28:31], s49 offen offset:1024 sc1
  v_accvgpr_read_b32 v176, a64
  v_accvgpr_read_b32 v177, a65
  v_accvgpr_read_b32 v178, a66
  v_accvgpr_read_b32 v179, a67
  v_accvgpr_read_b32 v180, a68
  v_accvgpr_read_b32 v181, a69
  v_accvgpr_read_b32 v182, a70
  v_accvgpr_read_b32 v183, a71
  v_accvgpr_read_b32 v184, a72
  v_accvgpr_read_b32 v185, a73
  v_accvgpr_read_b32 v186, a74
  v_accvgpr_read_b32 v187, a75
  v_accvgpr_read_b32 v188, a76
  v_accvgpr_read_b32 v189, a77
  v_accvgpr_read_b32 v190, a78
  v_accvgpr_read_b32 v191, a79
  v_cvt_pk_bf16_f32 v96, v176, v177
  v_cvt_pk_bf16_f32 v97, v178, v179
  v_cvt_pk_bf16_f32 v98, v180, v181
  v_cvt_pk_bf16_f32 v99, v182, v183
  v_cvt_pk_bf16_f32 v100, v184, v185
  v_cvt_pk_bf16_f32 v101, v186, v187
  v_cvt_pk_bf16_f32 v102, v188, v189
  v_cvt_pk_bf16_f32 v103, v190, v191
  v_permlane32_swap_b32 v96, v98
  v_permlane32_swap_b32 v97, v99
  v_permlane32_swap_b32 v100, v102
  v_permlane32_swap_b32 v101, v103
  s_waitcnt vmcnt(16)
  v_lshlrev_b32 v26, 16, v96
  v_and_b32 v27, 0xffff0000, v96
  v_lshlrev_b32 v28, 16, v152
  v_and_b32 v29, 0xffff0000, v152
  v_pk_mul_f32 v[26:27], v[26:27], v[28:29]
  v_cvt_pk_bf16_f32 v28, v26, v27
  v_lshlrev_b32 v26, 16, v28
  v_and_b32 v27, 0xffff0000, v28
  v_lshlrev_b32 v30, 16, v144
  v_and_b32 v31, 0xffff0000, v144
  v_pk_add_f32 v[26:27], v[26:27], v[30:31]
  v_cvt_pk_bf16_f32 v96, v26, v27
  v_lshlrev_b32 v26, 16, v97
  v_and_b32 v27, 0xffff0000, v97
  v_lshlrev_b32 v28, 16, v153
  v_and_b32 v29, 0xffff0000, v153
  v_pk_mul_f32 v[26:27], v[26:27], v[28:29]
  v_cvt_pk_bf16_f32 v28, v26, v27
  v_lshlrev_b32 v26, 16, v28
  v_and_b32 v27, 0xffff0000, v28
  v_lshlrev_b32 v30, 16, v145
  v_and_b32 v31, 0xffff0000, v145
  v_pk_add_f32 v[26:27], v[26:27], v[30:31]
  v_cvt_pk_bf16_f32 v97, v26, v27
  v_lshlrev_b32 v26, 16, v98
  v_and_b32 v27, 0xffff0000, v98
  v_lshlrev_b32 v28, 16, v154
  v_and_b32 v29, 0xffff0000, v154
  v_pk_mul_f32 v[26:27], v[26:27], v[28:29]
  v_cvt_pk_bf16_f32 v28, v26, v27
  v_lshlrev_b32 v26, 16, v28
  v_and_b32 v27, 0xffff0000, v28
  v_lshlrev_b32 v30, 16, v146
  v_and_b32 v31, 0xffff0000, v146
  v_pk_add_f32 v[26:27], v[26:27], v[30:31]
  v_cvt_pk_bf16_f32 v98, v26, v27
  v_lshlrev_b32 v26, 16, v99
  v_and_b32 v27, 0xffff0000, v99
  v_lshlrev_b32 v28, 16, v155
  v_and_b32 v29, 0xffff0000, v155
  v_pk_mul_f32 v[26:27], v[26:27], v[28:29]
  v_cvt_pk_bf16_f32 v28, v26, v27
  v_lshlrev_b32 v26, 16, v28
  v_and_b32 v27, 0xffff0000, v28
  v_lshlrev_b32 v30, 16, v147
  v_and_b32 v31, 0xffff0000, v147
  v_pk_add_f32 v[26:27], v[26:27], v[30:31]
  v_cvt_pk_bf16_f32 v99, v26, v27
  v_lshlrev_b32 v26, 16, v100
  v_and_b32 v27, 0xffff0000, v100
  v_lshlrev_b32 v28, 16, v156
  v_and_b32 v29, 0xffff0000, v156
  v_pk_mul_f32 v[26:27], v[26:27], v[28:29]
  v_cvt_pk_bf16_f32 v28, v26, v27
  v_lshlrev_b32 v26, 16, v28
  v_and_b32 v27, 0xffff0000, v28
  v_lshlrev_b32 v30, 16, v148
  v_and_b32 v31, 0xffff0000, v148
  v_pk_add_f32 v[26:27], v[26:27], v[30:31]
  v_cvt_pk_bf16_f32 v100, v26, v27
  v_lshlrev_b32 v26, 16, v101
  v_and_b32 v27, 0xffff0000, v101
  v_lshlrev_b32 v28, 16, v157
  v_and_b32 v29, 0xffff0000, v157
  v_pk_mul_f32 v[26:27], v[26:27], v[28:29]
  v_cvt_pk_bf16_f32 v28, v26, v27
  v_lshlrev_b32 v26, 16, v28
  v_and_b32 v27, 0xffff0000, v28
  v_lshlrev_b32 v30, 16, v149
  v_and_b32 v31, 0xffff0000, v149
  v_pk_add_f32 v[26:27], v[26:27], v[30:31]
  v_cvt_pk_bf16_f32 v101, v26, v27
  v_lshlrev_b32 v26, 16, v102
  v_and_b32 v27, 0xffff0000, v102
  v_lshlrev_b32 v28, 16, v158
  v_and_b32 v29, 0xffff0000, v158
  v_pk_mul_f32 v[26:27], v[26:27], v[28:29]
  v_cvt_pk_bf16_f32 v28, v26, v27
  v_lshlrev_b32 v26, 16, v28
  v_and_b32 v27, 0xffff0000, v28
  v_lshlrev_b32 v30, 16, v150
  v_and_b32 v31, 0xffff0000, v150
  v_pk_add_f32 v[26:27], v[26:27], v[30:31]
  v_cvt_pk_bf16_f32 v102, v26, v27
  v_lshlrev_b32 v26, 16, v103
  v_and_b32 v27, 0xffff0000, v103
  v_lshlrev_b32 v28, 16, v159
  v_and_b32 v29, 0xffff0000, v159
  v_pk_mul_f32 v[26:27], v[26:27], v[28:29]
  v_cvt_pk_bf16_f32 v28, v26, v27
  v_lshlrev_b32 v26, 16, v28
  v_and_b32 v27, 0xffff0000, v28
  v_lshlrev_b32 v30, 16, v151
  v_and_b32 v31, 0xffff0000, v151
  v_pk_add_f32 v[26:27], v[26:27], v[30:31]
  v_cvt_pk_bf16_f32 v103, v26, v27
  buffer_store_dwordx4 v[96:99], v14, s[36:39], s89 offen offset:128
  buffer_store_dwordx4 v[100:103], v14, s[36:39], s89 offen offset:160
  buffer_load_dwordx4 v[144:147], v15, s[32:35], s89 offen offset:128
  s_add_u32 s49, s85, 262144
  buffer_load_dwordx4 v[152:155], v18, s[28:31], s49 offen offset:1024 sc1
  buffer_load_dwordx4 v[148:151], v15, s[32:35], s89 offen offset:160
  s_add_u32 s49, s85, 327680
  buffer_load_dwordx4 v[156:159], v18, s[28:31], s49 offen offset:1024 sc1
  v_accvgpr_read_b32 v176, a96
  v_accvgpr_read_b32 v177, a97
  v_accvgpr_read_b32 v178, a98
  v_accvgpr_read_b32 v179, a99
  v_accvgpr_read_b32 v180, a100
  v_accvgpr_read_b32 v181, a101
  v_accvgpr_read_b32 v182, a102
  v_accvgpr_read_b32 v183, a103
  v_accvgpr_read_b32 v184, a104
  v_accvgpr_read_b32 v185, a105
  v_accvgpr_read_b32 v186, a106
  v_accvgpr_read_b32 v187, a107
  v_accvgpr_read_b32 v188, a108
  v_accvgpr_read_b32 v189, a109
  v_accvgpr_read_b32 v190, a110
  v_accvgpr_read_b32 v191, a111
  v_cvt_pk_bf16_f32 v104, v176, v177
  v_cvt_pk_bf16_f32 v105, v178, v179
  v_cvt_pk_bf16_f32 v106, v180, v181
  v_cvt_pk_bf16_f32 v107, v182, v183
  v_cvt_pk_bf16_f32 v108, v184, v185
  v_cvt_pk_bf16_f32 v109, v186, v187
  v_cvt_pk_bf16_f32 v110, v188, v189
  v_cvt_pk_bf16_f32 v111, v190, v191
  v_permlane32_swap_b32 v104, v106
  v_permlane32_swap_b32 v105, v107
  v_permlane32_swap_b32 v108, v110
  v_permlane32_swap_b32 v109, v111
  s_waitcnt vmcnt(18)
  v_lshlrev_b32 v26, 16, v104
  v_and_b32 v27, 0xffff0000, v104
  v_lshlrev_b32 v28, 16, v168
  v_and_b32 v29, 0xffff0000, v168
  v_pk_mul_f32 v[26:27], v[26:27], v[28:29]
  v_cvt_pk_bf16_f32 v28, v26, v27
  v_lshlrev_b32 v26, 16, v28
  v_and_b32 v27, 0xffff0000, v28
  v_lshlrev_b32 v30, 16, v160
  v_and_b32 v31, 0xffff0000, v160
  v_pk_add_f32 v[26:27], v[26:27], v[30:31]
  v_cvt_pk_bf16_f32 v104, v26, v27
  v_lshlrev_b32 v26, 16, v105
  v_and_b32 v27, 0xffff0000, v105
  v_lshlrev_b32 v28, 16, v169
  v_and_b32 v29, 0xffff0000, v169
  v_pk_mul_f32 v[26:27], v[26:27], v[28:29]
  v_cvt_pk_bf16_f32 v28, v26, v27
  v_lshlrev_b32 v26, 16, v28
  v_and_b32 v27, 0xffff0000, v28
  v_lshlrev_b32 v30, 16, v161
  v_and_b32 v31, 0xffff0000, v161
  v_pk_add_f32 v[26:27], v[26:27], v[30:31]
  v_cvt_pk_bf16_f32 v105, v26, v27
  v_lshlrev_b32 v26, 16, v106
  v_and_b32 v27, 0xffff0000, v106
  v_lshlrev_b32 v28, 16, v170
  v_and_b32 v29, 0xffff0000, v170
  v_pk_mul_f32 v[26:27], v[26:27], v[28:29]
  v_cvt_pk_bf16_f32 v28, v26, v27
  v_lshlrev_b32 v26, 16, v28
  v_and_b32 v27, 0xffff0000, v28
  v_lshlrev_b32 v30, 16, v162
  v_and_b32 v31, 0xffff0000, v162
  v_pk_add_f32 v[26:27], v[26:27], v[30:31]
  v_cvt_pk_bf16_f32 v106, v26, v27
  v_lshlrev_b32 v26, 16, v107
  v_and_b32 v27, 0xffff0000, v107
  v_lshlrev_b32 v28, 16, v171
  v_and_b32 v29, 0xffff0000, v171
  v_pk_mul_f32 v[26:27], v[26:27], v[28:29]
  v_cvt_pk_bf16_f32 v28, v26, v27
  v_lshlrev_b32 v26, 16, v28
  v_and_b32 v27, 0xffff0000, v28
  v_lshlrev_b32 v30, 16, v163
  v_and_b32 v31, 0xffff0000, v163
  v_pk_add_f32 v[26:27], v[26:27], v[30:31]
  v_cvt_pk_bf16_f32 v107, v26, v27
  v_lshlrev_b32 v26, 16, v108
  v_and_b32 v27, 0xffff0000, v108
  v_lshlrev_b32 v28, 16, v172
  v_and_b32 v29, 0xffff0000, v172
  v_pk_mul_f32 v[26:27], v[26:27], v[28:29]
  v_cvt_pk_bf16_f32 v28, v26, v27
  v_lshlrev_b32 v26, 16, v28
  v_and_b32 v27, 0xffff0000, v28
  v_lshlrev_b32 v30, 16, v164
  v_and_b32 v31, 0xffff0000, v164
  v_pk_add_f32 v[26:27], v[26:27], v[30:31]
  v_cvt_pk_bf16_f32 v108, v26, v27
  v_lshlrev_b32 v26, 16, v109
  v_and_b32 v27, 0xffff0000, v109
  v_lshlrev_b32 v28, 16, v173
  v_and_b32 v29, 0xffff0000, v173
  v_pk_mul_f32 v[26:27], v[26:27], v[28:29]
  v_cvt_pk_bf16_f32 v28, v26, v27
  v_lshlrev_b32 v26, 16, v28
  v_and_b32 v27, 0xffff0000, v28
  v_lshlrev_b32 v30, 16, v165
  v_and_b32 v31, 0xffff0000, v165
  v_pk_add_f32 v[26:27], v[26:27], v[30:31]
  v_cvt_pk_bf16_f32 v109, v26, v27
  v_lshlrev_b32 v26, 16, v110
  v_and_b32 v27, 0xffff0000, v110
  v_lshlrev_b32 v28, 16, v174
  v_and_b32 v29, 0xffff0000, v174
  v_pk_mul_f32 v[26:27], v[26:27], v[28:29]
  v_cvt_pk_bf16_f32 v28, v26, v27
  v_lshlrev_b32 v26, 16, v28
  v_and_b32 v27, 0xffff0000, v28
  v_lshlrev_b32 v30, 16, v166
  v_and_b32 v31, 0xffff0000, v166
  v_pk_add_f32 v[26:27], v[26:27], v[30:31]
  v_cvt_pk_bf16_f32 v110, v26, v27
  v_lshlrev_b32 v26, 16, v111
  v_and_b32 v27, 0xffff0000, v111
  v_lshlrev_b32 v28, 16, v175
  v_and_b32 v29, 0xffff0000, v175
  v_pk_mul_f32 v[26:27], v[26:27], v[28:29]
  v_cvt_pk_bf16_f32 v28, v26, v27
  v_lshlrev_b32 v26, 16, v28
  v_and_b32 v27, 0xffff0000, v28
  v_lshlrev_b32 v30, 16, v167
  v_and_b32 v31, 0xffff0000, v167
  v_pk_add_f32 v[26:27], v[26:27], v[30:31]
  v_cvt_pk_bf16_f32 v111, v26, v27
  buffer_store_dwordx4 v[104:107], v14, s[36:39], s89 offen offset:192
  buffer_store_dwordx4 v[108:111], v14, s[36:39], s89 offen offset:224
  buffer_load_dwordx4 v[160:163], v15, s[32:35], s89 offen offset:192
  s_add_u32 s49, s85, 393216
  buffer_load_dwordx4 v[168:171], v18, s[28:31], s49 offen offset:1024 sc1
  buffer_load_dwordx4 v[164:167], v15, s[32:35], s89 offen offset:224
  s_add_u32 s49, s85, 458752
  buffer_load_dwordx4 v[172:175], v18, s[28:31], s49 offen offset:1024 sc1
  v_accvgpr_read_b32 v176, a16
  v_accvgpr_read_b32 v177, a17
  v_accvgpr_read_b32 v178, a18
  v_accvgpr_read_b32 v179, a19
  v_accvgpr_read_b32 v180, a20
  v_accvgpr_read_b32 v181, a21
  v_accvgpr_read_b32 v182, a22
  v_accvgpr_read_b32 v183, a23
  v_accvgpr_read_b32 v184, a24
  v_accvgpr_read_b32 v185, a25
  v_accvgpr_read_b32 v186, a26
  v_accvgpr_read_b32 v187, a27
  v_accvgpr_read_b32 v188, a28
  v_accvgpr_read_b32 v189, a29
  v_accvgpr_read_b32 v190, a30
  v_accvgpr_read_b32 v191, a31
  v_cvt_pk_bf16_f32 v96, v176, v177
  v_cvt_pk_bf16_f32 v97, v178, v179
  v_cvt_pk_bf16_f32 v98, v180, v181
  v_cvt_pk_bf16_f32 v99, v182, v183
  v_cvt_pk_bf16_f32 v100, v184, v185
  v_cvt_pk_bf16_f32 v101, v186, v187
  v_cvt_pk_bf16_f32 v102, v188, v189
  v_cvt_pk_bf16_f32 v103, v190, v191
  v_permlane32_swap_b32 v96, v98
  v_permlane32_swap_b32 v97, v99
  v_permlane32_swap_b32 v100, v102
  v_permlane32_swap_b32 v101, v103
  s_waitcnt vmcnt(18)
  v_lshlrev_b32 v26, 16, v96
  v_and_b32 v27, 0xffff0000, v96
  v_lshlrev_b32 v28, 16, v120
  v_and_b32 v29, 0xffff0000, v120
  v_pk_mul_f32 v[26:27], v[26:27], v[28:29]
  v_cvt_pk_bf16_f32 v28, v26, v27
  v_lshlrev_b32 v26, 16, v28
  v_and_b32 v27, 0xffff0000, v28
  v_lshlrev_b32 v30, 16, v112
  v_and_b32 v31, 0xffff0000, v112
  v_pk_add_f32 v[26:27], v[26:27], v[30:31]
  v_cvt_pk_bf16_f32 v96, v26, v27
  v_lshlrev_b32 v26, 16, v97
  v_and_b32 v27, 0xffff0000, v97
  v_lshlrev_b32 v28, 16, v121
  v_and_b32 v29, 0xffff0000, v121
  v_pk_mul_f32 v[26:27], v[26:27], v[28:29]
  v_cvt_pk_bf16_f32 v28, v26, v27
  v_lshlrev_b32 v26, 16, v28
  v_and_b32 v27, 0xffff0000, v28
  v_lshlrev_b32 v30, 16, v113
  v_and_b32 v31, 0xffff0000, v113
  v_pk_add_f32 v[26:27], v[26:27], v[30:31]
  v_cvt_pk_bf16_f32 v97, v26, v27
  v_lshlrev_b32 v26, 16, v98
  v_and_b32 v27, 0xffff0000, v98
  v_lshlrev_b32 v28, 16, v122
  v_and_b32 v29, 0xffff0000, v122
  v_pk_mul_f32 v[26:27], v[26:27], v[28:29]
  v_cvt_pk_bf16_f32 v28, v26, v27
  v_lshlrev_b32 v26, 16, v28
  v_and_b32 v27, 0xffff0000, v28
  v_lshlrev_b32 v30, 16, v114
  v_and_b32 v31, 0xffff0000, v114
  v_pk_add_f32 v[26:27], v[26:27], v[30:31]
  v_cvt_pk_bf16_f32 v98, v26, v27
  v_lshlrev_b32 v26, 16, v99
  v_and_b32 v27, 0xffff0000, v99
  v_lshlrev_b32 v28, 16, v123
  v_and_b32 v29, 0xffff0000, v123
  v_pk_mul_f32 v[26:27], v[26:27], v[28:29]
  v_cvt_pk_bf16_f32 v28, v26, v27
  v_lshlrev_b32 v26, 16, v28
  v_and_b32 v27, 0xffff0000, v28
  v_lshlrev_b32 v30, 16, v115
  v_and_b32 v31, 0xffff0000, v115
  v_pk_add_f32 v[26:27], v[26:27], v[30:31]
  v_cvt_pk_bf16_f32 v99, v26, v27
  v_lshlrev_b32 v26, 16, v100
  v_and_b32 v27, 0xffff0000, v100
  v_lshlrev_b32 v28, 16, v124
  v_and_b32 v29, 0xffff0000, v124
  v_pk_mul_f32 v[26:27], v[26:27], v[28:29]
  v_cvt_pk_bf16_f32 v28, v26, v27
  v_lshlrev_b32 v26, 16, v28
  v_and_b32 v27, 0xffff0000, v28
  v_lshlrev_b32 v30, 16, v116
  v_and_b32 v31, 0xffff0000, v116
  v_pk_add_f32 v[26:27], v[26:27], v[30:31]
  v_cvt_pk_bf16_f32 v100, v26, v27
  v_lshlrev_b32 v26, 16, v101
  v_and_b32 v27, 0xffff0000, v101
  v_lshlrev_b32 v28, 16, v125
  v_and_b32 v29, 0xffff0000, v125
  v_pk_mul_f32 v[26:27], v[26:27], v[28:29]
  v_cvt_pk_bf16_f32 v28, v26, v27
  v_lshlrev_b32 v26, 16, v28
  v_and_b32 v27, 0xffff0000, v28
  v_lshlrev_b32 v30, 16, v117
  v_and_b32 v31, 0xffff0000, v117
  v_pk_add_f32 v[26:27], v[26:27], v[30:31]
  v_cvt_pk_bf16_f32 v101, v26, v27
  v_lshlrev_b32 v26, 16, v102
  v_and_b32 v27, 0xffff0000, v102
  v_lshlrev_b32 v28, 16, v126
  v_and_b32 v29, 0xffff0000, v126
  v_pk_mul_f32 v[26:27], v[26:27], v[28:29]
  v_cvt_pk_bf16_f32 v28, v26, v27
  v_lshlrev_b32 v26, 16, v28
  v_and_b32 v27, 0xffff0000, v28
  v_lshlrev_b32 v30, 16, v118
  v_and_b32 v31, 0xffff0000, v118
  v_pk_add_f32 v[26:27], v[26:27], v[30:31]
  v_cvt_pk_bf16_f32 v102, v26, v27
  v_lshlrev_b32 v26, 16, v103
  v_and_b32 v27, 0xffff0000, v103
  v_lshlrev_b32 v28, 16, v127
  v_and_b32 v29, 0xffff0000, v127
  v_pk_mul_f32 v[26:27], v[26:27], v[28:29]
  v_cvt_pk_bf16_f32 v28, v26, v27
  v_lshlrev_b32 v26, 16, v28
  v_and_b32 v27, 0xffff0000, v28
  v_lshlrev_b32 v30, 16, v119
  v_and_b32 v31, 0xffff0000, v119
  v_pk_add_f32 v[26:27], v[26:27], v[30:31]
  v_cvt_pk_bf16_f32 v103, v26, v27
  buffer_store_dwordx4 v[96:99], v15, s[36:39], s89 offen offset:0
  buffer_store_dwordx4 v[100:103], v15, s[36:39], s89 offen offset:32
  v_accvgpr_read_b32 v176, a48
  v_accvgpr_read_b32 v177, a49
  v_accvgpr_read_b32 v178, a50
  v_accvgpr_read_b32 v179, a51
  v_accvgpr_read_b32 v180, a52
  v_accvgpr_read_b32 v181, a53
  v_accvgpr_read_b32 v182, a54
  v_accvgpr_read_b32 v183, a55
  v_accvgpr_read_b32 v184, a56
  v_accvgpr_read_b32 v185, a57
  v_accvgpr_read_b32 v186, a58
  v_accvgpr_read_b32 v187, a59
  v_accvgpr_read_b32 v188, a60
  v_accvgpr_read_b32 v189, a61
  v_accvgpr_read_b32 v190, a62
  v_accvgpr_read_b32 v191, a63
  v_cvt_pk_bf16_f32 v104, v176, v177
  v_cvt_pk_bf16_f32 v105, v178, v179
  v_cvt_pk_bf16_f32 v106, v180, v181
  v_cvt_pk_bf16_f32 v107, v182, v183
  v_cvt_pk_bf16_f32 v108, v184, v185
  v_cvt_pk_bf16_f32 v109, v186, v187
  v_cvt_pk_bf16_f32 v110, v188, v189
  v_cvt_pk_bf16_f32 v111, v190, v191
  v_permlane32_swap_b32 v104, v106
  v_permlane32_swap_b32 v105, v107
  v_permlane32_swap_b32 v108, v110
  v_permlane32_swap_b32 v109, v111
  s_waitcnt vmcnt(14)
  v_lshlrev_b32 v26, 16, v104
  v_and_b32 v27, 0xffff0000, v104
  v_lshlrev_b32 v28, 16, v136
  v_and_b32 v29, 0xffff0000, v136
  v_pk_mul_f32 v[26:27], v[26:27], v[28:29]
  v_cvt_pk_bf16_f32 v28, v26, v27
  v_lshlrev_b32 v26, 16, v28
  v_and_b32 v27, 0xffff0000, v28
  v_lshlrev_b32 v30, 16, v128
  v_and_b32 v31, 0xffff0000, v128
  v_pk_add_f32 v[26:27], v[26:27], v[30:31]
  v_cvt_pk_bf16_f32 v104, v26, v27
  v_lshlrev_b32 v26, 16, v105
  v_and_b32 v27, 0xffff0000, v105
  v_lshlrev_b32 v28, 16, v137
  v_and_b32 v29, 0xffff0000, v137
  v_pk_mul_f32 v[26:27], v[26:27], v[28:29]
  v_cvt_pk_bf16_f32 v28, v26, v27
  v_lshlrev_b32 v26, 16, v28
  v_and_b32 v27, 0xffff0000, v28
  v_lshlrev_b32 v30, 16, v129
  v_and_b32 v31, 0xffff0000, v129
  v_pk_add_f32 v[26:27], v[26:27], v[30:31]
  v_cvt_pk_bf16_f32 v105, v26, v27
  v_lshlrev_b32 v26, 16, v106
  v_and_b32 v27, 0xffff0000, v106
  v_lshlrev_b32 v28, 16, v138
  v_and_b32 v29, 0xffff0000, v138
  v_pk_mul_f32 v[26:27], v[26:27], v[28:29]
  v_cvt_pk_bf16_f32 v28, v26, v27
  v_lshlrev_b32 v26, 16, v28
  v_and_b32 v27, 0xffff0000, v28
  v_lshlrev_b32 v30, 16, v130
  v_and_b32 v31, 0xffff0000, v130
  v_pk_add_f32 v[26:27], v[26:27], v[30:31]
  v_cvt_pk_bf16_f32 v106, v26, v27
  v_lshlrev_b32 v26, 16, v107
  v_and_b32 v27, 0xffff0000, v107
  v_lshlrev_b32 v28, 16, v139
  v_and_b32 v29, 0xffff0000, v139
  v_pk_mul_f32 v[26:27], v[26:27], v[28:29]
  v_cvt_pk_bf16_f32 v28, v26, v27
  v_lshlrev_b32 v26, 16, v28
  v_and_b32 v27, 0xffff0000, v28
  v_lshlrev_b32 v30, 16, v131
  v_and_b32 v31, 0xffff0000, v131
  v_pk_add_f32 v[26:27], v[26:27], v[30:31]
  v_cvt_pk_bf16_f32 v107, v26, v27
  v_lshlrev_b32 v26, 16, v108
  v_and_b32 v27, 0xffff0000, v108
  v_lshlrev_b32 v28, 16, v140
  v_and_b32 v29, 0xffff0000, v140
  v_pk_mul_f32 v[26:27], v[26:27], v[28:29]
  v_cvt_pk_bf16_f32 v28, v26, v27
  v_lshlrev_b32 v26, 16, v28
  v_and_b32 v27, 0xffff0000, v28
  v_lshlrev_b32 v30, 16, v132
  v_and_b32 v31, 0xffff0000, v132
  v_pk_add_f32 v[26:27], v[26:27], v[30:31]
  v_cvt_pk_bf16_f32 v108, v26, v27
  v_lshlrev_b32 v26, 16, v109
  v_and_b32 v27, 0xffff0000, v109
  v_lshlrev_b32 v28, 16, v141
  v_and_b32 v29, 0xffff0000, v141
  v_pk_mul_f32 v[26:27], v[26:27], v[28:29]
  v_cvt_pk_bf16_f32 v28, v26, v27
  v_lshlrev_b32 v26, 16, v28
  v_and_b32 v27, 0xffff0000, v28
  v_lshlrev_b32 v30, 16, v133
  v_and_b32 v31, 0xffff0000, v133
  v_pk_add_f32 v[26:27], v[26:27], v[30:31]
  v_cvt_pk_bf16_f32 v109, v26, v27
  v_lshlrev_b32 v26, 16, v110
  v_and_b32 v27, 0xffff0000, v110
  v_lshlrev_b32 v28, 16, v142
  v_and_b32 v29, 0xffff0000, v142
  v_pk_mul_f32 v[26:27], v[26:27], v[28:29]
  v_cvt_pk_bf16_f32 v28, v26, v27
  v_lshlrev_b32 v26, 16, v28
  v_and_b32 v27, 0xffff0000, v28
  v_lshlrev_b32 v30, 16, v134
  v_and_b32 v31, 0xffff0000, v134
  v_pk_add_f32 v[26:27], v[26:27], v[30:31]
  v_cvt_pk_bf16_f32 v110, v26, v27
  v_lshlrev_b32 v26, 16, v111
  v_and_b32 v27, 0xffff0000, v111
  v_lshlrev_b32 v28, 16, v143
  v_and_b32 v29, 0xffff0000, v143
  v_pk_mul_f32 v[26:27], v[26:27], v[28:29]
  v_cvt_pk_bf16_f32 v28, v26, v27
  v_lshlrev_b32 v26, 16, v28
  v_and_b32 v27, 0xffff0000, v28
  v_lshlrev_b32 v30, 16, v135
  v_and_b32 v31, 0xffff0000, v135
  v_pk_add_f32 v[26:27], v[26:27], v[30:31]
  v_cvt_pk_bf16_f32 v111, v26, v27
  buffer_store_dwordx4 v[104:107], v15, s[36:39], s89 offen offset:64
  buffer_store_dwordx4 v[108:111], v15, s[36:39], s89 offen offset:96
  v_accvgpr_read_b32 v176, a80
  v_accvgpr_read_b32 v177, a81
  v_accvgpr_read_b32 v178, a82
  v_accvgpr_read_b32 v179, a83
  v_accvgpr_read_b32 v180, a84
  v_accvgpr_read_b32 v181, a85
  v_accvgpr_read_b32 v182, a86
  v_accvgpr_read_b32 v183, a87
  v_accvgpr_read_b32 v184, a88
  v_accvgpr_read_b32 v185, a89
  v_accvgpr_read_b32 v186, a90
  v_accvgpr_read_b32 v187, a91
  v_accvgpr_read_b32 v188, a92
  v_accvgpr_read_b32 v189, a93
  v_accvgpr_read_b32 v190, a94
  v_accvgpr_read_b32 v191, a95
  v_cvt_pk_bf16_f32 v96, v176, v177
  v_cvt_pk_bf16_f32 v97, v178, v179
  v_cvt_pk_bf16_f32 v98, v180, v181
  v_cvt_pk_bf16_f32 v99, v182, v183
  v_cvt_pk_bf16_f32 v100, v184, v185
  v_cvt_pk_bf16_f32 v101, v186, v187
  v_cvt_pk_bf16_f32 v102, v188, v189
  v_cvt_pk_bf16_f32 v103, v190, v191
  v_permlane32_swap_b32 v96, v98
  v_permlane32_swap_b32 v97, v99
  v_permlane32_swap_b32 v100, v102
  v_permlane32_swap_b32 v101, v103
  s_waitcnt vmcnt(10)
  v_lshlrev_b32 v26, 16, v96
  v_and_b32 v27, 0xffff0000, v96
  v_lshlrev_b32 v28, 16, v152
  v_and_b32 v29, 0xffff0000, v152
  v_pk_mul_f32 v[26:27], v[26:27], v[28:29]
  v_cvt_pk_bf16_f32 v28, v26, v27
  v_lshlrev_b32 v26, 16, v28
  v_and_b32 v27, 0xffff0000, v28
  v_lshlrev_b32 v30, 16, v144
  v_and_b32 v31, 0xffff0000, v144
  v_pk_add_f32 v[26:27], v[26:27], v[30:31]
  v_cvt_pk_bf16_f32 v96, v26, v27
  v_lshlrev_b32 v26, 16, v97
  v_and_b32 v27, 0xffff0000, v97
  v_lshlrev_b32 v28, 16, v153
  v_and_b32 v29, 0xffff0000, v153
  v_pk_mul_f32 v[26:27], v[26:27], v[28:29]
  v_cvt_pk_bf16_f32 v28, v26, v27
  v_lshlrev_b32 v26, 16, v28
  v_and_b32 v27, 0xffff0000, v28
  v_lshlrev_b32 v30, 16, v145
  v_and_b32 v31, 0xffff0000, v145
  v_pk_add_f32 v[26:27], v[26:27], v[30:31]
  v_cvt_pk_bf16_f32 v97, v26, v27
  v_lshlrev_b32 v26, 16, v98
  v_and_b32 v27, 0xffff0000, v98
  v_lshlrev_b32 v28, 16, v154
  v_and_b32 v29, 0xffff0000, v154
  v_pk_mul_f32 v[26:27], v[26:27], v[28:29]
  v_cvt_pk_bf16_f32 v28, v26, v27
  v_lshlrev_b32 v26, 16, v28
  v_and_b32 v27, 0xffff0000, v28
  v_lshlrev_b32 v30, 16, v146
  v_and_b32 v31, 0xffff0000, v146
  v_pk_add_f32 v[26:27], v[26:27], v[30:31]
  v_cvt_pk_bf16_f32 v98, v26, v27
  v_lshlrev_b32 v26, 16, v99
  v_and_b32 v27, 0xffff0000, v99
  v_lshlrev_b32 v28, 16, v155
  v_and_b32 v29, 0xffff0000, v155
  v_pk_mul_f32 v[26:27], v[26:27], v[28:29]
  v_cvt_pk_bf16_f32 v28, v26, v27
  v_lshlrev_b32 v26, 16, v28
  v_and_b32 v27, 0xffff0000, v28
  v_lshlrev_b32 v30, 16, v147
  v_and_b32 v31, 0xffff0000, v147
  v_pk_add_f32 v[26:27], v[26:27], v[30:31]
  v_cvt_pk_bf16_f32 v99, v26, v27
  v_lshlrev_b32 v26, 16, v100
  v_and_b32 v27, 0xffff0000, v100
  v_lshlrev_b32 v28, 16, v156
  v_and_b32 v29, 0xffff0000, v156
  v_pk_mul_f32 v[26:27], v[26:27], v[28:29]
  v_cvt_pk_bf16_f32 v28, v26, v27
  v_lshlrev_b32 v26, 16, v28
  v_and_b32 v27, 0xffff0000, v28
  v_lshlrev_b32 v30, 16, v148
  v_and_b32 v31, 0xffff0000, v148
  v_pk_add_f32 v[26:27], v[26:27], v[30:31]
  v_cvt_pk_bf16_f32 v100, v26, v27
  v_lshlrev_b32 v26, 16, v101
  v_and_b32 v27, 0xffff0000, v101
  v_lshlrev_b32 v28, 16, v157
  v_and_b32 v29, 0xffff0000, v157
  v_pk_mul_f32 v[26:27], v[26:27], v[28:29]
  v_cvt_pk_bf16_f32 v28, v26, v27
  v_lshlrev_b32 v26, 16, v28
  v_and_b32 v27, 0xffff0000, v28
  v_lshlrev_b32 v30, 16, v149
  v_and_b32 v31, 0xffff0000, v149
  v_pk_add_f32 v[26:27], v[26:27], v[30:31]
  v_cvt_pk_bf16_f32 v101, v26, v27
  v_lshlrev_b32 v26, 16, v102
  v_and_b32 v27, 0xffff0000, v102
  v_lshlrev_b32 v28, 16, v158
  v_and_b32 v29, 0xffff0000, v158
  v_pk_mul_f32 v[26:27], v[26:27], v[28:29]
  v_cvt_pk_bf16_f32 v28, v26, v27
  v_lshlrev_b32 v26, 16, v28
  v_and_b32 v27, 0xffff0000, v28
  v_lshlrev_b32 v30, 16, v150
  v_and_b32 v31, 0xffff0000, v150
  v_pk_add_f32 v[26:27], v[26:27], v[30:31]
  v_cvt_pk_bf16_f32 v102, v26, v27
  v_lshlrev_b32 v26, 16, v103
  v_and_b32 v27, 0xffff0000, v103
  v_lshlrev_b32 v28, 16, v159
  v_and_b32 v29, 0xffff0000, v159
  v_pk_mul_f32 v[26:27], v[26:27], v[28:29]
  v_cvt_pk_bf16_f32 v28, v26, v27
  v_lshlrev_b32 v26, 16, v28
  v_and_b32 v27, 0xffff0000, v28
  v_lshlrev_b32 v30, 16, v151
  v_and_b32 v31, 0xffff0000, v151
  v_pk_add_f32 v[26:27], v[26:27], v[30:31]
  v_cvt_pk_bf16_f32 v103, v26, v27
  buffer_store_dwordx4 v[96:99], v15, s[36:39], s89 offen offset:128
  buffer_store_dwordx4 v[100:103], v15, s[36:39], s89 offen offset:160
  v_accvgpr_read_b32 v176, a112
  v_accvgpr_read_b32 v177, a113
  v_accvgpr_read_b32 v178, a114
  v_accvgpr_read_b32 v179, a115
  v_accvgpr_read_b32 v180, a116
  v_accvgpr_read_b32 v181, a117
  v_accvgpr_read_b32 v182, a118
  v_accvgpr_read_b32 v183, a119
  v_accvgpr_read_b32 v184, a120
  v_accvgpr_read_b32 v185, a121
  v_accvgpr_read_b32 v186, a122
  v_accvgpr_read_b32 v187, a123
  v_accvgpr_read_b32 v188, a124
  v_accvgpr_read_b32 v189, a125
  v_accvgpr_read_b32 v190, a126
  v_accvgpr_read_b32 v191, a127
  v_cvt_pk_bf16_f32 v104, v176, v177
  v_cvt_pk_bf16_f32 v105, v178, v179
  v_cvt_pk_bf16_f32 v106, v180, v181
  v_cvt_pk_bf16_f32 v107, v182, v183
  v_cvt_pk_bf16_f32 v108, v184, v185
  v_cvt_pk_bf16_f32 v109, v186, v187
  v_cvt_pk_bf16_f32 v110, v188, v189
  v_cvt_pk_bf16_f32 v111, v190, v191
  v_permlane32_swap_b32 v104, v106
  v_permlane32_swap_b32 v105, v107
  v_permlane32_swap_b32 v108, v110
  v_permlane32_swap_b32 v109, v111
  s_waitcnt vmcnt(6)
  v_lshlrev_b32 v26, 16, v104
  v_and_b32 v27, 0xffff0000, v104
  v_lshlrev_b32 v28, 16, v168
  v_and_b32 v29, 0xffff0000, v168
  v_pk_mul_f32 v[26:27], v[26:27], v[28:29]
  v_cvt_pk_bf16_f32 v28, v26, v27
  v_lshlrev_b32 v26, 16, v28
  v_and_b32 v27, 0xffff0000, v28
  v_lshlrev_b32 v30, 16, v160
  v_and_b32 v31, 0xffff0000, v160
  v_pk_add_f32 v[26:27], v[26:27], v[30:31]
  v_cvt_pk_bf16_f32 v104, v26, v27
  v_lshlrev_b32 v26, 16, v105
  v_and_b32 v27, 0xffff0000, v105
  v_lshlrev_b32 v28, 16, v169
  v_and_b32 v29, 0xffff0000, v169
  v_pk_mul_f32 v[26:27], v[26:27], v[28:29]
  v_cvt_pk_bf16_f32 v28, v26, v27
  v_lshlrev_b32 v26, 16, v28
  v_and_b32 v27, 0xffff0000, v28
  v_lshlrev_b32 v30, 16, v161
  v_and_b32 v31, 0xffff0000, v161
  v_pk_add_f32 v[26:27], v[26:27], v[30:31]
  v_cvt_pk_bf16_f32 v105, v26, v27
  v_lshlrev_b32 v26, 16, v106
  v_and_b32 v27, 0xffff0000, v106
  v_lshlrev_b32 v28, 16, v170
  v_and_b32 v29, 0xffff0000, v170
  v_pk_mul_f32 v[26:27], v[26:27], v[28:29]
  v_cvt_pk_bf16_f32 v28, v26, v27
  v_lshlrev_b32 v26, 16, v28
  v_and_b32 v27, 0xffff0000, v28
  v_lshlrev_b32 v30, 16, v162
  v_and_b32 v31, 0xffff0000, v162
  v_pk_add_f32 v[26:27], v[26:27], v[30:31]
  v_cvt_pk_bf16_f32 v106, v26, v27
  v_lshlrev_b32 v26, 16, v107
  v_and_b32 v27, 0xffff0000, v107
  v_lshlrev_b32 v28, 16, v171
  v_and_b32 v29, 0xffff0000, v171
  v_pk_mul_f32 v[26:27], v[26:27], v[28:29]
  v_cvt_pk_bf16_f32 v28, v26, v27
  v_lshlrev_b32 v26, 16, v28
  v_and_b32 v27, 0xffff0000, v28
  v_lshlrev_b32 v30, 16, v163
  v_and_b32 v31, 0xffff0000, v163
  v_pk_add_f32 v[26:27], v[26:27], v[30:31]
  v_cvt_pk_bf16_f32 v107, v26, v27
  v_lshlrev_b32 v26, 16, v108
  v_and_b32 v27, 0xffff0000, v108
  v_lshlrev_b32 v28, 16, v172
  v_and_b32 v29, 0xffff0000, v172
  v_pk_mul_f32 v[26:27], v[26:27], v[28:29]
  v_cvt_pk_bf16_f32 v28, v26, v27
  v_lshlrev_b32 v26, 16, v28
  v_and_b32 v27, 0xffff0000, v28
  v_lshlrev_b32 v30, 16, v164
  v_and_b32 v31, 0xffff0000, v164
  v_pk_add_f32 v[26:27], v[26:27], v[30:31]
  v_cvt_pk_bf16_f32 v108, v26, v27
  v_lshlrev_b32 v26, 16, v109
  v_and_b32 v27, 0xffff0000, v109
  v_lshlrev_b32 v28, 16, v173
  v_and_b32 v29, 0xffff0000, v173
  v_pk_mul_f32 v[26:27], v[26:27], v[28:29]
  v_cvt_pk_bf16_f32 v28, v26, v27
  v_lshlrev_b32 v26, 16, v28
  v_and_b32 v27, 0xffff0000, v28
  v_lshlrev_b32 v30, 16, v165
  v_and_b32 v31, 0xffff0000, v165
  v_pk_add_f32 v[26:27], v[26:27], v[30:31]
  v_cvt_pk_bf16_f32 v109, v26, v27
  v_lshlrev_b32 v26, 16, v110
  v_and_b32 v27, 0xffff0000, v110
  v_lshlrev_b32 v28, 16, v174
  v_and_b32 v29, 0xffff0000, v174
  v_pk_mul_f32 v[26:27], v[26:27], v[28:29]
  v_cvt_pk_bf16_f32 v28, v26, v27
  v_lshlrev_b32 v26, 16, v28
  v_and_b32 v27, 0xffff0000, v28
  v_lshlrev_b32 v30, 16, v166
  v_and_b32 v31, 0xffff0000, v166
  v_pk_add_f32 v[26:27], v[26:27], v[30:31]
  v_cvt_pk_bf16_f32 v110, v26, v27
  v_lshlrev_b32 v26, 16, v111
  v_and_b32 v27, 0xffff0000, v111
  v_lshlrev_b32 v28, 16, v175
  v_and_b32 v29, 0xffff0000, v175
  v_pk_mul_f32 v[26:27], v[26:27], v[28:29]
  v_cvt_pk_bf16_f32 v28, v26, v27
  v_lshlrev_b32 v26, 16, v28
  v_and_b32 v27, 0xffff0000, v28
  v_lshlrev_b32 v30, 16, v167
  v_and_b32 v31, 0xffff0000, v167
  v_pk_add_f32 v[26:27], v[26:27], v[30:31]
  v_cvt_pk_bf16_f32 v111, v26, v27
  buffer_store_dwordx4 v[104:107], v15, s[36:39], s89 offen offset:192
  buffer_store_dwordx4 v[108:111], v15, s[36:39], s89 offen offset:224
  s_waitcnt vmcnt(0)
  s_barrier
  s_branch w_next
w_g5se:
  s_lshl_b32 s87, s82, 2
  s_add_u32 s87, s87, s83
  s_lshl_b32 s85, s87, 3
  s_add_u32 s85, s85, s84
  s_lshl_b32 s85, s85, 16
  s_lshl_b32 s89, s58, 14
  s_add_u32 s85, s85, s89
  s_add_u32 s85, s85, 134217728
  v_lshlrev_b32 v26, 4, v1
  v_accvgpr_read_b32 v160, a0
  v_accvgpr_read_b32 v161, a1
  v_accvgpr_read_b32 v162, a2
  v_accvgpr_read_b32 v163, a3
  v_accvgpr_read_b32 v164, a4
  v_accvgpr_read_b32 v165, a5
  v_accvgpr_read_b32 v166, a6
  v_accvgpr_read_b32 v167, a7
  v_accvgpr_read_b32 v168, a8
  v_accvgpr_read_b32 v169, a9
  v_accvgpr_read_b32 v170, a10
  v_accvgpr_read_b32 v171, a11
  v_accvgpr_read_b32 v172, a12
  v_accvgpr_read_b32 v173, a13
  v_accvgpr_read_b32 v174, a14
  v_accvgpr_read_b32 v175, a15
  v_cvt_pk_bf16_f32 v96, v160, v161
  v_cvt_pk_bf16_f32 v97, v162, v163
  v_cvt_pk_bf16_f32 v98, v164, v165
  v_cvt_pk_bf16_f32 v99, v166, v167
  v_cvt_pk_bf16_f32 v100, v168, v169
  v_cvt_pk_bf16_f32 v101, v170, v171
  v_cvt_pk_bf16_f32 v102, v172, v173
  v_cvt_pk_bf16_f32 v103, v174, v175
  buffer_store_dwordx4 v[96:99], v26, s[28:31], s85 offen offset:0 sc1
  buffer_store_dwordx4 v[100:103], v26, s[28:31], s85 offen offset:1024 sc1
  v_accvgpr_read_b32 v160, a16
  v_accvgpr_read_b32 v161, a17
  v_accvgpr_read_b32 v162, a18
  v_accvgpr_read_b32 v163, a19
  v_accvgpr_read_b32 v164, a20
  v_accvgpr_read_b32 v165, a21
  v_accvgpr_read_b32 v166, a22
  v_accvgpr_read_b32 v167, a23
  v_accvgpr_read_b32 v168, a24
  v_accvgpr_read_b32 v169, a25
  v_accvgpr_read_b32 v170, a26
  v_accvgpr_read_b32 v171, a27
  v_accvgpr_read_b32 v172, a28
  v_accvgpr_read_b32 v173, a29
  v_accvgpr_read_b32 v174, a30
  v_accvgpr_read_b32 v175, a31
  v_cvt_pk_bf16_f32 v104, v160, v161
  v_cvt_pk_bf16_f32 v105, v162, v163
  v_cvt_pk_bf16_f32 v106, v164, v165
  v_cvt_pk_bf16_f32 v107, v166, v167
  v_cvt_pk_bf16_f32 v108, v168, v169
  v_cvt_pk_bf16_f32 v109, v170, v171
  v_cvt_pk_bf16_f32 v110, v172, v173
  v_cvt_pk_bf16_f32 v111, v174, v175
  buffer_store_dwordx4 v[104:107], v26, s[28:31], s85 offen offset:2048 sc1
  buffer_store_dwordx4 v[108:111], v26, s[28:31], s85 offen offset:3072 sc1
  s_add_u32 s85, s85, 4096
  v_accvgpr_read_b32 v160, a32
  v_accvgpr_read_b32 v161, a33
  v_accvgpr_read_b32 v162, a34
  v_accvgpr_read_b32 v163, a35
  v_accvgpr_read_b32 v164, a36
  v_accvgpr_read_b32 v165, a37
  v_accvgpr_read_b32 v166, a38
  v_accvgpr_read_b32 v167, a39
  v_accvgpr_read_b32 v168, a40
  v_accvgpr_read_b32 v169, a41
  v_accvgpr_read_b32 v170, a42
  v_accvgpr_read_b32 v171, a43
  v_accvgpr_read_b32 v172, a44
  v_accvgpr_read_b32 v173, a45
  v_accvgpr_read_b32 v174, a46
  v_accvgpr_read_b32 v175, a47
  v_cvt_pk_bf16_f32 v112, v160, v161
  v_cvt_pk_bf16_f32 v113, v162, v163
  v_cvt_pk_bf16_f32 v114, v164, v165
  v_cvt_pk_bf16_f32 v115, v166, v167
  v_cvt_pk_bf16_f32 v116, v168, v169
  v_cvt_pk_bf16_f32 v117, v170, v171
  v_cvt_pk_bf16_f32 v118, v172, v173
  v_cvt_pk_bf16_f32 v119, v174, v175
  buffer_store_dwordx4 v[112:115], v26, s[28:31], s85 offen offset:0 sc1
  buffer_store_dwordx4 v[116:119], v26, s[28:31], s85 offen offset:1024 sc1
  v_accvgpr_read_b32 v160, a48
  v_accvgpr_read_b32 v161, a49
  v_accvgpr_read_b32 v162, a50
  v_accvgpr_read_b32 v163, a51
  v_accvgpr_read_b32 v164, a52
  v_accvgpr_read_b32 v165, a53
  v_accvgpr_read_b32 v166, a54
  v_accvgpr_read_b32 v167, a55
  v_accvgpr_read_b32 v168, a56
  v_accvgpr_read_b32 v169, a57
  v_accvgpr_read_b32 v170, a58
  v_accvgpr_read_b32 v171, a59
  v_accvgpr_read_b32 v172, a60
  v_accvgpr_read_b32 v173, a61
  v_accvgpr_read_b32 v174, a62
  v_accvgpr_read_b32 v175, a63
  v_cvt_pk_bf16_f32 v120, v160, v161
  v_cvt_pk_bf16_f32 v121, v162, v163
  v_cvt_pk_bf16_f32 v122, v164, v165
  v_cvt_pk_bf16_f32 v123, v166, v167
  v_cvt_pk_bf16_f32 v124, v168, v169
  v_cvt_pk_bf16_f32 v125, v170, v171
  v_cvt_pk_bf16_f32 v126, v172, v173
  v_cvt_pk_bf16_f32 v127, v174, v175
  buffer_store_dwordx4 v[120:123], v26, s[28:31], s85 offen offset:2048 sc1
  buffer_store_dwordx4 v[124:127], v26, s[28:31], s85 offen offset:3072 sc1
  s_add_u32 s85, s85, 4096
  v_accvgpr_read_b32 v160, a64
  v_accvgpr_read_b32 v161, a65
  v_accvgpr_read_b32 v162, a66
  v_accvgpr_read_b32 v163, a67
  v_accvgpr_read_b32 v164, a68
  v_accvgpr_read_b32 v165, a69
  v_accvgpr_read_b32 v166, a70
  v_accvgpr_read_b32 v167, a71
  v_accvgpr_read_b32 v168, a72
  v_accvgpr_read_b32 v169, a73
  v_accvgpr_read_b32 v170, a74
  v_accvgpr_read_b32 v171, a75
  v_accvgpr_read_b32 v172, a76
  v_accvgpr_read_b32 v173, a77
  v_accvgpr_read_b32 v174, a78
  v_accvgpr_read_b32 v175, a79
  v_cvt_pk_bf16_f32 v96, v160, v161
  v_cvt_pk_bf16_f32 v97, v162, v163
  v_cvt_pk_bf16_f32 v98, v164, v165
  v_cvt_pk_bf16_f32 v99, v166, v167
  v_cvt_pk_bf16_f32 v100, v168, v169
  v_cvt_pk_bf16_f32 v101, v170, v171
  v_cvt_pk_bf16_f32 v102, v172, v173
  v_cvt_pk_bf16_f32 v103, v174, v175
  buffer_store_dwordx4 v[96:99], v26, s[28:31], s85 offen offset:0 sc1
  buffer_store_dwordx4 v[100:103], v26, s[28:31], s85 offen offset:1024 sc1
  v_accvgpr_read_b32 v160, a80
  v_accvgpr_read_b32 v161, a81
  v_accvgpr_read_b32 v162, a82
  v_accvgpr_read_b32 v163, a83
  v_accvgpr_read_b32 v164, a84
  v_accvgpr_read_b32 v165, a85
  v_accvgpr_read_b32 v166, a86
  v_accvgpr_read_b32 v167, a87
  v_accvgpr_read_b32 v168, a88
  v_accvgpr_read_b32 v169, a89
  v_accvgpr_read_b32 v170, a90
  v_accvgpr_read_b32 v171, a91
  v_accvgpr_read_b32 v172, a92
  v_accvgpr_read_b32 v173, a93
  v_accvgpr_read_b32 v174, a94
  v_accvgpr_read_b32 v175, a95
  v_cvt_pk_bf16_f32 v104, v160, v161
  v_cvt_pk_bf16_f32 v105, v162, v163
  v_cvt_pk_bf16_f32 v106, v164, v165
  v_cvt_pk_bf16_f32 v107, v166, v167
  v_cvt_pk_bf16_f32 v108, v168, v169
  v_cvt_pk_bf16_f32 v109, v170, v171
  v_cvt_pk_bf16_f32 v110, v172, v173
  v_cvt_pk_bf16_f32 v111, v174, v175
  buffer_store_dwordx4 v[104:107], v26, s[28:31], s85 offen offset:2048 sc1
  buffer_store_dwordx4 v[108:111], v26, s[28:31], s85 offen offset:3072 sc1
  s_add_u32 s85, s85, 4096
  v_accvgpr_read_b32 v160, a96
  v_accvgpr_read_b32 v161, a97
  v_accvgpr_read_b32 v162, a98
  v_accvgpr_read_b32 v163, a99
  v_accvgpr_read_b32 v164, a100
  v_accvgpr_read_b32 v165, a101
  v_accvgpr_read_b32 v166, a102
  v_accvgpr_read_b32 v167, a103
  v_accvgpr_read_b32 v168, a104
  v_accvgpr_read_b32 v169, a105
  v_accvgpr_read_b32 v170, a106
  v_accvgpr_read_b32 v171, a107
  v_accvgpr_read_b32 v172, a108
  v_accvgpr_read_b32 v173, a109
  v_accvgpr_read_b32 v174, a110
  v_accvgpr_read_b32 v175, a111
  v_cvt_pk_bf16_f32 v112, v160, v161
  v_cvt_pk_bf16_f32 v113, v162, v163
  v_cvt_pk_bf16_f32 v114, v164, v165
  v_cvt_pk_bf16_f32 v115, v166, v167
  v_cvt_pk_bf16_f32 v116, v168, v169
  v_cvt_pk_bf16_f32 v117, v170, v171
  v_cvt_pk_bf16_f32 v118, v172, v173
  v_cvt_pk_bf16_f32 v119, v174, v175
  buffer_store_dwordx4 v[112:115], v26, s[28:31], s85 offen offset:0 sc1
  buffer_store_dwordx4 v[116:119], v26, s[28:31], s85 offen offset:1024 sc1
  v_accvgpr_read_b32 v160, a112
  v_accvgpr_read_b32 v161, a113
  v_accvgpr_read_b32 v162, a114
  v_accvgpr_read_b32 v163, a115
  v_accvgpr_read_b32 v164, a116
  v_accvgpr_read_b32 v165, a117
  v_accvgpr_read_b32 v166, a118
  v_accvgpr_read_b32 v167, a119
  v_accvgpr_read_b32 v168, a120
  v_accvgpr_read_b32 v169, a121
  v_accvgpr_read_b32 v170, a122
  v_accvgpr_read_b32 v171, a123
  v_accvgpr_read_b32 v172, a124
  v_accvgpr_read_b32 v173, a125
  v_accvgpr_read_b32 v174, a126
  v_accvgpr_read_b32 v175, a127
  v_cvt_pk_bf16_f32 v120, v160, v161
  v_cvt_pk_bf16_f32 v121, v162, v163
  v_cvt_pk_bf16_f32 v122, v164, v165
  v_cvt_pk_bf16_f32 v123, v166, v167
  v_cvt_pk_bf16_f32 v124, v168, v169
  v_cvt_pk_bf16_f32 v125, v170, v171
  v_cvt_pk_bf16_f32 v126, v172, v173
  v_cvt_pk_bf16_f32 v127, v174, v175
  buffer_store_dwordx4 v[120:123], v26, s[28:31], s85 offen offset:2048 sc1
  buffer_store_dwordx4 v[124:127], v26, s[28:31], s85 offen offset:3072 sc1
  s_add_u32 s85, s85, 4096
  s_lshr_b32 s86, s82, 1
  s_add_u32 s86, s86, 40
  s_lshl_b32 s61, s86, 7
  s_add_u32 s61, s61, 99614720
  s_cmp_lg_u32 s58, 0
  s_cbranch_scc1 wf_65_ok
wf_65:
  buffer_load_dword v26, v255, s[28:31], s61 offen sc1
  s_waitcnt vmcnt(0)
  v_readfirstlane_b32 s62, v26
  s_nop 3
  s_cmp_ge_u32 s62, 4
  s_cbranch_scc1 wf_65_ok
  s_sub_u32 s88, s88, 1
  s_cselect_b32 s88, 0, s88
  s_cbranch_scc1 wf_65_ok
  s_sleep 3
  s_branch wf_65
wf_65_ok:
  s_barrier
  s_nop 0
  s_add_u32 s86, s87, 960
  s_waitcnt vmcnt(0)
  s_barrier
  s_cmp_lg_u32 s58, 0
  s_cbranch_scc1 sg_66
  v_mov_b32 v26, 1
  s_mov_b64 exec, 1
  s_lshl_b32 s61, s86, 7
  s_add_u32 s61, s61, 99614720
  buffer_atomic_add v26, v255, s[28:31], s61 offen sc1
  s_mov_b64 exec, -1
sg_66:
  s_nop 0
  s_lshl_b32 s61, s86, 7
  s_add_u32 s61, s61, 99614720
  s_cmp_lg_u32 s58, 0
  s_cbranch_scc1 wf_67_ok
wf_67:
  buffer_load_dword v26, v255, s[28:31], s61 offen sc1
  s_waitcnt vmcnt(0)
  v_readfirstlane_b32 s62, v26
  s_nop 3
  s_cmp_ge_u32 s62, 8
  s_cbranch_scc1 wf_67_ok
  s_sub_u32 s88, s88, 1
  s_cselect_b32 s88, 0, s88
  s_cbranch_scc1 wf_67_ok
  s_sleep 3
  s_branch wf_67
wf_67_ok:
  s_barrier
  s_nop 0
  s_lshl_b32 s85, s87, 19
  s_lshl_b32 s89, s58, 14
  s_add_u32 s85, s85, s89
  s_lshl_b32 s89, s84, 11
  s_add_u32 s85, s85, s89
  s_add_u32 s85, s85, 134217728
  s_lshl_b32 s89, s82, 2
  s_lshl_b32 s86, s60, 1
  s_add_u32 s89, s89, s86
  s_and_b32 s86, s84, 1
  s_add_u32 s89, s89, s86
  s_lshl_b32 s64, s89, 10
  s_lshl_b32 s89, s89, 16
  s_lshl_b32 s86, s83, 3
  s_lshl_b32 s87, s59, 2
  s_add_u32 s86, s86, s87
  s_lshr_b32 s87, s84, 1
  s_add_u32 s86, s86, s87
  s_lshl_b32 s65, s86, 17
  s_lshl_b32 s86, s86, 6
  s_add_u32 s89, s89, s86
  s_add_u32 s86, s64, s65
  s_add_u32 s86, s86, 67108864
  s_mov_b32 s32, s4
  s_mov_b32 s33, s5
  s_mov_b32 s34, 4194304
  s_mov_b32 s35, 0x20000
  s_mov_b32 s36, s24
  s_mov_b32 s37, s25
  s_mov_b32 s38, 4194304
  s_mov_b32 s39, 0x20000
  v_lshlrev_b32 v27, 4, v1
  v_and_b32 v14, 31, v1
  v_mul_u32_u24 v26, 2048, v14
  v_lshrrev_b32 v14, 5, v1
  v_lshl_add_u32 v26, v14, 4, v26
  v_and_b32 v14, 31, v1
  v_lshlrev_b32 v18, 5, v14
  v_lshrrev_b32 v14, 5, v1
  v_lshl_add_u32 v18, v14, 4, v18
  buffer_load_dwordx4 v[104:107], v26, s[32:35], s89 offen offset:0
  s_add_u32 s49, s86, 0
  buffer_load_dwordx4 v[112:115], v18, s[28:31], s49 offen sc1
  buffer_load_dwordx4 v[108:111], v26, s[32:35], s89 offen offset:32
  s_add_u32 s49, s86, 65536
  buffer_load_dwordx4 v[116:119], v18, s[28:31], s49 offen sc1
  buffer_load_dwordx4 v[140:143], v27, s[28:31], s85 offen offset:0 sc1
  buffer_load_dwordx4 v[144:147], v27, s[28:31], s85 offen offset:1024 sc1
  s_add_u32 s85, s85, 65536
  buffer_load_dwordx4 v[148:151], v27, s[28:31], s85 offen offset:0 sc1
  buffer_load_dwordx4 v[152:155], v27, s[28:31], s85 offen offset:1024 sc1
  s_add_u32 s85, s85, 65536
  buffer_load_dwordx4 v[156:159], v27, s[28:31], s85 offen offset:0 sc1
  buffer_load_dwordx4 v[160:163], v27, s[28:31], s85 offen offset:1024 sc1
  s_add_u32 s85, s85, 65536
  buffer_load_dwordx4 v[164:167], v27, s[28:31], s85 offen offset:0 sc1
  buffer_load_dwordx4 v[168:171], v27, s[28:31], s85 offen offset:1024 sc1
  s_add_u32 s85, s85, 65536
  buffer_load_dwordx4 v[172:175], v27, s[28:31], s85 offen offset:0 sc1
  buffer_load_dwordx4 v[176:179], v27, s[28:31], s85 offen offset:1024 sc1
  s_add_u32 s85, s85, 65536
  buffer_load_dwordx4 v[180:183], v27, s[28:31], s85 offen offset:0 sc1
  buffer_load_dwordx4 v[184:187], v27, s[28:31], s85 offen offset:1024 sc1
  s_add_u32 s85, s85, 65536
  buffer_load_dwordx4 v[188:191], v27, s[28:31], s85 offen offset:0 sc1
  buffer_load_dwordx4 v[192:195], v27, s[28:31], s85 offen offset:1024 sc1
  s_add_u32 s85, s85, 65536
  buffer_load_dwordx4 v[196:199], v27, s[28:31], s85 offen offset:0 sc1
  buffer_load_dwordx4 v[200:203], v27, s[28:31], s85 offen offset:1024 sc1
  s_add_u32 s85, s85, 65536
  v_mov_b32 v138, 0x3f80
  v_mov_b32 v139, 0x3f800000
  s_waitcnt vmcnt(14)
  v_dot2_f32_bf16 v120, v140, v138, 0
  v_dot2_f32_bf16 v121, v140, v139, 0
  v_dot2_f32_bf16 v122, v141, v138, 0
  v_dot2_f32_bf16 v123, v141, v139, 0
  v_dot2_f32_bf16 v124, v142, v138, 0
  v_dot2_f32_bf16 v125, v142, v139, 0
  v_dot2_f32_bf16 v126, v143, v138, 0
  v_dot2_f32_bf16 v127, v143, v139, 0
  v_dot2_f32_bf16 v128, v144, v138, 0
  v_dot2_f32_bf16 v129, v144, v139, 0
  v_dot2_f32_bf16 v130, v145, v138, 0
  v_dot2_f32_bf16 v131, v145, v139, 0
  v_dot2_f32_bf16 v132, v146, v138, 0
  v_dot2_f32_bf16 v133, v146, v139, 0
  v_dot2_f32_bf16 v134, v147, v138, 0
  v_dot2_f32_bf16 v135, v147, v139, 0
  s_waitcnt vmcnt(12)
  v_dot2_f32_bf16 v120, v148, v138, v120
  v_dot2_f32_bf16 v121, v148, v139, v121
  v_dot2_f32_bf16 v122, v149, v138, v122
  v_dot2_f32_bf16 v123, v149, v139, v123
  v_dot2_f32_bf16 v124, v150, v138, v124
  v_dot2_f32_bf16 v125, v150, v139, v125
  v_dot2_f32_bf16 v126, v151, v138, v126
  v_dot2_f32_bf16 v127, v151, v139, v127
  v_dot2_f32_bf16 v128, v152, v138, v128
  v_dot2_f32_bf16 v129, v152, v139, v129
  v_dot2_f32_bf16 v130, v153, v138, v130
  v_dot2_f32_bf16 v131, v153, v139, v131
  v_dot2_f32_bf16 v132, v154, v138, v132
  v_dot2_f32_bf16 v133, v154, v139, v133
  v_dot2_f32_bf16 v134, v155, v138, v134
  v_dot2_f32_bf16 v135, v155, v139, v135
  s_waitcnt vmcnt(10)
  v_dot2_f32_bf16 v120, v156, v138, v120
  v_dot2_f32_bf16 v121, v156, v139, v121
  v_dot2_f32_bf16 v122, v157, v138, v122
  v_dot2_f32_bf16 v123, v157, v139, v123
  v_dot2_f32_bf16 v124, v158, v138, v124
  v_dot2_f32_bf16 v125, v158, v139, v125
  v_dot2_f32_bf16 v126, v159, v138, v126
  v_dot2_f32_bf16 v127, v159, v139, v127
  v_dot2_f32_bf16 v128, v160, v138, v128
  v_dot2_f32_bf16 v129, v160, v139, v129
  v_dot2_f32_bf16 v130, v161, v138, v130
  v_dot2_f32_bf16 v131, v161, v139, v131
  v_dot2_f32_bf16 v132, v162, v138, v132
  v_dot2_f32_bf16 v133, v162, v139, v133
  v_dot2_f32_bf16 v134, v163, v138, v134
  v_dot2_f32_bf16 v135, v163, v139, v135
  s_waitcnt vmcnt(8)
  v_dot2_f32_bf16 v120, v164, v138, v120
  v_dot2_f32_bf16 v121, v164, v139, v121
  v_dot2_f32_bf16 v122, v165, v138, v122
  v_dot2_f32_bf16 v123, v165, v139, v123
  v_dot2_f32_bf16 v124, v166, v138, v124
  v_dot2_f32_bf16 v125, v166, v139, v125
  v_dot2_f32_bf16 v126, v167, v138, v126
  v_dot2_f32_bf16 v127, v167, v139, v127
  v_dot2_f32_bf16 v128, v168, v138, v128
  v_dot2_f32_bf16 v129, v168, v139, v129
  v_dot2_f32_bf16 v130, v169, v138, v130
  v_dot2_f32_bf16 v131, v169, v139, v131
  v_dot2_f32_bf16 v132, v170, v138, v132
  v_dot2_f32_bf16 v133, v170, v139, v133
  v_dot2_f32_bf16 v134, v171, v138, v134
  v_dot2_f32_bf16 v135, v171, v139, v135
  s_waitcnt vmcnt(6)
  v_dot2_f32_bf16 v120, v172, v138, v120
  v_dot2_f32_bf16 v121, v172, v139, v121
  v_dot2_f32_bf16 v122, v173, v138, v122
  v_dot2_f32_bf16 v123, v173, v139, v123
  v_dot2_f32_bf16 v124, v174, v138, v124
  v_dot2_f32_bf16 v125, v174, v139, v125
  v_dot2_f32_bf16 v126, v175, v138, v126
  v_dot2_f32_bf16 v127, v175, v139, v127
  v_dot2_f32_bf16 v128, v176, v138, v128
  v_dot2_f32_bf16 v129, v176, v139, v129
  v_dot2_f32_bf16 v130, v177, v138, v130
  v_dot2_f32_bf16 v131, v177, v139, v131
  v_dot2_f32_bf16 v132, v178, v138, v132
  v_dot2_f32_bf16 v133, v178, v139, v133
  v_dot2_f32_bf16 v134, v179, v138, v134
  v_dot2_f32_bf16 v135, v179, v139, v135
  s_waitcnt vmcnt(4)
  v_dot2_f32_bf16 v120, v180, v138, v120
  v_dot2_f32_bf16 v121, v180, v139, v121
  v_dot2_f32_bf16 v122, v181, v138, v122
  v_dot2_f32_bf16 v123, v181, v139, v123
  v_dot2_f32_bf16 v124, v182, v138, v124
  v_dot2_f32_bf16 v125, v182, v139, v125
  v_dot2_f32_bf16 v126, v183, v138, v126
  v_dot2_f32_bf16 v127, v183, v139, v127
  v_dot2_f32_bf16 v128, v184, v138, v128
  v_dot2_f32_bf16 v129, v184, v139, v129
  v_dot2_f32_bf16 v130, v185, v138, v130
  v_dot2_f32_bf16 v131, v185, v139, v131
  v_dot2_f32_bf16 v132, v186, v138, v132
  v_dot2_f32_bf16 v133, v186, v139, v133
  v_dot2_f32_bf16 v134, v187, v138, v134
  v_dot2_f32_bf16 v135, v187, v139, v135
  s_waitcnt vmcnt(2)
  v_dot2_f32_bf16 v120, v188, v138, v120
  v_dot2_f32_bf16 v121, v188, v139, v121
  v_dot2_f32_bf16 v122, v189, v138, v122
  v_dot2_f32_bf16 v123, v189, v139, v123
  v_dot2_f32_bf16 v124, v190, v138, v124
  v_dot2_f32_bf16 v125, v190, v139, v125
  v_dot2_f32_bf16 v126, v191, v138, v126
  v_dot2_f32_bf16 v127, v191, v139, v127
  v_dot2_f32_bf16 v128, v192, v138, v128
  v_dot2_f32_bf16 v129, v192, v139, v129
  v_dot2_f32_bf16 v130, v193, v138, v130
  v_dot2_f32_bf16 v131, v193, v139, v131
  v_dot2_f32_bf16 v132, v194, v138, v132
  v_dot2_f32_bf16 v133, v194, v139, v133
  v_dot2_f32_bf16 v134, v195, v138, v134
  v_dot2_f32_bf16 v135, v195, v139, v135
  s_waitcnt vmcnt(0)
  v_dot2_f32_bf16 v120, v196, v138, v120
  v_dot2_f32_bf16 v121, v196, v139, v121
  v_dot2_f32_bf16 v122, v197, v138, v122
  v_dot2_f32_bf16 v123, v197, v139, v123
  v_dot2_f32_bf16 v124, v198, v138, v124
  v_dot2_f32_bf16 v125, v198, v139, v125
  v_dot2_f32_bf16 v126, v199, v138, v126
  v_dot2_f32_bf16 v127, v199, v139, v127
  v_dot2_f32_bf16 v128, v200, v138, v128
  v_dot2_f32_bf16 v129, v200, v139, v129
  v_dot2_f32_bf16 v130, v201, v138, v130
  v_dot2_f32_bf16 v131, v201, v139, v131
  v_dot2_f32_bf16 v132, v202, v138, v132
  v_dot2_f32_bf16 v133, v202, v139, v133
  v_dot2_f32_bf16 v134, v203, v138, v134
  v_dot2_f32_bf16 v135, v203, v139, v135
  v_cvt_pk_bf16_f32 v96, v120, v121
  v_cvt_pk_bf16_f32 v97, v122, v123
  v_cvt_pk_bf16_f32 v98, v124, v125
  v_cvt_pk_bf16_f32 v99, v126, v127
  v_cvt_pk_bf16_f32 v100, v128, v129
  v_cvt_pk_bf16_f32 v101, v130, v131
  v_cvt_pk_bf16_f32 v102, v132, v133
  v_cvt_pk_bf16_f32 v103, v134, v135
  v_permlane32_swap_b32 v96, v98
  v_permlane32_swap_b32 v97, v99
  v_permlane32_swap_b32 v100, v102
  v_permlane32_swap_b32 v101, v103
  v_lshlrev_b32 v248, 16, v96
  v_and_b32 v249, 0xffff0000, v96
  v_lshlrev_b32 v250, 16, v112
  v_and_b32 v251, 0xffff0000, v112
  v_pk_mul_f32 v[248:249], v[248:249], v[250:251]
  v_cvt_pk_bf16_f32 v250, v248, v249
  v_lshlrev_b32 v248, 16, v250
  v_and_b32 v249, 0xffff0000, v250
  v_lshlrev_b32 v252, 16, v104
  v_and_b32 v253, 0xffff0000, v104
  v_pk_add_f32 v[248:249], v[248:249], v[252:253]
  v_cvt_pk_bf16_f32 v96, v248, v249
  v_lshlrev_b32 v248, 16, v97
  v_and_b32 v249, 0xffff0000, v97
  v_lshlrev_b32 v250, 16, v113
  v_and_b32 v251, 0xffff0000, v113
  v_pk_mul_f32 v[248:249], v[248:249], v[250:251]
  v_cvt_pk_bf16_f32 v250, v248, v249
  v_lshlrev_b32 v248, 16, v250
  v_and_b32 v249, 0xffff0000, v250
  v_lshlrev_b32 v252, 16, v105
  v_and_b32 v253, 0xffff0000, v105
  v_pk_add_f32 v[248:249], v[248:249], v[252:253]
  v_cvt_pk_bf16_f32 v97, v248, v249
  v_lshlrev_b32 v248, 16, v98
  v_and_b32 v249, 0xffff0000, v98
  v_lshlrev_b32 v250, 16, v114
  v_and_b32 v251, 0xffff0000, v114
  v_pk_mul_f32 v[248:249], v[248:249], v[250:251]
  v_cvt_pk_bf16_f32 v250, v248, v249
  v_lshlrev_b32 v248, 16, v250
  v_and_b32 v249, 0xffff0000, v250
  v_lshlrev_b32 v252, 16, v106
  v_and_b32 v253, 0xffff0000, v106
  v_pk_add_f32 v[248:249], v[248:249], v[252:253]
  v_cvt_pk_bf16_f32 v98, v248, v249
  v_lshlrev_b32 v248, 16, v99
  v_and_b32 v249, 0xffff0000, v99
  v_lshlrev_b32 v250, 16, v115
  v_and_b32 v251, 0xffff0000, v115
  v_pk_mul_f32 v[248:249], v[248:249], v[250:251]
  v_cvt_pk_bf16_f32 v250, v248, v249
  v_lshlrev_b32 v248, 16, v250
  v_and_b32 v249, 0xffff0000, v250
  v_lshlrev_b32 v252, 16, v107
  v_and_b32 v253, 0xffff0000, v107
  v_pk_add_f32 v[248:249], v[248:249], v[252:253]
  v_cvt_pk_bf16_f32 v99, v248, v249
  v_lshlrev_b32 v248, 16, v100
  v_and_b32 v249, 0xffff0000, v100
  v_lshlrev_b32 v250, 16, v116
  v_and_b32 v251, 0xffff0000, v116
  v_pk_mul_f32 v[248:249], v[248:249], v[250:251]
  v_cvt_pk_bf16_f32 v250, v248, v249
  v_lshlrev_b32 v248, 16, v250
  v_and_b32 v249, 0xffff0000, v250
  v_lshlrev_b32 v252, 16, v108
  v_and_b32 v253, 0xffff0000, v108
  v_pk_add_f32 v[248:249], v[248:249], v[252:253]
  v_cvt_pk_bf16_f32 v100, v248, v249
  v_lshlrev_b32 v248, 16, v101
  v_and_b32 v249, 0xffff0000, v101
  v_lshlrev_b32 v250, 16, v117
  v_and_b32 v251, 0xffff0000, v117
  v_pk_mul_f32 v[248:249], v[248:249], v[250:251]
  v_cvt_pk_bf16_f32 v250, v248, v249
  v_lshlrev_b32 v248, 16, v250
  v_and_b32 v249, 0xffff0000, v250
  v_lshlrev_b32 v252, 16, v109
  v_and_b32 v253, 0xffff0000, v109
  v_pk_add_f32 v[248:249], v[248:249], v[252:253]
  v_cvt_pk_bf16_f32 v101, v248, v249
  v_lshlrev_b32 v248, 16, v102
  v_and_b32 v249, 0xffff0000, v102
  v_lshlrev_b32 v250, 16, v118
  v_and_b32 v251, 0xffff0000, v118
  v_pk_mul_f32 v[248:249], v[248:249], v[250:251]
  v_cvt_pk_bf16_f32 v250, v248, v249
  v_lshlrev_b32 v248, 16, v250
  v_and_b32 v249, 0xffff0000, v250
  v_lshlrev_b32 v252, 16, v110
  v_and_b32 v253, 0xffff0000, v110
  v_pk_add_f32 v[248:249], v[248:249], v[252:253]
  v_cvt_pk_bf16_f32 v102, v248, v249
  v_lshlrev_b32 v248, 16, v103
  v_and_b32 v249, 0xffff0000, v103
  v_lshlrev_b32 v250, 16, v119
  v_and_b32 v251, 0xffff0000, v119
  v_pk_mul_f32 v[248:249], v[248:249], v[250:251]
  v_cvt_pk_bf16_f32 v250, v248, v249
  v_lshlrev_b32 v248, 16, v250
  v_and_b32 v249, 0xffff0000, v250
  v_lshlrev_b32 v252, 16, v111
  v_and_b32 v253, 0xffff0000, v111
  v_pk_add_f32 v[248:249], v[248:249], v[252:253]
  v_cvt_pk_bf16_f32 v103, v248, v249
  buffer_store_dwordx4 v[96:99], v26, s[36:39], s89 offen offset:0
  buffer_store_dwordx4 v[100:103], v26, s[36:39], s89 offen offset:32
  s_waitcnt vmcnt(0)
  s_barrier
  s_branch w_next
w_g4:
  s_add_u32 s86, s82, 32
  s_lshl_b32 s61, s86, 7
  s_add_u32 s61, s61, 99614720
  s_cmp_lg_u32 s58, 0
  s_cbranch_scc1 wf_68_ok
wf_68:
  buffer_load_dword v26, v255, s[28:31], s61 offen sc1
  s_waitcnt vmcnt(0)
  v_readfirstlane_b32 s62, v26
  s_nop 3
  s_cmp_ge_u32 s62, 14
  s_cbranch_scc1 wf_68_ok
  s_sub_u32 s88, s88, 1
  s_cselect_b32 s88, 0, s88
  s_cbranch_scc1 wf_68_ok
  s_sleep 3
  s_branch wf_68
wf_68_ok:
  s_barrier
  s_nop 0
  s_lshl_b32 s89, s83, 9
  s_add_u32 s44, s20, s89
  s_addc_u32 s45, s21, 0
  s_sub_u32 s46, 14680064, s89
  s_mov_b32 s47, 0x20000
  s_lshl_b32 s89, s82, 13
  s_add_u32 s89, s89, 58720256
  s_add_u32 s40, s14, s89
  s_addc_u32 s41, s15, 0
  s_sub_u32 s40, s40, 4096
  s_subb_u32 s41, s41, 0
  s_sub_u32 s42, 268439552, s89
  s_mov_b32 s43, 0x20000
  s_mov_b32 s56, 32
  s_mov_b32 s75, 1
  s_mov_b32 s76, 32768
  s_mov_b32 s77, 131072
  s_mov_b32 s56, 32
  s_mov_b32 s57, 4096
  s_mov_b32 s51, 27
  v_and_b32 v26, 31, v1
  s_mul_i32 s61, s60, 128
  v_add_u32 v27, s61, v26
  v_lshlrev_b32 v27, 7, v27
  v_bfe_u32 v26, v1, 1, 3
  v_lshrrev_b32 v18, 5, v1
  v_add_u32 v19, 0, v18
  v_xor_b32 v19, v19, v26
  v_lshl_add_u32 v14, v19, 4, v27
  v_add_u32 v19, 2, v18
  v_xor_b32 v19, v19, v26
  v_lshl_add_u32 v15, v19, 4, v27
  v_add_u32 v19, 4, v18
  v_xor_b32 v19, v19, v26
  v_lshl_add_u32 v16, v19, 4, v27
  v_add_u32 v19, 6, v18
  v_xor_b32 v19, v19, v26
  v_lshl_add_u32 v17, v19, 4, v27
  v_lshrrev_b32 v26, 3, v1
  s_mul_i32 s61, s58, 64
  v_add_u32 v26, s61, v26
  v_mul_lo_u32 v26, v26, s56
  v_lshrrev_b32 v27, 4, v1
  v_and_b32 v18, 7, v1
  s_lshl_b32 s62, s56, 3
  s_lshl_b32 s54, 1, s75
  s_sub_u32 s54, s54, 1
  v_add_u32 v19, 0, v27
  v_xor_b32 v19, v19, v18
  v_lshrrev_b32 v20, s75, v19
  v_mul_lo_u32 v20, v20, s76
  v_and_b32 v19, s54, v19
  v_lshl_add_u32 v2, v19, 4, v26
  v_add_u32 v2, v2, v20
  v_add_u32 v2, 4096, v2
  v_add_u32 v26, s62, v26
  v_add_u32 v19, 4, v27
  v_xor_b32 v19, v19, v18
  v_lshrrev_b32 v20, s75, v19
  v_mul_lo_u32 v20, v20, s76
  v_and_b32 v19, s54, v19
  v_lshl_add_u32 v3, v19, 4, v26
  v_add_u32 v3, v3, v20
  v_add_u32 v3, 3072, v3
  v_add_u32 v26, s62, v26
  v_add_u32 v19, 0, v27
  v_xor_b32 v19, v19, v18
  v_lshrrev_b32 v20, s75, v19
  v_mul_lo_u32 v20, v20, s76
  v_and_b32 v19, s54, v19
  v_lshl_add_u32 v4, v19, 4, v26
  v_add_u32 v4, v4, v20
  v_add_u32 v4, 2048, v4
  v_add_u32 v26, s62, v26
  v_add_u32 v19, 4, v27
  v_xor_b32 v19, v19, v18
  v_lshrrev_b32 v20, s75, v19
  v_mul_lo_u32 v20, v20, s76
  v_and_b32 v19, s54, v19
  v_lshl_add_u32 v5, v19, 4, v26
  v_add_u32 v5, v5, v20
  v_add_u32 v5, 1024, v5
  v_add_u32 v26, s62, v26
  v_add_u32 v19, 0, v27
  v_xor_b32 v19, v19, v18
  v_lshrrev_b32 v20, s75, v19
  v_mul_lo_u32 v20, v20, s76
  v_and_b32 v19, s54, v19
  v_lshl_add_u32 v6, v19, 4, v26
  v_add_u32 v6, v6, v20
  v_add_u32 v6, 4096, v6
  v_add_u32 v26, s62, v26
  v_add_u32 v19, 4, v27
  v_xor_b32 v19, v19, v18
  v_lshrrev_b32 v20, s75, v19
  v_mul_lo_u32 v20, v20, s76
  v_and_b32 v19, s54, v19
  v_lshl_add_u32 v7, v19, 4, v26
  v_add_u32 v7, v7, v20
  v_add_u32 v7, 3072, v7
  v_add_u32 v26, s62, v26
  v_add_u32 v19, 0, v27
  v_xor_b32 v19, v19, v18
  v_lshrrev_b32 v20, s75, v19
  v_mul_lo_u32 v20, v20, s76
  v_and_b32 v19, s54, v19
  v_lshl_add_u32 v8, v19, 4, v26
  v_add_u32 v8, v8, v20
  v_add_u32 v8, 2048, v8
  v_add_u32 v26, s62, v26
  v_add_u32 v19, 4, v27
  v_xor_b32 v19, v19, v18
  v_lshrrev_b32 v20, s75, v19
  v_mul_lo_u32 v20, v20, s76
  v_and_b32 v19, s54, v19
  v_lshl_add_u32 v9, v19, 4, v26
  v_add_u32 v9, v9, v20
  v_add_u32 v9, 1024, v9
  s_mul_i32 s54, s58, 8192
  v_lshrrev_b32 v27, 5, v1
  s_lshl_b32 s61, s58, 3
  v_add_u32 v26, s61, v27
  v_mul_lo_u32 v26, v26, s57
  v_and_b32 v18, 31, v1
  s_lshl_b32 s62, s57, 1
  v_add_u32 v19, 0, v27
  v_lshlrev_b32 v19, 2, v19
  v_xor_b32 v19, v19, v18
  v_lshl_add_u32 v10, v19, 4, v26
  v_add_u32 v26, s62, v26
  v_add_u32 v19, 2, v27
  v_lshlrev_b32 v19, 2, v19
  v_xor_b32 v19, v19, v18
  v_lshl_add_u32 v11, v19, 4, v26
  v_subrev_u32 v11, 1024, v11
  v_add_u32 v26, s62, v26
  v_add_u32 v19, 0, v27
  v_lshlrev_b32 v19, 2, v19
  v_xor_b32 v19, v19, v18
  v_lshl_add_u32 v12, v19, 4, v26
  v_subrev_u32 v12, 2048, v12
  v_add_u32 v26, s62, v26
  v_add_u32 v19, 2, v27
  v_lshlrev_b32 v19, 2, v19
  v_xor_b32 v19, v19, v18
  v_lshl_add_u32 v13, v19, 4, v26
  v_subrev_u32 v13, 3072, v13
  s_lshl_b32 s50, s57, 5
  s_mov_b32 s48, 0
  s_mov_b32 s53, s54
  s_mov_b32 s49, 0
  s_add_u32 m0, s53, 0
  s_nop 0
  buffer_load_dwordx4 v2, s[40:43], s48 offen offset:0 sc1 lds
  buffer_load_dwordx4 v3, s[40:43], s48 offen offset:1024 sc1 lds
  buffer_load_dwordx4 v4, s[40:43], s48 offen offset:2048 sc1 lds
  buffer_load_dwordx4 v5, s[40:43], s48 offen offset:3072 sc1 lds
  s_add_u32 m0, s55, 0
  s_nop 0
  buffer_load_dwordx4 v10, s[44:47], s49 offen offset:0 lds
  buffer_load_dwordx4 v11, s[44:47], s49 offen offset:1024 lds
  buffer_load_dwordx4 v12, s[44:47], s49 offen offset:2048 lds
  buffer_load_dwordx4 v13, s[44:47], s49 offen offset:3072 lds
  s_add_u32 s49, s49, s50
  s_add_u32 m0, s53, 4096
  s_nop 0
  buffer_load_dwordx4 v6, s[40:43], s48 offen offset:0 sc1 lds
  buffer_load_dwordx4 v7, s[40:43], s48 offen offset:1024 sc1 lds
  buffer_load_dwordx4 v8, s[40:43], s48 offen offset:2048 sc1 lds
  buffer_load_dwordx4 v9, s[40:43], s48 offen offset:3072 sc1 lds
  s_add_u32 s48, s48, s77
  s_add_u32 s53, s54, 32768
  s_add_u32 m0, s55, 16384
  s_nop 0
  buffer_load_dwordx4 v10, s[44:47], s49 offen offset:0 lds
  buffer_load_dwordx4 v11, s[44:47], s49 offen offset:1024 lds
  buffer_load_dwordx4 v12, s[44:47], s49 offen offset:2048 lds
  buffer_load_dwordx4 v13, s[44:47], s49 offen offset:3072 lds
  s_add_u32 s49, s49, s50
  s_add_u32 m0, s53, 0
  s_nop 0
  buffer_load_dwordx4 v2, s[40:43], s48 offen offset:0 sc1 lds
  buffer_load_dwordx4 v3, s[40:43], s48 offen offset:1024 sc1 lds
  buffer_load_dwordx4 v4, s[40:43], s48 offen offset:2048 sc1 lds
  buffer_load_dwordx4 v5, s[40:43], s48 offen offset:3072 sc1 lds
  s_add_u32 m0, s55, 32768
  s_nop 0
  buffer_load_dwordx4 v10, s[44:47], s49 offen offset:0 lds
  buffer_load_dwordx4 v11, s[44:47], s49 offen offset:1024 lds
  buffer_load_dwordx4 v12, s[44:47], s49 offen offset:2048 lds
  buffer_load_dwordx4 v13, s[44:47], s49 offen offset:3072 lds
  s_add_u32 s49, s49, s50
  s_add_u32 m0, s53, 4096
  s_nop 0
  buffer_load_dwordx4 v6, s[40:43], s48 offen offset:0 sc1 lds
  buffer_load_dwordx4 v7, s[40:43], s48 offen offset:1024 sc1 lds
  buffer_load_dwordx4 v8, s[40:43], s48 offen offset:2048 sc1 lds
  buffer_load_dwordx4 v9, s[40:43], s48 offen offset:3072 sc1 lds
  s_add_u32 s48, s48, s77
  s_add_u32 s53, s54, 65536
  s_add_u32 m0, s55, 49152
  s_nop 0
  buffer_load_dwordx4 v10, s[44:47], s49 offen offset:0 lds
  buffer_load_dwordx4 v11, s[44:47], s49 offen offset:1024 lds
  buffer_load_dwordx4 v12, s[44:47], s49 offen offset:2048 lds
  buffer_load_dwordx4 v13, s[44:47], s49 offen offset:3072 lds
  s_add_u32 s49, s49, s50
  s_add_u32 m0, s53, 0
  s_nop 0
  buffer_load_dwordx4 v2, s[40:43], s48 offen offset:0 sc1 lds
  buffer_load_dwordx4 v3, s[40:43], s48 offen offset:1024 sc1 lds
  buffer_load_dwordx4 v4, s[40:43], s48 offen offset:2048 sc1 lds
  buffer_load_dwordx4 v5, s[40:43], s48 offen offset:3072 sc1 lds
  s_mov_b32 s52, 0
  v_mov_b32 v18, v14
  v_mov_b32 v19, v15
  v_mov_b32 v20, v16
  v_mov_b32 v21, v17
  s_waitcnt vmcnt(24)
  s_barrier
  ds_read_b128 v[48:51], v18 offset:0
  ds_read_b64_tr_b16 v[32:33], v22 offset:0
  ds_read_b64_tr_b16 v[34:35], v22 offset:2048
  ds_read_b128 v[52:55], v18 offset:4096
  ds_read_b64_tr_b16 v[36:37], v23 offset:0
  ds_read_b64_tr_b16 v[38:39], v23 offset:2048
  ds_read_b128 v[56:59], v18 offset:8192
  ds_read_b64_tr_b16 v[40:41], v24 offset:0
  ds_read_b64_tr_b16 v[42:43], v24 offset:2048
  ds_read_b128 v[60:63], v18 offset:12288
  ds_read_b64_tr_b16 v[44:45], v25 offset:0
  ds_read_b64_tr_b16 v[46:47], v25 offset:2048
  s_waitcnt lgkmcnt(0)
  v_mfma_f32_32x32x16_bf16 a[0:15], v[48:51], v[32:35], 0
  ds_read_b128 v[80:83], v19 offset:0
  v_mfma_f32_32x32x16_bf16 a[16:31], v[52:55], v[32:35], 0
  ds_read_b64_tr_b16 v[64:65], v22 offset:8192
  v_mfma_f32_32x32x16_bf16 a[32:47], v[56:59], v[32:35], 0
  ds_read_b64_tr_b16 v[66:67], v22 offset:10240
  v_mfma_f32_32x32x16_bf16 a[48:63], v[60:63], v[32:35], 0
  ds_read_b128 v[84:87], v19 offset:4096
  v_mfma_f32_32x32x16_bf16 a[64:79], v[48:51], v[36:39], 0
  ds_read_b64_tr_b16 v[68:69], v23 offset:8192
  v_mfma_f32_32x32x16_bf16 a[80:95], v[52:55], v[36:39], 0
  ds_read_b64_tr_b16 v[70:71], v23 offset:10240
  v_mfma_f32_32x32x16_bf16 a[96:111], v[56:59], v[36:39], 0
  ds_read_b128 v[88:91], v19 offset:8192
  v_mfma_f32_32x32x16_bf16 a[112:127], v[60:63], v[36:39], 0
  ds_read_b64_tr_b16 v[72:73], v24 offset:8192
  v_mfma_f32_32x32x16_bf16 a[128:143], v[48:51], v[40:43], 0
  ds_read_b64_tr_b16 v[74:75], v24 offset:10240
  v_mfma_f32_32x32x16_bf16 a[144:159], v[52:55], v[40:43], 0
  ds_read_b128 v[92:95], v19 offset:12288
  v_mfma_f32_32x32x16_bf16 a[160:175], v[56:59], v[40:43], 0
  ds_read_b64_tr_b16 v[76:77], v25 offset:8192
  v_mfma_f32_32x32x16_bf16 a[176:191], v[60:63], v[40:43], 0
  ds_read_b64_tr_b16 v[78:79], v25 offset:10240
  v_mfma_f32_32x32x16_bf16 a[192:207], v[48:51], v[44:47], 0
  v_mfma_f32_32x32x16_bf16 a[208:223], v[52:55], v[44:47], 0
  v_mfma_f32_32x32x16_bf16 a[224:239], v[56:59], v[44:47], 0
  v_mfma_f32_32x32x16_bf16 a[240:255], v[60:63], v[44:47], 0
  s_branch gm_s
  s_nop 10
gl_s:
  s_waitcnt lgkmcnt(0)
  v_mfma_f32_32x32x16_bf16 a[0:15], v[48:51], v[32:35], a[0:15]
  ds_read_b128 v[80:83], v19 offset:0
  v_mfma_f32_32x32x16_bf16 a[16:31], v[52:55], v[32:35], a[16:31]
  ds_read_b64_tr_b16 v[64:65], v22 offset:8192
  v_mfma_f32_32x32x16_bf16 a[32:47], v[56:59], v[32:35], a[32:47]
  ds_read_b64_tr_b16 v[66:67], v22 offset:10240
  v_mfma_f32_32x32x16_bf16 a[48:63], v[60:63], v[32:35], a[48:63]
  ds_read_b128 v[84:87], v19 offset:4096
  v_mfma_f32_32x32x16_bf16 a[64:79], v[48:51], v[36:39], a[64:79]
  ds_read_b64_tr_b16 v[68:69], v23 offset:8192
  v_mfma_f32_32x32x16_bf16 a[80:95], v[52:55], v[36:39], a[80:95]
  ds_read_b64_tr_b16 v[70:71], v23 offset:10240
  v_mfma_f32_32x32x16_bf16 a[96:111], v[56:59], v[36:39], a[96:111]
  ds_read_b128 v[88:91], v19 offset:8192
  v_mfma_f32_32x32x16_bf16 a[112:127], v[60:63], v[36:39], a[112:127]
  ds_read_b64_tr_b16 v[72:73], v24 offset:8192
  v_mfma_f32_32x32x16_bf16 a[128:143], v[48:51], v[40:43], a[128:143]
  ds_read_b64_tr_b16 v[74:75], v24 offset:10240
  v_mfma_f32_32x32x16_bf16 a[144:159], v[52:55], v[40:43], a[144:159]
  ds_read_b128 v[92:95], v19 offset:12288
  v_mfma_f32_32x32x16_bf16 a[160:175], v[56:59], v[40:43], a[160:175]
  ds_read_b64_tr_b16 v[76:77], v25 offset:8192
  v_mfma_f32_32x32x16_bf16 a[176:191], v[60:63], v[40:43], a[176:191]
  ds_read_b64_tr_b16 v[78:79], v25 offset:10240
  v_mfma_f32_32x32x16_bf16 a[192:207], v[48:51], v[44:47], a[192:207]
  v_mfma_f32_32x32x16_bf16 a[208:223], v[52:55], v[44:47], a[208:223]
  v_mfma_f32_32x32x16_bf16 a[224:239], v[56:59], v[44:47], a[224:239]
  v_mfma_f32_32x32x16_bf16 a[240:255], v[60:63], v[44:47], a[240:255]
gm_s:
  s_waitcnt lgkmcnt(0)
  v_mfma_f32_32x32x16_bf16 a[0:15], v[80:83], v[64:67], a[0:15]
  v_mfma_f32_32x32x16_bf16 a[16:31], v[84:87], v[64:67], a[16:31]
  s_waitcnt vmcnt(16)
  s_barrier
  v_mfma_f32_32x32x16_bf16 a[32:47], v[88:91], v[64:67], a[32:47]
  ds_read_b128 v[48:51], v20 offset:0
  s_add_u32 m0, s55, 0
  v_mfma_f32_32x32x16_bf16 a[48:63], v[92:95], v[64:67], a[48:63]
  ds_read_b64_tr_b16 v[32:33], v22 offset:16384
  buffer_load_dwordx4 v10, s[44:47], s49 offen offset:0 lds
  v_mfma_f32_32x32x16_bf16 a[64:79], v[80:83], v[68:71], a[64:79]
  ds_read_b64_tr_b16 v[34:35], v22 offset:18432
  buffer_load_dwordx4 v11, s[44:47], s49 offen offset:1024 lds
  v_mfma_f32_32x32x16_bf16 a[80:95], v[84:87], v[68:71], a[80:95]
  ds_read_b128 v[52:55], v20 offset:4096
  buffer_load_dwordx4 v12, s[44:47], s49 offen offset:2048 lds
  v_mfma_f32_32x32x16_bf16 a[96:111], v[88:91], v[68:71], a[96:111]
  ds_read_b64_tr_b16 v[36:37], v23 offset:16384
  buffer_load_dwordx4 v13, s[44:47], s49 offen offset:3072 lds
  v_mfma_f32_32x32x16_bf16 a[112:127], v[92:95], v[68:71], a[112:127]
  ds_read_b64_tr_b16 v[38:39], v23 offset:18432
  s_add_u32 s49, s49, s50
  v_mfma_f32_32x32x16_bf16 a[128:143], v[80:83], v[72:75], a[128:143]
  ds_read_b128 v[56:59], v20 offset:8192
  s_add_u32 m0, s53, 4096
  v_mfma_f32_32x32x16_bf16 a[144:159], v[84:87], v[72:75], a[144:159]
  ds_read_b64_tr_b16 v[40:41], v24 offset:16384
  buffer_load_dwordx4 v6, s[40:43], s48 offen offset:0 sc1 lds
  v_mfma_f32_32x32x16_bf16 a[160:175], v[88:91], v[72:75], a[160:175]
  ds_read_b64_tr_b16 v[42:43], v24 offset:18432
  buffer_load_dwordx4 v7, s[40:43], s48 offen offset:1024 sc1 lds
  v_mfma_f32_32x32x16_bf16 a[176:191], v[92:95], v[72:75], a[176:191]
  ds_read_b128 v[60:63], v20 offset:12288
  buffer_load_dwordx4 v8, s[40:43], s48 offen offset:2048 sc1 lds
  v_mfma_f32_32x32x16_bf16 a[192:207], v[80:83], v[76:79], a[192:207]
  ds_read_b64_tr_b16 v[44:45], v25 offset:16384
  buffer_load_dwordx4 v9, s[40:43], s48 offen offset:3072 sc1 lds
  v_mfma_f32_32x32x16_bf16 a[208:223], v[84:87], v[76:79], a[208:223]
  ds_read_b64_tr_b16 v[46:47], v25 offset:18432
  s_add_u32 s48, s48, s77
  v_mfma_f32_32x32x16_bf16 a[224:239], v[88:91], v[76:79], a[224:239]
  v_mfma_f32_32x32x16_bf16 a[240:255], v[92:95], v[76:79], a[240:255]
  s_waitcnt lgkmcnt(0)
  v_mfma_f32_32x32x16_bf16 a[0:15], v[48:51], v[32:35], a[0:15]
  ds_read_b128 v[80:83], v21 offset:0
  v_mfma_f32_32x32x16_bf16 a[16:31], v[52:55], v[32:35], a[16:31]
  ds_read_b64_tr_b16 v[64:65], v22 offset:24576
  v_mfma_f32_32x32x16_bf16 a[32:47], v[56:59], v[32:35], a[32:47]
  ds_read_b64_tr_b16 v[66:67], v22 offset:26624
  v_mfma_f32_32x32x16_bf16 a[48:63], v[60:63], v[32:35], a[48:63]
  ds_read_b128 v[84:87], v21 offset:4096
  v_mfma_f32_32x32x16_bf16 a[64:79], v[48:51], v[36:39], a[64:79]
  ds_read_b64_tr_b16 v[68:69], v23 offset:24576
  v_mfma_f32_32x32x16_bf16 a[80:95], v[52:55], v[36:39], a[80:95]
  ds_read_b64_tr_b16 v[70:71], v23 offset:26624
  v_mfma_f32_32x32x16_bf16 a[96:111], v[56:59], v[36:39], a[96:111]
  ds_read_b128 v[88:91], v21 offset:8192
  v_mfma_f32_32x32x16_bf16 a[112:127], v[60:63], v[36:39], a[112:127]
  ds_read_b64_tr_b16 v[72:73], v24 offset:24576
  v_mfma_f32_32x32x16_bf16 a[128:143], v[48:51], v[40:43], a[128:143]
  ds_read_b64_tr_b16 v[74:75], v24 offset:26624
  v_mfma_f32_32x32x16_bf16 a[144:159], v[52:55], v[40:43], a[144:159]
  ds_read_b128 v[92:95], v21 offset:12288
  v_mfma_f32_32x32x16_bf16 a[160:175], v[56:59], v[40:43], a[160:175]
  ds_read_b64_tr_b16 v[76:77], v25 offset:24576
  v_mfma_f32_32x32x16_bf16 a[176:191], v[60:63], v[40:43], a[176:191]
  ds_read_b64_tr_b16 v[78:79], v25 offset:26624
  v_mfma_f32_32x32x16_bf16 a[192:207], v[48:51], v[44:47], a[192:207]
  v_mfma_f32_32x32x16_bf16 a[208:223], v[52:55], v[44:47], a[208:223]
  v_mfma_f32_32x32x16_bf16 a[224:239], v[56:59], v[44:47], a[224:239]
  v_mfma_f32_32x32x16_bf16 a[240:255], v[60:63], v[44:47], a[240:255]
  s_waitcnt lgkmcnt(0)
  v_mfma_f32_32x32x16_bf16 a[0:15], v[80:83], v[64:67], a[0:15]
  v_mfma_f32_32x32x16_bf16 a[16:31], v[84:87], v[64:67], a[16:31]
  s_add_u32 s53, s52, s54
  s_add_u32 s52, s52, 32768
  s_cmp_eq_u32 s52, 98304
  s_cselect_b32 s52, 0, s52
  v_add_u32 v18, s52, v14
  v_add_u32 v19, s52, v15
  v_add_u32 v20, s52, v16
  v_add_u32 v21, s52, v17
  s_waitcnt vmcnt(16)
  s_barrier
  v_mfma_f32_32x32x16_bf16 a[32:47], v[88:91], v[64:67], a[32:47]
  ds_read_b128 v[48:51], v18 offset:0
  s_add_u32 m0, s55, 16384
  v_mfma_f32_32x32x16_bf16 a[48:63], v[92:95], v[64:67], a[48:63]
  ds_read_b64_tr_b16 v[32:33], v22 offset:32768
  buffer_load_dwordx4 v10, s[44:47], s49 offen offset:0 lds
  v_mfma_f32_32x32x16_bf16 a[64:79], v[80:83], v[68:71], a[64:79]
  ds_read_b64_tr_b16 v[34:35], v22 offset:34816
  buffer_load_dwordx4 v11, s[44:47], s49 offen offset:1024 lds
  v_mfma_f32_32x32x16_bf16 a[80:95], v[84:87], v[68:71], a[80:95]
  ds_read_b128 v[52:55], v18 offset:4096
  buffer_load_dwordx4 v12, s[44:47], s49 offen offset:2048 lds
  v_mfma_f32_32x32x16_bf16 a[96:111], v[88:91], v[68:71], a[96:111]
  ds_read_b64_tr_b16 v[36:37], v23 offset:32768
  buffer_load_dwordx4 v13, s[44:47], s49 offen offset:3072 lds
  v_mfma_f32_32x32x16_bf16 a[112:127], v[92:95], v[68:71], a[112:127]
  ds_read_b64_tr_b16 v[38:39], v23 offset:34816
  s_add_u32 s49, s49, s50
  v_mfma_f32_32x32x16_bf16 a[128:143], v[80:83], v[72:75], a[128:143]
  ds_read_b128 v[56:59], v18 offset:8192
  s_add_u32 m0, s53, 0
  v_mfma_f32_32x32x16_bf16 a[144:159], v[84:87], v[72:75], a[144:159]
  ds_read_b64_tr_b16 v[40:41], v24 offset:32768
  buffer_load_dwordx4 v2, s[40:43], s48 offen offset:0 sc1 lds
  v_mfma_f32_32x32x16_bf16 a[160:175], v[88:91], v[72:75], a[160:175]
  ds_read_b64_tr_b16 v[42:43], v24 offset:34816
  buffer_load_dwordx4 v3, s[40:43], s48 offen offset:1024 sc1 lds
  v_mfma_f32_32x32x16_bf16 a[176:191], v[92:95], v[72:75], a[176:191]
  ds_read_b128 v[60:63], v18 offset:12288
  buffer_load_dwordx4 v4, s[40:43], s48 offen offset:2048 sc1 lds
  v_mfma_f32_32x32x16_bf16 a[192:207], v[80:83], v[76:79], a[192:207]
  ds_read_b64_tr_b16 v[44:45], v25 offset:32768
  buffer_load_dwordx4 v5, s[40:43], s48 offen offset:3072 sc1 lds
  v_mfma_f32_32x32x16_bf16 a[208:223], v[84:87], v[76:79], a[208:223]
  ds_read_b64_tr_b16 v[46:47], v25 offset:34816
  v_mfma_f32_32x32x16_bf16 a[224:239], v[88:91], v[76:79], a[224:239]
  v_mfma_f32_32x32x16_bf16 a[240:255], v[92:95], v[76:79], a[240:255]
  s_waitcnt lgkmcnt(0)
  v_mfma_f32_32x32x16_bf16 a[0:15], v[48:51], v[32:35], a[0:15]
  ds_read_b128 v[80:83], v19 offset:0
  v_mfma_f32_32x32x16_bf16 a[16:31], v[52:55], v[32:35], a[16:31]
  ds_read_b64_tr_b16 v[64:65], v22 offset:40960
  v_mfma_f32_32x32x16_bf16 a[32:47], v[56:59], v[32:35], a[32:47]
  ds_read_b64_tr_b16 v[66:67], v22 offset:43008
  v_mfma_f32_32x32x16_bf16 a[48:63], v[60:63], v[32:35], a[48:63]
  ds_read_b128 v[84:87], v19 offset:4096
  v_mfma_f32_32x32x16_bf16 a[64:79], v[48:51], v[36:39], a[64:79]
  ds_read_b64_tr_b16 v[68:69], v23 offset:40960
  v_mfma_f32_32x32x16_bf16 a[80:95], v[52:55], v[36:39], a[80:95]
  ds_read_b64_tr_b16 v[70:71], v23 offset:43008
  v_mfma_f32_32x32x16_bf16 a[96:111], v[56:59], v[36:39], a[96:111]
  ds_read_b128 v[88:91], v19 offset:8192
  v_mfma_f32_32x32x16_bf16 a[112:127], v[60:63], v[36:39], a[112:127]
  ds_read_b64_tr_b16 v[72:73], v24 offset:40960
  v_mfma_f32_32x32x16_bf16 a[128:143], v[48:51], v[40:43], a[128:143]
  ds_read_b64_tr_b16 v[74:75], v24 offset:43008
  v_mfma_f32_32x32x16_bf16 a[144:159], v[52:55], v[40:43], a[144:159]
  ds_read_b128 v[92:95], v19 offset:12288
  v_mfma_f32_32x32x16_bf16 a[160:175], v[56:59], v[40:43], a[160:175]
  ds_read_b64_tr_b16 v[76:77], v25 offset:40960
  v_mfma_f32_32x32x16_bf16 a[176:191], v[60:63], v[40:43], a[176:191]
  ds_read_b64_tr_b16 v[78:79], v25 offset:43008
  v_mfma_f32_32x32x16_bf16 a[192:207], v[48:51], v[44:47], a[192:207]
  v_mfma_f32_32x32x16_bf16 a[208:223], v[52:55], v[44:47], a[208:223]
  v_mfma_f32_32x32x16_bf16 a[224:239], v[56:59], v[44:47], a[224:239]
  v_mfma_f32_32x32x16_bf16 a[240:255], v[60:63], v[44:47], a[240:255]
  s_waitcnt lgkmcnt(0)
  v_mfma_f32_32x32x16_bf16 a[0:15], v[80:83], v[64:67], a[0:15]
  v_mfma_f32_32x32x16_bf16 a[16:31], v[84:87], v[64:67], a[16:31]
  s_waitcnt vmcnt(16)
  s_barrier
  v_mfma_f32_32x32x16_bf16 a[32:47], v[88:91], v[64:67], a[32:47]
  ds_read_b128 v[48:51], v20 offset:0
  s_add_u32 m0, s55, 32768
  v_mfma_f32_32x32x16_bf16 a[48:63], v[92:95], v[64:67], a[48:63]
  ds_read_b64_tr_b16 v[32:33], v22 offset:49152
  buffer_load_dwordx4 v10, s[44:47], s49 offen offset:0 lds
  v_mfma_f32_32x32x16_bf16 a[64:79], v[80:83], v[68:71], a[64:79]
  ds_read_b64_tr_b16 v[34:35], v22 offset:51200
  buffer_load_dwordx4 v11, s[44:47], s49 offen offset:1024 lds
  v_mfma_f32_32x32x16_bf16 a[80:95], v[84:87], v[68:71], a[80:95]
  ds_read_b128 v[52:55], v20 offset:4096
  buffer_load_dwordx4 v12, s[44:47], s49 offen offset:2048 lds
  v_mfma_f32_32x32x16_bf16 a[96:111], v[88:91], v[68:71], a[96:111]
  ds_read_b64_tr_b16 v[36:37], v23 offset:49152
  buffer_load_dwordx4 v13, s[44:47], s49 offen offset:3072 lds
  v_mfma_f32_32x32x16_bf16 a[112:127], v[92:95], v[68:71], a[112:127]
  ds_read_b64_tr_b16 v[38:39], v23 offset:51200
  s_add_u32 s49, s49, s50
  v_mfma_f32_32x32x16_bf16 a[128:143], v[80:83], v[72:75], a[128:143]
  ds_read_b128 v[56:59], v20 offset:8192
  s_add_u32 m0, s53, 4096
  v_mfma_f32_32x32x16_bf16 a[144:159], v[84:87], v[72:75], a[144:159]
  ds_read_b64_tr_b16 v[40:41], v24 offset:49152
  buffer_load_dwordx4 v6, s[40:43], s48 offen offset:0 sc1 lds
  v_mfma_f32_32x32x16_bf16 a[160:175], v[88:91], v[72:75], a[160:175]
  ds_read_b64_tr_b16 v[42:43], v24 offset:51200
  buffer_load_dwordx4 v7, s[40:43], s48 offen offset:1024 sc1 lds
  v_mfma_f32_32x32x16_bf16 a[176:191], v[92:95], v[72:75], a[176:191]
  ds_read_b128 v[60:63], v20 offset:12288
  buffer_load_dwordx4 v8, s[40:43], s48 offen offset:2048 sc1 lds
  v_mfma_f32_32x32x16_bf16 a[192:207], v[80:83], v[76:79], a[192:207]
  ds_read_b64_tr_b16 v[44:45], v25 offset:49152
  buffer_load_dwordx4 v9, s[40:43], s48 offen offset:3072 sc1 lds
  v_mfma_f32_32x32x16_bf16 a[208:223], v[84:87], v[76:79], a[208:223]
  ds_read_b64_tr_b16 v[46:47], v25 offset:51200
  s_add_u32 s48, s48, s77
  v_mfma_f32_32x32x16_bf16 a[224:239], v[88:91], v[76:79], a[224:239]
  v_mfma_f32_32x32x16_bf16 a[240:255], v[92:95], v[76:79], a[240:255]
  s_waitcnt lgkmcnt(0)
  v_mfma_f32_32x32x16_bf16 a[0:15], v[48:51], v[32:35], a[0:15]
  ds_read_b128 v[80:83], v21 offset:0
  v_mfma_f32_32x32x16_bf16 a[16:31], v[52:55], v[32:35], a[16:31]
  ds_read_b64_tr_b16 v[64:65], v22 offset:57344
  v_mfma_f32_32x32x16_bf16 a[32:47], v[56:59], v[32:35], a[32:47]
  ds_read_b64_tr_b16 v[66:67], v22 offset:59392
  v_mfma_f32_32x32x16_bf16 a[48:63], v[60:63], v[32:35], a[48:63]
  ds_read_b128 v[84:87], v21 offset:4096
  v_mfma_f32_32x32x16_bf16 a[64:79], v[48:51], v[36:39], a[64:79]
  ds_read_b64_tr_b16 v[68:69], v23 offset:57344
  v_mfma_f32_32x32x16_bf16 a[80:95], v[52:55], v[36:39], a[80:95]
  ds_read_b64_tr_b16 v[70:71], v23 offset:59392
  v_mfma_f32_32x32x16_bf16 a[96:111], v[56:59], v[36:39], a[96:111]
  ds_read_b128 v[88:91], v21 offset:8192
  v_mfma_f32_32x32x16_bf16 a[112:127], v[60:63], v[36:39], a[112:127]
  ds_read_b64_tr_b16 v[72:73], v24 offset:57344
  v_mfma_f32_32x32x16_bf16 a[128:143], v[48:51], v[40:43], a[128:143]
  ds_read_b64_tr_b16 v[74:75], v24 offset:59392
  v_mfma_f32_32x32x16_bf16 a[144:159], v[52:55], v[40:43], a[144:159]
  ds_read_b128 v[92:95], v21 offset:12288
  v_mfma_f32_32x32x16_bf16 a[160:175], v[56:59], v[40:43], a[160:175]
  ds_read_b64_tr_b16 v[76:77], v25 offset:57344
  v_mfma_f32_32x32x16_bf16 a[176:191], v[60:63], v[40:43], a[176:191]
  ds_read_b64_tr_b16 v[78:79], v25 offset:59392
  v_mfma_f32_32x32x16_bf16 a[192:207], v[48:51], v[44:47], a[192:207]
  v_mfma_f32_32x32x16_bf16 a[208:223], v[52:55], v[44:47], a[208:223]
  v_mfma_f32_32x32x16_bf16 a[224:239], v[56:59], v[44:47], a[224:239]
  v_mfma_f32_32x32x16_bf16 a[240:255], v[60:63], v[44:47], a[240:255]
  s_waitcnt lgkmcnt(0)
  v_mfma_f32_32x32x16_bf16 a[0:15], v[80:83], v[64:67], a[0:15]
  v_mfma_f32_32x32x16_bf16 a[16:31], v[84:87], v[64:67], a[16:31]
  s_add_u32 s53, s52, s54
  s_add_u32 s52, s52, 32768
  s_cmp_eq_u32 s52, 98304
  s_cselect_b32 s52, 0, s52
  v_add_u32 v18, s52, v14
  v_add_u32 v19, s52, v15
  v_add_u32 v20, s52, v16
  v_add_u32 v21, s52, v17
  s_waitcnt vmcnt(16)
  s_barrier
  v_mfma_f32_32x32x16_bf16 a[32:47], v[88:91], v[64:67], a[32:47]
  s_add_u32 m0, s55, 49152
  s_nop 0
  buffer_load_dwordx4 v10, s[44:47], s49 offen offset:0 lds
  buffer_load_dwordx4 v11, s[44:47], s49 offen offset:1024 lds
  buffer_load_dwordx4 v12, s[44:47], s49 offen offset:2048 lds
  buffer_load_dwordx4 v13, s[44:47], s49 offen offset:3072 lds
  s_add_u32 s49, s49, s50
  s_cmp_eq_u32 s51, 1
  s_cbranch_scc1 gs_s
  s_add_u32 m0, s53, 0
  s_nop 0
  buffer_load_dwordx4 v2, s[40:43], s48 offen offset:0 sc1 lds
  buffer_load_dwordx4 v3, s[40:43], s48 offen offset:1024 sc1 lds
  buffer_load_dwordx4 v4, s[40:43], s48 offen offset:2048 sc1 lds
  buffer_load_dwordx4 v5, s[40:43], s48 offen offset:3072 sc1 lds
gs_s:
  v_mfma_f32_32x32x16_bf16 a[48:63], v[92:95], v[64:67], a[48:63]
  ds_read_b128 v[48:51], v18 offset:0
  v_mfma_f32_32x32x16_bf16 a[64:79], v[80:83], v[68:71], a[64:79]
  ds_read_b64_tr_b16 v[32:33], v22 offset:0
  v_mfma_f32_32x32x16_bf16 a[80:95], v[84:87], v[68:71], a[80:95]
  ds_read_b64_tr_b16 v[34:35], v22 offset:2048
  v_mfma_f32_32x32x16_bf16 a[96:111], v[88:91], v[68:71], a[96:111]
  ds_read_b128 v[52:55], v18 offset:4096
  v_mfma_f32_32x32x16_bf16 a[112:127], v[92:95], v[68:71], a[112:127]
  ds_read_b64_tr_b16 v[36:37], v23 offset:0
  v_mfma_f32_32x32x16_bf16 a[128:143], v[80:83], v[72:75], a[128:143]
  ds_read_b64_tr_b16 v[38:39], v23 offset:2048
  v_mfma_f32_32x32x16_bf16 a[144:159], v[84:87], v[72:75], a[144:159]
  ds_read_b128 v[56:59], v18 offset:8192
  v_mfma_f32_32x32x16_bf16 a[160:175], v[88:91], v[72:75], a[160:175]
  ds_read_b64_tr_b16 v[40:41], v24 offset:0
  v_mfma_f32_32x32x16_bf16 a[176:191], v[92:95], v[72:75], a[176:191]
  ds_read_b64_tr_b16 v[42:43], v24 offset:2048
  v_mfma_f32_32x32x16_bf16 a[192:207], v[80:83], v[76:79], a[192:207]
  ds_read_b128 v[60:63], v18 offset:12288
  v_mfma_f32_32x32x16_bf16 a[208:223], v[84:87], v[76:79], a[208:223]
  ds_read_b64_tr_b16 v[44:45], v25 offset:0
  v_mfma_f32_32x32x16_bf16 a[224:239], v[88:91], v[76:79], a[224:239]
  ds_read_b64_tr_b16 v[46:47], v25 offset:2048
  v_mfma_f32_32x32x16_bf16 a[240:255], v[92:95], v[76:79], a[240:255]
  s_sub_u32 s51, s51, 1
  s_cmp_lg_u32 s51, 0
  s_cbranch_scc1 gl_s
  s_waitcnt lgkmcnt(0)
  v_mfma_f32_32x32x16_bf16 a[0:15], v[48:51], v[32:35], a[0:15]
  ds_read_b128 v[80:83], v19 offset:0
  v_mfma_f32_32x32x16_bf16 a[16:31], v[52:55], v[32:35], a[16:31]
  ds_read_b64_tr_b16 v[64:65], v22 offset:8192
  v_mfma_f32_32x32x16_bf16 a[32:47], v[56:59], v[32:35], a[32:47]
  ds_read_b64_tr_b16 v[66:67], v22 offset:10240
  v_mfma_f32_32x32x16_bf16 a[48:63], v[60:63], v[32:35], a[48:63]
  ds_read_b128 v[84:87], v19 offset:4096
  v_mfma_f32_32x32x16_bf16 a[64:79], v[48:51], v[36:39], a[64:79]
  ds_read_b64_tr_b16 v[68:69], v23 offset:8192
  v_mfma_f32_32x32x16_bf16 a[80:95], v[52:55], v[36:39], a[80:95]
  ds_read_b64_tr_b16 v[70:71], v23 offset:10240
  v_mfma_f32_32x32x16_bf16 a[96:111], v[56:59], v[36:39], a[96:111]
  ds_read_b128 v[88:91], v19 offset:8192
  v_mfma_f32_32x32x16_bf16 a[112:127], v[60:63], v[36:39], a[112:127]
  ds_read_b64_tr_b16 v[72:73], v24 offset:8192
  v_mfma_f32_32x32x16_bf16 a[128:143], v[48:51], v[40:43], a[128:143]
  ds_read_b64_tr_b16 v[74:75], v24 offset:10240
  v_mfma_f32_32x32x16_bf16 a[144:159], v[52:55], v[40:43], a[144:159]
  ds_read_b128 v[92:95], v19 offset:12288
  v_mfma_f32_32x32x16_bf16 a[160:175], v[56:59], v[40:43], a[160:175]
  ds_read_b64_tr_b16 v[76:77], v25 offset:8192
  v_mfma_f32_32x32x16_bf16 a[176:191], v[60:63], v[40:43], a[176:191]
  ds_read_b64_tr_b16 v[78:79], v25 offset:10240
  v_mfma_f32_32x32x16_bf16 a[192:207], v[48:51], v[44:47], a[192:207]
  v_mfma_f32_32x32x16_bf16 a[208:223], v[52:55], v[44:47], a[208:223]
  v_mfma_f32_32x32x16_bf16 a[224:239], v[56:59], v[44:47], a[224:239]
  v_mfma_f32_32x32x16_bf16 a[240:255], v[60:63], v[44:47], a[240:255]
  s_waitcnt lgkmcnt(0)
  v_mfma_f32_32x32x16_bf16 a[0:15], v[80:83], v[64:67], a[0:15]
  v_mfma_f32_32x32x16_bf16 a[16:31], v[84:87], v[64:67], a[16:31]
  s_waitcnt vmcnt(12)
  s_barrier
  v_mfma_f32_32x32x16_bf16 a[32:47], v[88:91], v[64:67], a[32:47]
  ds_read_b128 v[48:51], v20 offset:0
  v_mfma_f32_32x32x16_bf16 a[48:63], v[92:95], v[64:67], a[48:63]
  ds_read_b64_tr_b16 v[32:33], v22 offset:16384
  v_mfma_f32_32x32x16_bf16 a[64:79], v[80:83], v[68:71], a[64:79]
  ds_read_b64_tr_b16 v[34:35], v22 offset:18432
  v_mfma_f32_32x32x16_bf16 a[80:95], v[84:87], v[68:71], a[80:95]
  ds_read_b128 v[52:55], v20 offset:4096
  v_mfma_f32_32x32x16_bf16 a[96:111], v[88:91], v[68:71], a[96:111]
  ds_read_b64_tr_b16 v[36:37], v23 offset:16384
  v_mfma_f32_32x32x16_bf16 a[112:127], v[92:95], v[68:71], a[112:127]
  ds_read_b64_tr_b16 v[38:39], v23 offset:18432
  v_mfma_f32_32x32x16_bf16 a[128:143], v[80:83], v[72:75], a[128:143]
  ds_read_b128 v[56:59], v20 offset:8192
  v_mfma_f32_32x32x16_bf16 a[144:159], v[84:87], v[72:75], a[144:159]
  ds_read_b64_tr_b16 v[40:41], v24 offset:16384
  v_mfma_f32_32x32x16_bf16 a[160:175], v[88:91], v[72:75], a[160:175]
  ds_read_b64_tr_b16 v[42:43], v24 offset:18432
  v_mfma_f32_32x32x16_bf16 a[176:191], v[92:95], v[72:75], a[176:191]
  ds_read_b128 v[60:63], v20 offset:12288
  v_mfma_f32_32x32x16_bf16 a[192:207], v[80:83], v[76:79], a[192:207]
  ds_read_b64_tr_b16 v[44:45], v25 offset:16384
  v_mfma_f32_32x32x16_bf16 a[208:223], v[84:87], v[76:79], a[208:223]
  ds_read_b64_tr_b16 v[46:47], v25 offset:18432
  v_mfma_f32_32x32x16_bf16 a[224:239], v[88:91], v[76:79], a[224:239]
  v_mfma_f32_32x32x16_bf16 a[240:255], v[92:95], v[76:79], a[240:255]
  s_waitcnt lgkmcnt(0)
  v_mfma_f32_32x32x16_bf16 a[0:15], v[48:51], v[32:35], a[0:15]
  ds_read_b128 v[80:83], v21 offset:0
  v_mfma_f32_32x32x16_bf16 a[16:31], v[52:55], v[32:35], a[16:31]
  ds_read_b64_tr_b16 v[64:65], v22 offset:24576
  v_mfma_f32_32x32x16_bf16 a[32:47], v[56:59], v[32:35], a[32:47]
  ds_read_b64_tr_b16 v[66:67], v22 offset:26624
  v_mfma_f32_32x32x16_bf16 a[48:63], v[60:63], v[32:35], a[48:63]
  ds_read_b128 v[84:87], v21 offset:4096
  v_mfma_f32_32x32x16_bf16 a[64:79], v[48:51], v[36:39], a[64:79]
  ds_read_b64_tr_b16 v[68:69], v23 offset:24576
  v_mfma_f32_32x32x16_bf16 a[80:95], v[52:55], v[36:39], a[80:95]
  ds_read_b64_tr_b16 v[70:71], v23 offset:26624
  v_mfma_f32_32x32x16_bf16 a[96:111], v[56:59], v[36:39], a[96:111]
  ds_read_b128 v[88:91], v21 offset:8192
  v_mfma_f32_32x32x16_bf16 a[112:127], v[60:63], v[36:39], a[112:127]
  ds_read_b64_tr_b16 v[72:73], v24 offset:24576
  v_mfma_f32_32x32x16_bf16 a[128:143], v[48:51], v[40:43], a[128:143]
  ds_read_b64_tr_b16 v[74:75], v24 offset:26624
  v_mfma_f32_32x32x16_bf16 a[144:159], v[52:55], v[40:43], a[144:159]
  ds_read_b128 v[92:95], v21 offset:12288
  v_mfma_f32_32x32x16_bf16 a[160:175], v[56:59], v[40:43], a[160:175]
  ds_read_b64_tr_b16 v[76:77], v25 offset:24576
  v_mfma_f32_32x32x16_bf16 a[176:191], v[60:63], v[40:43], a[176:191]
  ds_read_b64_tr_b16 v[78:79], v25 offset:26624
  v_mfma_f32_32x32x16_bf16 a[192:207], v[48:51], v[44:47], a[192:207]
  v_mfma_f32_32x32x16_bf16 a[208:223], v[52:55], v[44:47], a[208:223]
  v_mfma_f32_32x32x16_bf16 a[224:239], v[56:59], v[44:47], a[224:239]
  v_mfma_f32_32x32x16_bf16 a[240:255], v[60:63], v[44:47], a[240:255]
  s_waitcnt lgkmcnt(0)
  v_mfma_f32_32x32x16_bf16 a[0:15], v[80:83], v[64:67], a[0:15]
  v_mfma_f32_32x32x16_bf16 a[16:31], v[84:87], v[64:67], a[16:31]
  s_add_u32 s53, s52, s54
  s_add_u32 s52, s52, 32768
  s_cmp_eq_u32 s52, 98304
  s_cselect_b32 s52, 0, s52
  v_add_u32 v18, s52, v14
  v_add_u32 v19, s52, v15
  v_add_u32 v20, s52, v16
  v_add_u32 v21, s52, v17
  s_waitcnt vmcnt(4)
  s_barrier
  v_mfma_f32_32x32x16_bf16 a[32:47], v[88:91], v[64:67], a[32:47]
  ds_read_b128 v[48:51], v18 offset:0
  v_mfma_f32_32x32x16_bf16 a[48:63], v[92:95], v[64:67], a[48:63]
  ds_read_b64_tr_b16 v[32:33], v22 offset:32768
  v_mfma_f32_32x32x16_bf16 a[64:79], v[80:83], v[68:71], a[64:79]
  ds_read_b64_tr_b16 v[34:35], v22 offset:34816
  v_mfma_f32_32x32x16_bf16 a[80:95], v[84:87], v[68:71], a[80:95]
  ds_read_b128 v[52:55], v18 offset:4096
  v_mfma_f32_32x32x16_bf16 a[96:111], v[88:91], v[68:71], a[96:111]
  ds_read_b64_tr_b16 v[36:37], v23 offset:32768
  v_mfma_f32_32x32x16_bf16 a[112:127], v[92:95], v[68:71], a[112:127]
  ds_read_b64_tr_b16 v[38:39], v23 offset:34816
  v_mfma_f32_32x32x16_bf16 a[128:143], v[80:83], v[72:75], a[128:143]
  ds_read_b128 v[56:59], v18 offset:8192
  v_mfma_f32_32x32x16_bf16 a[144:159], v[84:87], v[72:75], a[144:159]
  ds_read_b64_tr_b16 v[40:41], v24 offset:32768
  v_mfma_f32_32x32x16_bf16 a[160:175], v[88:91], v[72:75], a[160:175]
  ds_read_b64_tr_b16 v[42:43], v24 offset:34816
  v_mfma_f32_32x32x16_bf16 a[176:191], v[92:95], v[72:75], a[176:191]
  ds_read_b128 v[60:63], v18 offset:12288
  v_mfma_f32_32x32x16_bf16 a[192:207], v[80:83], v[76:79], a[192:207]
  ds_read_b64_tr_b16 v[44:45], v25 offset:32768
  v_mfma_f32_32x32x16_bf16 a[208:223], v[84:87], v[76:79], a[208:223]
  ds_read_b64_tr_b16 v[46:47], v25 offset:34816
  v_mfma_f32_32x32x16_bf16 a[224:239], v[88:91], v[76:79], a[224:239]
  v_mfma_f32_32x32x16_bf16 a[240:255], v[92:95], v[76:79], a[240:255]
  s_waitcnt lgkmcnt(0)
  v_mfma_f32_32x32x16_bf16 a[0:15], v[48:51], v[32:35], a[0:15]
  ds_read_b128 v[80:83], v19 offset:0
  v_mfma_f32_32x32x16_bf16 a[16:31], v[52:55], v[32:35], a[16:31]
  ds_read_b64_tr_b16 v[64:65], v22 offset:40960
  v_mfma_f32_32x32x16_bf16 a[32:47], v[56:59], v[32:35], a[32:47]
  ds_read_b64_tr_b16 v[66:67], v22 offset:43008
  v_mfma_f32_32x32x16_bf16 a[48:63], v[60:63], v[32:35], a[48:63]
  ds_read_b128 v[84:87], v19 offset:4096
  v_mfma_f32_32x32x16_bf16 a[64:79], v[48:51], v[36:39], a[64:79]
  ds_read_b64_tr_b16 v[68:69], v23 offset:40960
  v_mfma_f32_32x32x16_bf16 a[80:95], v[52:55], v[36:39], a[80:95]
  ds_read_b64_tr_b16 v[70:71], v23 offset:43008
  v_mfma_f32_32x32x16_bf16 a[96:111], v[56:59], v[36:39], a[96:111]
  ds_read_b128 v[88:91], v19 offset:8192
  v_mfma_f32_32x32x16_bf16 a[112:127], v[60:63], v[36:39], a[112:127]
  ds_read_b64_tr_b16 v[72:73], v24 offset:40960
  v_mfma_f32_32x32x16_bf16 a[128:143], v[48:51], v[40:43], a[128:143]
  ds_read_b64_tr_b16 v[74:75], v24 offset:43008
  v_mfma_f32_32x32x16_bf16 a[144:159], v[52:55], v[40:43], a[144:159]
  ds_read_b128 v[92:95], v19 offset:12288
  v_mfma_f32_32x32x16_bf16 a[160:175], v[56:59], v[40:43], a[160:175]
  ds_read_b64_tr_b16 v[76:77], v25 offset:40960
  v_mfma_f32_32x32x16_bf16 a[176:191], v[60:63], v[40:43], a[176:191]
  ds_read_b64_tr_b16 v[78:79], v25 offset:43008
  v_mfma_f32_32x32x16_bf16 a[192:207], v[48:51], v[44:47], a[192:207]
  v_mfma_f32_32x32x16_bf16 a[208:223], v[52:55], v[44:47], a[208:223]
  v_mfma_f32_32x32x16_bf16 a[224:239], v[56:59], v[44:47], a[224:239]
  v_mfma_f32_32x32x16_bf16 a[240:255], v[60:63], v[44:47], a[240:255]
  s_waitcnt lgkmcnt(0)
  v_mfma_f32_32x32x16_bf16 a[0:15], v[80:83], v[64:67], a[0:15]
  v_mfma_f32_32x32x16_bf16 a[16:31], v[84:87], v[64:67], a[16:31]
  s_waitcnt vmcnt(0)
  s_barrier
  v_mfma_f32_32x32x16_bf16 a[32:47], v[88:91], v[64:67], a[32:47]
  ds_read_b128 v[48:51], v20 offset:0
  v_mfma_f32_32x32x16_bf16 a[48:63], v[92:95], v[64:67], a[48:63]
  ds_read_b64_tr_b16 v[32:33], v22 offset:49152
  v_mfma_f32_32x32x16_bf16 a[64:79], v[80:83], v[68:71], a[64:79]
  ds_read_b64_tr_b16 v[34:35], v22 offset:51200
  v_mfma_f32_32x32x16_bf16 a[80:95], v[84:87], v[68:71], a[80:95]
  ds_read_b128 v[52:55], v20 offset:4096
  v_mfma_f32_32x32x16_bf16 a[96:111], v[88:91], v[68:71], a[96:111]
  ds_read_b64_tr_b16 v[36:37], v23 offset:49152
  v_mfma_f32_32x32x16_bf16 a[112:127], v[92:95], v[68:71], a[112:127]
  ds_read_b64_tr_b16 v[38:39], v23 offset:51200
  v_mfma_f32_32x32x16_bf16 a[128:143], v[80:83], v[72:75], a[128:143]
  ds_read_b128 v[56:59], v20 offset:8192
  v_mfma_f32_32x32x16_bf16 a[144:159], v[84:87], v[72:75], a[144:159]
  ds_read_b64_tr_b16 v[40:41], v24 offset:49152
  v_mfma_f32_32x32x16_bf16 a[160:175], v[88:91], v[72:75], a[160:175]
  ds_read_b64_tr_b16 v[42:43], v24 offset:51200
  v_mfma_f32_32x32x16_bf16 a[176:191], v[92:95], v[72:75], a[176:191]
  ds_read_b128 v[60:63], v20 offset:12288
  v_mfma_f32_32x32x16_bf16 a[192:207], v[80:83], v[76:79], a[192:207]
  ds_read_b64_tr_b16 v[44:45], v25 offset:49152
  v_mfma_f32_32x32x16_bf16 a[208:223], v[84:87], v[76:79], a[208:223]
  ds_read_b64_tr_b16 v[46:47], v25 offset:51200
  v_mfma_f32_32x32x16_bf16 a[224:239], v[88:91], v[76:79], a[224:239]
  v_mfma_f32_32x32x16_bf16 a[240:255], v[92:95], v[76:79], a[240:255]
  s_waitcnt lgkmcnt(0)
  v_mfma_f32_32x32x16_bf16 a[0:15], v[48:51], v[32:35], a[0:15]
  ds_read_b128 v[80:83], v21 offset:0
  v_mfma_f32_32x32x16_bf16 a[16:31], v[52:55], v[32:35], a[16:31]
  ds_read_b64_tr_b16 v[64:65], v22 offset:57344
  v_mfma_f32_32x32x16_bf16 a[32:47], v[56:59], v[32:35], a[32:47]
  ds_read_b64_tr_b16 v[66:67], v22 offset:59392
  v_mfma_f32_32x32x16_bf16 a[48:63], v[60:63], v[32:35], a[48:63]
  ds_read_b128 v[84:87], v21 offset:4096
  v_mfma_f32_32x32x16_bf16 a[64:79], v[48:51], v[36:39], a[64:79]
  ds_read_b64_tr_b16 v[68:69], v23 offset:57344
  v_mfma_f32_32x32x16_bf16 a[80:95], v[52:55], v[36:39], a[80:95]
  ds_read_b64_tr_b16 v[70:71], v23 offset:59392
  v_mfma_f32_32x32x16_bf16 a[96:111], v[56:59], v[36:39], a[96:111]
  ds_read_b128 v[88:91], v21 offset:8192
  v_mfma_f32_32x32x16_bf16 a[112:127], v[60:63], v[36:39], a[112:127]
  ds_read_b64_tr_b16 v[72:73], v24 offset:57344
  v_mfma_f32_32x32x16_bf16 a[128:143], v[48:51], v[40:43], a[128:143]
  ds_read_b64_tr_b16 v[74:75], v24 offset:59392
  v_mfma_f32_32x32x16_bf16 a[144:159], v[52:55], v[40:43], a[144:159]
  ds_read_b128 v[92:95], v21 offset:12288
  v_mfma_f32_32x32x16_bf16 a[160:175], v[56:59], v[40:43], a[160:175]
  ds_read_b64_tr_b16 v[76:77], v25 offset:57344
  v_mfma_f32_32x32x16_bf16 a[176:191], v[60:63], v[40:43], a[176:191]
  ds_read_b64_tr_b16 v[78:79], v25 offset:59392
  v_mfma_f32_32x32x16_bf16 a[192:207], v[48:51], v[44:47], a[192:207]
  v_mfma_f32_32x32x16_bf16 a[208:223], v[52:55], v[44:47], a[208:223]
  v_mfma_f32_32x32x16_bf16 a[224:239], v[56:59], v[44:47], a[224:239]
  v_mfma_f32_32x32x16_bf16 a[240:255], v[60:63], v[44:47], a[240:255]
  s_waitcnt lgkmcnt(0)
  v_mfma_f32_32x32x16_bf16 a[0:15], v[80:83], v[64:67], a[0:15]
  v_mfma_f32_32x32x16_bf16 a[16:31], v[84:87], v[64:67], a[16:31]
  v_mfma_f32_32x32x16_bf16 a[32:47], v[88:91], v[64:67], a[32:47]
  v_mfma_f32_32x32x16_bf16 a[48:63], v[92:95], v[64:67], a[48:63]
  v_mfma_f32_32x32x16_bf16 a[64:79], v[80:83], v[68:71], a[64:79]
  v_mfma_f32_32x32x16_bf16 a[80:95], v[84:87], v[68:71], a[80:95]
  v_mfma_f32_32x32x16_bf16 a[96:111], v[88:91], v[68:71], a[96:111]
  v_mfma_f32_32x32x16_bf16 a[112:127], v[92:95], v[68:71], a[112:127]
  v_mfma_f32_32x32x16_bf16 a[128:143], v[80:83], v[72:75], a[128:143]
  v_mfma_f32_32x32x16_bf16 a[144:159], v[84:87], v[72:75], a[144:159]
  v_mfma_f32_32x32x16_bf16 a[160:175], v[88:91], v[72:75], a[160:175]
  v_mfma_f32_32x32x16_bf16 a[176:191], v[92:95], v[72:75], a[176:191]
  v_mfma_f32_32x32x16_bf16 a[192:207], v[80:83], v[76:79], a[192:207]
  v_mfma_f32_32x32x16_bf16 a[208:223], v[84:87], v[76:79], a[208:223]
  v_mfma_f32_32x32x16_bf16 a[224:239], v[88:91], v[76:79], a[224:239]
  v_mfma_f32_32x32x16_bf16 a[240:255], v[92:95], v[76:79], a[240:255]
  s_nop 11
  s_lshl_b32 s89, s83, 1
  s_add_u32 s89, s89, s59
  s_lshl_b32 s85, s89, 12
  s_lshl_b32 s89, s89, 8
  s_lshl_b32 s86, s82, 1
  s_add_u32 s86, s86, s60
  s_lshl_b32 s86, s86, 19
  s_add_u32 s85, s85, s86
  s_add_u32 s85, s85, 67108864
  s_mov_b32 s32, s22
  s_mov_b32 s33, s23
  s_mov_b32 s34, 4096
  s_mov_b32 s35, 0x20000
  v_and_b32 v27, 31, v1
  v_lshlrev_b32 v26, 5, v27
  v_lshrrev_b32 v27, 5, v1
  v_lshl_add_u32 v26, v27, 4, v26
  v_and_b32 v27, 31, v1
  v_lshlrev_b32 v27, 1, v27
  buffer_load_ushort v128, v27, s[32:35], s89 offen offset:0
  buffer_load_ushort v130, v27, s[32:35], s89 offen offset:64
  buffer_load_ushort v132, v27, s[32:35], s89 offen offset:128
  buffer_load_ushort v134, v27, s[32:35], s89 offen offset:192
  s_mov_b32 s62, 0xbfb8aa3b
  s_mov_b32 s63, 0xbfb8aa3b
  v_mov_b32 v28, 1.0
  v_mov_b32 v29, 1.0
  s_waitcnt vmcnt(0)
  v_lshlrev_b32 v128, 16, v128
  v_lshlrev_b32 v130, 16, v130
  v_lshlrev_b32 v132, 16, v132
  v_lshlrev_b32 v134, 16, v134
  v_accvgpr_read_b32 v160, a0
  v_accvgpr_read_b32 v161, a1
  v_accvgpr_read_b32 v162, a2
  v_accvgpr_read_b32 v163, a3
  v_accvgpr_read_b32 v164, a4
  v_accvgpr_read_b32 v165, a5
  v_accvgpr_read_b32 v166, a6
  v_accvgpr_read_b32 v167, a7
  v_accvgpr_read_b32 v168, a8
  v_accvgpr_read_b32 v169, a9
  v_accvgpr_read_b32 v170, a10
  v_accvgpr_read_b32 v171, a11
  v_accvgpr_read_b32 v172, a12
  v_accvgpr_read_b32 v173, a13
  v_accvgpr_read_b32 v174, a14
  v_accvgpr_read_b32 v175, a15
  v_pk_add_f32 v[160:161], v[160:161], v[128:129] op_sel_hi:[1,0]
  v_pk_add_f32 v[162:163], v[162:163], v[128:129] op_sel_hi:[1,0]
  v_pk_add_f32 v[164:165], v[164:165], v[128:129] op_sel_hi:[1,0]
  v_pk_add_f32 v[166:167], v[166:167], v[128:129] op_sel_hi:[1,0]
  v_pk_add_f32 v[168:169], v[168:169], v[128:129] op_sel_hi:[1,0]
  v_pk_add_f32 v[170:171], v[170:171], v[128:129] op_sel_hi:[1,0]
  v_pk_add_f32 v[172:173], v[172:173], v[128:129] op_sel_hi:[1,0]
  v_pk_add_f32 v[174:175], v[174:175], v[128:129] op_sel_hi:[1,0]
  v_pk_mul_f32 v[176:177], v[160:161], s[62:63]
  v_pk_mul_f32 v[178:179], v[162:163], s[62:63]
  v_pk_mul_f32 v[180:181], v[164:165], s[62:63]
  v_pk_mul_f32 v[182:183], v[166:167], s[62:63]
  v_pk_mul_f32 v[184:185], v[168:169], s[62:63]
  v_pk_mul_f32 v[186:187], v[170:171], s[62:63]
  v_pk_mul_f32 v[188:189], v[172:173], s[62:63]
  v_pk_mul_f32 v[190:191], v[174:175], s[62:63]
  v_exp_f32 v176, v176
  v_exp_f32 v177, v177
  v_exp_f32 v178, v178
  v_exp_f32 v179, v179
  v_exp_f32 v180, v180
  v_exp_f32 v181, v181
  v_exp_f32 v182, v182
  v_exp_f32 v183, v183
  v_exp_f32 v184, v184
  v_exp_f32 v185, v185
  v_exp_f32 v186, v186
  v_exp_f32 v187, v187
  v_exp_f32 v188, v188
  v_exp_f32 v189, v189
  v_exp_f32 v190, v190
  v_exp_f32 v191, v191
  v_pk_add_f32 v[176:177], v[176:177], v[28:29]
  v_pk_add_f32 v[178:179], v[178:179], v[28:29]
  v_pk_add_f32 v[180:181], v[180:181], v[28:29]
  v_pk_add_f32 v[182:183], v[182:183], v[28:29]
  v_pk_add_f32 v[184:185], v[184:185], v[28:29]
  v_pk_add_f32 v[186:187], v[186:187], v[28:29]
  v_pk_add_f32 v[188:189], v[188:189], v[28:29]
  v_pk_add_f32 v[190:191], v[190:191], v[28:29]
  v_rcp_f32 v176, v176
  v_rcp_f32 v177, v177
  v_rcp_f32 v178, v178
  v_rcp_f32 v179, v179
  v_rcp_f32 v180, v180
  v_rcp_f32 v181, v181
  v_rcp_f32 v182, v182
  v_rcp_f32 v183, v183
  v_rcp_f32 v184, v184
  v_rcp_f32 v185, v185
  v_rcp_f32 v186, v186
  v_rcp_f32 v187, v187
  v_rcp_f32 v188, v188
  v_rcp_f32 v189, v189
  v_rcp_f32 v190, v190
  v_rcp_f32 v191, v191
  v_pk_mul_f32 v[160:161], v[160:161], v[176:177]
  v_pk_mul_f32 v[162:163], v[162:163], v[178:179]
  v_pk_mul_f32 v[164:165], v[164:165], v[180:181]
  v_pk_mul_f32 v[166:167], v[166:167], v[182:183]
  v_pk_mul_f32 v[168:169], v[168:169], v[184:185]
  v_pk_mul_f32 v[170:171], v[170:171], v[186:187]
  v_pk_mul_f32 v[172:173], v[172:173], v[188:189]
  v_pk_mul_f32 v[174:175], v[174:175], v[190:191]
  v_cvt_pk_bf16_f32 v96, v160, v161
  v_cvt_pk_bf16_f32 v97, v162, v163
  v_cvt_pk_bf16_f32 v98, v164, v165
  v_cvt_pk_bf16_f32 v99, v166, v167
  v_cvt_pk_bf16_f32 v100, v168, v169
  v_cvt_pk_bf16_f32 v101, v170, v171
  v_cvt_pk_bf16_f32 v102, v172, v173
  v_cvt_pk_bf16_f32 v103, v174, v175
  v_permlane32_swap_b32 v96, v98
  v_permlane32_swap_b32 v97, v99
  v_permlane32_swap_b32 v100, v102
  v_permlane32_swap_b32 v101, v103
  s_add_u32 s49, s85, 0
  buffer_store_dwordx4 v[96:99], v26, s[28:31], s49 offen offset:0 sc1
  s_add_u32 s49, s85, 65536
  buffer_store_dwordx4 v[100:103], v26, s[28:31], s49 offen offset:0 sc1
  v_accvgpr_read_b32 v160, a16
  v_accvgpr_read_b32 v161, a17
  v_accvgpr_read_b32 v162, a18
  v_accvgpr_read_b32 v163, a19
  v_accvgpr_read_b32 v164, a20
  v_accvgpr_read_b32 v165, a21
  v_accvgpr_read_b32 v166, a22
  v_accvgpr_read_b32 v167, a23
  v_accvgpr_read_b32 v168, a24
  v_accvgpr_read_b32 v169, a25
  v_accvgpr_read_b32 v170, a26
  v_accvgpr_read_b32 v171, a27
  v_accvgpr_read_b32 v172, a28
  v_accvgpr_read_b32 v173, a29
  v_accvgpr_read_b32 v174, a30
  v_accvgpr_read_b32 v175, a31
  v_pk_add_f32 v[160:161], v[160:161], v[128:129] op_sel_hi:[1,0]
  v_pk_add_f32 v[162:163], v[162:163], v[128:129] op_sel_hi:[1,0]
  v_pk_add_f32 v[164:165], v[164:165], v[128:129] op_sel_hi:[1,0]
  v_pk_add_f32 v[166:167], v[166:167], v[128:129] op_sel_hi:[1,0]
  v_pk_add_f32 v[168:169], v[168:169], v[128:129] op_sel_hi:[1,0]
  v_pk_add_f32 v[170:171], v[170:171], v[128:129] op_sel_hi:[1,0]
  v_pk_add_f32 v[172:173], v[172:173], v[128:129] op_sel_hi:[1,0]
  v_pk_add_f32 v[174:175], v[174:175], v[128:129] op_sel_hi:[1,0]
  v_pk_mul_f32 v[176:177], v[160:161], s[62:63]
  v_pk_mul_f32 v[178:179], v[162:163], s[62:63]
  v_pk_mul_f32 v[180:181], v[164:165], s[62:63]
  v_pk_mul_f32 v[182:183], v[166:167], s[62:63]
  v_pk_mul_f32 v[184:185], v[168:169], s[62:63]
  v_pk_mul_f32 v[186:187], v[170:171], s[62:63]
  v_pk_mul_f32 v[188:189], v[172:173], s[62:63]
  v_pk_mul_f32 v[190:191], v[174:175], s[62:63]
  v_exp_f32 v176, v176
  v_exp_f32 v177, v177
  v_exp_f32 v178, v178
  v_exp_f32 v179, v179
  v_exp_f32 v180, v180
  v_exp_f32 v181, v181
  v_exp_f32 v182, v182
  v_exp_f32 v183, v183
  v_exp_f32 v184, v184
  v_exp_f32 v185, v185
  v_exp_f32 v186, v186
  v_exp_f32 v187, v187
  v_exp_f32 v188, v188
  v_exp_f32 v189, v189
  v_exp_f32 v190, v190
  v_exp_f32 v191, v191
  v_pk_add_f32 v[176:177], v[176:177], v[28:29]
  v_pk_add_f32 v[178:179], v[178:179], v[28:29]
  v_pk_add_f32 v[180:181], v[180:181], v[28:29]
  v_pk_add_f32 v[182:183], v[182:183], v[28:29]
  v_pk_add_f32 v[184:185], v[184:185], v[28:29]
  v_pk_add_f32 v[186:187], v[186:187], v[28:29]
  v_pk_add_f32 v[188:189], v[188:189], v[28:29]
  v_pk_add_f32 v[190:191], v[190:191], v[28:29]
  v_rcp_f32 v176, v176
  v_rcp_f32 v177, v177
  v_rcp_f32 v178, v178
  v_rcp_f32 v179, v179
  v_rcp_f32 v180, v180
  v_rcp_f32 v181, v181
  v_rcp_f32 v182, v182
  v_rcp_f32 v183, v183
  v_rcp_f32 v184, v184
  v_rcp_f32 v185, v185
  v_rcp_f32 v186, v186
  v_rcp_f32 v187, v187
  v_rcp_f32 v188, v188
  v_rcp_f32 v189, v189
  v_rcp_f32 v190, v190
  v_rcp_f32 v191, v191
  v_pk_mul_f32 v[160:161], v[160:161], v[176:177]
  v_pk_mul_f32 v[162:163], v[162:163], v[178:179]
  v_pk_mul_f32 v[164:165], v[164:165], v[180:181]
  v_pk_mul_f32 v[166:167], v[166:167], v[182:183]
  v_pk_mul_f32 v[168:169], v[168:169], v[184:185]
  v_pk_mul_f32 v[170:171], v[170:171], v[186:187]
  v_pk_mul_f32 v[172:173], v[172:173], v[188:189]
  v_pk_mul_f32 v[174:175], v[174:175], v[190:191]
  v_cvt_pk_bf16_f32 v104, v160, v161
  v_cvt_pk_bf16_f32 v105, v162, v163
  v_cvt_pk_bf16_f32 v106, v164, v165
  v_cvt_pk_bf16_f32 v107, v166, v167
  v_cvt_pk_bf16_f32 v108, v168, v169
  v_cvt_pk_bf16_f32 v109, v170, v171
  v_cvt_pk_bf16_f32 v110, v172, v173
  v_cvt_pk_bf16_f32 v111, v174, v175
  v_permlane32_swap_b32 v104, v106
  v_permlane32_swap_b32 v105, v107
  v_permlane32_swap_b32 v108, v110
  v_permlane32_swap_b32 v109, v111
  s_add_u32 s49, s85, 131072
  buffer_store_dwordx4 v[104:107], v26, s[28:31], s49 offen offset:0 sc1
  s_add_u32 s49, s85, 196608
  buffer_store_dwordx4 v[108:111], v26, s[28:31], s49 offen offset:0 sc1
  v_accvgpr_read_b32 v160, a32
  v_accvgpr_read_b32 v161, a33
  v_accvgpr_read_b32 v162, a34
  v_accvgpr_read_b32 v163, a35
  v_accvgpr_read_b32 v164, a36
  v_accvgpr_read_b32 v165, a37
  v_accvgpr_read_b32 v166, a38
  v_accvgpr_read_b32 v167, a39
  v_accvgpr_read_b32 v168, a40
  v_accvgpr_read_b32 v169, a41
  v_accvgpr_read_b32 v170, a42
  v_accvgpr_read_b32 v171, a43
  v_accvgpr_read_b32 v172, a44
  v_accvgpr_read_b32 v173, a45
  v_accvgpr_read_b32 v174, a46
  v_accvgpr_read_b32 v175, a47
  v_pk_add_f32 v[160:161], v[160:161], v[128:129] op_sel_hi:[1,0]
  v_pk_add_f32 v[162:163], v[162:163], v[128:129] op_sel_hi:[1,0]
  v_pk_add_f32 v[164:165], v[164:165], v[128:129] op_sel_hi:[1,0]
  v_pk_add_f32 v[166:167], v[166:167], v[128:129] op_sel_hi:[1,0]
  v_pk_add_f32 v[168:169], v[168:169], v[128:129] op_sel_hi:[1,0]
  v_pk_add_f32 v[170:171], v[170:171], v[128:129] op_sel_hi:[1,0]
  v_pk_add_f32 v[172:173], v[172:173], v[128:129] op_sel_hi:[1,0]
  v_pk_add_f32 v[174:175], v[174:175], v[128:129] op_sel_hi:[1,0]
  v_pk_mul_f32 v[176:177], v[160:161], s[62:63]
  v_pk_mul_f32 v[178:179], v[162:163], s[62:63]
  v_pk_mul_f32 v[180:181], v[164:165], s[62:63]
  v_pk_mul_f32 v[182:183], v[166:167], s[62:63]
  v_pk_mul_f32 v[184:185], v[168:169], s[62:63]
  v_pk_mul_f32 v[186:187], v[170:171], s[62:63]
  v_pk_mul_f32 v[188:189], v[172:173], s[62:63]
  v_pk_mul_f32 v[190:191], v[174:175], s[62:63]
  v_exp_f32 v176, v176
  v_exp_f32 v177, v177
  v_exp_f32 v178, v178
  v_exp_f32 v179, v179
  v_exp_f32 v180, v180
  v_exp_f32 v181, v181
  v_exp_f32 v182, v182
  v_exp_f32 v183, v183
  v_exp_f32 v184, v184
  v_exp_f32 v185, v185
  v_exp_f32 v186, v186
  v_exp_f32 v187, v187
  v_exp_f32 v188, v188
  v_exp_f32 v189, v189
  v_exp_f32 v190, v190
  v_exp_f32 v191, v191
  v_pk_add_f32 v[176:177], v[176:177], v[28:29]
  v_pk_add_f32 v[178:179], v[178:179], v[28:29]
  v_pk_add_f32 v[180:181], v[180:181], v[28:29]
  v_pk_add_f32 v[182:183], v[182:183], v[28:29]
  v_pk_add_f32 v[184:185], v[184:185], v[28:29]
  v_pk_add_f32 v[186:187], v[186:187], v[28:29]
  v_pk_add_f32 v[188:189], v[188:189], v[28:29]
  v_pk_add_f32 v[190:191], v[190:191], v[28:29]
  v_rcp_f32 v176, v176
  v_rcp_f32 v177, v177
  v_rcp_f32 v178, v178
  v_rcp_f32 v179, v179
  v_rcp_f32 v180, v180
  v_rcp_f32 v181, v181
  v_rcp_f32 v182, v182
  v_rcp_f32 v183, v183
  v_rcp_f32 v184, v184
  v_rcp_f32 v185, v185
  v_rcp_f32 v186, v186
  v_rcp_f32 v187, v187
  v_rcp_f32 v188, v188
  v_rcp_f32 v189, v189
  v_rcp_f32 v190, v190
  v_rcp_f32 v191, v191
  v_pk_mul_f32 v[160:161], v[160:161], v[176:177]
  v_pk_mul_f32 v[162:163], v[162:163], v[178:179]
  v_pk_mul_f32 v[164:165], v[164:165], v[180:181]
  v_pk_mul_f32 v[166:167], v[166:167], v[182:183]
  v_pk_mul_f32 v[168:169], v[168:169], v[184:185]
  v_pk_mul_f32 v[170:171], v[170:171], v[186:187]
  v_pk_mul_f32 v[172:173], v[172:173], v[188:189]
  v_pk_mul_f32 v[174:175], v[174:175], v[190:191]
  v_cvt_pk_bf16_f32 v96, v160, v161
  v_cvt_pk_bf16_f32 v97, v162, v163
  v_cvt_pk_bf16_f32 v98, v164, v165
  v_cvt_pk_bf16_f32 v99, v166, v167
  v_cvt_pk_bf16_f32 v100, v168, v169
  v_cvt_pk_bf16_f32 v101, v170, v171
  v_cvt_pk_bf16_f32 v102, v172, v173
  v_cvt_pk_bf16_f32 v103, v174, v175
  v_permlane32_swap_b32 v96, v98
  v_permlane32_swap_b32 v97, v99
  v_permlane32_swap_b32 v100, v102
  v_permlane32_swap_b32 v101, v103
  s_add_u32 s49, s85, 262144
  buffer_store_dwordx4 v[96:99], v26, s[28:31], s49 offen offset:0 sc1
  s_add_u32 s49, s85, 327680
  buffer_store_dwordx4 v[100:103], v26, s[28:31], s49 offen offset:0 sc1
  v_accvgpr_read_b32 v160, a48
  v_accvgpr_read_b32 v161, a49
  v_accvgpr_read_b32 v162, a50
  v_accvgpr_read_b32 v163, a51
  v_accvgpr_read_b32 v164, a52
  v_accvgpr_read_b32 v165, a53
  v_accvgpr_read_b32 v166, a54
  v_accvgpr_read_b32 v167, a55
  v_accvgpr_read_b32 v168, a56
  v_accvgpr_read_b32 v169, a57
  v_accvgpr_read_b32 v170, a58
  v_accvgpr_read_b32 v171, a59
  v_accvgpr_read_b32 v172, a60
  v_accvgpr_read_b32 v173, a61
  v_accvgpr_read_b32 v174, a62
  v_accvgpr_read_b32 v175, a63
  v_pk_add_f32 v[160:161], v[160:161], v[128:129] op_sel_hi:[1,0]
  v_pk_add_f32 v[162:163], v[162:163], v[128:129] op_sel_hi:[1,0]
  v_pk_add_f32 v[164:165], v[164:165], v[128:129] op_sel_hi:[1,0]
  v_pk_add_f32 v[166:167], v[166:167], v[128:129] op_sel_hi:[1,0]
  v_pk_add_f32 v[168:169], v[168:169], v[128:129] op_sel_hi:[1,0]
  v_pk_add_f32 v[170:171], v[170:171], v[128:129] op_sel_hi:[1,0]
  v_pk_add_f32 v[172:173], v[172:173], v[128:129] op_sel_hi:[1,0]
  v_pk_add_f32 v[174:175], v[174:175], v[128:129] op_sel_hi:[1,0]
  v_pk_mul_f32 v[176:177], v[160:161], s[62:63]
  v_pk_mul_f32 v[178:179], v[162:163], s[62:63]
  v_pk_mul_f32 v[180:181], v[164:165], s[62:63]
  v_pk_mul_f32 v[182:183], v[166:167], s[62:63]
  v_pk_mul_f32 v[184:185], v[168:169], s[62:63]
  v_pk_mul_f32 v[186:187], v[170:171], s[62:63]
  v_pk_mul_f32 v[188:189], v[172:173], s[62:63]
  v_pk_mul_f32 v[190:191], v[174:175], s[62:63]
  v_exp_f32 v176, v176
  v_exp_f32 v177, v177
  v_exp_f32 v178, v178
  v_exp_f32 v179, v179
  v_exp_f32 v180, v180
  v_exp_f32 v181, v181
  v_exp_f32 v182, v182
  v_exp_f32 v183, v183
  v_exp_f32 v184, v184
  v_exp_f32 v185, v185
  v_exp_f32 v186, v186
  v_exp_f32 v187, v187
  v_exp_f32 v188, v188
  v_exp_f32 v189, v189
  v_exp_f32 v190, v190
  v_exp_f32 v191, v191
  v_pk_add_f32 v[176:177], v[176:177], v[28:29]
  v_pk_add_f32 v[178:179], v[178:179], v[28:29]
  v_pk_add_f32 v[180:181], v[180:181], v[28:29]
  v_pk_add_f32 v[182:183], v[182:183], v[28:29]
  v_pk_add_f32 v[184:185], v[184:185], v[28:29]
  v_pk_add_f32 v[186:187], v[186:187], v[28:29]
  v_pk_add_f32 v[188:189], v[188:189], v[28:29]
  v_pk_add_f32 v[190:191], v[190:191], v[28:29]
  v_rcp_f32 v176, v176
  v_rcp_f32 v177, v177
  v_rcp_f32 v178, v178
  v_rcp_f32 v179, v179
  v_rcp_f32 v180, v180
  v_rcp_f32 v181, v181
  v_rcp_f32 v182, v182
  v_rcp_f32 v183, v183
  v_rcp_f32 v184, v184
  v_rcp_f32 v185, v185
  v_rcp_f32 v186, v186
  v_rcp_f32 v187, v187
  v_rcp_f32 v188, v188
  v_rcp_f32 v189, v189
  v_rcp_f32 v190, v190
  v_rcp_f32 v191, v191
  v_pk_mul_f32 v[160:161], v[160:161], v[176:177]
  v_pk_mul_f32 v[162:163], v[162:163], v[178:179]
  v_pk_mul_f32 v[164:165], v[164:165], v[180:181]
  v_pk_mul_f32 v[166:167], v[166:167], v[182:183]
  v_pk_mul_f32 v[168:169], v[168:169], v[184:185]
  v_pk_mul_f32 v[170:171], v[170:171], v[186:187]
  v_pk_mul_f32 v[172:173], v[172:173], v[188:189]
  v_pk_mul_f32 v[174:175], v[174:175], v[190:191]
  v_cvt_pk_bf16_f32 v104, v160, v161
  v_cvt_pk_bf16_f32 v105, v162, v163
  v_cvt_pk_bf16_f32 v106, v164, v165
  v_cvt_pk_bf16_f32 v107, v166, v167
  v_cvt_pk_bf16_f32 v108, v168, v169
  v_cvt_pk_bf16_f32 v109, v170, v171
  v_cvt_pk_bf16_f32 v110, v172, v173
  v_cvt_pk_bf16_f32 v111, v174, v175
  v_permlane32_swap_b32 v104, v106
  v_permlane32_swap_b32 v105, v107
  v_permlane32_swap_b32 v108, v110
  v_permlane32_swap_b32 v109, v111
  s_add_u32 s49, s85, 393216
  buffer_store_dwordx4 v[104:107], v26, s[28:31], s49 offen offset:0 sc1
  s_add_u32 s49, s85, 458752
  buffer_store_dwordx4 v[108:111], v26, s[28:31], s49 offen offset:0 sc1
  v_accvgpr_read_b32 v160, a64
  v_accvgpr_read_b32 v161, a65
  v_accvgpr_read_b32 v162, a66
  v_accvgpr_read_b32 v163, a67
  v_accvgpr_read_b32 v164, a68
  v_accvgpr_read_b32 v165, a69
  v_accvgpr_read_b32 v166, a70
  v_accvgpr_read_b32 v167, a71
  v_accvgpr_read_b32 v168, a72
  v_accvgpr_read_b32 v169, a73
  v_accvgpr_read_b32 v170, a74
  v_accvgpr_read_b32 v171, a75
  v_accvgpr_read_b32 v172, a76
  v_accvgpr_read_b32 v173, a77
  v_accvgpr_read_b32 v174, a78
  v_accvgpr_read_b32 v175, a79
  v_pk_add_f32 v[160:161], v[160:161], v[130:131] op_sel_hi:[1,0]
  v_pk_add_f32 v[162:163], v[162:163], v[130:131] op_sel_hi:[1,0]
  v_pk_add_f32 v[164:165], v[164:165], v[130:131] op_sel_hi:[1,0]
  v_pk_add_f32 v[166:167], v[166:167], v[130:131] op_sel_hi:[1,0]
  v_pk_add_f32 v[168:169], v[168:169], v[130:131] op_sel_hi:[1,0]
  v_pk_add_f32 v[170:171], v[170:171], v[130:131] op_sel_hi:[1,0]
  v_pk_add_f32 v[172:173], v[172:173], v[130:131] op_sel_hi:[1,0]
  v_pk_add_f32 v[174:175], v[174:175], v[130:131] op_sel_hi:[1,0]
  v_pk_mul_f32 v[176:177], v[160:161], s[62:63]
  v_pk_mul_f32 v[178:179], v[162:163], s[62:63]
  v_pk_mul_f32 v[180:181], v[164:165], s[62:63]
  v_pk_mul_f32 v[182:183], v[166:167], s[62:63]
  v_pk_mul_f32 v[184:185], v[168:169], s[62:63]
  v_pk_mul_f32 v[186:187], v[170:171], s[62:63]
  v_pk_mul_f32 v[188:189], v[172:173], s[62:63]
  v_pk_mul_f32 v[190:191], v[174:175], s[62:63]
  v_exp_f32 v176, v176
  v_exp_f32 v177, v177
  v_exp_f32 v178, v178
  v_exp_f32 v179, v179
  v_exp_f32 v180, v180
  v_exp_f32 v181, v181
  v_exp_f32 v182, v182
  v_exp_f32 v183, v183
  v_exp_f32 v184, v184
  v_exp_f32 v185, v185
  v_exp_f32 v186, v186
  v_exp_f32 v187, v187
  v_exp_f32 v188, v188
  v_exp_f32 v189, v189
  v_exp_f32 v190, v190
  v_exp_f32 v191, v191
  v_pk_add_f32 v[176:177], v[176:177], v[28:29]
  v_pk_add_f32 v[178:179], v[178:179], v[28:29]
  v_pk_add_f32 v[180:181], v[180:181], v[28:29]
  v_pk_add_f32 v[182:183], v[182:183], v[28:29]
  v_pk_add_f32 v[184:185], v[184:185], v[28:29]
  v_pk_add_f32 v[186:187], v[186:187], v[28:29]
  v_pk_add_f32 v[188:189], v[188:189], v[28:29]
  v_pk_add_f32 v[190:191], v[190:191], v[28:29]
  v_rcp_f32 v176, v176
  v_rcp_f32 v177, v177
  v_rcp_f32 v178, v178
  v_rcp_f32 v179, v179
  v_rcp_f32 v180, v180
  v_rcp_f32 v181, v181
  v_rcp_f32 v182, v182
  v_rcp_f32 v183, v183
  v_rcp_f32 v184, v184
  v_rcp_f32 v185, v185
  v_rcp_f32 v186, v186
  v_rcp_f32 v187, v187
  v_rcp_f32 v188, v188
  v_rcp_f32 v189, v189
  v_rcp_f32 v190, v190
  v_rcp_f32 v191, v191
  v_pk_mul_f32 v[160:161], v[160:161], v[176:177]
  v_pk_mul_f32 v[162:163], v[162:163], v[178:179]
  v_pk_mul_f32 v[164:165], v[164:165], v[180:181]
  v_pk_mul_f32 v[166:167], v[166:167], v[182:183]
  v_pk_mul_f32 v[168:169], v[168:169], v[184:185]
  v_pk_mul_f32 v[170:171], v[170:171], v[186:187]
  v_pk_mul_f32 v[172:173], v[172:173], v[188:189]
  v_pk_mul_f32 v[174:175], v[174:175], v[190:191]
  v_cvt_pk_bf16_f32 v96, v160, v161
  v_cvt_pk_bf16_f32 v97, v162, v163
  v_cvt_pk_bf16_f32 v98, v164, v165
  v_cvt_pk_bf16_f32 v99, v166, v167
  v_cvt_pk_bf16_f32 v100, v168, v169
  v_cvt_pk_bf16_f32 v101, v170, v171
  v_cvt_pk_bf16_f32 v102, v172, v173
  v_cvt_pk_bf16_f32 v103, v174, v175
  v_permlane32_swap_b32 v96, v98
  v_permlane32_swap_b32 v97, v99
  v_permlane32_swap_b32 v100, v102
  v_permlane32_swap_b32 v101, v103
  s_add_u32 s49, s85, 0
  buffer_store_dwordx4 v[96:99], v26, s[28:31], s49 offen offset:1024 sc1
  s_add_u32 s49, s85, 65536
  buffer_store_dwordx4 v[100:103], v26, s[28:31], s49 offen offset:1024 sc1
  v_accvgpr_read_b32 v160, a80
  v_accvgpr_read_b32 v161, a81
  v_accvgpr_read_b32 v162, a82
  v_accvgpr_read_b32 v163, a83
  v_accvgpr_read_b32 v164, a84
  v_accvgpr_read_b32 v165, a85
  v_accvgpr_read_b32 v166, a86
  v_accvgpr_read_b32 v167, a87
  v_accvgpr_read_b32 v168, a88
  v_accvgpr_read_b32 v169, a89
  v_accvgpr_read_b32 v170, a90
  v_accvgpr_read_b32 v171, a91
  v_accvgpr_read_b32 v172, a92
  v_accvgpr_read_b32 v173, a93
  v_accvgpr_read_b32 v174, a94
  v_accvgpr_read_b32 v175, a95
  v_pk_add_f32 v[160:161], v[160:161], v[130:131] op_sel_hi:[1,0]
  v_pk_add_f32 v[162:163], v[162:163], v[130:131] op_sel_hi:[1,0]
  v_pk_add_f32 v[164:165], v[164:165], v[130:131] op_sel_hi:[1,0]
  v_pk_add_f32 v[166:167], v[166:167], v[130:131] op_sel_hi:[1,0]
  v_pk_add_f32 v[168:169], v[168:169], v[130:131] op_sel_hi:[1,0]
  v_pk_add_f32 v[170:171], v[170:171], v[130:131] op_sel_hi:[1,0]
  v_pk_add_f32 v[172:173], v[172:173], v[130:131] op_sel_hi:[1,0]
  v_pk_add_f32 v[174:175], v[174:175], v[130:131] op_sel_hi:[1,0]
  v_pk_mul_f32 v[176:177], v[160:161], s[62:63]
  v_pk_mul_f32 v[178:179], v[162:163], s[62:63]
  v_pk_mul_f32 v[180:181], v[164:165], s[62:63]
  v_pk_mul_f32 v[182:183], v[166:167], s[62:63]
  v_pk_mul_f32 v[184:185], v[168:169], s[62:63]
  v_pk_mul_f32 v[186:187], v[170:171], s[62:63]
  v_pk_mul_f32 v[188:189], v[172:173], s[62:63]
  v_pk_mul_f32 v[190:191], v[174:175], s[62:63]
  v_exp_f32 v176, v176
  v_exp_f32 v177, v177
  v_exp_f32 v178, v178
  v_exp_f32 v179, v179
  v_exp_f32 v180, v180
  v_exp_f32 v181, v181
  v_exp_f32 v182, v182
  v_exp_f32 v183, v183
  v_exp_f32 v184, v184
  v_exp_f32 v185, v185
  v_exp_f32 v186, v186
  v_exp_f32 v187, v187
  v_exp_f32 v188, v188
  v_exp_f32 v189, v189
  v_exp_f32 v190, v190
  v_exp_f32 v191, v191
  v_pk_add_f32 v[176:177], v[176:177], v[28:29]
  v_pk_add_f32 v[178:179], v[178:179], v[28:29]
  v_pk_add_f32 v[180:181], v[180:181], v[28:29]
  v_pk_add_f32 v[182:183], v[182:183], v[28:29]
  v_pk_add_f32 v[184:185], v[184:185], v[28:29]
  v_pk_add_f32 v[186:187], v[186:187], v[28:29]
  v_pk_add_f32 v[188:189], v[188:189], v[28:29]
  v_pk_add_f32 v[190:191], v[190:191], v[28:29]
  v_rcp_f32 v176, v176
  v_rcp_f32 v177, v177
  v_rcp_f32 v178, v178
  v_rcp_f32 v179, v179
  v_rcp_f32 v180, v180
  v_rcp_f32 v181, v181
  v_rcp_f32 v182, v182
  v_rcp_f32 v183, v183
  v_rcp_f32 v184, v184
  v_rcp_f32 v185, v185
  v_rcp_f32 v186, v186
  v_rcp_f32 v187, v187
  v_rcp_f32 v188, v188
  v_rcp_f32 v189, v189
  v_rcp_f32 v190, v190
  v_rcp_f32 v191, v191
  v_pk_mul_f32 v[160:161], v[160:161], v[176:177]
  v_pk_mul_f32 v[162:163], v[162:163], v[178:179]
  v_pk_mul_f32 v[164:165], v[164:165], v[180:181]
  v_pk_mul_f32 v[166:167], v[166:167], v[182:183]
  v_pk_mul_f32 v[168:169], v[168:169], v[184:185]
  v_pk_mul_f32 v[170:171], v[170:171], v[186:187]
  v_pk_mul_f32 v[172:173], v[172:173], v[188:189]
  v_pk_mul_f32 v[174:175], v[174:175], v[190:191]
  v_cvt_pk_bf16_f32 v104, v160, v161
  v_cvt_pk_bf16_f32 v105, v162, v163
  v_cvt_pk_bf16_f32 v106, v164, v165
  v_cvt_pk_bf16_f32 v107, v166, v167
  v_cvt_pk_bf16_f32 v108, v168, v169
  v_cvt_pk_bf16_f32 v109, v170, v171
  v_cvt_pk_bf16_f32 v110, v172, v173
  v_cvt_pk_bf16_f32 v111, v174, v175
  v_permlane32_swap_b32 v104, v106
  v_permlane32_swap_b32 v105, v107
  v_permlane32_swap_b32 v108, v110
  v_permlane32_swap_b32 v109, v111
  s_add_u32 s49, s85, 131072
  buffer_store_dwordx4 v[104:107], v26, s[28:31], s49 offen offset:1024 sc1
  s_add_u32 s49, s85, 196608
  buffer_store_dwordx4 v[108:111], v26, s[28:31], s49 offen offset:1024 sc1
  v_accvgpr_read_b32 v160, a96
  v_accvgpr_read_b32 v161, a97
  v_accvgpr_read_b32 v162, a98
  v_accvgpr_read_b32 v163, a99
  v_accvgpr_read_b32 v164, a100
  v_accvgpr_read_b32 v165, a101
  v_accvgpr_read_b32 v166, a102
  v_accvgpr_read_b32 v167, a103
  v_accvgpr_read_b32 v168, a104
  v_accvgpr_read_b32 v169, a105
  v_accvgpr_read_b32 v170, a106
  v_accvgpr_read_b32 v171, a107
  v_accvgpr_read_b32 v172, a108
  v_accvgpr_read_b32 v173, a109
  v_accvgpr_read_b32 v174, a110
  v_accvgpr_read_b32 v175, a111
  v_pk_add_f32 v[160:161], v[160:161], v[130:131] op_sel_hi:[1,0]
  v_pk_add_f32 v[162:163], v[162:163], v[130:131] op_sel_hi:[1,0]
  v_pk_add_f32 v[164:165], v[164:165], v[130:131] op_sel_hi:[1,0]
  v_pk_add_f32 v[166:167], v[166:167], v[130:131] op_sel_hi:[1,0]
  v_pk_add_f32 v[168:169], v[168:169], v[130:131] op_sel_hi:[1,0]
  v_pk_add_f32 v[170:171], v[170:171], v[130:131] op_sel_hi:[1,0]
  v_pk_add_f32 v[172:173], v[172:173], v[130:131] op_sel_hi:[1,0]
  v_pk_add_f32 v[174:175], v[174:175], v[130:131] op_sel_hi:[1,0]
  v_pk_mul_f32 v[176:177], v[160:161], s[62:63]
  v_pk_mul_f32 v[178:179], v[162:163], s[62:63]
  v_pk_mul_f32 v[180:181], v[164:165], s[62:63]
  v_pk_mul_f32 v[182:183], v[166:167], s[62:63]
  v_pk_mul_f32 v[184:185], v[168:169], s[62:63]
  v_pk_mul_f32 v[186:187], v[170:171], s[62:63]
  v_pk_mul_f32 v[188:189], v[172:173], s[62:63]
  v_pk_mul_f32 v[190:191], v[174:175], s[62:63]
  v_exp_f32 v176, v176
  v_exp_f32 v177, v177
  v_exp_f32 v178, v178
  v_exp_f32 v179, v179
  v_exp_f32 v180, v180
  v_exp_f32 v181, v181
  v_exp_f32 v182, v182
  v_exp_f32 v183, v183
  v_exp_f32 v184, v184
  v_exp_f32 v185, v185
  v_exp_f32 v186, v186
  v_exp_f32 v187, v187
  v_exp_f32 v188, v188
  v_exp_f32 v189, v189
  v_exp_f32 v190, v190
  v_exp_f32 v191, v191
  v_pk_add_f32 v[176:177], v[176:177], v[28:29]
  v_pk_add_f32 v[178:179], v[178:179], v[28:29]
  v_pk_add_f32 v[180:181], v[180:181], v[28:29]
  v_pk_add_f32 v[182:183], v[182:183], v[28:29]
  v_pk_add_f32 v[184:185], v[184:185], v[28:29]
  v_pk_add_f32 v[186:187], v[186:187], v[28:29]
  v_pk_add_f32 v[188:189], v[188:189], v[28:29]
  v_pk_add_f32 v[190:191], v[190:191], v[28:29]
  v_rcp_f32 v176, v176
  v_rcp_f32 v177, v177
  v_rcp_f32 v178, v178
  v_rcp_f32 v179, v179
  v_rcp_f32 v180, v180
  v_rcp_f32 v181, v181
  v_rcp_f32 v182, v182
  v_rcp_f32 v183, v183
  v_rcp_f32 v184, v184
  v_rcp_f32 v185, v185
  v_rcp_f32 v186, v186
  v_rcp_f32 v187, v187
  v_rcp_f32 v188, v188
  v_rcp_f32 v189, v189
  v_rcp_f32 v190, v190
  v_rcp_f32 v191, v191
  v_pk_mul_f32 v[160:161], v[160:161], v[176:177]
  v_pk_mul_f32 v[162:163], v[162:163], v[178:179]
  v_pk_mul_f32 v[164:165], v[164:165], v[180:181]
  v_pk_mul_f32 v[166:167], v[166:167], v[182:183]
  v_pk_mul_f32 v[168:169], v[168:169], v[184:185]
  v_pk_mul_f32 v[170:171], v[170:171], v[186:187]
  v_pk_mul_f32 v[172:173], v[172:173], v[188:189]
  v_pk_mul_f32 v[174:175], v[174:175], v[190:191]
  v_cvt_pk_bf16_f32 v96, v160, v161
  v_cvt_pk_bf16_f32 v97, v162, v163
  v_cvt_pk_bf16_f32 v98, v164, v165
  v_cvt_pk_bf16_f32 v99, v166, v167
  v_cvt_pk_bf16_f32 v100, v168, v169
  v_cvt_pk_bf16_f32 v101, v170, v171
  v_cvt_pk_bf16_f32 v102, v172, v173
  v_cvt_pk_bf16_f32 v103, v174, v175
  v_permlane32_swap_b32 v96, v98
  v_permlane32_swap_b32 v97, v99
  v_permlane32_swap_b32 v100, v102
  v_permlane32_swap_b32 v101, v103
  s_add_u32 s49, s85, 262144
  buffer_store_dwordx4 v[96:99], v26, s[28:31], s49 offen offset:1024 sc1
  s_add_u32 s49, s85, 327680
  buffer_store_dwordx4 v[100:103], v26, s[28:31], s49 offen offset:1024 sc1
  v_accvgpr_read_b32 v160, a112
  v_accvgpr_read_b32 v161, a113
  v_accvgpr_read_b32 v162, a114
  v_accvgpr_read_b32 v163, a115
  v_accvgpr_read_b32 v164, a116
  v_accvgpr_read_b32 v165, a117
  v_accvgpr_read_b32 v166, a118
  v_accvgpr_read_b32 v167, a119
  v_accvgpr_read_b32 v168, a120
  v_accvgpr_read_b32 v169, a121
  v_accvgpr_read_b32 v170, a122
  v_accvgpr_read_b32 v171, a123
  v_accvgpr_read_b32 v172, a124
  v_accvgpr_read_b32 v173, a125
  v_accvgpr_read_b32 v174, a126
  v_accvgpr_read_b32 v175, a127
  v_pk_add_f32 v[160:161], v[160:161], v[130:131] op_sel_hi:[1,0]
  v_pk_add_f32 v[162:163], v[162:163], v[130:131] op_sel_hi:[1,0]
  v_pk_add_f32 v[164:165], v[164:165], v[130:131] op_sel_hi:[1,0]
  v_pk_add_f32 v[166:167], v[166:167], v[130:131] op_sel_hi:[1,0]
  v_pk_add_f32 v[168:169], v[168:169], v[130:131] op_sel_hi:[1,0]
  v_pk_add_f32 v[170:171], v[170:171], v[130:131] op_sel_hi:[1,0]
  v_pk_add_f32 v[172:173], v[172:173], v[130:131] op_sel_hi:[1,0]
  v_pk_add_f32 v[174:175], v[174:175], v[130:131] op_sel_hi:[1,0]
  v_pk_mul_f32 v[176:177], v[160:161], s[62:63]
  v_pk_mul_f32 v[178:179], v[162:163], s[62:63]
  v_pk_mul_f32 v[180:181], v[164:165], s[62:63]
  v_pk_mul_f32 v[182:183], v[166:167], s[62:63]
  v_pk_mul_f32 v[184:185], v[168:169], s[62:63]
  v_pk_mul_f32 v[186:187], v[170:171], s[62:63]
  v_pk_mul_f32 v[188:189], v[172:173], s[62:63]
  v_pk_mul_f32 v[190:191], v[174:175], s[62:63]
  v_exp_f32 v176, v176
  v_exp_f32 v177, v177
  v_exp_f32 v178, v178
  v_exp_f32 v179, v179
  v_exp_f32 v180, v180
  v_exp_f32 v181, v181
  v_exp_f32 v182, v182
  v_exp_f32 v183, v183
  v_exp_f32 v184, v184
  v_exp_f32 v185, v185
  v_exp_f32 v186, v186
  v_exp_f32 v187, v187
  v_exp_f32 v188, v188
  v_exp_f32 v189, v189
  v_exp_f32 v190, v190
  v_exp_f32 v191, v191
  v_pk_add_f32 v[176:177], v[176:177], v[28:29]
  v_pk_add_f32 v[178:179], v[178:179], v[28:29]
  v_pk_add_f32 v[180:181], v[180:181], v[28:29]
  v_pk_add_f32 v[182:183], v[182:183], v[28:29]
  v_pk_add_f32 v[184:185], v[184:185], v[28:29]
  v_pk_add_f32 v[186:187], v[186:187], v[28:29]
  v_pk_add_f32 v[188:189], v[188:189], v[28:29]
  v_pk_add_f32 v[190:191], v[190:191], v[28:29]
  v_rcp_f32 v176, v176
  v_rcp_f32 v177, v177
  v_rcp_f32 v178, v178
  v_rcp_f32 v179, v179
  v_rcp_f32 v180, v180
  v_rcp_f32 v181, v181
  v_rcp_f32 v182, v182
  v_rcp_f32 v183, v183
  v_rcp_f32 v184, v184
  v_rcp_f32 v185, v185
  v_rcp_f32 v186, v186
  v_rcp_f32 v187, v187
  v_rcp_f32 v188, v188
  v_rcp_f32 v189, v189
  v_rcp_f32 v190, v190
  v_rcp_f32 v191, v191
  v_pk_mul_f32 v[160:161], v[160:161], v[176:177]
  v_pk_mul_f32 v[162:163], v[162:163], v[178:179]
  v_pk_mul_f32 v[164:165], v[164:165], v[180:181]
  v_pk_mul_f32 v[166:167], v[166:167], v[182:183]
  v_pk_mul_f32 v[168:169], v[168:169], v[184:185]
  v_pk_mul_f32 v[170:171], v[170:171], v[186:187]
  v_pk_mul_f32 v[172:173], v[172:173], v[188:189]
  v_pk_mul_f32 v[174:175], v[174:175], v[190:191]
  v_cvt_pk_bf16_f32 v104, v160, v161
  v_cvt_pk_bf16_f32 v105, v162, v163
  v_cvt_pk_bf16_f32 v106, v164, v165
  v_cvt_pk_bf16_f32 v107, v166, v167
  v_cvt_pk_bf16_f32 v108, v168, v169
  v_cvt_pk_bf16_f32 v109, v170, v171
  v_cvt_pk_bf16_f32 v110, v172, v173
  v_cvt_pk_bf16_f32 v111, v174, v175
  v_permlane32_swap_b32 v104, v106
  v_permlane32_swap_b32 v105, v107
  v_permlane32_swap_b32 v108, v110
  v_permlane32_swap_b32 v109, v111
  s_add_u32 s49, s85, 393216
  buffer_store_dwordx4 v[104:107], v26, s[28:31], s49 offen offset:1024 sc1
  s_add_u32 s49, s85, 458752
  buffer_store_dwordx4 v[108:111], v26, s[28:31], s49 offen offset:1024 sc1
  v_accvgpr_read_b32 v160, a128
  v_accvgpr_read_b32 v161, a129
  v_accvgpr_read_b32 v162, a130
  v_accvgpr_read_b32 v163, a131
  v_accvgpr_read_b32 v164, a132
  v_accvgpr_read_b32 v165, a133
  v_accvgpr_read_b32 v166, a134
  v_accvgpr_read_b32 v167, a135
  v_accvgpr_read_b32 v168, a136
  v_accvgpr_read_b32 v169, a137
  v_accvgpr_read_b32 v170, a138
  v_accvgpr_read_b32 v171, a139
  v_accvgpr_read_b32 v172, a140
  v_accvgpr_read_b32 v173, a141
  v_accvgpr_read_b32 v174, a142
  v_accvgpr_read_b32 v175, a143
  v_pk_add_f32 v[160:161], v[160:161], v[132:133] op_sel_hi:[1,0]
  v_pk_add_f32 v[162:163], v[162:163], v[132:133] op_sel_hi:[1,0]
  v_pk_add_f32 v[164:165], v[164:165], v[132:133] op_sel_hi:[1,0]
  v_pk_add_f32 v[166:167], v[166:167], v[132:133] op_sel_hi:[1,0]
  v_pk_add_f32 v[168:169], v[168:169], v[132:133] op_sel_hi:[1,0]
  v_pk_add_f32 v[170:171], v[170:171], v[132:133] op_sel_hi:[1,0]
  v_pk_add_f32 v[172:173], v[172:173], v[132:133] op_sel_hi:[1,0]
  v_pk_add_f32 v[174:175], v[174:175], v[132:133] op_sel_hi:[1,0]
  v_pk_mul_f32 v[176:177], v[160:161], s[62:63]
  v_pk_mul_f32 v[178:179], v[162:163], s[62:63]
  v_pk_mul_f32 v[180:181], v[164:165], s[62:63]
  v_pk_mul_f32 v[182:183], v[166:167], s[62:63]
  v_pk_mul_f32 v[184:185], v[168:169], s[62:63]
  v_pk_mul_f32 v[186:187], v[170:171], s[62:63]
  v_pk_mul_f32 v[188:189], v[172:173], s[62:63]
  v_pk_mul_f32 v[190:191], v[174:175], s[62:63]
  v_exp_f32 v176, v176
  v_exp_f32 v177, v177
  v_exp_f32 v178, v178
  v_exp_f32 v179, v179
  v_exp_f32 v180, v180
  v_exp_f32 v181, v181
  v_exp_f32 v182, v182
  v_exp_f32 v183, v183
  v_exp_f32 v184, v184
  v_exp_f32 v185, v185
  v_exp_f32 v186, v186
  v_exp_f32 v187, v187
  v_exp_f32 v188, v188
  v_exp_f32 v189, v189
  v_exp_f32 v190, v190
  v_exp_f32 v191, v191
  v_pk_add_f32 v[176:177], v[176:177], v[28:29]
  v_pk_add_f32 v[178:179], v[178:179], v[28:29]
  v_pk_add_f32 v[180:181], v[180:181], v[28:29]
  v_pk_add_f32 v[182:183], v[182:183], v[28:29]
  v_pk_add_f32 v[184:185], v[184:185], v[28:29]
  v_pk_add_f32 v[186:187], v[186:187], v[28:29]
  v_pk_add_f32 v[188:189], v[188:189], v[28:29]
  v_pk_add_f32 v[190:191], v[190:191], v[28:29]
  v_rcp_f32 v176, v176
  v_rcp_f32 v177, v177
  v_rcp_f32 v178, v178
  v_rcp_f32 v179, v179
  v_rcp_f32 v180, v180
  v_rcp_f32 v181, v181
  v_rcp_f32 v182, v182
  v_rcp_f32 v183, v183
  v_rcp_f32 v184, v184
  v_rcp_f32 v185, v185
  v_rcp_f32 v186, v186
  v_rcp_f32 v187, v187
  v_rcp_f32 v188, v188
  v_rcp_f32 v189, v189
  v_rcp_f32 v190, v190
  v_rcp_f32 v191, v191
  v_pk_mul_f32 v[160:161], v[160:161], v[176:177]
  v_pk_mul_f32 v[162:163], v[162:163], v[178:179]
  v_pk_mul_f32 v[164:165], v[164:165], v[180:181]
  v_pk_mul_f32 v[166:167], v[166:167], v[182:183]
  v_pk_mul_f32 v[168:169], v[168:169], v[184:185]
  v_pk_mul_f32 v[170:171], v[170:171], v[186:187]
  v_pk_mul_f32 v[172:173], v[172:173], v[188:189]
  v_pk_mul_f32 v[174:175], v[174:175], v[190:191]
  v_cvt_pk_bf16_f32 v96, v160, v161
  v_cvt_pk_bf16_f32 v97, v162, v163
  v_cvt_pk_bf16_f32 v98, v164, v165
  v_cvt_pk_bf16_f32 v99, v166, v167
  v_cvt_pk_bf16_f32 v100, v168, v169
  v_cvt_pk_bf16_f32 v101, v170, v171
  v_cvt_pk_bf16_f32 v102, v172, v173
  v_cvt_pk_bf16_f32 v103, v174, v175
  v_permlane32_swap_b32 v96, v98
  v_permlane32_swap_b32 v97, v99
  v_permlane32_swap_b32 v100, v102
  v_permlane32_swap_b32 v101, v103
  s_add_u32 s49, s85, 0
  buffer_store_dwordx4 v[96:99], v26, s[28:31], s49 offen offset:2048 sc1
  s_add_u32 s49, s85, 65536
  buffer_store_dwordx4 v[100:103], v26, s[28:31], s49 offen offset:2048 sc1
  v_accvgpr_read_b32 v160, a144
  v_accvgpr_read_b32 v161, a145
  v_accvgpr_read_b32 v162, a146
  v_accvgpr_read_b32 v163, a147
  v_accvgpr_read_b32 v164, a148
  v_accvgpr_read_b32 v165, a149
  v_accvgpr_read_b32 v166, a150
  v_accvgpr_read_b32 v167, a151
  v_accvgpr_read_b32 v168, a152
  v_accvgpr_read_b32 v169, a153
  v_accvgpr_read_b32 v170, a154
  v_accvgpr_read_b32 v171, a155
  v_accvgpr_read_b32 v172, a156
  v_accvgpr_read_b32 v173, a157
  v_accvgpr_read_b32 v174, a158
  v_accvgpr_read_b32 v175, a159
  v_pk_add_f32 v[160:161], v[160:161], v[132:133] op_sel_hi:[1,0]
  v_pk_add_f32 v[162:163], v[162:163], v[132:133] op_sel_hi:[1,0]
  v_pk_add_f32 v[164:165], v[164:165], v[132:133] op_sel_hi:[1,0]
  v_pk_add_f32 v[166:167], v[166:167], v[132:133] op_sel_hi:[1,0]
  v_pk_add_f32 v[168:169], v[168:169], v[132:133] op_sel_hi:[1,0]
  v_pk_add_f32 v[170:171], v[170:171], v[132:133] op_sel_hi:[1,0]
  v_pk_add_f32 v[172:173], v[172:173], v[132:133] op_sel_hi:[1,0]
  v_pk_add_f32 v[174:175], v[174:175], v[132:133] op_sel_hi:[1,0]
  v_pk_mul_f32 v[176:177], v[160:161], s[62:63]
  v_pk_mul_f32 v[178:179], v[162:163], s[62:63]
  v_pk_mul_f32 v[180:181], v[164:165], s[62:63]
  v_pk_mul_f32 v[182:183], v[166:167], s[62:63]
  v_pk_mul_f32 v[184:185], v[168:169], s[62:63]
  v_pk_mul_f32 v[186:187], v[170:171], s[62:63]
  v_pk_mul_f32 v[188:189], v[172:173], s[62:63]
  v_pk_mul_f32 v[190:191], v[174:175], s[62:63]
  v_exp_f32 v176, v176
  v_exp_f32 v177, v177
  v_exp_f32 v178, v178
  v_exp_f32 v179, v179
  v_exp_f32 v180, v180
  v_exp_f32 v181, v181
  v_exp_f32 v182, v182
  v_exp_f32 v183, v183
  v_exp_f32 v184, v184
  v_exp_f32 v185, v185
  v_exp_f32 v186, v186
  v_exp_f32 v187, v187
  v_exp_f32 v188, v188
  v_exp_f32 v189, v189
  v_exp_f32 v190, v190
  v_exp_f32 v191, v191
  v_pk_add_f32 v[176:177], v[176:177], v[28:29]
  v_pk_add_f32 v[178:179], v[178:179], v[28:29]
  v_pk_add_f32 v[180:181], v[180:181], v[28:29]
  v_pk_add_f32 v[182:183], v[182:183], v[28:29]
  v_pk_add_f32 v[184:185], v[184:185], v[28:29]
  v_pk_add_f32 v[186:187], v[186:187], v[28:29]
  v_pk_add_f32 v[188:189], v[188:189], v[28:29]
  v_pk_add_f32 v[190:191], v[190:191], v[28:29]
  v_rcp_f32 v176, v176
  v_rcp_f32 v177, v177
  v_rcp_f32 v178, v178
  v_rcp_f32 v179, v179
  v_rcp_f32 v180, v180
  v_rcp_f32 v181, v181
  v_rcp_f32 v182, v182
  v_rcp_f32 v183, v183
  v_rcp_f32 v184, v184
  v_rcp_f32 v185, v185
  v_rcp_f32 v186, v186
  v_rcp_f32 v187, v187
  v_rcp_f32 v188, v188
  v_rcp_f32 v189, v189
  v_rcp_f32 v190, v190
  v_rcp_f32 v191, v191
  v_pk_mul_f32 v[160:161], v[160:161], v[176:177]
  v_pk_mul_f32 v[162:163], v[162:163], v[178:179]
  v_pk_mul_f32 v[164:165], v[164:165], v[180:181]
  v_pk_mul_f32 v[166:167], v[166:167], v[182:183]
  v_pk_mul_f32 v[168:169], v[168:169], v[184:185]
  v_pk_mul_f32 v[170:171], v[170:171], v[186:187]
  v_pk_mul_f32 v[172:173], v[172:173], v[188:189]
  v_pk_mul_f32 v[174:175], v[174:175], v[190:191]
  v_cvt_pk_bf16_f32 v104, v160, v161
  v_cvt_pk_bf16_f32 v105, v162, v163
  v_cvt_pk_bf16_f32 v106, v164, v165
  v_cvt_pk_bf16_f32 v107, v166, v167
  v_cvt_pk_bf16_f32 v108, v168, v169
  v_cvt_pk_bf16_f32 v109, v170, v171
  v_cvt_pk_bf16_f32 v110, v172, v173
  v_cvt_pk_bf16_f32 v111, v174, v175
  v_permlane32_swap_b32 v104, v106
  v_permlane32_swap_b32 v105, v107
  v_permlane32_swap_b32 v108, v110
  v_permlane32_swap_b32 v109, v111
  s_add_u32 s49, s85, 131072
  buffer_store_dwordx4 v[104:107], v26, s[28:31], s49 offen offset:2048 sc1
  s_add_u32 s49, s85, 196608
  buffer_store_dwordx4 v[108:111], v26, s[28:31], s49 offen offset:2048 sc1
  v_accvgpr_read_b32 v160, a160
  v_accvgpr_read_b32 v161, a161
  v_accvgpr_read_b32 v162, a162
  v_accvgpr_read_b32 v163, a163
  v_accvgpr_read_b32 v164, a164
  v_accvgpr_read_b32 v165, a165
  v_accvgpr_read_b32 v166, a166
  v_accvgpr_read_b32 v167, a167
  v_accvgpr_read_b32 v168, a168
  v_accvgpr_read_b32 v169, a169
  v_accvgpr_read_b32 v170, a170
  v_accvgpr_read_b32 v171, a171
  v_accvgpr_read_b32 v172, a172
  v_accvgpr_read_b32 v173, a173
  v_accvgpr_read_b32 v174, a174
  v_accvgpr_read_b32 v175, a175
  v_pk_add_f32 v[160:161], v[160:161], v[132:133] op_sel_hi:[1,0]
  v_pk_add_f32 v[162:163], v[162:163], v[132:133] op_sel_hi:[1,0]
  v_pk_add_f32 v[164:165], v[164:165], v[132:133] op_sel_hi:[1,0]
  v_pk_add_f32 v[166:167], v[166:167], v[132:133] op_sel_hi:[1,0]
  v_pk_add_f32 v[168:169], v[168:169], v[132:133] op_sel_hi:[1,0]
  v_pk_add_f32 v[170:171], v[170:171], v[132:133] op_sel_hi:[1,0]
  v_pk_add_f32 v[172:173], v[172:173], v[132:133] op_sel_hi:[1,0]
  v_pk_add_f32 v[174:175], v[174:175], v[132:133] op_sel_hi:[1,0]
  v_pk_mul_f32 v[176:177], v[160:161], s[62:63]
  v_pk_mul_f32 v[178:179], v[162:163], s[62:63]
  v_pk_mul_f32 v[180:181], v[164:165], s[62:63]
  v_pk_mul_f32 v[182:183], v[166:167], s[62:63]
  v_pk_mul_f32 v[184:185], v[168:169], s[62:63]
  v_pk_mul_f32 v[186:187], v[170:171], s[62:63]
  v_pk_mul_f32 v[188:189], v[172:173], s[62:63]
  v_pk_mul_f32 v[190:191], v[174:175], s[62:63]
  v_exp_f32 v176, v176
  v_exp_f32 v177, v177
  v_exp_f32 v178, v178
  v_exp_f32 v179, v179
  v_exp_f32 v180, v180
  v_exp_f32 v181, v181
  v_exp_f32 v182, v182
  v_exp_f32 v183, v183
  v_exp_f32 v184, v184
  v_exp_f32 v185, v185
  v_exp_f32 v186, v186
  v_exp_f32 v187, v187
  v_exp_f32 v188, v188
  v_exp_f32 v189, v189
  v_exp_f32 v190, v190
  v_exp_f32 v191, v191
  v_pk_add_f32 v[176:177], v[176:177], v[28:29]
  v_pk_add_f32 v[178:179], v[178:179], v[28:29]
  v_pk_add_f32 v[180:181], v[180:181], v[28:29]
  v_pk_add_f32 v[182:183], v[182:183], v[28:29]
  v_pk_add_f32 v[184:185], v[184:185], v[28:29]
  v_pk_add_f32 v[186:187], v[186:187], v[28:29]
  v_pk_add_f32 v[188:189], v[188:189], v[28:29]
  v_pk_add_f32 v[190:191], v[190:191], v[28:29]
  v_rcp_f32 v176, v176
  v_rcp_f32 v177, v177
  v_rcp_f32 v178, v178
  v_rcp_f32 v179, v179
  v_rcp_f32 v180, v180
  v_rcp_f32 v181, v181
  v_rcp_f32 v182, v182
  v_rcp_f32 v183, v183
  v_rcp_f32 v184, v184
  v_rcp_f32 v185, v185
  v_rcp_f32 v186, v186
  v_rcp_f32 v187, v187
  v_rcp_f32 v188, v188
  v_rcp_f32 v189, v189
  v_rcp_f32 v190, v190
  v_rcp_f32 v191, v191
  v_pk_mul_f32 v[160:161], v[160:161], v[176:177]
  v_pk_mul_f32 v[162:163], v[162:163], v[178:179]
  v_pk_mul_f32 v[164:165], v[164:165], v[180:181]
  v_pk_mul_f32 v[166:167], v[166:167], v[182:183]
  v_pk_mul_f32 v[168:169], v[168:169], v[184:185]
  v_pk_mul_f32 v[170:171], v[170:171], v[186:187]
  v_pk_mul_f32 v[172:173], v[172:173], v[188:189]
  v_pk_mul_f32 v[174:175], v[174:175], v[190:191]
  v_cvt_pk_bf16_f32 v96, v160, v161
  v_cvt_pk_bf16_f32 v97, v162, v163
  v_cvt_pk_bf16_f32 v98, v164, v165
  v_cvt_pk_bf16_f32 v99, v166, v167
  v_cvt_pk_bf16_f32 v100, v168, v169
  v_cvt_pk_bf16_f32 v101, v170, v171
  v_cvt_pk_bf16_f32 v102, v172, v173
  v_cvt_pk_bf16_f32 v103, v174, v175
  v_permlane32_swap_b32 v96, v98
  v_permlane32_swap_b32 v97, v99
  v_permlane32_swap_b32 v100, v102
  v_permlane32_swap_b32 v101, v103
  s_add_u32 s49, s85, 262144
  buffer_store_dwordx4 v[96:99], v26, s[28:31], s49 offen offset:2048 sc1
  s_add_u32 s49, s85, 327680
  buffer_store_dwordx4 v[100:103], v26, s[28:31], s49 offen offset:2048 sc1
  v_accvgpr_read_b32 v160, a176
  v_accvgpr_read_b32 v161, a177
  v_accvgpr_read_b32 v162, a178
  v_accvgpr_read_b32 v163, a179
  v_accvgpr_read_b32 v164, a180
  v_accvgpr_read_b32 v165, a181
  v_accvgpr_read_b32 v166, a182
  v_accvgpr_read_b32 v167, a183
  v_accvgpr_read_b32 v168, a184
  v_accvgpr_read_b32 v169, a185
  v_accvgpr_read_b32 v170, a186
  v_accvgpr_read_b32 v171, a187
  v_accvgpr_read_b32 v172, a188
  v_accvgpr_read_b32 v173, a189
  v_accvgpr_read_b32 v174, a190
  v_accvgpr_read_b32 v175, a191
  v_pk_add_f32 v[160:161], v[160:161], v[132:133] op_sel_hi:[1,0]
  v_pk_add_f32 v[162:163], v[162:163], v[132:133] op_sel_hi:[1,0]
  v_pk_add_f32 v[164:165], v[164:165], v[132:133] op_sel_hi:[1,0]
  v_pk_add_f32 v[166:167], v[166:167], v[132:133] op_sel_hi:[1,0]
  v_pk_add_f32 v[168:169], v[168:169], v[132:133] op_sel_hi:[1,0]
  v_pk_add_f32 v[170:171], v[170:171], v[132:133] op_sel_hi:[1,0]
  v_pk_add_f32 v[172:173], v[172:173], v[132:133] op_sel_hi:[1,0]
  v_pk_add_f32 v[174:175], v[174:175], v[132:133] op_sel_hi:[1,0]
  v_pk_mul_f32 v[176:177], v[160:161], s[62:63]
  v_pk_mul_f32 v[178:179], v[162:163], s[62:63]
  v_pk_mul_f32 v[180:181], v[164:165], s[62:63]
  v_pk_mul_f32 v[182:183], v[166:167], s[62:63]
  v_pk_mul_f32 v[184:185], v[168:169], s[62:63]
  v_pk_mul_f32 v[186:187], v[170:171], s[62:63]
  v_pk_mul_f32 v[188:189], v[172:173], s[62:63]
  v_pk_mul_f32 v[190:191], v[174:175], s[62:63]
  v_exp_f32 v176, v176
  v_exp_f32 v177, v177
  v_exp_f32 v178, v178
  v_exp_f32 v179, v179
  v_exp_f32 v180, v180
  v_exp_f32 v181, v181
  v_exp_f32 v182, v182
  v_exp_f32 v183, v183
  v_exp_f32 v184, v184
  v_exp_f32 v185, v185
  v_exp_f32 v186, v186
  v_exp_f32 v187, v187
  v_exp_f32 v188, v188
  v_exp_f32 v189, v189
  v_exp_f32 v190, v190
  v_exp_f32 v191, v191
  v_pk_add_f32 v[176:177], v[176:177], v[28:29]
  v_pk_add_f32 v[178:179], v[178:179], v[28:29]
  v_pk_add_f32 v[180:181], v[180:181], v[28:29]
  v_pk_add_f32 v[182:183], v[182:183], v[28:29]
  v_pk_add_f32 v[184:185], v[184:185], v[28:29]
  v_pk_add_f32 v[186:187], v[186:187], v[28:29]
  v_pk_add_f32 v[188:189], v[188:189], v[28:29]
  v_pk_add_f32 v[190:191], v[190:191], v[28:29]
  v_rcp_f32 v176, v176
  v_rcp_f32 v177, v177
  v_rcp_f32 v178, v178
  v_rcp_f32 v179, v179
  v_rcp_f32 v180, v180
  v_rcp_f32 v181, v181
  v_rcp_f32 v182, v182
  v_rcp_f32 v183, v183
  v_rcp_f32 v184, v184
  v_rcp_f32 v185, v185
  v_rcp_f32 v186, v186
  v_rcp_f32 v187, v187
  v_rcp_f32 v188, v188
  v_rcp_f32 v189, v189
  v_rcp_f32 v190, v190
  v_rcp_f32 v191, v191
  v_pk_mul_f32 v[160:161], v[160:161], v[176:177]
  v_pk_mul_f32 v[162:163], v[162:163], v[178:179]
  v_pk_mul_f32 v[164:165], v[164:165], v[180:181]
  v_pk_mul_f32 v[166:167], v[166:167], v[182:183]
  v_pk_mul_f32 v[168:169], v[168:169], v[184:185]
  v_pk_mul_f32 v[170:171], v[170:171], v[186:187]
  v_pk_mul_f32 v[172:173], v[172:173], v[188:189]
  v_pk_mul_f32 v[174:175], v[174:175], v[190:191]
  v_cvt_pk_bf16_f32 v104, v160, v161
  v_cvt_pk_bf16_f32 v105, v162, v163
  v_cvt_pk_bf16_f32 v106, v164, v165
  v_cvt_pk_bf16_f32 v107, v166, v167
  v_cvt_pk_bf16_f32 v108, v168, v169
  v_cvt_pk_bf16_f32 v109, v170, v171
  v_cvt_pk_bf16_f32 v110, v172, v173
  v_cvt_pk_bf16_f32 v111, v174, v175
  v_permlane32_swap_b32 v104, v106
  v_permlane32_swap_b32 v105, v107
  v_permlane32_swap_b32 v108, v110
  v_permlane32_swap_b32 v109, v111
  s_add_u32 s49, s85, 393216
  buffer_store_dwordx4 v[104:107], v26, s[28:31], s49 offen offset:2048 sc1
  s_add_u32 s49, s85, 458752
  buffer_store_dwordx4 v[108:111], v26, s[28:31], s49 offen offset:2048 sc1
  v_accvgpr_read_b32 v160, a192
  v_accvgpr_read_b32 v161, a193
  v_accvgpr_read_b32 v162, a194
  v_accvgpr_read_b32 v163, a195
  v_accvgpr_read_b32 v164, a196
  v_accvgpr_read_b32 v165, a197
  v_accvgpr_read_b32 v166, a198
  v_accvgpr_read_b32 v167, a199
  v_accvgpr_read_b32 v168, a200
  v_accvgpr_read_b32 v169, a201
  v_accvgpr_read_b32 v170, a202
  v_accvgpr_read_b32 v171, a203
  v_accvgpr_read_b32 v172, a204
  v_accvgpr_read_b32 v173, a205
  v_accvgpr_read_b32 v174, a206
  v_accvgpr_read_b32 v175, a207
  v_pk_add_f32 v[160:161], v[160:161], v[134:135] op_sel_hi:[1,0]
  v_pk_add_f32 v[162:163], v[162:163], v[134:135] op_sel_hi:[1,0]
  v_pk_add_f32 v[164:165], v[164:165], v[134:135] op_sel_hi:[1,0]
  v_pk_add_f32 v[166:167], v[166:167], v[134:135] op_sel_hi:[1,0]
  v_pk_add_f32 v[168:169], v[168:169], v[134:135] op_sel_hi:[1,0]
  v_pk_add_f32 v[170:171], v[170:171], v[134:135] op_sel_hi:[1,0]
  v_pk_add_f32 v[172:173], v[172:173], v[134:135] op_sel_hi:[1,0]
  v_pk_add_f32 v[174:175], v[174:175], v[134:135] op_sel_hi:[1,0]
  v_pk_mul_f32 v[176:177], v[160:161], s[62:63]
  v_pk_mul_f32 v[178:179], v[162:163], s[62:63]
  v_pk_mul_f32 v[180:181], v[164:165], s[62:63]
  v_pk_mul_f32 v[182:183], v[166:167], s[62:63]
  v_pk_mul_f32 v[184:185], v[168:169], s[62:63]
  v_pk_mul_f32 v[186:187], v[170:171], s[62:63]
  v_pk_mul_f32 v[188:189], v[172:173], s[62:63]
  v_pk_mul_f32 v[190:191], v[174:175], s[62:63]
  v_exp_f32 v176, v176
  v_exp_f32 v177, v177
  v_exp_f32 v178, v178
  v_exp_f32 v179, v179
  v_exp_f32 v180, v180
  v_exp_f32 v181, v181
  v_exp_f32 v182, v182
  v_exp_f32 v183, v183
  v_exp_f32 v184, v184
  v_exp_f32 v185, v185
  v_exp_f32 v186, v186
  v_exp_f32 v187, v187
  v_exp_f32 v188, v188
  v_exp_f32 v189, v189
  v_exp_f32 v190, v190
  v_exp_f32 v191, v191
  v_pk_add_f32 v[176:177], v[176:177], v[28:29]
  v_pk_add_f32 v[178:179], v[178:179], v[28:29]
  v_pk_add_f32 v[180:181], v[180:181], v[28:29]
  v_pk_add_f32 v[182:183], v[182:183], v[28:29]
  v_pk_add_f32 v[184:185], v[184:185], v[28:29]
  v_pk_add_f32 v[186:187], v[186:187], v[28:29]
  v_pk_add_f32 v[188:189], v[188:189], v[28:29]
  v_pk_add_f32 v[190:191], v[190:191], v[28:29]
  v_rcp_f32 v176, v176
  v_rcp_f32 v177, v177
  v_rcp_f32 v178, v178
  v_rcp_f32 v179, v179
  v_rcp_f32 v180, v180
  v_rcp_f32 v181, v181
  v_rcp_f32 v182, v182
  v_rcp_f32 v183, v183
  v_rcp_f32 v184, v184
  v_rcp_f32 v185, v185
  v_rcp_f32 v186, v186
  v_rcp_f32 v187, v187
  v_rcp_f32 v188, v188
  v_rcp_f32 v189, v189
  v_rcp_f32 v190, v190
  v_rcp_f32 v191, v191
  v_pk_mul_f32 v[160:161], v[160:161], v[176:177]
  v_pk_mul_f32 v[162:163], v[162:163], v[178:179]
  v_pk_mul_f32 v[164:165], v[164:165], v[180:181]
  v_pk_mul_f32 v[166:167], v[166:167], v[182:183]
  v_pk_mul_f32 v[168:169], v[168:169], v[184:185]
  v_pk_mul_f32 v[170:171], v[170:171], v[186:187]
  v_pk_mul_f32 v[172:173], v[172:173], v[188:189]
  v_pk_mul_f32 v[174:175], v[174:175], v[190:191]
  v_cvt_pk_bf16_f32 v96, v160, v161
  v_cvt_pk_bf16_f32 v97, v162, v163
  v_cvt_pk_bf16_f32 v98, v164, v165
  v_cvt_pk_bf16_f32 v99, v166, v167
  v_cvt_pk_bf16_f32 v100, v168, v169
  v_cvt_pk_bf16_f32 v101, v170, v171
  v_cvt_pk_bf16_f32 v102, v172, v173
  v_cvt_pk_bf16_f32 v103, v174, v175
  v_permlane32_swap_b32 v96, v98
  v_permlane32_swap_b32 v97, v99
  v_permlane32_swap_b32 v100, v102
  v_permlane32_swap_b32 v101, v103
  s_add_u32 s49, s85, 0
  buffer_store_dwordx4 v[96:99], v26, s[28:31], s49 offen offset:3072 sc1
  s_add_u32 s49, s85, 65536
  buffer_store_dwordx4 v[100:103], v26, s[28:31], s49 offen offset:3072 sc1
  v_accvgpr_read_b32 v160, a208
  v_accvgpr_read_b32 v161, a209
  v_accvgpr_read_b32 v162, a210
  v_accvgpr_read_b32 v163, a211
  v_accvgpr_read_b32 v164, a212
  v_accvgpr_read_b32 v165, a213
  v_accvgpr_read_b32 v166, a214
  v_accvgpr_read_b32 v167, a215
  v_accvgpr_read_b32 v168, a216
  v_accvgpr_read_b32 v169, a217
  v_accvgpr_read_b32 v170, a218
  v_accvgpr_read_b32 v171, a219
  v_accvgpr_read_b32 v172, a220
  v_accvgpr_read_b32 v173, a221
  v_accvgpr_read_b32 v174, a222
  v_accvgpr_read_b32 v175, a223
  v_pk_add_f32 v[160:161], v[160:161], v[134:135] op_sel_hi:[1,0]
  v_pk_add_f32 v[162:163], v[162:163], v[134:135] op_sel_hi:[1,0]
  v_pk_add_f32 v[164:165], v[164:165], v[134:135] op_sel_hi:[1,0]
  v_pk_add_f32 v[166:167], v[166:167], v[134:135] op_sel_hi:[1,0]
  v_pk_add_f32 v[168:169], v[168:169], v[134:135] op_sel_hi:[1,0]
  v_pk_add_f32 v[170:171], v[170:171], v[134:135] op_sel_hi:[1,0]
  v_pk_add_f32 v[172:173], v[172:173], v[134:135] op_sel_hi:[1,0]
  v_pk_add_f32 v[174:175], v[174:175], v[134:135] op_sel_hi:[1,0]
  v_pk_mul_f32 v[176:177], v[160:161], s[62:63]
  v_pk_mul_f32 v[178:179], v[162:163], s[62:63]
  v_pk_mul_f32 v[180:181], v[164:165], s[62:63]
  v_pk_mul_f32 v[182:183], v[166:167], s[62:63]
  v_pk_mul_f32 v[184:185], v[168:169], s[62:63]
  v_pk_mul_f32 v[186:187], v[170:171], s[62:63]
  v_pk_mul_f32 v[188:189], v[172:173], s[62:63]
  v_pk_mul_f32 v[190:191], v[174:175], s[62:63]
  v_exp_f32 v176, v176
  v_exp_f32 v177, v177
  v_exp_f32 v178, v178
  v_exp_f32 v179, v179
  v_exp_f32 v180, v180
  v_exp_f32 v181, v181
  v_exp_f32 v182, v182
  v_exp_f32 v183, v183
  v_exp_f32 v184, v184
  v_exp_f32 v185, v185
  v_exp_f32 v186, v186
  v_exp_f32 v187, v187
  v_exp_f32 v188, v188
  v_exp_f32 v189, v189
  v_exp_f32 v190, v190
  v_exp_f32 v191, v191
  v_pk_add_f32 v[176:177], v[176:177], v[28:29]
  v_pk_add_f32 v[178:179], v[178:179], v[28:29]
  v_pk_add_f32 v[180:181], v[180:181], v[28:29]
  v_pk_add_f32 v[182:183], v[182:183], v[28:29]
  v_pk_add_f32 v[184:185], v[184:185], v[28:29]
  v_pk_add_f32 v[186:187], v[186:187], v[28:29]
  v_pk_add_f32 v[188:189], v[188:189], v[28:29]
  v_pk_add_f32 v[190:191], v[190:191], v[28:29]
  v_rcp_f32 v176, v176
  v_rcp_f32 v177, v177
  v_rcp_f32 v178, v178
  v_rcp_f32 v179, v179
  v_rcp_f32 v180, v180
  v_rcp_f32 v181, v181
  v_rcp_f32 v182, v182
  v_rcp_f32 v183, v183
  v_rcp_f32 v184, v184
  v_rcp_f32 v185, v185
  v_rcp_f32 v186, v186
  v_rcp_f32 v187, v187
  v_rcp_f32 v188, v188
  v_rcp_f32 v189, v189
  v_rcp_f32 v190, v190
  v_rcp_f32 v191, v191
  v_pk_mul_f32 v[160:161], v[160:161], v[176:177]
  v_pk_mul_f32 v[162:163], v[162:163], v[178:179]
  v_pk_mul_f32 v[164:165], v[164:165], v[180:181]
  v_pk_mul_f32 v[166:167], v[166:167], v[182:183]
  v_pk_mul_f32 v[168:169], v[168:169], v[184:185]
  v_pk_mul_f32 v[170:171], v[170:171], v[186:187]
  v_pk_mul_f32 v[172:173], v[172:173], v[188:189]
  v_pk_mul_f32 v[174:175], v[174:175], v[190:191]
  v_cvt_pk_bf16_f32 v104, v160, v161
  v_cvt_pk_bf16_f32 v105, v162, v163
  v_cvt_pk_bf16_f32 v106, v164, v165
  v_cvt_pk_bf16_f32 v107, v166, v167
  v_cvt_pk_bf16_f32 v108, v168, v169
  v_cvt_pk_bf16_f32 v109, v170, v171
  v_cvt_pk_bf16_f32 v110, v172, v173
  v_cvt_pk_bf16_f32 v111, v174, v175
  v_permlane32_swap_b32 v104, v106
  v_permlane32_swap_b32 v105, v107
  v_permlane32_swap_b32 v108, v110
  v_permlane32_swap_b32 v109, v111
  s_add_u32 s49, s85, 131072
  buffer_store_dwordx4 v[104:107], v26, s[28:31], s49 offen offset:3072 sc1
  s_add_u32 s49, s85, 196608
  buffer_store_dwordx4 v[108:111], v26, s[28:31], s49 offen offset:3072 sc1
  v_accvgpr_read_b32 v160, a224
  v_accvgpr_read_b32 v161, a225
  v_accvgpr_read_b32 v162, a226
  v_accvgpr_read_b32 v163, a227
  v_accvgpr_read_b32 v164, a228
  v_accvgpr_read_b32 v165, a229
  v_accvgpr_read_b32 v166, a230
  v_accvgpr_read_b32 v167, a231
  v_accvgpr_read_b32 v168, a232
  v_accvgpr_read_b32 v169, a233
  v_accvgpr_read_b32 v170, a234
  v_accvgpr_read_b32 v171, a235
  v_accvgpr_read_b32 v172, a236
  v_accvgpr_read_b32 v173, a237
  v_accvgpr_read_b32 v174, a238
  v_accvgpr_read_b32 v175, a239
  v_pk_add_f32 v[160:161], v[160:161], v[134:135] op_sel_hi:[1,0]
  v_pk_add_f32 v[162:163], v[162:163], v[134:135] op_sel_hi:[1,0]
  v_pk_add_f32 v[164:165], v[164:165], v[134:135] op_sel_hi:[1,0]
  v_pk_add_f32 v[166:167], v[166:167], v[134:135] op_sel_hi:[1,0]
  v_pk_add_f32 v[168:169], v[168:169], v[134:135] op_sel_hi:[1,0]
  v_pk_add_f32 v[170:171], v[170:171], v[134:135] op_sel_hi:[1,0]
  v_pk_add_f32 v[172:173], v[172:173], v[134:135] op_sel_hi:[1,0]
  v_pk_add_f32 v[174:175], v[174:175], v[134:135] op_sel_hi:[1,0]
  v_pk_mul_f32 v[176:177], v[160:161], s[62:63]
  v_pk_mul_f32 v[178:179], v[162:163], s[62:63]
  v_pk_mul_f32 v[180:181], v[164:165], s[62:63]
  v_pk_mul_f32 v[182:183], v[166:167], s[62:63]
  v_pk_mul_f32 v[184:185], v[168:169], s[62:63]
  v_pk_mul_f32 v[186:187], v[170:171], s[62:63]
  v_pk_mul_f32 v[188:189], v[172:173], s[62:63]
  v_pk_mul_f32 v[190:191], v[174:175], s[62:63]
  v_exp_f32 v176, v176
  v_exp_f32 v177, v177
  v_exp_f32 v178, v178
  v_exp_f32 v179, v179
  v_exp_f32 v180, v180
  v_exp_f32 v181, v181
  v_exp_f32 v182, v182
  v_exp_f32 v183, v183
  v_exp_f32 v184, v184
  v_exp_f32 v185, v185
  v_exp_f32 v186, v186
  v_exp_f32 v187, v187
  v_exp_f32 v188, v188
  v_exp_f32 v189, v189
  v_exp_f32 v190, v190
  v_exp_f32 v191, v191
  v_pk_add_f32 v[176:177], v[176:177], v[28:29]
  v_pk_add_f32 v[178:179], v[178:179], v[28:29]
  v_pk_add_f32 v[180:181], v[180:181], v[28:29]
  v_pk_add_f32 v[182:183], v[182:183], v[28:29]
  v_pk_add_f32 v[184:185], v[184:185], v[28:29]
  v_pk_add_f32 v[186:187], v[186:187], v[28:29]
  v_pk_add_f32 v[188:189], v[188:189], v[28:29]
  v_pk_add_f32 v[190:191], v[190:191], v[28:29]
  v_rcp_f32 v176, v176
  v_rcp_f32 v177, v177
  v_rcp_f32 v178, v178
  v_rcp_f32 v179, v179
  v_rcp_f32 v180, v180
  v_rcp_f32 v181, v181
  v_rcp_f32 v182, v182
  v_rcp_f32 v183, v183
  v_rcp_f32 v184, v184
  v_rcp_f32 v185, v185
  v_rcp_f32 v186, v186
  v_rcp_f32 v187, v187
  v_rcp_f32 v188, v188
  v_rcp_f32 v189, v189
  v_rcp_f32 v190, v190
  v_rcp_f32 v191, v191
  v_pk_mul_f32 v[160:161], v[160:161], v[176:177]
  v_pk_mul_f32 v[162:163], v[162:163], v[178:179]
  v_pk_mul_f32 v[164:165], v[164:165], v[180:181]
  v_pk_mul_f32 v[166:167], v[166:167], v[182:183]
  v_pk_mul_f32 v[168:169], v[168:169], v[184:185]
  v_pk_mul_f32 v[170:171], v[170:171], v[186:187]
  v_pk_mul_f32 v[172:173], v[172:173], v[188:189]
  v_pk_mul_f32 v[174:175], v[174:175], v[190:191]
  v_cvt_pk_bf16_f32 v96, v160, v161
  v_cvt_pk_bf16_f32 v97, v162, v163
  v_cvt_pk_bf16_f32 v98, v164, v165
  v_cvt_pk_bf16_f32 v99, v166, v167
  v_cvt_pk_bf16_f32 v100, v168, v169
  v_cvt_pk_bf16_f32 v101, v170, v171
  v_cvt_pk_bf16_f32 v102, v172, v173
  v_cvt_pk_bf16_f32 v103, v174, v175
  v_permlane32_swap_b32 v96, v98
  v_permlane32_swap_b32 v97, v99
  v_permlane32_swap_b32 v100, v102
  v_permlane32_swap_b32 v101, v103
  s_add_u32 s49, s85, 262144
  buffer_store_dwordx4 v[96:99], v26, s[28:31], s49 offen offset:3072 sc1
  s_add_u32 s49, s85, 327680
  buffer_store_dwordx4 v[100:103], v26, s[28:31], s49 offen offset:3072 sc1
  v_accvgpr_read_b32 v160, a240
  v_accvgpr_read_b32 v161, a241
  v_accvgpr_read_b32 v162, a242
  v_accvgpr_read_b32 v163, a243
  v_accvgpr_read_b32 v164, a244
  v_accvgpr_read_b32 v165, a245
  v_accvgpr_read_b32 v166, a246
  v_accvgpr_read_b32 v167, a247
  v_accvgpr_read_b32 v168, a248
  v_accvgpr_read_b32 v169, a249
  v_accvgpr_read_b32 v170, a250
  v_accvgpr_read_b32 v171, a251
  v_accvgpr_read_b32 v172, a252
  v_accvgpr_read_b32 v173, a253
  v_accvgpr_read_b32 v174, a254
  v_accvgpr_read_b32 v175, a255
  v_pk_add_f32 v[160:161], v[160:161], v[134:135] op_sel_hi:[1,0]
  v_pk_add_f32 v[162:163], v[162:163], v[134:135] op_sel_hi:[1,0]
  v_pk_add_f32 v[164:165], v[164:165], v[134:135] op_sel_hi:[1,0]
  v_pk_add_f32 v[166:167], v[166:167], v[134:135] op_sel_hi:[1,0]
  v_pk_add_f32 v[168:169], v[168:169], v[134:135] op_sel_hi:[1,0]
  v_pk_add_f32 v[170:171], v[170:171], v[134:135] op_sel_hi:[1,0]
  v_pk_add_f32 v[172:173], v[172:173], v[134:135] op_sel_hi:[1,0]
  v_pk_add_f32 v[174:175], v[174:175], v[134:135] op_sel_hi:[1,0]
  v_pk_mul_f32 v[176:177], v[160:161], s[62:63]
  v_pk_mul_f32 v[178:179], v[162:163], s[62:63]
  v_pk_mul_f32 v[180:181], v[164:165], s[62:63]
  v_pk_mul_f32 v[182:183], v[166:167], s[62:63]
  v_pk_mul_f32 v[184:185], v[168:169], s[62:63]
  v_pk_mul_f32 v[186:187], v[170:171], s[62:63]
  v_pk_mul_f32 v[188:189], v[172:173], s[62:63]
  v_pk_mul_f32 v[190:191], v[174:175], s[62:63]
  v_exp_f32 v176, v176
  v_exp_f32 v177, v177
  v_exp_f32 v178, v178
  v_exp_f32 v179, v179
  v_exp_f32 v180, v180
  v_exp_f32 v181, v181
  v_exp_f32 v182, v182
  v_exp_f32 v183, v183
  v_exp_f32 v184, v184
  v_exp_f32 v185, v185
  v_exp_f32 v186, v186
  v_exp_f32 v187, v187
  v_exp_f32 v188, v188
  v_exp_f32 v189, v189
  v_exp_f32 v190, v190
  v_exp_f32 v191, v191
  v_pk_add_f32 v[176:177], v[176:177], v[28:29]
  v_pk_add_f32 v[178:179], v[178:179], v[28:29]
  v_pk_add_f32 v[180:181], v[180:181], v[28:29]
  v_pk_add_f32 v[182:183], v[182:183], v[28:29]
  v_pk_add_f32 v[184:185], v[184:185], v[28:29]
  v_pk_add_f32 v[186:187], v[186:187], v[28:29]
  v_pk_add_f32 v[188:189], v[188:189], v[28:29]
  v_pk_add_f32 v[190:191], v[190:191], v[28:29]
  v_rcp_f32 v176, v176
  v_rcp_f32 v177, v177
  v_rcp_f32 v178, v178
  v_rcp_f32 v179, v179
  v_rcp_f32 v180, v180
  v_rcp_f32 v181, v181
  v_rcp_f32 v182, v182
  v_rcp_f32 v183, v183
  v_rcp_f32 v184, v184
  v_rcp_f32 v185, v185
  v_rcp_f32 v186, v186
  v_rcp_f32 v187, v187
  v_rcp_f32 v188, v188
  v_rcp_f32 v189, v189
  v_rcp_f32 v190, v190
  v_rcp_f32 v191, v191
  v_pk_mul_f32 v[160:161], v[160:161], v[176:177]
  v_pk_mul_f32 v[162:163], v[162:163], v[178:179]
  v_pk_mul_f32 v[164:165], v[164:165], v[180:181]
  v_pk_mul_f32 v[166:167], v[166:167], v[182:183]
  v_pk_mul_f32 v[168:169], v[168:169], v[184:185]
  v_pk_mul_f32 v[170:171], v[170:171], v[186:187]
  v_pk_mul_f32 v[172:173], v[172:173], v[188:189]
  v_pk_mul_f32 v[174:175], v[174:175], v[190:191]
  v_cvt_pk_bf16_f32 v104, v160, v161
  v_cvt_pk_bf16_f32 v105, v162, v163
  v_cvt_pk_bf16_f32 v106, v164, v165
  v_cvt_pk_bf16_f32 v107, v166, v167
  v_cvt_pk_bf16_f32 v108, v168, v169
  v_cvt_pk_bf16_f32 v109, v170, v171
  v_cvt_pk_bf16_f32 v110, v172, v173
  v_cvt_pk_bf16_f32 v111, v174, v175
  v_permlane32_swap_b32 v104, v106
  v_permlane32_swap_b32 v105, v107
  v_permlane32_swap_b32 v108, v110
  v_permlane32_swap_b32 v109, v111
  s_add_u32 s49, s85, 393216
  buffer_store_dwordx4 v[104:107], v26, s[28:31], s49 offen offset:3072 sc1
  s_add_u32 s49, s85, 458752
  buffer_store_dwordx4 v[108:111], v26, s[28:31], s49 offen offset:3072 sc1
  s_add_u32 s86, s83, 40
  s_waitcnt vmcnt(0)
  s_barrier
  s_cmp_lg_u32 s58, 0
  s_cbranch_scc1 sg_69
  v_mov_b32 v26, 1
  s_mov_b64 exec, 1
  s_lshl_b32 s61, s86, 7
  s_add_u32 s61, s61, 99614720
  buffer_atomic_add v26, v255, s[28:31], s61 offen sc1
  s_mov_b64 exec, -1
sg_69:
  s_nop 0
  s_branch w_next
w_att:
  s_add_u32 s86, s82, 0
  s_lshl_b32 s61, s86, 7
  s_add_u32 s61, s61, 99614720
  s_cmp_lg_u32 s58, 0
  s_cbranch_scc1 wf_70_ok
wf_70:
  buffer_load_dword v26, v255, s[28:31], s61 offen sc1
  s_waitcnt vmcnt(0)
  v_readfirstlane_b32 s62, v26
  s_nop 3
  s_cmp_ge_u32 s62, 64
  s_cbranch_scc1 wf_70_ok
  s_sub_u32 s88, s88, 1
  s_cselect_b32 s88, 0, s88
  s_cbranch_scc1 wf_70_ok
  s_sleep 3
  s_branch wf_70
wf_70_ok:
  s_barrier
  s_nop 0
  s_add_u32 s86, s82, 16
  s_lshl_b32 s61, s86, 7
  s_add_u32 s61, s61, 99614720
  s_cmp_lg_u32 s58, 0
  s_cbranch_scc1 wf_71_ok
wf_71:
  buffer_load_dword v26, v255, s[28:31], s61 offen sc1
  s_waitcnt vmcnt(0)
  v_readfirstlane_b32 s62, v26
  s_nop 3
  s_cmp_ge_u32 s62, 16
  s_cbranch_scc1 wf_71_ok
  s_sub_u32 s88, s88, 1
  s_cselect_b32 s88, 0, s88
  s_cbranch_scc1 wf_71_ok
  s_sleep 3
  s_branch wf_71
wf_71_ok:
  s_barrier
  s_nop 0
  s_lshl_b32 s85, s82, 2
  s_add_u32 s85, s85, s84
  s_cmp_eq_u32 s81, 4
  s_cselect_b32 s89, 4, 1
  s_add_u32 s87, s85, s89
  s_sub_u32 s87, s87, 1
  s_lshl_b32 s86, s83, 6
  s_add_u32 s86, s86, s87
  s_add_u32 s86, s86, 448
  v_lshlrev_b32 v2, 4, v1
  v_add_u32 v3, 4096, v2
  s_lshl_b32 s72, s83, 2
  s_add_u32 s72, s72, s58
  s_lshl_b32 s73, s85, 5
  s_add_u32 s73, s73, s72
  s_lshl_b32 s73, s73, 13
  s_add_u32 s64, s73, 8388608
  s_add_u32 s65, s73, 25165824
  s_add_u32 s66, s73, 41943040
  s_lshl_b32 s73, s85, 5
  s_add_u32 s73, s73, s72
  s_lshl_b32 s73, s73, 12
  s_add_u32 s67, s73, 88080384
  s_lshl_b32 s73, s85, 11
  s_lshl_b32 s72, s72, 19
  s_add_u32 s68, s73, s72
  s_add_u32 s68, s68, 71303168
  s_lshl_b32 s74, s58, 15
  s_mov_b32 s70, 0x3e0293ee
  s_mov_b32 s71, s70
  v_lshrrev_b32 v4, 4, v1
  v_lshlrev_b32 v4, 2, v4
  v_bfe_u32 v5, v1, 2, 2
  v_add_u32 v4, v4, v5
  v_lshlrev_b32 v6, 4, v4
  v_bfe_u32 v5, v1, 1, 1
  v_lshl_add_u32 v6, v5, 8, v6
  v_and_b32 v5, 1, v1
  v_lshl_add_u32 v6, v5, 3, v6
  v_add_u32 v6, s74, v6
  v_and_b32 v4, 7, v4
  v_lshlrev_b32 v7, 8, v4
  v_and_b32 v5, 3, v1
  v_lshl_add_u32 v7, v5, 3, v7
  v_add_u32 v7, s74, v7
  v_add_u32 v7, 8192, v7
  v_and_b32 v4, 15, v1
  v_lshlrev_b32 v8, 6, v4
  v_bfe_u32 v5, v1, 4, 1
  v_lshl_add_u32 v8, v5, 5, v8
  v_lshrrev_b32 v5, 5, v1
  v_lshl_add_u32 v8, v5, 4, v8
  v_mov_b32 v218, 0xff800000
  v_cmp_gt_u32 vcc, 32, v1
  s_nop 1
  v_cndmask_b32_e64 v12, v218, 0, vcc
  v_mov_b32 v13, v12
  v_mov_b32 v14, v12
  v_mov_b32 v15, v12
  v_lshrrev_b32 v5, 4, v1
  v_lshlrev_b32 v5, 2, v5
  v_add_u32 v219, 0, v5
  v_cmp_le_u32 vcc, v219, v4
  s_nop 1
  v_cndmask_b32_e64 v16, v218, 0, vcc
  v_add_u32 v219, 1, v5
  v_cmp_le_u32 vcc, v219, v4
  s_nop 1
  v_cndmask_b32_e64 v17, v218, 0, vcc
  v_add_u32 v219, 2, v5
  v_cmp_le_u32 vcc, v219, v4
  s_nop 1
  v_cndmask_b32_e64 v18, v218, 0, vcc
  v_add_u32 v219, 3, v5
  v_cmp_le_u32 vcc, v219, v4
  s_nop 1
  v_cndmask_b32_e64 v19, v218, 0, vcc
  s_mov_b32 s69, s89
  s_add_u32 m0, s74, 0
  s_nop 0
  buffer_load_dwordx4 v2, s[28:31], s66 offen offset:0 sc1 lds
  buffer_load_dwordx4 v2, s[28:31], s66 offen offset:1024 sc1 lds
  buffer_load_dwordx4 v2, s[28:31], s66 offen offset:2048 sc1 lds
  buffer_load_dwordx4 v2, s[28:31], s66 offen offset:3072 sc1 lds
  s_add_u32 m0, s74, 4096
  s_nop 0
  buffer_load_dwordx4 v3, s[28:31], s66 offen offset:0 sc1 lds
  buffer_load_dwordx4 v3, s[28:31], s66 offen offset:1024 sc1 lds
  buffer_load_dwordx4 v3, s[28:31], s66 offen offset:2048 sc1 lds
  buffer_load_dwordx4 v3, s[28:31], s66 offen offset:3072 sc1 lds
  buffer_load_dwordx4 v[56:59], v2, s[28:31], s65 offen offset:0 sc1
  buffer_load_dwordx4 v[60:63], v2, s[28:31], s65 offen offset:1024 sc1
  buffer_load_dwordx4 v[64:67], v2, s[28:31], s65 offen offset:2048 sc1
  buffer_load_dwordx4 v[68:71], v2, s[28:31], s65 offen offset:3072 sc1
  buffer_load_dwordx4 v[72:75], v3, s[28:31], s65 offen offset:0 sc1
  buffer_load_dwordx4 v[76:79], v3, s[28:31], s65 offen offset:1024 sc1
  buffer_load_dwordx4 v[80:83], v3, s[28:31], s65 offen offset:2048 sc1
  buffer_load_dwordx4 v[84:87], v3, s[28:31], s65 offen offset:3072 sc1
  buffer_load_dwordx4 v[24:27], v2, s[28:31], s64 offen offset:0 sc1
  buffer_load_dwordx4 v[28:31], v2, s[28:31], s64 offen offset:1024 sc1
  buffer_load_dwordx4 v[32:35], v2, s[28:31], s64 offen offset:2048 sc1
  buffer_load_dwordx4 v[36:39], v2, s[28:31], s64 offen offset:3072 sc1
  buffer_load_dwordx4 v[40:43], v3, s[28:31], s64 offen offset:0 sc1
  buffer_load_dwordx4 v[44:47], v3, s[28:31], s64 offen offset:1024 sc1
  buffer_load_dwordx4 v[48:51], v3, s[28:31], s64 offen offset:2048 sc1
  buffer_load_dwordx4 v[52:55], v3, s[28:31], s64 offen offset:3072 sc1
  s_lshl_b32 s61, s86, 7
  s_add_u32 s61, s61, 99614720
  v_and_b32 v251, 15, v1
  v_lshlrev_b32 v251, 2, v251
  s_cmp_lg_u32 s58, 0
  s_cbranch_scc1 wa_72_ok
wa_72:
  buffer_load_dword v250, v251, s[28:31], s61 offen sc1
  s_waitcnt vmcnt(0)
  v_cmp_eq_u32 vcc, 0, v250
  s_cbranch_vccz wa_72_ok
  s_sub_u32 s88, s88, 1
  s_cselect_b32 s88, 0, s88
  s_cbranch_scc1 wa_72_ok
  s_sleep 3
  s_branch wa_72
wa_72_ok:
  s_barrier
  s_nop 0
  s_add_u32 m0, s74, 8192
  s_add_u32 s72, s67, 2048
  buffer_load_dwordx4 v2, s[28:31], s72 offen offset:0 sc1 lds
  buffer_load_dwordx4 v2, s[28:31], s72 offen offset:1024 sc1 lds
  buffer_load_dwordx4 v[88:91], v2, s[28:31], s67 offen offset:0 sc1
  buffer_load_dwordx4 v[92:95], v2, s[28:31], s67 offen offset:1024 sc1
  s_add_u32 s64, s64, 262144
  s_add_u32 s65, s65, 262144
  s_add_u32 s66, s66, 262144
  s_add_u32 s67, s67, 131072
  s_xor_b32 s74, s74, 16384
  s_waitcnt vmcnt(0)
  s_nop 0
att_x:
  v_mov_b32_dpp v96, v88 row_ror:8 row_mask:0xf bank_mask:0xf
  v_mov_b32_dpp v97, v89 row_ror:8 row_mask:0xf bank_mask:0xf
  v_mov_b32_dpp v98, v90 row_ror:8 row_mask:0xf bank_mask:0xf
  v_mov_b32_dpp v99, v91 row_ror:8 row_mask:0xf bank_mask:0xf
  v_mov_b32_dpp v100, v92 row_ror:8 row_mask:0xf bank_mask:0xf
  v_mov_b32_dpp v101, v93 row_ror:8 row_mask:0xf bank_mask:0xf
  v_mov_b32_dpp v102, v94 row_ror:8 row_mask:0xf bank_mask:0xf
  v_mov_b32_dpp v103, v95 row_ror:8 row_mask:0xf bank_mask:0xf
  v_mfma_f32_16x16x32_bf16 v[108:111], v[56:59], v[24:27], v[16:19]
  v_mfma_f32_16x16x32_bf16 v[108:111], v[60:63], v[28:31], v[108:111]
  v_mfma_f32_16x16x32_bf16 v[108:111], v[64:67], v[32:35], v[108:111]
  v_mfma_f32_16x16x32_bf16 v[108:111], v[68:71], v[36:39], v[108:111]
  v_mfma_f32_16x16x32_bf16 v[116:119], v[56:59], v[40:43], 0
  v_mfma_f32_16x16x32_bf16 v[116:119], v[60:63], v[44:47], v[116:119]
  v_mfma_f32_16x16x32_bf16 v[116:119], v[64:67], v[48:51], v[116:119]
  v_mfma_f32_16x16x32_bf16 v[116:119], v[68:71], v[52:55], v[116:119]
  v_mfma_f32_16x16x32_bf16 v[120:123], v[72:75], v[40:43], v[16:19]
  v_mfma_f32_16x16x32_bf16 v[120:123], v[76:79], v[44:47], v[120:123]
  v_mfma_f32_16x16x32_bf16 v[120:123], v[80:83], v[48:51], v[120:123]
  v_mfma_f32_16x16x32_bf16 v[120:123], v[84:87], v[52:55], v[120:123]
  v_mfma_f32_16x16x32_bf16 v[104:107], v[88:91], v[24:27], v[12:15]
  v_mfma_f32_16x16x32_bf16 v[104:107], v[96:99], v[28:31], v[104:107]
  v_mfma_f32_16x16x32_bf16 v[104:107], v[92:95], v[32:35], v[104:107]
  v_mfma_f32_16x16x32_bf16 v[104:107], v[100:103], v[36:39], v[104:107]
  v_mfma_f32_16x16x32_bf16 v[112:115], v[88:91], v[40:43], v[12:15]
  v_mfma_f32_16x16x32_bf16 v[112:115], v[96:99], v[44:47], v[112:115]
  v_mfma_f32_16x16x32_bf16 v[112:115], v[92:95], v[48:51], v[112:115]
  v_mfma_f32_16x16x32_bf16 v[112:115], v[100:103], v[52:55], v[112:115]
  s_cmp_le_u32 s69, 1
  s_cbranch_scc1 att_nl_x
  s_add_u32 m0, s74, 0
  s_nop 0
  buffer_load_dwordx4 v2, s[28:31], s66 offen offset:0 sc1 lds
  buffer_load_dwordx4 v2, s[28:31], s66 offen offset:1024 sc1 lds
  buffer_load_dwordx4 v2, s[28:31], s66 offen offset:2048 sc1 lds
  buffer_load_dwordx4 v2, s[28:31], s66 offen offset:3072 sc1 lds
  s_add_u32 m0, s74, 4096
  s_nop 0
  buffer_load_dwordx4 v3, s[28:31], s66 offen offset:0 sc1 lds
  buffer_load_dwordx4 v3, s[28:31], s66 offen offset:1024 sc1 lds
  buffer_load_dwordx4 v3, s[28:31], s66 offen offset:2048 sc1 lds
  buffer_load_dwordx4 v3, s[28:31], s66 offen offset:3072 sc1 lds
  buffer_load_dwordx4 v[56:59], v2, s[28:31], s65 offen offset:0 sc1
  buffer_load_dwordx4 v[60:63], v2, s[28:31], s65 offen offset:1024 sc1
  buffer_load_dwordx4 v[64:67], v2, s[28:31], s65 offen offset:2048 sc1
  buffer_load_dwordx4 v[68:71], v2, s[28:31], s65 offen offset:3072 sc1
  buffer_load_dwordx4 v[72:75], v3, s[28:31], s65 offen offset:0 sc1
  buffer_load_dwordx4 v[76:79], v3, s[28:31], s65 offen offset:1024 sc1
  buffer_load_dwordx4 v[80:83], v3, s[28:31], s65 offen offset:2048 sc1
  buffer_load_dwordx4 v[84:87], v3, s[28:31], s65 offen offset:3072 sc1
  buffer_load_dwordx4 v[24:27], v2, s[28:31], s64 offen offset:0 sc1
  buffer_load_dwordx4 v[28:31], v2, s[28:31], s64 offen offset:1024 sc1
  buffer_load_dwordx4 v[32:35], v2, s[28:31], s64 offen offset:2048 sc1
  buffer_load_dwordx4 v[36:39], v2, s[28:31], s64 offen offset:3072 sc1
  buffer_load_dwordx4 v[40:43], v3, s[28:31], s64 offen offset:0 sc1
  buffer_load_dwordx4 v[44:47], v3, s[28:31], s64 offen offset:1024 sc1
  buffer_load_dwordx4 v[48:51], v3, s[28:31], s64 offen offset:2048 sc1
  buffer_load_dwordx4 v[52:55], v3, s[28:31], s64 offen offset:3072 sc1
  s_add_u32 m0, s74, 8192
  s_add_u32 s72, s67, 2048
  buffer_load_dwordx4 v2, s[28:31], s72 offen offset:0 sc1 lds
  buffer_load_dwordx4 v2, s[28:31], s72 offen offset:1024 sc1 lds
  buffer_load_dwordx4 v[88:91], v2, s[28:31], s67 offen offset:0 sc1
  buffer_load_dwordx4 v[92:95], v2, s[28:31], s67 offen offset:1024 sc1
  s_add_u32 s64, s64, 262144
  s_add_u32 s65, s65, 262144
  s_add_u32 s66, s66, 262144
  s_add_u32 s67, s67, 131072
  s_xor_b32 s74, s74, 16384
att_nl_x:
  s_nop 0
  v_max3_f32 v216, v104, v105, v106
  v_max3_f32 v216, v216, v107, v108
  v_max3_f32 v216, v216, v109, v110
  v_max_f32 v216, v216, v111
  v_mov_b32 v218, v216
  s_nop 1
  v_permlane32_swap_b32 v216, v218
  v_max_f32 v216, v216, v218
  v_mov_b32 v218, v216
  s_nop 1
  v_permlane16_swap_b32 v216, v218
  v_max_f32 v216, v216, v218
  v_mul_f32 v216, s70, v216
  v_pk_fma_f32 v[104:105], v[104:105], s[70:71], v[216:217] op_sel_hi:[1,1,0] neg_lo:[0,0,1] neg_hi:[0,0,1]
  v_pk_fma_f32 v[106:107], v[106:107], s[70:71], v[216:217] op_sel_hi:[1,1,0] neg_lo:[0,0,1] neg_hi:[0,0,1]
  v_pk_fma_f32 v[108:109], v[108:109], s[70:71], v[216:217] op_sel_hi:[1,1,0] neg_lo:[0,0,1] neg_hi:[0,0,1]
  v_pk_fma_f32 v[110:111], v[110:111], s[70:71], v[216:217] op_sel_hi:[1,1,0] neg_lo:[0,0,1] neg_hi:[0,0,1]
  v_exp_f32 v104, v104
  v_exp_f32 v105, v105
  v_exp_f32 v106, v106
  v_exp_f32 v107, v107
  v_exp_f32 v108, v108
  v_exp_f32 v109, v109
  v_exp_f32 v110, v110
  v_exp_f32 v111, v111
  v_add_f32 v220, v104, v105
  v_add_f32 v220, v220, v106
  v_add_f32 v220, v220, v107
  v_add_f32 v220, v220, v108
  v_add_f32 v220, v220, v109
  v_add_f32 v220, v220, v110
  v_add_f32 v220, v220, v111
  v_mov_b32 v218, v220
  s_nop 1
  v_permlane32_swap_b32 v220, v218
  v_add_f32 v220, v220, v218
  v_mov_b32 v218, v220
  s_nop 1
  v_permlane16_swap_b32 v220, v218
  v_add_f32 v220, v220, v218
  v_rcp_f32 v220, v220
  s_nop 0
  v_pk_mul_f32 v[104:105], v[104:105], v[220:221] op_sel_hi:[1,0]
  v_pk_mul_f32 v[106:107], v[106:107], v[220:221] op_sel_hi:[1,0]
  v_pk_mul_f32 v[108:109], v[108:109], v[220:221] op_sel_hi:[1,0]
  v_pk_mul_f32 v[110:111], v[110:111], v[220:221] op_sel_hi:[1,0]
  v_cvt_pk_bf16_f32 v128, v104, v105
  v_cvt_pk_bf16_f32 v129, v106, v107
  v_cvt_pk_bf16_f32 v124, v108, v109
  v_cvt_pk_bf16_f32 v125, v110, v111
  v_mov_b32 v126, 0
  v_mov_b32 v127, 0
  v_max3_f32 v216, v112, v113, v114
  v_max3_f32 v216, v216, v115, v116
  v_max3_f32 v216, v216, v117, v118
  v_max3_f32 v216, v216, v119, v120
  v_max3_f32 v216, v216, v121, v122
  v_max_f32 v216, v216, v123
  v_mov_b32 v218, v216
  s_nop 1
  v_permlane32_swap_b32 v216, v218
  v_max_f32 v216, v216, v218
  v_mov_b32 v218, v216
  s_nop 1
  v_permlane16_swap_b32 v216, v218
  v_max_f32 v216, v216, v218
  v_mul_f32 v216, s70, v216
  v_pk_fma_f32 v[112:113], v[112:113], s[70:71], v[216:217] op_sel_hi:[1,1,0] neg_lo:[0,0,1] neg_hi:[0,0,1]
  v_pk_fma_f32 v[114:115], v[114:115], s[70:71], v[216:217] op_sel_hi:[1,1,0] neg_lo:[0,0,1] neg_hi:[0,0,1]
  v_pk_fma_f32 v[116:117], v[116:117], s[70:71], v[216:217] op_sel_hi:[1,1,0] neg_lo:[0,0,1] neg_hi:[0,0,1]
  v_pk_fma_f32 v[118:119], v[118:119], s[70:71], v[216:217] op_sel_hi:[1,1,0] neg_lo:[0,0,1] neg_hi:[0,0,1]
  v_pk_fma_f32 v[120:121], v[120:121], s[70:71], v[216:217] op_sel_hi:[1,1,0] neg_lo:[0,0,1] neg_hi:[0,0,1]
  v_pk_fma_f32 v[122:123], v[122:123], s[70:71], v[216:217] op_sel_hi:[1,1,0] neg_lo:[0,0,1] neg_hi:[0,0,1]
  v_exp_f32 v112, v112
  v_exp_f32 v113, v113
  v_exp_f32 v114, v114
  v_exp_f32 v115, v115
  v_exp_f32 v116, v116
  v_exp_f32 v117, v117
  v_exp_f32 v118, v118
  v_exp_f32 v119, v119
  v_exp_f32 v120, v120
  v_exp_f32 v121, v121
  v_exp_f32 v122, v122
  v_exp_f32 v123, v123
  v_add_f32 v222, v112, v113
  v_add_f32 v222, v222, v114
  v_add_f32 v222, v222, v115
  v_add_f32 v222, v222, v116
  v_add_f32 v222, v222, v117
  v_add_f32 v222, v222, v118
  v_add_f32 v222, v222, v119
  v_add_f32 v222, v222, v120
  v_add_f32 v222, v222, v121
  v_add_f32 v222, v222, v122
  v_add_f32 v222, v222, v123
  v_mov_b32 v218, v222
  s_nop 1
  v_permlane32_swap_b32 v222, v218
  v_add_f32 v222, v222, v218
  v_mov_b32 v218, v222
  s_nop 1
  v_permlane16_swap_b32 v222, v218
  v_add_f32 v222, v222, v218
  v_rcp_f32 v222, v222
  s_nop 0
  v_pk_mul_f32 v[112:113], v[112:113], v[222:223] op_sel_hi:[1,0]
  v_pk_mul_f32 v[114:115], v[114:115], v[222:223] op_sel_hi:[1,0]
  v_pk_mul_f32 v[116:117], v[116:117], v[222:223] op_sel_hi:[1,0]
  v_pk_mul_f32 v[118:119], v[118:119], v[222:223] op_sel_hi:[1,0]
  v_pk_mul_f32 v[120:121], v[120:121], v[222:223] op_sel_hi:[1,0]
  v_pk_mul_f32 v[122:123], v[122:123], v[222:223] op_sel_hi:[1,0]
  v_cvt_pk_bf16_f32 v134, v112, v113
  v_cvt_pk_bf16_f32 v135, v114, v115
  v_cvt_pk_bf16_f32 v130, v116, v117
  v_cvt_pk_bf16_f32 v131, v118, v119
  v_cvt_pk_bf16_f32 v132, v120, v121
  v_cvt_pk_bf16_f32 v133, v122, v123
  ds_read_b64_tr_b16 v[200:201], v6 offset:0
  ds_read_b64_tr_b16 v[202:203], v6 offset:4096
  ds_read_b64_tr_b16 v[204:205], v7 offset:0
  ds_read_b64_tr_b16 v[208:209], v6 offset:512
  ds_read_b64_tr_b16 v[210:211], v6 offset:4608
  ds_read_b64_tr_b16 v[212:213], v7 offset:32
  s_waitcnt lgkmcnt(3)
  v_mfma_f32_16x16x32_bf16 v[136:139], v[200:203], v[124:127], 0
  v_mfma_f32_16x16x32_bf16 v[140:143], v[200:203], v[130:133], 0
  v_mfma_f32_16x16x16_bf16 v[136:139], v[204:205], v[128:129], v[136:139]
  v_mfma_f32_16x16x16_bf16 v[140:143], v[204:205], v[134:135], v[140:143]
  ds_read_b64_tr_b16 v[200:201], v6 offset:1024
  ds_read_b64_tr_b16 v[202:203], v6 offset:5120
  ds_read_b64_tr_b16 v[204:205], v7 offset:64
  s_waitcnt lgkmcnt(3)
  v_mfma_f32_16x16x32_bf16 v[144:147], v[208:211], v[124:127], 0
  v_mfma_f32_16x16x32_bf16 v[148:151], v[208:211], v[130:133], 0
  v_mfma_f32_16x16x16_bf16 v[144:147], v[212:213], v[128:129], v[144:147]
  v_mfma_f32_16x16x16_bf16 v[148:151], v[212:213], v[134:135], v[148:151]
  ds_read_b64_tr_b16 v[208:209], v6 offset:1536
  ds_read_b64_tr_b16 v[210:211], v6 offset:5632
  ds_read_b64_tr_b16 v[212:213], v7 offset:96
  s_waitcnt lgkmcnt(3)
  v_mfma_f32_16x16x32_bf16 v[152:155], v[200:203], v[124:127], 0
  v_mfma_f32_16x16x32_bf16 v[156:159], v[200:203], v[130:133], 0
  v_mfma_f32_16x16x16_bf16 v[152:155], v[204:205], v[128:129], v[152:155]
  v_mfma_f32_16x16x16_bf16 v[156:159], v[204:205], v[134:135], v[156:159]
  ds_read_b64_tr_b16 v[200:201], v6 offset:2048
  ds_read_b64_tr_b16 v[202:203], v6 offset:6144
  ds_read_b64_tr_b16 v[204:205], v7 offset:128
  s_waitcnt lgkmcnt(3)
  v_mfma_f32_16x16x32_bf16 v[160:163], v[208:211], v[124:127], 0
  v_mfma_f32_16x16x32_bf16 v[164:167], v[208:211], v[130:133], 0
  v_mfma_f32_16x16x16_bf16 v[160:163], v[212:213], v[128:129], v[160:163]
  v_mfma_f32_16x16x16_bf16 v[164:167], v[212:213], v[134:135], v[164:167]
  ds_read_b64_tr_b16 v[208:209], v6 offset:2560
  ds_read_b64_tr_b16 v[210:211], v6 offset:6656
  ds_read_b64_tr_b16 v[212:213], v7 offset:160
  s_waitcnt lgkmcnt(3)
  v_mfma_f32_16x16x32_bf16 v[168:171], v[200:203], v[124:127], 0
  v_mfma_f32_16x16x32_bf16 v[172:175], v[200:203], v[130:133], 0
  v_mfma_f32_16x16x16_bf16 v[168:171], v[204:205], v[128:129], v[168:171]
  v_mfma_f32_16x16x16_bf16 v[172:175], v[204:205], v[134:135], v[172:175]
  ds_read_b64_tr_b16 v[200:201], v6 offset:3072
  ds_read_b64_tr_b16 v[202:203], v6 offset:7168
  ds_read_b64_tr_b16 v[204:205], v7 offset:192
  s_waitcnt lgkmcnt(3)
  v_mfma_f32_16x16x32_bf16 v[176:179], v[208:211], v[124:127], 0
  v_mfma_f32_16x16x32_bf16 v[180:183], v[208:211], v[130:133], 0
  v_mfma_f32_16x16x16_bf16 v[176:179], v[212:213], v[128:129], v[176:179]
  v_mfma_f32_16x16x16_bf16 v[180:183], v[212:213], v[134:135], v[180:183]
  ds_read_b64_tr_b16 v[208:209], v6 offset:3584
  ds_read_b64_tr_b16 v[210:211], v6 offset:7680
  ds_read_b64_tr_b16 v[212:213], v7 offset:224
  s_waitcnt lgkmcnt(3)
  v_mfma_f32_16x16x32_bf16 v[184:187], v[200:203], v[124:127], 0
  v_mfma_f32_16x16x32_bf16 v[188:191], v[200:203], v[130:133], 0
  v_mfma_f32_16x16x16_bf16 v[184:187], v[204:205], v[128:129], v[184:187]
  v_mfma_f32_16x16x16_bf16 v[188:191], v[204:205], v[134:135], v[188:191]
  s_waitcnt lgkmcnt(0)
  v_mfma_f32_16x16x32_bf16 v[192:195], v[208:211], v[124:127], 0
  v_mfma_f32_16x16x32_bf16 v[196:199], v[208:211], v[130:133], 0
  v_mfma_f32_16x16x16_bf16 v[192:195], v[212:213], v[128:129], v[192:195]
  v_mfma_f32_16x16x16_bf16 v[196:199], v[212:213], v[134:135], v[196:199]
  v_cvt_pk_bf16_f32 v224, v136, v137
  v_cvt_pk_bf16_f32 v225, v138, v139
  v_cvt_pk_bf16_f32 v226, v144, v145
  v_cvt_pk_bf16_f32 v227, v146, v147
  s_nop 0
  v_permlane16_swap_b32 v224, v226
  v_permlane16_swap_b32 v225, v227
  s_add_u32 s72, s68, 0
  buffer_store_dwordx4 v[224:227], v8, s[28:31], s72 offen offset:0 sc1
  v_cvt_pk_bf16_f32 v228, v152, v153
  v_cvt_pk_bf16_f32 v229, v154, v155
  v_cvt_pk_bf16_f32 v230, v160, v161
  v_cvt_pk_bf16_f32 v231, v162, v163
  s_nop 0
  v_permlane16_swap_b32 v228, v230
  v_permlane16_swap_b32 v229, v231
  s_add_u32 s72, s68, 131072
  buffer_store_dwordx4 v[228:231], v8, s[28:31], s72 offen offset:0 sc1
  v_cvt_pk_bf16_f32 v224, v168, v169
  v_cvt_pk_bf16_f32 v225, v170, v171
  v_cvt_pk_bf16_f32 v226, v176, v177
  v_cvt_pk_bf16_f32 v227, v178, v179
  s_nop 0
  v_permlane16_swap_b32 v224, v226
  v_permlane16_swap_b32 v225, v227
  s_add_u32 s72, s68, 262144
  buffer_store_dwordx4 v[224:227], v8, s[28:31], s72 offen offset:0 sc1
  v_cvt_pk_bf16_f32 v228, v184, v185
  v_cvt_pk_bf16_f32 v229, v186, v187
  v_cvt_pk_bf16_f32 v230, v192, v193
  v_cvt_pk_bf16_f32 v231, v194, v195
  s_nop 0
  v_permlane16_swap_b32 v228, v230
  v_permlane16_swap_b32 v229, v231
  s_add_u32 s72, s68, 393216
  buffer_store_dwordx4 v[228:231], v8, s[28:31], s72 offen offset:0 sc1
  v_cvt_pk_bf16_f32 v224, v140, v141
  v_cvt_pk_bf16_f32 v225, v142, v143
  v_cvt_pk_bf16_f32 v226, v148, v149
  v_cvt_pk_bf16_f32 v227, v150, v151
  s_nop 0
  v_permlane16_swap_b32 v224, v226
  v_permlane16_swap_b32 v225, v227
  s_add_u32 s72, s68, 0
  buffer_store_dwordx4 v[224:227], v8, s[28:31], s72 offen offset:1024 sc1
  v_cvt_pk_bf16_f32 v228, v156, v157
  v_cvt_pk_bf16_f32 v229, v158, v159
  v_cvt_pk_bf16_f32 v230, v164, v165
  v_cvt_pk_bf16_f32 v231, v166, v167
  s_nop 0
  v_permlane16_swap_b32 v228, v230
  v_permlane16_swap_b32 v229, v231
  s_add_u32 s72, s68, 131072
  buffer_store_dwordx4 v[228:231], v8, s[28:31], s72 offen offset:1024 sc1
  v_cvt_pk_bf16_f32 v224, v172, v173
  v_cvt_pk_bf16_f32 v225, v174, v175
  v_cvt_pk_bf16_f32 v226, v180, v181
  v_cvt_pk_bf16_f32 v227, v182, v183
  s_nop 0
  v_permlane16_swap_b32 v224, v226
  v_permlane16_swap_b32 v225, v227
  s_add_u32 s72, s68, 262144
  buffer_store_dwordx4 v[224:227], v8, s[28:31], s72 offen offset:1024 sc1
  v_cvt_pk_bf16_f32 v228, v188, v189
  v_cvt_pk_bf16_f32 v229, v190, v191
  v_cvt_pk_bf16_f32 v230, v196, v197
  v_cvt_pk_bf16_f32 v231, v198, v199
  s_nop 0
  v_permlane16_swap_b32 v228, v230
  v_permlane16_swap_b32 v229, v231
  s_add_u32 s72, s68, 393216
  buffer_store_dwordx4 v[228:231], v8, s[28:31], s72 offen offset:1024 sc1
  s_add_u32 s68, s68, 2048
  v_xor_b32 v6, 16384, v6
  v_xor_b32 v7, 16384, v7
  s_waitcnt vmcnt(8)
  s_sub_u32 s69, s69, 1
  s_cmp_lg_u32 s69, 0
  s_nop 0
  s_cbranch_scc1 att_x
  s_add_u32 s86, s82, 48
  s_lshl_b32 s87, s82, 3
  s_add_u32 s87, s87, s83
  s_add_u32 s87, s87, 320
  s_waitcnt vmcnt(0)
  s_barrier
  s_cmp_lg_u32 s58, 0
  s_cbranch_scc1 sg_73
  v_mov_b32 v26, s89
  s_mov_b64 exec, 1
  s_lshl_b32 s61, s86, 7
  s_add_u32 s61, s61, 99614720
  buffer_atomic_add v26, v255, s[28:31], s61 offen sc1
  s_lshl_b32 s61, s87, 7
  s_add_u32 s61, s61, 99614720
  buffer_atomic_add v26, v255, s[28:31], s61 offen sc1
  s_mov_b64 exec, -1
sg_73:
  s_nop 0
  v_lshrrev_b32 v26, 6, v0
  v_and_b32 v1, 63, v0
  v_readfirstlane_b32 s58, v26
  s_nop 3
  s_and_b32 s59, s58, 1
  s_lshr_b32 s60, s58, 1
  v_lshrrev_b32 v26, 5, v1
  v_lshlrev_b32 v26, 3, v26
  v_bfe_u32 v27, v1, 2, 2
  v_add_u32 v26, v26, v27
  v_lshlrev_b32 v26, 9, v26
  v_bfe_u32 v18, v1, 4, 1
  v_lshlrev_b32 v18, 5, v18
  v_add_u32 v26, v26, v18
  v_and_b32 v18, 3, v1
  v_lshlrev_b32 v18, 3, v18
  v_add_u32 v26, v26, v18
  s_lshl_b32 s61, s59, 8
  s_add_u32 s61, s61, 98304
  v_add_u32 v26, s61, v26
  v_xor_b32 v18, 0, v27
  v_lshl_add_u32 v22, v18, 6, v26
  v_xor_b32 v18, 1, v27
  v_lshl_add_u32 v23, v18, 6, v26
  v_xor_b32 v18, 2, v27
  v_lshl_add_u32 v24, v18, 6, v26
  v_xor_b32 v18, 3, v27
  v_lshl_add_u32 v25, v18, 6, v26
  s_lshl_b32 s55, s58, 12
  s_add_u32 s55, s55, 98304
  s_branch w_next
L_exit:
  s_endpgm
.p2align 6
.type sched_table,@object
sched_table:
.long 0x10009, 0x10021, 0x1, 0x12041, 0x3, 0xc7, 0xe7, 0xffffffff, 0xffffffff, 0xffffffff, 0xffffffff, 0xffffffff, 0xffffffff, 0xffffffff, 0xffffffff, 0xffffffff, 0xffffffff, 0xffffffff, 0xffffffff, 0xffffffff, 0xffffffff, 0xffffffff, 0xffffffff, 0xffffffff, 0xffffffff, 0xffffffff, 0xffffffff, 0xffffffff, 0xffffffff, 0xffffffff, 0xffffffff, 0xffffffff
.long 0x10409, 0x10421, 0x401, 0x12441, 0x403, 0x4c7, 0x4e7, 0xffffffff, 0xffffffff, 0xffffffff, 0xffffffff, 0xffffffff, 0xffffffff, 0xffffffff, 0xffffffff, 0xffffffff, 0xffffffff, 0xffffffff, 0xffffffff, 0xffffffff, 0xffffffff, 0xffffffff, 0xffffffff, 0xffffffff, 0xffffffff, 0xffffffff, 0xffffffff, 0xffffffff, 0xffffffff, 0xffffffff, 0xffffffff, 0xffffffff
.long 0x10809, 0x10821, 0x811, 0x22841, 0x803, 0x8c7, 0x8e7, 0xffffffff, 0xffffffff, 0xffffffff, 0xffffffff, 0xffffffff, 0xffffffff, 0xffffffff, 0xffffffff, 0xffffffff, 0xffffffff, 0xffffffff, 0xffffffff, 0xffffffff, 0xffffffff, 0xffffffff, 0xffffffff, 0xffffffff, 0xffffffff, 0xffffffff, 0xffffffff, 0xffffffff, 0xffffffff, 0xffffffff, 0xffffffff, 0xffffffff
.long 0x10c09, 0x10c21, 0xc11, 0x22c41, 0xc03, 0xcc7, 0xce7, 0xffffffff, 0xffffffff, 0xffffffff, 0xffffffff, 0xffffffff, 0xffffffff, 0xffffffff, 0xffffffff, 0xffffffff, 0xffffffff, 0xffffffff, 0xffffffff, 0xffffffff, 0xffffffff, 0xffffffff, 0xffffffff, 0xffffffff, 0xffffffff, 0xffffffff, 0xffffffff, 0xffffffff, 0xffffffff, 0xffffffff, 0xffffffff, 0xffffffff
.long 0x11009, 0x11021, 0x1001, 0x13041, 0x13, 0x100c7, 0x100e7, 0xffffffff, 0xffffffff, 0xffffffff, 0xffffffff, 0xffffffff, 0xffffffff, 0xffffffff, 0xffffffff, 0xffffffff, 0xffffffff, 0xffffffff, 0xffffffff, 0xffffffff, 0xffffffff, 0xffffffff, 0xffffffff, 0xffffffff, 0xffffffff, 0xffffffff, 0xffffffff, 0xffffffff, 0xffffffff, 0xffffffff, 0xffffffff, 0xffffffff
.long 0x11409, 0x11421, 0x1401, 0x13441, 0x413, 0x104c7, 0x104e7, 0xffffffff, 0xffffffff, 0xffffffff, 0xffffffff, 0xffffffff, 0xffffffff, 0xffffffff, 0xffffffff, 0xffffffff, 0xffffffff, 0xffffffff, 0xffffffff, 0xffffffff, 0xffffffff, 0xffffffff, 0xffffffff, 0xffffffff, 0xffffffff, 0xffffffff, 0xffffffff, 0xffffffff, 0xffffffff, 0xffffffff, 0xffffffff, 0xffffffff
.long 0x11809, 0x11821, 0x1811, 0x23841, 0x813, 0x108c7, 0x108e7, 0xffffffff, 0xffffffff, 0xffffffff, 0xffffffff, 0xffffffff, 0xffffffff, 0xffffffff, 0xffffffff, 0xffffffff, 0xffffffff, 0xffffffff, 0xffffffff, 0xffffffff, 0xffffffff, 0xffffffff, 0xffffffff, 0xffffffff, 0xffffffff, 0xffffffff, 0xffffffff, 0xffffffff, 0xffffffff, 0xffffffff, 0xffffffff, 0xffffffff
.long 0x11c09, 0x11c21, 0x1c11, 0x23c41, 0xc13, 0x10cc7, 0x10ce7, 0xffffffff, 0xffffffff, 0xffffffff, 0xffffffff, 0xffffffff, 0xffffffff, 0xffffffff, 0xffffffff, 0xffffffff, 0xffffffff, 0xffffffff, 0xffffffff, 0xffffffff, 0xffffffff, 0xffffffff, 0xffffffff, 0xffffffff, 0xffffffff, 0xffffffff, 0xffffffff, 0xffffffff, 0xffffffff, 0xffffffff, 0xffffffff, 0xffffffff
.long 0x12009, 0x12021, 0x2001, 0x20041, 0x23, 0x200c7, 0x200e7, 0xffffffff, 0xffffffff, 0xffffffff, 0xffffffff, 0xffffffff, 0xffffffff, 0xffffffff, 0xffffffff, 0xffffffff, 0xffffffff, 0xffffffff, 0xffffffff, 0xffffffff, 0xffffffff, 0xffffffff, 0xffffffff, 0xffffffff, 0xffffffff, 0xffffffff, 0xffffffff, 0xffffffff, 0xffffffff, 0xffffffff, 0xffffffff, 0xffffffff
.long 0x12409, 0x12421, 0x2401, 0x20441, 0x423, 0x204c7, 0x204e7, 0xffffffff, 0xffffffff, 0xffffffff, 0xffffffff, 0xffffffff, 0xffffffff, 0xffffffff, 0xffffffff, 0xffffffff, 0xffffffff, 0xffffffff, 0xffffffff, 0xffffffff, 0xffffffff, 0xffffffff, 0xffffffff, 0xffffffff, 0xffffffff, 0xffffffff, 0xffffffff, 0xffffffff, 0xffffffff, 0xffffffff, 0xffffffff, 0xffffffff
.long 0x12809, 0x12821, 0x2811, 0x21041, 0x823, 0x208c7, 0x208e7, 0xffffffff, 0xffffffff, 0xffffffff, 0xffffffff, 0xffffffff, 0xffffffff, 0xffffffff, 0xffffffff, 0xffffffff, 0xffffffff, 0xffffffff, 0xffffffff, 0xffffffff, 0xffffffff, 0xffffffff, 0xffffffff, 0xffffffff, 0xffffffff, 0xffffffff, 0xffffffff, 0xffffffff, 0xffffffff, 0xffffffff, 0xffffffff, 0xffffffff
.long 0x12c09, 0x12c21, 0x2c11, 0x21441, 0xc23, 0x20cc7, 0x20ce7, 0xffffffff, 0xffffffff, 0xffffffff, 0xffffffff, 0xffffffff, 0xffffffff, 0xffffffff, 0xffffffff, 0xffffffff, 0xffffffff, 0xffffffff, 0xffffffff, 0xffffffff, 0xffffffff, 0xffffffff, 0xffffffff, 0xffffffff, 0xffffffff, 0xffffffff, 0xffffffff, 0xffffffff, 0xffffffff, 0xffffffff, 0xffffffff, 0xffffffff
.long 0x13009, 0x13021, 0x3001, 0x22041, 0x33, 0x300c7, 0x300e7, 0xffffffff, 0xffffffff, 0xffffffff, 0xffffffff, 0xffffffff, 0xffffffff, 0xffffffff, 0xffffffff, 0xffffffff, 0xffffffff, 0xffffffff, 0xffffffff, 0xffffffff, 0xffffffff, 0xffffffff, 0xffffffff, 0xffffffff, 0xffffffff, 0xffffffff, 0xffffffff, 0xffffffff, 0xffffffff, 0xffffffff, 0xffffffff, 0xffffffff
.long 0x13409, 0x13421, 0x3401, 0x22441, 0x433, 0x304c7, 0x304e7, 0xffffffff, 0xffffffff, 0xffffffff, 0xffffffff, 0xffffffff, 0xffffffff, 0xffffffff, 0xffffffff, 0xffffffff, 0xffffffff, 0xffffffff, 0xffffffff, 0xffffffff, 0xffffffff, 0xffffffff, 0xffffffff, 0xffffffff, 0xffffffff, 0xffffffff, 0xffffffff, 0xffffffff, 0xffffffff, 0xffffffff, 0xffffffff, 0xffffffff
.long 0x13809, 0x13821, 0x3811, 0x23041, 0x833, 0x308c7, 0x308e7, 0xffffffff, 0xffffffff, 0xffffffff, 0xffffffff, 0xffffffff, 0xffffffff, 0xffffffff, 0xffffffff, 0xffffffff, 0xffffffff, 0xffffffff, 0xffffffff, 0xffffffff, 0xffffffff, 0xffffffff, 0xffffffff, 0xffffffff, 0xffffffff, 0xffffffff, 0xffffffff, 0xffffffff, 0xffffffff, 0xffffffff, 0xffffffff, 0xffffffff
.long 0x13c09, 0x13c21, 0x3c11, 0x23441, 0xc33, 0x30cc7, 0x30ce7, 0xffffffff, 0xffffffff, 0xffffffff, 0xffffffff, 0xffffffff, 0xffffffff, 0xffffffff, 0xffffffff, 0xffffffff, 0xffffffff, 0xffffffff, 0xffffffff, 0xffffffff, 0xffffffff, 0xffffffff, 0xffffffff, 0xffffffff, 0xffffffff, 0xffffffff, 0xffffffff, 0xffffffff, 0xffffffff, 0xffffffff, 0xffffffff, 0xffffffff
.long 0x20009, 0x20021, 0x11, 0x4, 0x44, 0x54, 0x1003, 0x400c7, 0x400e7, 0xffffffff, 0xffffffff, 0xffffffff, 0xffffffff, 0xffffffff, 0xffffffff, 0xffffffff, 0xffffffff, 0xffffffff, 0xffffffff, 0xffffffff, 0xffffffff, 0xffffffff, 0xffffffff, 0xffffffff, 0xffffffff, 0xffffffff, 0xffffffff, 0xffffffff, 0xffffffff, 0xffffffff, 0xffffffff, 0xffffffff
.long 0x20409, 0x20421, 0x411, 0x404, 0x444, 0x454, 0x1403, 0x404c7, 0x404e7, 0xffffffff, 0xffffffff, 0xffffffff, 0xffffffff, 0xffffffff, 0xffffffff, 0xffffffff, 0xffffffff, 0xffffffff, 0xffffffff, 0xffffffff, 0xffffffff, 0xffffffff, 0xffffffff, 0xffffffff, 0xffffffff, 0xffffffff, 0xffffffff, 0xffffffff, 0xffffffff, 0xffffffff, 0xffffffff, 0xffffffff
.long 0x20809, 0x20821, 0x821, 0x804, 0x844, 0x854, 0x1803, 0x408c7, 0x408e7, 0xffffffff, 0xffffffff, 0xffffffff, 0xffffffff, 0xffffffff, 0xffffffff, 0xffffffff, 0xffffffff, 0xffffffff, 0xffffffff, 0xffffffff, 0xffffffff, 0xffffffff, 0xffffffff, 0xffffffff, 0xffffffff, 0xffffffff, 0xffffffff, 0xffffffff, 0xffffffff, 0xffffffff, 0xffffffff, 0xffffffff
.long 0x20c09, 0x20c21, 0xc21, 0xc04, 0xc44, 0xc54, 0x1c03, 0x40cc7, 0x40ce7, 0xffffffff, 0xffffffff, 0xffffffff, 0xffffffff, 0xffffffff, 0xffffffff, 0xffffffff, 0xffffffff, 0xffffffff, 0xffffffff, 0xffffffff, 0xffffffff, 0xffffffff, 0xffffffff, 0xffffffff, 0xffffffff, 0xffffffff, 0xffffffff, 0xffffffff, 0xffffffff, 0xffffffff, 0xffffffff, 0xffffffff
.long 0x21009, 0x21021, 0x1011, 0x1004, 0x1044, 0x1054, 0x1013, 0x500c7, 0x500e7, 0xffffffff, 0xffffffff, 0xffffffff, 0xffffffff, 0xffffffff, 0xffffffff, 0xffffffff, 0xffffffff, 0xffffffff, 0xffffffff, 0xffffffff, 0xffffffff, 0xffffffff, 0xffffffff, 0xffffffff, 0xffffffff, 0xffffffff, 0xffffffff, 0xffffffff, 0xffffffff, 0xffffffff, 0xffffffff, 0xffffffff
.long 0x21409, 0x21421, 0x1411, 0x1404, 0x1444, 0x1454, 0x1413, 0x504c7, 0x504e7, 0xffffffff, 0xffffffff, 0xffffffff, 0xffffffff, 0xffffffff, 0xffffffff, 0xffffffff, 0xffffffff, 0xffffffff, 0xffffffff, 0xffffffff, 0xffffffff, 0xffffffff, 0xffffffff, 0xffffffff, 0xffffffff, 0xffffffff, 0xffffffff, 0xffffffff, 0xffffffff, 0xffffffff, 0xffffffff, 0xffffffff
.long 0x21809, 0x21821, 0x1821, 0x1804, 0x1844, 0x1854, 0x1813, 0x508c7, 0x508e7, 0xffffffff, 0xffffffff, 0xffffffff, 0xffffffff, 0xffffffff, 0xffffffff, 0xffffffff, 0xffffffff, 0xffffffff, 0xffffffff, 0xffffffff, 0xffffffff, 0xffffffff, 0xffffffff, 0xffffffff, 0xffffffff, 0xffffffff, 0xffffffff, 0xffffffff, 0xffffffff, 0xffffffff, 0xffffffff, 0xffffffff
.long 0x21c09, 0x21c21, 0x1c21, 0x1c04, 0x1c44, 0x1c54, 0x1c13, 0x50cc7, 0x50ce7, 0xffffffff, 0xffffffff, 0xffffffff, 0xffffffff, 0xffffffff, 0xffffffff, 0xffffffff, 0xffffffff, 0xffffffff, 0xffffffff, 0xffffffff, 0xffffffff, 0xffffffff, 0xffffffff, 0xffffffff, 0xffffffff, 0xffffffff, 0xffffffff, 0xffffffff, 0xffffffff, 0xffffffff, 0xffffffff, 0xffffffff
.long 0x22009, 0x22021, 0x2011, 0x14, 0x1023, 0x600c7, 0x600e7, 0xffffffff, 0xffffffff, 0xffffffff, 0xffffffff, 0xffffffff, 0xffffffff, 0xffffffff, 0xffffffff, 0xffffffff, 0xffffffff, 0xffffffff, 0xffffffff, 0xffffffff, 0xffffffff, 0xffffffff, 0xffffffff, 0xffffffff, 0xffffffff, 0xffffffff, 0xffffffff, 0xffffffff, 0xffffffff, 0xffffffff, 0xffffffff, 0xffffffff
.long 0x22409, 0x22421, 0x2411, 0x414, 0x1423, 0x604c7, 0x604e7, 0xffffffff, 0xffffffff, 0xffffffff, 0xffffffff, 0xffffffff, 0xffffffff, 0xffffffff, 0xffffffff, 0xffffffff, 0xffffffff, 0xffffffff, 0xffffffff, 0xffffffff, 0xffffffff, 0xffffffff, 0xffffffff, 0xffffffff, 0xffffffff, 0xffffffff, 0xffffffff, 0xffffffff, 0xffffffff, 0xffffffff, 0xffffffff, 0xffffffff
.long 0x22809, 0x22821, 0x2821, 0x814, 0x1823, 0x608c7, 0x608e7, 0xffffffff, 0xffffffff, 0xffffffff, 0xffffffff, 0xffffffff, 0xffffffff, 0xffffffff, 0xffffffff, 0xffffffff, 0xffffffff, 0xffffffff, 0xffffffff, 0xffffffff, 0xffffffff, 0xffffffff, 0xffffffff, 0xffffffff, 0xffffffff, 0xffffffff, 0xffffffff, 0xffffffff, 0xffffffff, 0xffffffff, 0xffffffff, 0xffffffff
.long 0x22c09, 0x22c21, 0x2c21, 0xc14, 0x1c23, 0x60cc7, 0x60ce7, 0xffffffff, 0xffffffff, 0xffffffff, 0xffffffff, 0xffffffff, 0xffffffff, 0xffffffff, 0xffffffff, 0xffffffff, 0xffffffff, 0xffffffff, 0xffffffff, 0xffffffff, 0xffffffff, 0xffffffff, 0xffffffff, 0xffffffff, 0xffffffff, 0xffffffff, 0xffffffff, 0xffffffff, 0xffffffff, 0xffffffff, 0xffffffff, 0xffffffff
.long 0x23009, 0x23021, 0x3011, 0x1014, 0x1033, 0x700c7, 0x700e7, 0xffffffff, 0xffffffff, 0xffffffff, 0xffffffff, 0xffffffff, 0xffffffff, 0xffffffff, 0xffffffff, 0xffffffff, 0xffffffff, 0xffffffff, 0xffffffff, 0xffffffff, 0xffffffff, 0xffffffff, 0xffffffff, 0xffffffff, 0xffffffff, 0xffffffff, 0xffffffff, 0xffffffff, 0xffffffff, 0xffffffff, 0xffffffff, 0xffffffff
.long 0x23409, 0x23421, 0x3411, 0x1414, 0x1433, 0x704c7, 0x704e7, 0xffffffff, 0xffffffff, 0xffffffff, 0xffffffff, 0xffffffff, 0xffffffff, 0xffffffff, 0xffffffff, 0xffffffff, 0xffffffff, 0xffffffff, 0xffffffff, 0xffffffff, 0xffffffff, 0xffffffff, 0xffffffff, 0xffffffff, 0xffffffff, 0xffffffff, 0xffffffff, 0xffffffff, 0xffffffff, 0xffffffff, 0xffffffff, 0xffffffff
.long 0x23809, 0x23821, 0x3821, 0x1814, 0x1833, 0x708c7, 0x708e7, 0xffffffff, 0xffffffff, 0xffffffff, 0xffffffff, 0xffffffff, 0xffffffff, 0xffffffff, 0xffffffff, 0xffffffff, 0xffffffff, 0xffffffff, 0xffffffff, 0xffffffff, 0xffffffff, 0xffffffff, 0xffffffff, 0xffffffff, 0xffffffff, 0xffffffff, 0xffffffff, 0xffffffff, 0xffffffff, 0xffffffff, 0xffffffff, 0xffffffff
.long 0x23c09, 0x23c21, 0x3c21, 0x1c14, 0x1c33, 0x70cc7, 0x70ce7, 0xffffffff, 0xffffffff, 0xffffffff, 0xffffffff, 0xffffffff, 0xffffffff, 0xffffffff, 0xffffffff, 0xffffffff, 0xffffffff, 0xffffffff, 0xffffffff, 0xffffffff, 0xffffffff, 0xffffffff, 0xffffffff, 0xffffffff, 0xffffffff, 0xffffffff, 0xffffffff, 0xffffffff, 0xffffffff, 0xffffffff, 0xffffffff, 0xffffffff
.long 0x10019, 0x10031, 0x21, 0x24, 0x5, 0xd7, 0xf7, 0xffffffff, 0xffffffff, 0xffffffff, 0xffffffff, 0xffffffff, 0xffffffff, 0xffffffff, 0xffffffff, 0xffffffff, 0xffffffff, 0xffffffff, 0xffffffff, 0xffffffff, 0xffffffff, 0xffffffff, 0xffffffff, 0xffffffff, 0xffffffff, 0xffffffff, 0xffffffff, 0xffffffff, 0xffffffff, 0xffffffff, 0xffffffff, 0xffffffff
.long 0x10419, 0x10431, 0x421, 0x424, 0x405, 0x4d7, 0x4f7, 0xffffffff, 0xffffffff, 0xffffffff, 0xffffffff, 0xffffffff, 0xffffffff, 0xffffffff, 0xffffffff, 0xffffffff, 0xffffffff, 0xffffffff, 0xffffffff, 0xffffffff, 0xffffffff, 0xffffffff, 0xffffffff, 0xffffffff, 0xffffffff, 0xffffffff, 0xffffffff, 0xffffffff, 0xffffffff, 0xffffffff, 0xffffffff, 0xffffffff
.long 0x10819, 0x10831, 0x1021, 0x824, 0x805, 0x8d7, 0x8f7, 0xffffffff, 0xffffffff, 0xffffffff, 0xffffffff, 0xffffffff, 0xffffffff, 0xffffffff, 0xffffffff, 0xffffffff, 0xffffffff, 0xffffffff, 0xffffffff, 0xffffffff, 0xffffffff, 0xffffffff, 0xffffffff, 0xffffffff, 0xffffffff, 0xffffffff, 0xffffffff, 0xffffffff, 0xffffffff, 0xffffffff, 0xffffffff, 0xffffffff
.long 0x10c19, 0x10c31, 0x1421, 0xc24, 0xc05, 0xcd7, 0xcf7, 0xffffffff, 0xffffffff, 0xffffffff, 0xffffffff, 0xffffffff, 0xffffffff, 0xffffffff, 0xffffffff, 0xffffffff, 0xffffffff, 0xffffffff, 0xffffffff, 0xffffffff, 0xffffffff, 0xffffffff, 0xffffffff, 0xffffffff, 0xffffffff, 0xffffffff, 0xffffffff, 0xffffffff, 0xffffffff, 0xffffffff, 0xffffffff, 0xffffffff
.long 0x11019, 0x11031, 0x2021, 0x1024, 0x15, 0x100d7, 0x100f7, 0xffffffff, 0xffffffff, 0xffffffff, 0xffffffff, 0xffffffff, 0xffffffff, 0xffffffff, 0xffffffff, 0xffffffff, 0xffffffff, 0xffffffff, 0xffffffff, 0xffffffff, 0xffffffff, 0xffffffff, 0xffffffff, 0xffffffff, 0xffffffff, 0xffffffff, 0xffffffff, 0xffffffff, 0xffffffff, 0xffffffff, 0xffffffff, 0xffffffff
.long 0x11419, 0x11431, 0x2421, 0x1424, 0x415, 0x104d7, 0x104f7, 0xffffffff, 0xffffffff, 0xffffffff, 0xffffffff, 0xffffffff, 0xffffffff, 0xffffffff, 0xffffffff, 0xffffffff, 0xffffffff, 0xffffffff, 0xffffffff, 0xffffffff, 0xffffffff, 0xffffffff, 0xffffffff, 0xffffffff, 0xffffffff, 0xffffffff, 0xffffffff, 0xffffffff, 0xffffffff, 0xffffffff, 0xffffffff, 0xffffffff
.long 0x11819, 0x11831, 0x3021, 0x1824, 0x815, 0x108d7, 0x108f7, 0xffffffff, 0xffffffff, 0xffffffff, 0xffffffff, 0xffffffff, 0xffffffff, 0xffffffff, 0xffffffff, 0xffffffff, 0xffffffff, 0xffffffff, 0xffffffff, 0xffffffff, 0xffffffff, 0xffffffff, 0xffffffff, 0xffffffff, 0xffffffff, 0xffffffff, 0xffffffff, 0xffffffff, 0xffffffff, 0xffffffff, 0xffffffff, 0xffffffff
.long 0x11c19, 0x11c31, 0x3421, 0x1c24, 0xc15, 0x10cd7, 0x10cf7, 0xffffffff, 0xffffffff, 0xffffffff, 0xffffffff, 0xffffffff, 0xffffffff, 0xffffffff, 0xffffffff, 0xffffffff, 0xffffffff, 0xffffffff, 0xffffffff, 0xffffffff, 0xffffffff, 0xffffffff, 0xffffffff, 0xffffffff, 0xffffffff, 0xffffffff, 0xffffffff, 0xffffffff, 0xffffffff, 0xffffffff, 0xffffffff, 0xffffffff
.long 0x12019, 0x12031, 0x31, 0x34, 0x25, 0x200d7, 0x200f7, 0xffffffff, 0xffffffff, 0xffffffff, 0xffffffff, 0xffffffff, 0xffffffff, 0xffffffff, 0xffffffff, 0xffffffff, 0xffffffff, 0xffffffff, 0xffffffff, 0xffffffff, 0xffffffff, 0xffffffff, 0xffffffff, 0xffffffff, 0xffffffff, 0xffffffff, 0xffffffff, 0xffffffff, 0xffffffff, 0xffffffff, 0xffffffff, 0xffffffff
.long 0x12419, 0x12431, 0x431, 0x434, 0x425, 0x204d7, 0x204f7, 0xffffffff, 0xffffffff, 0xffffffff, 0xffffffff, 0xffffffff, 0xffffffff, 0xffffffff, 0xffffffff, 0xffffffff, 0xffffffff, 0xffffffff, 0xffffffff, 0xffffffff, 0xffffffff, 0xffffffff, 0xffffffff, 0xffffffff, 0xffffffff, 0xffffffff, 0xffffffff, 0xffffffff, 0xffffffff, 0xffffffff, 0xffffffff, 0xffffffff
.long 0x12819, 0x12831, 0x831, 0x834, 0x825, 0x208d7, 0x208f7, 0xffffffff, 0xffffffff, 0xffffffff, 0xffffffff, 0xffffffff, 0xffffffff, 0xffffffff, 0xffffffff, 0xffffffff, 0xffffffff, 0xffffffff, 0xffffffff, 0xffffffff, 0xffffffff, 0xffffffff, 0xffffffff, 0xffffffff, 0xffffffff, 0xffffffff, 0xffffffff, 0xffffffff, 0xffffffff, 0xffffffff, 0xffffffff, 0xffffffff
.long 0x12c19, 0x12c31, 0xc31, 0xc34, 0xc25, 0x20cd7, 0x20cf7, 0xffffffff, 0xffffffff, 0xffffffff, 0xffffffff, 0xffffffff, 0xffffffff, 0xffffffff, 0xffffffff, 0xffffffff, 0xffffffff, 0xffffffff, 0xffffffff, 0xffffffff, 0xffffffff, 0xffffffff, 0xffffffff, 0xffffffff, 0xffffffff, 0xffffffff, 0xffffffff, 0xffffffff, 0xffffffff, 0xffffffff, 0xffffffff, 0xffffffff
.long 0x13019, 0x13031, 0x1031, 0x1034, 0x10051, 0x22861, 0x871, 0x300d7, 0x300f7, 0xffffffff, 0xffffffff, 0xffffffff, 0xffffffff, 0xffffffff, 0xffffffff, 0xffffffff, 0xffffffff, 0xffffffff, 0xffffffff, 0xffffffff, 0xffffffff, 0xffffffff, 0xffffffff, 0xffffffff, 0xffffffff, 0xffffffff, 0xffffffff, 0xffffffff, 0xffffffff, 0xffffffff, 0xffffffff, 0xffffffff
.long 0x13419, 0x13431, 0x1431, 0x1434, 0x10451, 0x22c61, 0xc71, 0x304d7, 0x304f7, 0xffffffff, 0xffffffff, 0xffffffff, 0xffffffff, 0xffffffff, 0xffffffff, 0xffffffff, 0xffffffff, 0xffffffff, 0xffffffff, 0xffffffff, 0xffffffff, 0xffffffff, 0xffffffff, 0xffffffff, 0xffffffff, 0xffffffff, 0xffffffff, 0xffffffff, 0xffffffff, 0xffffffff, 0xffffffff, 0xffffffff
.long 0x13819, 0x13831, 0x1831, 0x1834, 0x10851, 0x23861, 0x1871, 0x308d7, 0x308f7, 0xffffffff, 0xffffffff, 0xffffffff, 0xffffffff, 0xffffffff, 0xffffffff, 0xffffffff, 0xffffffff, 0xffffffff, 0xffffffff, 0xffffffff, 0xffffffff, 0xffffffff, 0xffffffff, 0xffffffff, 0xffffffff, 0xffffffff, 0xffffffff, 0xffffffff, 0xffffffff, 0xffffffff, 0xffffffff, 0xffffffff
.long 0x13c19, 0x13c31, 0x1c31, 0x1c34, 0x10c51, 0x23c61, 0x1c71, 0x30cd7, 0x30cf7, 0xffffffff, 0xffffffff, 0xffffffff, 0xffffffff, 0xffffffff, 0xffffffff, 0xffffffff, 0xffffffff, 0xffffffff, 0xffffffff, 0xffffffff, 0xffffffff, 0xffffffff, 0xffffffff, 0xffffffff, 0xffffffff, 0xffffffff, 0xffffffff, 0xffffffff, 0xffffffff, 0xffffffff, 0xffffffff, 0xffffffff
.long 0x20019, 0x20031, 0x2031, 0x41, 0x11051, 0x1074, 0x2871, 0x400d7, 0x400f7, 0xffffffff, 0xffffffff, 0xffffffff, 0xffffffff, 0xffffffff, 0xffffffff, 0xffffffff, 0xffffffff, 0xffffffff, 0xffffffff, 0xffffffff, 0xffffffff, 0xffffffff, 0xffffffff, 0xffffffff, 0xffffffff, 0xffffffff, 0xffffffff, 0xffffffff, 0xffffffff, 0xffffffff, 0xffffffff, 0xffffffff
.long 0x20419, 0x20431, 0x2431, 0x441, 0x11451, 0x1474, 0x2c71, 0x404d7, 0x404f7, 0xffffffff, 0xffffffff, 0xffffffff, 0xffffffff, 0xffffffff, 0xffffffff, 0xffffffff, 0xffffffff, 0xffffffff, 0xffffffff, 0xffffffff, 0xffffffff, 0xffffffff, 0xffffffff, 0xffffffff, 0xffffffff, 0xffffffff, 0xffffffff, 0xffffffff, 0xffffffff, 0xffffffff, 0xffffffff, 0xffffffff
.long 0x20819, 0x20831, 0x2831, 0x841, 0x21851, 0x1874, 0x3871, 0x408d7, 0x408f7, 0xffffffff, 0xffffffff, 0xffffffff, 0xffffffff, 0xffffffff, 0xffffffff, 0xffffffff, 0xffffffff, 0xffffffff, 0xffffffff, 0xffffffff, 0xffffffff, 0xffffffff, 0xffffffff, 0xffffffff, 0xffffffff, 0xffffffff, 0xffffffff, 0xffffffff, 0xffffffff, 0xffffffff, 0xffffffff, 0xffffffff
.long 0x20c19, 0x20c31, 0x2c31, 0xc41, 0x21c51, 0x1c74, 0x3c71, 0x40cd7, 0x40cf7, 0xffffffff, 0xffffffff, 0xffffffff, 0xffffffff, 0xffffffff, 0xffffffff, 0xffffffff, 0xffffffff, 0xffffffff, 0xffffffff, 0xffffffff, 0xffffffff, 0xffffffff, 0xffffffff, 0xffffffff, 0xffffffff, 0xffffffff, 0xffffffff, 0xffffffff, 0xffffffff, 0xffffffff, 0xffffffff, 0xffffffff
.long 0x21019, 0x21031, 0x3031, 0x1041, 0x12051, 0x61, 0xa4, 0x500d7, 0x500f7, 0xffffffff, 0xffffffff, 0xffffffff, 0xffffffff, 0xffffffff, 0xffffffff, 0xffffffff, 0xffffffff, 0xffffffff, 0xffffffff, 0xffffffff, 0xffffffff, 0xffffffff, 0xffffffff, 0xffffffff, 0xffffffff, 0xffffffff, 0xffffffff, 0xffffffff, 0xffffffff, 0xffffffff, 0xffffffff, 0xffffffff
.long 0x21419, 0x21431, 0x3431, 0x1441, 0x12451, 0x461, 0x4a4, 0x504d7, 0x504f7, 0xffffffff, 0xffffffff, 0xffffffff, 0xffffffff, 0xffffffff, 0xffffffff, 0xffffffff, 0xffffffff, 0xffffffff, 0xffffffff, 0xffffffff, 0xffffffff, 0xffffffff, 0xffffffff, 0xffffffff, 0xffffffff, 0xffffffff, 0xffffffff, 0xffffffff, 0xffffffff, 0xffffffff, 0xffffffff, 0xffffffff
.long 0x21819, 0x21831, 0x3831, 0x1841, 0x22851, 0x1061, 0x8a4, 0x508d7, 0x508f7, 0xffffffff, 0xffffffff, 0xffffffff, 0xffffffff, 0xffffffff, 0xffffffff, 0xffffffff, 0xffffffff, 0xffffffff, 0xffffffff, 0xffffffff, 0xffffffff, 0xffffffff, 0xffffffff, 0xffffffff, 0xffffffff, 0xffffffff, 0xffffffff, 0xffffffff, 0xffffffff, 0xffffffff, 0xffffffff, 0xffffffff
.long 0x21c19, 0x21c31, 0x3c31, 0x1c41, 0x22c51, 0x1461, 0xca4, 0x50cd7, 0x50cf7, 0xffffffff, 0xffffffff, 0xffffffff, 0xffffffff, 0xffffffff, 0xffffffff, 0xffffffff, 0xffffffff, 0xffffffff, 0xffffffff, 0xffffffff, 0xffffffff, 0xffffffff, 0xffffffff, 0xffffffff, 0xffffffff, 0xffffffff, 0xffffffff, 0xffffffff, 0xffffffff, 0xffffffff, 0xffffffff, 0xffffffff
.long 0x22019, 0x22031, 0x10041, 0x2041, 0x13051, 0x2061, 0x10a4, 0x600d7, 0x600f7, 0xffffffff, 0xffffffff, 0xffffffff, 0xffffffff, 0xffffffff, 0xffffffff, 0xffffffff, 0xffffffff, 0xffffffff, 0xffffffff, 0xffffffff, 0xffffffff, 0xffffffff, 0xffffffff, 0xffffffff, 0xffffffff, 0xffffffff, 0xffffffff, 0xffffffff, 0xffffffff, 0xffffffff, 0xffffffff, 0xffffffff
.long 0x22419, 0x22431, 0x10441, 0x2441, 0x13451, 0x2461, 0x14a4, 0x604d7, 0x604f7, 0xffffffff, 0xffffffff, 0xffffffff, 0xffffffff, 0xffffffff, 0xffffffff, 0xffffffff, 0xffffffff, 0xffffffff, 0xffffffff, 0xffffffff, 0xffffffff, 0xffffffff, 0xffffffff, 0xffffffff, 0xffffffff, 0xffffffff, 0xffffffff, 0xffffffff, 0xffffffff, 0xffffffff, 0xffffffff, 0xffffffff
.long 0x22819, 0x22831, 0x10841, 0x2841, 0x23851, 0x3061, 0x18a4, 0x608d7, 0x608f7, 0xffffffff, 0xffffffff, 0xffffffff, 0xffffffff, 0xffffffff, 0xffffffff, 0xffffffff, 0xffffffff, 0xffffffff, 0xffffffff, 0xffffffff, 0xffffffff, 0xffffffff, 0xffffffff, 0xffffffff, 0xffffffff, 0xffffffff, 0xffffffff, 0xffffffff, 0xffffffff, 0xffffffff, 0xffffffff, 0xffffffff
.long 0x22c19, 0x22c31, 0x10c41, 0x2c41, 0x23c51, 0x3461, 0x1ca4, 0x60cd7, 0x60cf7, 0xffffffff, 0xffffffff, 0xffffffff, 0xffffffff, 0xffffffff, 0xffffffff, 0xffffffff, 0xffffffff, 0xffffffff, 0xffffffff, 0xffffffff, 0xffffffff, 0xffffffff, 0xffffffff, 0xffffffff, 0xffffffff, 0xffffffff, 0xffffffff, 0xffffffff, 0xffffffff, 0xffffffff, 0xffffffff, 0xffffffff
.long 0x23019, 0x23031, 0x11041, 0x3041, 0x20051, 0x10071, 0x700d7, 0x700f7, 0xffffffff, 0xffffffff, 0xffffffff, 0xffffffff, 0xffffffff, 0xffffffff, 0xffffffff, 0xffffffff, 0xffffffff, 0xffffffff, 0xffffffff, 0xffffffff, 0xffffffff, 0xffffffff, 0xffffffff, 0xffffffff, 0xffffffff, 0xffffffff, 0xffffffff, 0xffffffff, 0xffffffff, 0xffffffff, 0xffffffff, 0xffffffff
.long 0x23419, 0x23431, 0x11441, 0x3441, 0x20451, 0x10471, 0x704d7, 0x704f7, 0xffffffff, 0xffffffff, 0xffffffff, 0xffffffff, 0xffffffff, 0xffffffff, 0xffffffff, 0xffffffff, 0xffffffff, 0xffffffff, 0xffffffff, 0xffffffff, 0xffffffff, 0xffffffff, 0xffffffff, 0xffffffff, 0xffffffff, 0xffffffff, 0xffffffff, 0xffffffff, 0xffffffff, 0xffffffff, 0xffffffff, 0xffffffff
.long 0x23819, 0x23831, 0x11841, 0x3841, 0x21051, 0x10871, 0x708d7, 0x708f7, 0xffffffff, 0xffffffff, 0xffffffff, 0xffffffff, 0xffffffff, 0xffffffff, 0xffffffff, 0xffffffff, 0xffffffff, 0xffffffff, 0xffffffff, 0xffffffff, 0xffffffff, 0xffffffff, 0xffffffff, 0xffffffff, 0xffffffff, 0xffffffff, 0xffffffff, 0xffffffff, 0xffffffff, 0xffffffff, 0xffffffff, 0xffffffff
.long 0x23c19, 0x23c31, 0x11c41, 0x3c41, 0x21451, 0x10c71, 0x70cd7, 0x70cf7, 0xffffffff, 0xffffffff, 0xffffffff, 0xffffffff, 0xffffffff, 0xffffffff, 0xffffffff, 0xffffffff, 0xffffffff, 0xffffffff, 0xffffffff, 0xffffffff, 0xffffffff, 0xffffffff, 0xffffffff, 0xffffffff, 0xffffffff, 0xffffffff, 0xffffffff, 0xffffffff, 0xffffffff, 0xffffffff, 0xffffffff, 0xffffffff
.long 0xa, 0x10010, 0x2, 0x64, 0x68, 0xffffffff, 0xffffffff, 0xffffffff, 0xffffffff, 0xffffffff, 0xffffffff, 0xffffffff, 0xffffffff, 0xffffffff, 0xffffffff, 0xffffffff, 0xffffffff, 0xffffffff, 0xffffffff, 0xffffffff, 0xffffffff, 0xffffffff, 0xffffffff, 0xffffffff, 0xffffffff, 0xffffffff, 0xffffffff, 0xffffffff, 0xffffffff, 0xffffffff, 0xffffffff, 0xffffffff
.long 0x1a, 0x10410, 0x402, 0x464, 0x468, 0xffffffff, 0xffffffff, 0xffffffff, 0xffffffff, 0xffffffff, 0xffffffff, 0xffffffff, 0xffffffff, 0xffffffff, 0xffffffff, 0xffffffff, 0xffffffff, 0xffffffff, 0xffffffff, 0xffffffff, 0xffffffff, 0xffffffff, 0xffffffff, 0xffffffff, 0xffffffff, 0xffffffff, 0xffffffff, 0xffffffff, 0xffffffff, 0xffffffff, 0xffffffff, 0xffffffff
.long 0x2a, 0x10810, 0x802, 0x864, 0x868, 0xffffffff, 0xffffffff, 0xffffffff, 0xffffffff, 0xffffffff, 0xffffffff, 0xffffffff, 0xffffffff, 0xffffffff, 0xffffffff, 0xffffffff, 0xffffffff, 0xffffffff, 0xffffffff, 0xffffffff, 0xffffffff, 0xffffffff, 0xffffffff, 0xffffffff, 0xffffffff, 0xffffffff, 0xffffffff, 0xffffffff, 0xffffffff, 0xffffffff, 0xffffffff, 0xffffffff
.long 0x3a, 0x10c10, 0xc02, 0xc64, 0xc68, 0xffffffff, 0xffffffff, 0xffffffff, 0xffffffff, 0xffffffff, 0xffffffff, 0xffffffff, 0xffffffff, 0xffffffff, 0xffffffff, 0xffffffff, 0xffffffff, 0xffffffff, 0xffffffff, 0xffffffff, 0xffffffff, 0xffffffff, 0xffffffff, 0xffffffff, 0xffffffff, 0xffffffff, 0xffffffff, 0xffffffff, 0xffffffff, 0xffffffff, 0xffffffff, 0xffffffff
.long 0x4a, 0x11010, 0x1002, 0x1064, 0x74, 0x78, 0xffffffff, 0xffffffff, 0xffffffff, 0xffffffff, 0xffffffff, 0xffffffff, 0xffffffff, 0xffffffff, 0xffffffff, 0xffffffff, 0xffffffff, 0xffffffff, 0xffffffff, 0xffffffff, 0xffffffff, 0xffffffff, 0xffffffff, 0xffffffff, 0xffffffff, 0xffffffff, 0xffffffff, 0xffffffff, 0xffffffff, 0xffffffff, 0xffffffff, 0xffffffff
.long 0x5a, 0x11410, 0x1402, 0x1464, 0x474, 0x478, 0xffffffff, 0xffffffff, 0xffffffff, 0xffffffff, 0xffffffff, 0xffffffff, 0xffffffff, 0xffffffff, 0xffffffff, 0xffffffff, 0xffffffff, 0xffffffff, 0xffffffff, 0xffffffff, 0xffffffff, 0xffffffff, 0xffffffff, 0xffffffff, 0xffffffff, 0xffffffff, 0xffffffff, 0xffffffff, 0xffffffff, 0xffffffff, 0xffffffff, 0xffffffff
.long 0x6a, 0x11810, 0x1802, 0x1864, 0x874, 0x878, 0xffffffff, 0xffffffff, 0xffffffff, 0xffffffff, 0xffffffff, 0xffffffff, 0xffffffff, 0xffffffff, 0xffffffff, 0xffffffff, 0xffffffff, 0xffffffff, 0xffffffff, 0xffffffff, 0xffffffff, 0xffffffff, 0xffffffff, 0xffffffff, 0xffffffff, 0xffffffff, 0xffffffff, 0xffffffff, 0xffffffff, 0xffffffff, 0xffffffff, 0xffffffff
.long 0x7a, 0x11c10, 0x1c02, 0x1c64, 0xc74, 0xc78, 0xffffffff, 0xffffffff, 0xffffffff, 0xffffffff, 0xffffffff, 0xffffffff, 0xffffffff, 0xffffffff, 0xffffffff, 0xffffffff, 0xffffffff, 0xffffffff, 0xffffffff, 0xffffffff, 0xffffffff, 0xffffffff, 0xffffffff, 0xffffffff, 0xffffffff, 0xffffffff, 0xffffffff, 0xffffffff, 0xffffffff, 0xffffffff, 0xffffffff, 0xffffffff
.long 0x8a, 0x12010, 0x2002, 0x22051, 0x88, 0xffffffff, 0xffffffff, 0xffffffff, 0xffffffff, 0xffffffff, 0xffffffff, 0xffffffff, 0xffffffff, 0xffffffff, 0xffffffff, 0xffffffff, 0xffffffff, 0xffffffff, 0xffffffff, 0xffffffff, 0xffffffff, 0xffffffff, 0xffffffff, 0xffffffff, 0xffffffff, 0xffffffff, 0xffffffff, 0xffffffff, 0xffffffff, 0xffffffff, 0xffffffff, 0xffffffff
.long 0x9a, 0x12410, 0x2402, 0x22451, 0x488, 0xffffffff, 0xffffffff, 0xffffffff, 0xffffffff, 0xffffffff, 0xffffffff, 0xffffffff, 0xffffffff, 0xffffffff, 0xffffffff, 0xffffffff, 0xffffffff, 0xffffffff, 0xffffffff, 0xffffffff, 0xffffffff, 0xffffffff, 0xffffffff, 0xffffffff, 0xffffffff, 0xffffffff, 0xffffffff, 0xffffffff, 0xffffffff, 0xffffffff, 0xffffffff, 0xffffffff
.long 0xaa, 0x12810, 0x2802, 0x23051, 0x888, 0xffffffff, 0xffffffff, 0xffffffff, 0xffffffff, 0xffffffff, 0xffffffff, 0xffffffff, 0xffffffff, 0xffffffff, 0xffffffff, 0xffffffff, 0xffffffff, 0xffffffff, 0xffffffff, 0xffffffff, 0xffffffff, 0xffffffff, 0xffffffff, 0xffffffff, 0xffffffff, 0xffffffff, 0xffffffff, 0xffffffff, 0xffffffff, 0xffffffff, 0xffffffff, 0xffffffff
.long 0xba, 0x12c10, 0x2c02, 0x23451, 0xc88, 0xffffffff, 0xffffffff, 0xffffffff, 0xffffffff, 0xffffffff, 0xffffffff, 0xffffffff, 0xffffffff, 0xffffffff, 0xffffffff, 0xffffffff, 0xffffffff, 0xffffffff, 0xffffffff, 0xffffffff, 0xffffffff, 0xffffffff, 0xffffffff, 0xffffffff, 0xffffffff, 0xffffffff, 0xffffffff, 0xffffffff, 0xffffffff, 0xffffffff, 0xffffffff, 0xffffffff
.long 0xca, 0x13010, 0x3002, 0x51, 0x84, 0x94, 0x98, 0xffffffff, 0xffffffff, 0xffffffff, 0xffffffff, 0xffffffff, 0xffffffff, 0xffffffff, 0xffffffff, 0xffffffff, 0xffffffff, 0xffffffff, 0xffffffff, 0xffffffff, 0xffffffff, 0xffffffff, 0xffffffff, 0xffffffff, 0xffffffff, 0xffffffff, 0xffffffff, 0xffffffff, 0xffffffff, 0xffffffff, 0xffffffff, 0xffffffff
.long 0xda, 0x13410, 0x3402, 0x451, 0x484, 0x494, 0x498, 0xffffffff, 0xffffffff, 0xffffffff, 0xffffffff, 0xffffffff, 0xffffffff, 0xffffffff, 0xffffffff, 0xffffffff, 0xffffffff, 0xffffffff, 0xffffffff, 0xffffffff, 0xffffffff, 0xffffffff, 0xffffffff, 0xffffffff, 0xffffffff, 0xffffffff, 0xffffffff, 0xffffffff, 0xffffffff, 0xffffffff, 0xffffffff, 0xffffffff
.long 0xea, 0x13810, 0x812, 0x851, 0x884, 0x894, 0x898, 0xffffffff, 0xffffffff, 0xffffffff, 0xffffffff, 0xffffffff, 0xffffffff, 0xffffffff, 0xffffffff, 0xffffffff, 0xffffffff, 0xffffffff, 0xffffffff, 0xffffffff, 0xffffffff, 0xffffffff, 0xffffffff, 0xffffffff, 0xffffffff, 0xffffffff, 0xffffffff, 0xffffffff, 0xffffffff, 0xffffffff, 0xffffffff, 0xffffffff
.long 0xfa, 0x13c10, 0xc12, 0xc51, 0xc84, 0xc94, 0xc98, 0xffffffff, 0xffffffff, 0xffffffff, 0xffffffff, 0xffffffff, 0xffffffff, 0xffffffff, 0xffffffff, 0xffffffff, 0xffffffff, 0xffffffff, 0xffffffff, 0xffffffff, 0xffffffff, 0xffffffff, 0xffffffff, 0xffffffff, 0xffffffff, 0xffffffff, 0xffffffff, 0xffffffff, 0xffffffff, 0xffffffff, 0xffffffff, 0xffffffff
.long 0x10a, 0x20010, 0x12, 0x1051, 0x1084, 0x1094, 0xa8, 0xffffffff, 0xffffffff, 0xffffffff, 0xffffffff, 0xffffffff, 0xffffffff, 0xffffffff, 0xffffffff, 0xffffffff, 0xffffffff, 0xffffffff, 0xffffffff, 0xffffffff, 0xffffffff, 0xffffffff, 0xffffffff, 0xffffffff, 0xffffffff, 0xffffffff, 0xffffffff, 0xffffffff, 0xffffffff, 0xffffffff, 0xffffffff, 0xffffffff
.long 0x11a, 0x20410, 0x412, 0x1451, 0x1484, 0x1494, 0x4a8, 0xffffffff, 0xffffffff, 0xffffffff, 0xffffffff, 0xffffffff, 0xffffffff, 0xffffffff, 0xffffffff, 0xffffffff, 0xffffffff, 0xffffffff, 0xffffffff, 0xffffffff, 0xffffffff, 0xffffffff, 0xffffffff, 0xffffffff, 0xffffffff, 0xffffffff, 0xffffffff, 0xffffffff, 0xffffffff, 0xffffffff, 0xffffffff, 0xffffffff
.long 0x12a, 0x20810, 0x1812, 0x1851, 0x1884, 0x1894, 0x8a8, 0xffffffff, 0xffffffff, 0xffffffff, 0xffffffff, 0xffffffff, 0xffffffff, 0xffffffff, 0xffffffff, 0xffffffff, 0xffffffff, 0xffffffff, 0xffffffff, 0xffffffff, 0xffffffff, 0xffffffff, 0xffffffff, 0xffffffff, 0xffffffff, 0xffffffff, 0xffffffff, 0xffffffff, 0xffffffff, 0xffffffff, 0xffffffff, 0xffffffff
.long 0x13a, 0x20c10, 0x1c12, 0x1c51, 0x1c84, 0x1c94, 0xca8, 0xffffffff, 0xffffffff, 0xffffffff, 0xffffffff, 0xffffffff, 0xffffffff, 0xffffffff, 0xffffffff, 0xffffffff, 0xffffffff, 0xffffffff, 0xffffffff, 0xffffffff, 0xffffffff, 0xffffffff, 0xffffffff, 0xffffffff, 0xffffffff, 0xffffffff, 0xffffffff, 0xffffffff, 0xffffffff, 0xffffffff, 0xffffffff, 0xffffffff
.long 0x14a, 0x21010, 0x1012, 0x2051, 0x11071, 0xb8, 0xffffffff, 0xffffffff, 0xffffffff, 0xffffffff, 0xffffffff, 0xffffffff, 0xffffffff, 0xffffffff, 0xffffffff, 0xffffffff, 0xffffffff, 0xffffffff, 0xffffffff, 0xffffffff, 0xffffffff, 0xffffffff, 0xffffffff, 0xffffffff, 0xffffffff, 0xffffffff, 0xffffffff, 0xffffffff, 0xffffffff, 0xffffffff, 0xffffffff, 0xffffffff
.long 0x15a, 0x21410, 0x1412, 0x2451, 0x11471, 0x4b8, 0xffffffff, 0xffffffff, 0xffffffff, 0xffffffff, 0xffffffff, 0xffffffff, 0xffffffff, 0xffffffff, 0xffffffff, 0xffffffff, 0xffffffff, 0xffffffff, 0xffffffff, 0xffffffff, 0xffffffff, 0xffffffff, 0xffffffff, 0xffffffff, 0xffffffff, 0xffffffff, 0xffffffff, 0xffffffff, 0xffffffff, 0xffffffff, 0xffffffff, 0xffffffff
.long 0x16a, 0x21810, 0x2812, 0x2851, 0x11871, 0x8b8, 0xffffffff, 0xffffffff, 0xffffffff, 0xffffffff, 0xffffffff, 0xffffffff, 0xffffffff, 0xffffffff, 0xffffffff, 0xffffffff, 0xffffffff, 0xffffffff, 0xffffffff, 0xffffffff, 0xffffffff, 0xffffffff, 0xffffffff, 0xffffffff, 0xffffffff, 0xffffffff, 0xffffffff, 0xffffffff, 0xffffffff, 0xffffffff, 0xffffffff, 0xffffffff
.long 0x17a, 0x21c10, 0x2c12, 0x2c51, 0x11c71, 0xcb8, 0xffffffff, 0xffffffff, 0xffffffff, 0xffffffff, 0xffffffff, 0xffffffff, 0xffffffff, 0xffffffff, 0xffffffff, 0xffffffff, 0xffffffff, 0xffffffff, 0xffffffff, 0xffffffff, 0xffffffff, 0xffffffff, 0xffffffff, 0xffffffff, 0xffffffff, 0xffffffff, 0xffffffff, 0xffffffff, 0xffffffff, 0xffffffff, 0xffffffff, 0xffffffff
.long 0x18a, 0x22010, 0x2012, 0x3051, 0x12071, 0xb4, 0xffffffff, 0xffffffff, 0xffffffff, 0xffffffff, 0xffffffff, 0xffffffff, 0xffffffff, 0xffffffff, 0xffffffff, 0xffffffff, 0xffffffff, 0xffffffff, 0xffffffff, 0xffffffff, 0xffffffff, 0xffffffff, 0xffffffff, 0xffffffff, 0xffffffff, 0xffffffff, 0xffffffff, 0xffffffff, 0xffffffff, 0xffffffff, 0xffffffff, 0xffffffff
.long 0x19a, 0x22410, 0x2412, 0x3451, 0x12471, 0x4b4, 0xffffffff, 0xffffffff, 0xffffffff, 0xffffffff, 0xffffffff, 0xffffffff, 0xffffffff, 0xffffffff, 0xffffffff, 0xffffffff, 0xffffffff, 0xffffffff, 0xffffffff, 0xffffffff, 0xffffffff, 0xffffffff, 0xffffffff, 0xffffffff, 0xffffffff, 0xffffffff, 0xffffffff, 0xffffffff, 0xffffffff, 0xffffffff, 0xffffffff, 0xffffffff
.long 0x1aa, 0x22810, 0x822, 0x3851, 0x12871, 0x8b4, 0xffffffff, 0xffffffff, 0xffffffff, 0xffffffff, 0xffffffff, 0xffffffff, 0xffffffff, 0xffffffff, 0xffffffff, 0xffffffff, 0xffffffff, 0xffffffff, 0xffffffff, 0xffffffff, 0xffffffff, 0xffffffff, 0xffffffff, 0xffffffff, 0xffffffff, 0xffffffff, 0xffffffff, 0xffffffff, 0xffffffff, 0xffffffff, 0xffffffff, 0xffffffff
.long 0x1ba, 0x22c10, 0xc22, 0x3c51, 0x12c71, 0xcb4, 0xffffffff, 0xffffffff, 0xffffffff, 0xffffffff, 0xffffffff, 0xffffffff, 0xffffffff, 0xffffffff, 0xffffffff, 0xffffffff, 0xffffffff, 0xffffffff, 0xffffffff, 0xffffffff, 0xffffffff, 0xffffffff, 0xffffffff, 0xffffffff, 0xffffffff, 0xffffffff, 0xffffffff, 0xffffffff, 0xffffffff, 0xffffffff, 0xffffffff, 0xffffffff
.long 0x1ca, 0x23010, 0x3012, 0x10061, 0x13071, 0x10b4, 0xffffffff, 0xffffffff, 0xffffffff, 0xffffffff, 0xffffffff, 0xffffffff, 0xffffffff, 0xffffffff, 0xffffffff, 0xffffffff, 0xffffffff, 0xffffffff, 0xffffffff, 0xffffffff, 0xffffffff, 0xffffffff, 0xffffffff, 0xffffffff, 0xffffffff, 0xffffffff, 0xffffffff, 0xffffffff, 0xffffffff, 0xffffffff, 0xffffffff, 0xffffffff
.long 0x1da, 0x23410, 0x3412, 0x10461, 0x13471, 0x14b4, 0xffffffff, 0xffffffff, 0xffffffff, 0xffffffff, 0xffffffff, 0xffffffff, 0xffffffff, 0xffffffff, 0xffffffff, 0xffffffff, 0xffffffff, 0xffffffff, 0xffffffff, 0xffffffff, 0xffffffff, 0xffffffff, 0xffffffff, 0xffffffff, 0xffffffff, 0xffffffff, 0xffffffff, 0xffffffff, 0xffffffff, 0xffffffff, 0xffffffff, 0xffffffff
.long 0x1ea, 0x23810, 0x1822, 0x10861, 0x13871, 0x18b4, 0xffffffff, 0xffffffff, 0xffffffff, 0xffffffff, 0xffffffff, 0xffffffff, 0xffffffff, 0xffffffff, 0xffffffff, 0xffffffff, 0xffffffff, 0xffffffff, 0xffffffff, 0xffffffff, 0xffffffff, 0xffffffff, 0xffffffff, 0xffffffff, 0xffffffff, 0xffffffff, 0xffffffff, 0xffffffff, 0xffffffff, 0xffffffff, 0xffffffff, 0xffffffff
.long 0x1fa, 0x23c10, 0x1c22, 0x10c61, 0x13c71, 0x1cb4, 0xffffffff, 0xffffffff, 0xffffffff, 0xffffffff, 0xffffffff, 0xffffffff, 0xffffffff, 0xffffffff, 0xffffffff, 0xffffffff, 0xffffffff, 0xffffffff, 0xffffffff, 0xffffffff, 0xffffffff, 0xffffffff, 0xffffffff, 0xffffffff, 0xffffffff, 0xffffffff, 0xffffffff, 0xffffffff, 0xffffffff, 0xffffffff, 0xffffffff, 0xffffffff
.long 0x20a, 0x10011, 0x22, 0x11061, 0x20071, 0xc6, 0xd6, 0xe6, 0xf6, 0xffffffff, 0xffffffff, 0xffffffff, 0xffffffff, 0xffffffff, 0xffffffff, 0xffffffff, 0xffffffff, 0xffffffff, 0xffffffff, 0xffffffff, 0xffffffff, 0xffffffff, 0xffffffff, 0xffffffff, 0xffffffff, 0xffffffff, 0xffffffff, 0xffffffff, 0xffffffff, 0xffffffff, 0xffffffff, 0xffffffff
.long 0x21a, 0x10411, 0x422, 0x11461, 0x20471, 0x4c6, 0x4d6, 0x4e6, 0x4f6, 0xffffffff, 0xffffffff, 0xffffffff, 0xffffffff, 0xffffffff, 0xffffffff, 0xffffffff, 0xffffffff, 0xffffffff, 0xffffffff, 0xffffffff, 0xffffffff, 0xffffffff, 0xffffffff, 0xffffffff, 0xffffffff, 0xffffffff, 0xffffffff, 0xffffffff, 0xffffffff, 0xffffffff, 0xffffffff, 0xffffffff
.long 0x22a, 0x10811, 0x2822, 0x11861, 0x20871, 0x8c6, 0x8d6, 0x8e6, 0x8f6, 0xffffffff, 0xffffffff, 0xffffffff, 0xffffffff, 0xffffffff, 0xffffffff, 0xffffffff, 0xffffffff, 0xffffffff, 0xffffffff, 0xffffffff, 0xffffffff, 0xffffffff, 0xffffffff, 0xffffffff, 0xffffffff, 0xffffffff, 0xffffffff, 0xffffffff, 0xffffffff, 0xffffffff, 0xffffffff, 0xffffffff
.long 0x23a, 0x10c11, 0x2c22, 0x11c61, 0x20c71, 0xcc6, 0xcd6, 0xce6, 0xcf6, 0xffffffff, 0xffffffff, 0xffffffff, 0xffffffff, 0xffffffff, 0xffffffff, 0xffffffff, 0xffffffff, 0xffffffff, 0xffffffff, 0xffffffff, 0xffffffff, 0xffffffff, 0xffffffff, 0xffffffff, 0xffffffff, 0xffffffff, 0xffffffff, 0xffffffff, 0xffffffff, 0xffffffff, 0xffffffff, 0xffffffff
.long 0x24a, 0x11011, 0x1022, 0x12061, 0x21071, 0x10c6, 0x10d6, 0x10e6, 0x10f6, 0xffffffff, 0xffffffff, 0xffffffff, 0xffffffff, 0xffffffff, 0xffffffff, 0xffffffff, 0xffffffff, 0xffffffff, 0xffffffff, 0xffffffff, 0xffffffff, 0xffffffff, 0xffffffff, 0xffffffff, 0xffffffff, 0xffffffff, 0xffffffff, 0xffffffff, 0xffffffff, 0xffffffff, 0xffffffff, 0xffffffff
.long 0x25a, 0x11411, 0x1422, 0x12461, 0x21471, 0x14c6, 0x14d6, 0x14e6, 0x14f6, 0xffffffff, 0xffffffff, 0xffffffff, 0xffffffff, 0xffffffff, 0xffffffff, 0xffffffff, 0xffffffff, 0xffffffff, 0xffffffff, 0xffffffff, 0xffffffff, 0xffffffff, 0xffffffff, 0xffffffff, 0xffffffff, 0xffffffff, 0xffffffff, 0xffffffff, 0xffffffff, 0xffffffff, 0xffffffff, 0xffffffff
.long 0x26a, 0x11811, 0x832, 0x12861, 0x21871, 0x18c6, 0x18d6, 0x18e6, 0x18f6, 0xffffffff, 0xffffffff, 0xffffffff, 0xffffffff, 0xffffffff, 0xffffffff, 0xffffffff, 0xffffffff, 0xffffffff, 0xffffffff, 0xffffffff, 0xffffffff, 0xffffffff, 0xffffffff, 0xffffffff, 0xffffffff, 0xffffffff, 0xffffffff, 0xffffffff, 0xffffffff, 0xffffffff, 0xffffffff, 0xffffffff
.long 0x27a, 0x11c11, 0xc32, 0x12c61, 0x21c71, 0x1cc6, 0x1cd6, 0x1ce6, 0x1cf6, 0xffffffff, 0xffffffff, 0xffffffff, 0xffffffff, 0xffffffff, 0xffffffff, 0xffffffff, 0xffffffff, 0xffffffff, 0xffffffff, 0xffffffff, 0xffffffff, 0xffffffff, 0xffffffff, 0xffffffff, 0xffffffff, 0xffffffff, 0xffffffff, 0xffffffff, 0xffffffff, 0xffffffff, 0xffffffff, 0xffffffff
.long 0x28a, 0x12011, 0x2022, 0x13061, 0x22071, 0x100c6, 0x100d6, 0x100e6, 0x100f6, 0xffffffff, 0xffffffff, 0xffffffff, 0xffffffff, 0xffffffff, 0xffffffff, 0xffffffff, 0xffffffff, 0xffffffff, 0xffffffff, 0xffffffff, 0xffffffff, 0xffffffff, 0xffffffff, 0xffffffff, 0xffffffff, 0xffffffff, 0xffffffff, 0xffffffff, 0xffffffff, 0xffffffff, 0xffffffff, 0xffffffff
.long 0x29a, 0x12411, 0x2422, 0x13461, 0x22471, 0x104c6, 0x104d6, 0x104e6, 0x104f6, 0xffffffff, 0xffffffff, 0xffffffff, 0xffffffff, 0xffffffff, 0xffffffff, 0xffffffff, 0xffffffff, 0xffffffff, 0xffffffff, 0xffffffff, 0xffffffff, 0xffffffff, 0xffffffff, 0xffffffff, 0xffffffff, 0xffffffff, 0xffffffff, 0xffffffff, 0xffffffff, 0xffffffff, 0xffffffff, 0xffffffff
.long 0x2aa, 0x12811, 0x1832, 0x13861, 0x22871, 0x108c6, 0x108d6, 0x108e6, 0x108f6, 0xffffffff, 0xffffffff, 0xffffffff, 0xffffffff, 0xffffffff, 0xffffffff, 0xffffffff, 0xffffffff, 0xffffffff, 0xffffffff, 0xffffffff, 0xffffffff, 0xffffffff, 0xffffffff, 0xffffffff, 0xffffffff, 0xffffffff, 0xffffffff, 0xffffffff, 0xffffffff, 0xffffffff, 0xffffffff, 0xffffffff
.long 0x2ba, 0x12c11, 0x1c32, 0x13c61, 0x22c71, 0x10cc6, 0x10cd6, 0x10ce6, 0x10cf6, 0xffffffff, 0xffffffff, 0xffffffff, 0xffffffff, 0xffffffff, 0xffffffff, 0xffffffff, 0xffffffff, 0xffffffff, 0xffffffff, 0xffffffff, 0xffffffff, 0xffffffff, 0xffffffff, 0xffffffff, 0xffffffff, 0xffffffff, 0xffffffff, 0xffffffff, 0xffffffff, 0xffffffff, 0xffffffff, 0xffffffff
.long 0x2ca, 0x13011, 0x3022, 0x20061, 0x23071, 0x110c6, 0x110d6, 0x110e6, 0x110f6, 0xffffffff, 0xffffffff, 0xffffffff, 0xffffffff, 0xffffffff, 0xffffffff, 0xffffffff, 0xffffffff, 0xffffffff, 0xffffffff, 0xffffffff, 0xffffffff, 0xffffffff, 0xffffffff, 0xffffffff, 0xffffffff, 0xffffffff, 0xffffffff, 0xffffffff, 0xffffffff, 0xffffffff, 0xffffffff, 0xffffffff
.long 0x2da, 0x13411, 0x3422, 0x20461, 0x23471, 0x114c6, 0x114d6, 0x114e6, 0x114f6, 0xffffffff, 0xffffffff, 0xffffffff, 0xffffffff, 0xffffffff, 0xffffffff, 0xffffffff, 0xffffffff, 0xffffffff, 0xffffffff, 0xffffffff, 0xffffffff, 0xffffffff, 0xffffffff, 0xffffffff, 0xffffffff, 0xffffffff, 0xffffffff, 0xffffffff, 0xffffffff, 0xffffffff, 0xffffffff, 0xffffffff
.long 0x2ea, 0x13811, 0x2832, 0x20861, 0x23871, 0x118c6, 0x118d6, 0x118e6, 0x118f6, 0xffffffff, 0xffffffff, 0xffffffff, 0xffffffff, 0xffffffff, 0xffffffff, 0xffffffff, 0xffffffff, 0xffffffff, 0xffffffff, 0xffffffff, 0xffffffff, 0xffffffff, 0xffffffff, 0xffffffff, 0xffffffff, 0xffffffff, 0xffffffff, 0xffffffff, 0xffffffff, 0xffffffff, 0xffffffff, 0xffffffff
.long 0x2fa, 0x13c11, 0x2c32, 0x20c61, 0x23c71, 0x11cc6, 0x11cd6, 0x11ce6, 0x11cf6, 0xffffffff, 0xffffffff, 0xffffffff, 0xffffffff, 0xffffffff, 0xffffffff, 0xffffffff, 0xffffffff, 0xffffffff, 0xffffffff, 0xffffffff, 0xffffffff, 0xffffffff, 0xffffffff, 0xffffffff, 0xffffffff, 0xffffffff, 0xffffffff, 0xffffffff, 0xffffffff, 0xffffffff, 0xffffffff, 0xffffffff
.long 0x30a, 0x20011, 0x32, 0x21061, 0x71, 0x200c6, 0x200d6, 0x200e6, 0x200f6, 0xffffffff, 0xffffffff, 0xffffffff, 0xffffffff, 0xffffffff, 0xffffffff, 0xffffffff, 0xffffffff, 0xffffffff, 0xffffffff, 0xffffffff, 0xffffffff, 0xffffffff, 0xffffffff, 0xffffffff, 0xffffffff, 0xffffffff, 0xffffffff, 0xffffffff, 0xffffffff, 0xffffffff, 0xffffffff, 0xffffffff
.long 0x31a, 0x20411, 0x432, 0x21461, 0x471, 0x204c6, 0x204d6, 0x204e6, 0x204f6, 0xffffffff, 0xffffffff, 0xffffffff, 0xffffffff, 0xffffffff, 0xffffffff, 0xffffffff, 0xffffffff, 0xffffffff, 0xffffffff, 0xffffffff, 0xffffffff, 0xffffffff, 0xffffffff, 0xffffffff, 0xffffffff, 0xffffffff, 0xffffffff, 0xffffffff, 0xffffffff, 0xffffffff, 0xffffffff, 0xffffffff
.long 0x32a, 0x20811, 0x801, 0x12841, 0x11851, 0x861, 0x208c6, 0x208d6, 0x208e6, 0x208f6, 0xffffffff, 0xffffffff, 0xffffffff, 0xffffffff, 0xffffffff, 0xffffffff, 0xffffffff, 0xffffffff, 0xffffffff, 0xffffffff, 0xffffffff, 0xffffffff, 0xffffffff, 0xffffffff, 0xffffffff, 0xffffffff, 0xffffffff, 0xffffffff, 0xffffffff, 0xffffffff, 0xffffffff, 0xffffffff
.long 0x33a, 0x20c11, 0xc01, 0x12c41, 0x11c51, 0xc61, 0x20cc6, 0x20cd6, 0x20ce6, 0x20cf6, 0xffffffff, 0xffffffff, 0xffffffff, 0xffffffff, 0xffffffff, 0xffffffff, 0xffffffff, 0xffffffff, 0xffffffff, 0xffffffff, 0xffffffff, 0xffffffff, 0xffffffff, 0xffffffff, 0xffffffff, 0xffffffff, 0xffffffff, 0xffffffff, 0xffffffff, 0xffffffff, 0xffffffff, 0xffffffff
.long 0x34a, 0x21011, 0x1032, 0x22061, 0x1071, 0x210c6, 0x210d6, 0x210e6, 0x210f6, 0xffffffff, 0xffffffff, 0xffffffff, 0xffffffff, 0xffffffff, 0xffffffff, 0xffffffff, 0xffffffff, 0xffffffff, 0xffffffff, 0xffffffff, 0xffffffff, 0xffffffff, 0xffffffff, 0xffffffff, 0xffffffff, 0xffffffff, 0xffffffff, 0xffffffff, 0xffffffff, 0xffffffff, 0xffffffff, 0xffffffff
.long 0x35a, 0x21411, 0x1432, 0x22461, 0x1471, 0x214c6, 0x214d6, 0x214e6, 0x214f6, 0xffffffff, 0xffffffff, 0xffffffff, 0xffffffff, 0xffffffff, 0xffffffff, 0xffffffff, 0xffffffff, 0xffffffff, 0xffffffff, 0xffffffff, 0xffffffff, 0xffffffff, 0xffffffff, 0xffffffff, 0xffffffff, 0xffffffff, 0xffffffff, 0xffffffff, 0xffffffff, 0xffffffff, 0xffffffff, 0xffffffff
.long 0x36a, 0x21811, 0x1801, 0x13841, 0x12851, 0x1861, 0x218c6, 0x218d6, 0x218e6, 0x218f6, 0xffffffff, 0xffffffff, 0xffffffff, 0xffffffff, 0xffffffff, 0xffffffff, 0xffffffff, 0xffffffff, 0xffffffff, 0xffffffff, 0xffffffff, 0xffffffff, 0xffffffff, 0xffffffff, 0xffffffff, 0xffffffff, 0xffffffff, 0xffffffff, 0xffffffff, 0xffffffff, 0xffffffff, 0xffffffff
.long 0x37a, 0x21c11, 0x1c01, 0x13c41, 0x12c51, 0x1c61, 0x21cc6, 0x21cd6, 0x21ce6, 0x21cf6, 0xffffffff, 0xffffffff, 0xffffffff, 0xffffffff, 0xffffffff, 0xffffffff, 0xffffffff, 0xffffffff, 0xffffffff, 0xffffffff, 0xffffffff, 0xffffffff, 0xffffffff, 0xffffffff, 0xffffffff, 0xffffffff, 0xffffffff, 0xffffffff, 0xffffffff, 0xffffffff, 0xffffffff, 0xffffffff
.long 0x38a, 0x22011, 0x2032, 0x23061, 0x2071, 0x300c6, 0x300d6, 0x300e6, 0x300f6, 0xffffffff, 0xffffffff, 0xffffffff, 0xffffffff, 0xffffffff, 0xffffffff, 0xffffffff, 0xffffffff, 0xffffffff, 0xffffffff, 0xffffffff, 0xffffffff, 0xffffffff, 0xffffffff, 0xffffffff, 0xffffffff, 0xffffffff, 0xffffffff, 0xffffffff, 0xffffffff, 0xffffffff, 0xffffffff, 0xffffffff
.long 0x39a, 0x22411, 0x2432, 0x23461, 0x2471, 0x304c6, 0x304d6, 0x304e6, 0x304f6, 0xffffffff, 0xffffffff, 0xffffffff, 0xffffffff, 0xffffffff, 0xffffffff, 0xffffffff, 0xffffffff, 0xffffffff, 0xffffffff, 0xffffffff, 0xffffffff, 0xffffffff, 0xffffffff, 0xffffffff, 0xffffffff, 0xffffffff, 0xffffffff, 0xffffffff, 0xffffffff, 0xffffffff, 0xffffffff, 0xffffffff
.long 0x3aa, 0x22811, 0x2801, 0x20841, 0x13851, 0x2861, 0x308c6, 0x308d6, 0x308e6, 0x308f6, 0xffffffff, 0xffffffff, 0xffffffff, 0xffffffff, 0xffffffff, 0xffffffff, 0xffffffff, 0xffffffff, 0xffffffff, 0xffffffff, 0xffffffff, 0xffffffff, 0xffffffff, 0xffffffff, 0xffffffff, 0xffffffff, 0xffffffff, 0xffffffff, 0xffffffff, 0xffffffff, 0xffffffff, 0xffffffff
.long 0x3ba, 0x22c11, 0x2c01, 0x20c41, 0x13c51, 0x2c61, 0x30cc6, 0x30cd6, 0x30ce6, 0x30cf6, 0xffffffff, 0xffffffff, 0xffffffff, 0xffffffff, 0xffffffff, 0xffffffff, 0xffffffff, 0xffffffff, 0xffffffff, 0xffffffff, 0xffffffff, 0xffffffff, 0xffffffff, 0xffffffff, 0xffffffff, 0xffffffff, 0xffffffff, 0xffffffff, 0xffffffff, 0xffffffff, 0xffffffff, 0xffffffff
.long 0x3ca, 0x23011, 0x3032, 0x21861, 0x3071, 0x310c6, 0x310d6, 0x310e6, 0x310f6, 0xffffffff, 0xffffffff, 0xffffffff, 0xffffffff, 0xffffffff, 0xffffffff, 0xffffffff, 0xffffffff, 0xffffffff, 0xffffffff, 0xffffffff, 0xffffffff, 0xffffffff, 0xffffffff, 0xffffffff, 0xffffffff, 0xffffffff, 0xffffffff, 0xffffffff, 0xffffffff, 0xffffffff, 0xffffffff, 0xffffffff
.long 0x3da, 0x23411, 0x3432, 0x21c61, 0x3471, 0x314c6, 0x314d6, 0x314e6, 0x314f6, 0xffffffff, 0xffffffff, 0xffffffff, 0xffffffff, 0xffffffff, 0xffffffff, 0xffffffff, 0xffffffff, 0xffffffff, 0xffffffff, 0xffffffff, 0xffffffff, 0xffffffff, 0xffffffff, 0xffffffff, 0xffffffff, 0xffffffff, 0xffffffff, 0xffffffff, 0xffffffff, 0xffffffff, 0xffffffff, 0xffffffff
.long 0x3ea, 0x23811, 0x3801, 0x21841, 0x20851, 0x3861, 0x318c6, 0x318d6, 0x318e6, 0x318f6, 0xffffffff, 0xffffffff, 0xffffffff, 0xffffffff, 0xffffffff, 0xffffffff, 0xffffffff, 0xffffffff, 0xffffffff, 0xffffffff, 0xffffffff, 0xffffffff, 0xffffffff, 0xffffffff, 0xffffffff, 0xffffffff, 0xffffffff, 0xffffffff, 0xffffffff, 0xffffffff, 0xffffffff, 0xffffffff
.long 0x3fa, 0x23c11, 0x3c01, 0x21c41, 0x20c51, 0x3c61, 0x31cc6, 0x31cd6, 0x31ce6, 0x31cf6, 0xffffffff, 0xffffffff, 0xffffffff, 0xffffffff, 0xffffffff, 0xffffffff, 0xffffffff, 0xffffffff, 0xffffffff, 0xffffffff, 0xffffffff, 0xffffffff, 0xffffffff, 0xffffffff, 0xffffffff, 0xffffffff, 0xffffffff, 0xffffffff, 0xffffffff, 0xffffffff, 0xffffffff, 0xffffffff
.size sched_table, 16384
.section .rodata,"a"
.p2align 6
.amdhsa_kernel recurrent_scan__memory_aug_recurrent_mem_tr__mixer_token_mlp__prompt_kernel
  .amdhsa_next_free_vgpr 512
  .amdhsa_next_free_sgpr 102
  .amdhsa_accum_offset 256
  .amdhsa_group_segment_fixed_size 0
  .amdhsa_kernarg_size 120
  .amdhsa_user_sgpr_count 2
  .amdhsa_user_sgpr_kernarg_segment_ptr 1
  .amdhsa_system_sgpr_workgroup_id_x 1
.end_amdhsa_kernel
```
